```python
import torch

def _softmax(x, axis=-1):
    return torch.softmax(x, dim=axis)
def _gelu(x):
    return torch.nn.functional.gelu(x, approximate="tanh")
def _silu(x):
    return torch.nn.functional.silu(x)
def _sigmoid(x):
    return torch.sigmoid(x)
def _layernorm(x, axis=-1, eps=1e-5):
    m = x.mean(dim=axis, keepdim=True)
    v = x.var(dim=axis, keepdim=True, unbiased=False)
    return (x - m) / torch.sqrt(v + eps)
def _scatter_add(tgt, idx, src, axis=0):
    return tgt.clone().index_add_(axis, idx, src)
def _segment_sum(src, seg, n):
    out = torch.zeros((n,) + src.shape[1:], dtype=src.dtype)
    return out.index_add_(0, seg, src)
def _pad(x, pw):
    flat = tuple(v for pair in reversed(pw) for v in pair)
    return torch.nn.functional.pad(x, flat)

kernel_name = 'sequential_preLN__sliding_block__dense_activation_gelu__prompt'

def setup_inputs():

    _w = (lambda a: (lambda t: t.to(torch.bfloat16) if t.is_floating_point() else t)(torch.as_tensor(a)))
    def _A_setup():
        B, S, D = 1, 2048, 1024
        return {
            "x": _w((lambda *s: torch.randn(*s, dtype=torch.bfloat16) * 0.05)(B, S, D)),
            "wqkv": _w((lambda *s: torch.randn(*s, dtype=torch.bfloat16) * 0.05)(D, 3 * D)),
            "wo": _w((lambda *s: torch.randn(*s, dtype=torch.bfloat16) * 0.05)(D, D)),
        }
    _A_in = _A_setup()

    def _B_setup():
        B, S, D, F = 1, 2048, 1024, 3584
        return {
            "x": _w((lambda *s: torch.randn(*s, dtype=torch.bfloat16) * 0.05)(B, S, D)),
            "w1": _w((lambda *s: torch.randn(*s, dtype=torch.bfloat16) * 3.2)(D, F) * (D ** -0.5)),
            "b1": _w((lambda *s: torch.randn(*s, dtype=torch.bfloat16) * 3.2)(F) * 0.01),
            "w2": _w((lambda *s: torch.randn(*s, dtype=torch.bfloat16) * 0.4)(F, D) * (F ** -0.5)),
            "b2": _w((lambda *s: torch.randn(*s, dtype=torch.bfloat16) * 0.4)(D) * 0.01),
        }
    _B_in = _B_setup()

    return {
        "A_x": _A_in["x"],
        "A_wqkv": _A_in["wqkv"],
        "A_wo": _A_in["wo"],
        "B_x": _B_in["x"],
        "B_w1": _B_in["w1"],
        "B_b1": _B_in["b1"],
        "B_w2": _B_in["w2"],
        "B_b2": _B_in["b2"],
    }

def reference(A_x, A_wqkv, A_wo, B_x, B_w1, B_b1, B_w2, B_b2):
    def _A_ref(x, wqkv, wo):
        B, S, D = x.shape
        H = 32; Dh = D // H; W = 256
        qkv = (lambda x, *d: x.permute(*d))((x @ wqkv).reshape(B, S, 3, H, Dh), 2, 0, 3, 1, 4)
        q, k, v = qkv[0], qkv[1], qkv[2]
        scores = torch.einsum("bhqd,bhkd->bhqk", q, k) * (Dh ** -0.5)
        idx = torch.arange(S)
        mask = (idx[:, None] - idx[None, :] >= 0) & (idx[:, None] - idx[None, :] < W)
        scores = torch.where(mask[None, None], scores, -1e9)
        p = _softmax(scores, axis=-1)
        o = torch.einsum("bhqk,bhkd->bhqd", p, v)
        return (lambda x, *d: x.permute(*d))(o, 0, 2, 1, 3).reshape(B, S, D) @ wo

    def _B_ref(x, w1, b1, w2, b2):
        h = torch.einsum("bsd,df->bsf", x, w1) + b1
        h = _gelu(h)
        return torch.einsum("bsf,fd->bsd", h, w2) + b2

    x = A_x
    h = x + _A_ref(_layernorm(x, axis=-1), A_wqkv, A_wo)
    h2 = h + _B_ref(_layernorm(h, axis=-1), B_w1, B_b1, B_w2, B_b2)
    return h2
```

```asm
; @launch grid=(256,1,1) block=(512,1,1) lds=163840
.amdgcn_target "amdgcn-amd-amdhsa--gfx950"
.text
.globl sequential_preLN__sliding_block__dense_activation_gelu__prompt_kernel
.p2align 8
.type sequential_preLN__sliding_block__dense_activation_gelu__prompt_kernel,@function
sequential_preLN__sliding_block__dense_activation_gelu__prompt_kernel:
    s_cmp_ge_u32 s2, 256
    s_cbranch_scc1 sequential_preLN__sliding_block__dense_activation_gelu__prompt_kernel_exit1
    s_load_dwordx2 s[4:5], s[0:1], 0
    s_load_dwordx2 s[8:9], s[0:1], 8
    v_lshrrev_b32 v3, 6, v0
    v_and_b32 v1, 63, v0
    v_readfirstlane_b32 s46, v3
    v_lshlrev_b32 v2, 4, v1
    s_and_b32 s53, s2, 1
    s_lshl_b32 s44, s53, 3
    s_bfe_u32 s53, s2, 0x30003
    s_add_u32 s44, s44, s53
    s_bfe_u32 s53, s2, 0x20001
    s_lshl_b32 s45, s53, 2
    s_lshr_b32 s53, s2, 6
    s_add_u32 s45, s45, s53
    s_lshl_b32 s49, s44, 4
    s_add_u32 s49, s49, s45
    s_and_b32 s47, s46, 3
    s_mov_b32 s6, 0x400000
    s_mov_b32 s7, 0x20000
    s_mov_b32 s10, 0x600000
    s_mov_b32 s11, 0x20000
    s_and_b32 s54, s44, 14
    s_and_b32 s55, s45, 14
    s_add_u32 s51, s54, s55
    s_and_b32 s51, s51, 15
    s_add_u32 s52, s44, s45
    s_and_b32 s52, s52, 1
    s_cmp_lt_u32 s46, 4
    s_cbranch_scc1 sequential_preLN__sliding_block__dense_activation_gelu__prompt_kernel_consumer2
    s_lshl_b32 s53, s44, 2
    s_add_u32 s53, s53, s47
    s_lshl_b32 s53, s53, 16
    v_lshrrev_b32 v3, 4, v1
    v_xor_b32 v3, v3, v1
    v_and_b32 v3, 7, v3
    v_lshlrev_b32 v3, 4, v3
    v_lshrrev_b32 v4, 3, v1
    v_lshl_add_u32 v3, v4, 11, v3
    v_add_u32 v18, s53, v3
    v_xor_b32 v19, 64, v18
    v_add_u32 v19, 15360, v19
    v_add_u32 v20, 30720, v18
    v_add_u32 v21, 30720, v19
    s_lshl_b32 s76, s51, 7
    s_mul_i32 s77, s51, 393216
    s_lshl_b32 s78, s47, 12
    s_lshl_b32 s79, s47, 11
    s_mul_i32 s53, s47, 98304
    s_lshl_b32 s54, s45, 7
    s_add_u32 s53, s53, s54
    v_bfe_u32 v3, v1, 4, 1
    v_lshlrev_b32 v3, 1, v3
    v_xor_b32 v3, v3, v1
    v_and_b32 v3, 7, v3
    v_lshlrev_b32 v3, 4, v3
    v_mul_u32_u24 v4, 6144, v4
    v_add3_u32 v22, v3, v4, s53
    v_xor_b32 v23, 64, v22
    v_add_u32 v23, 48128, v23
    v_add_u32 v24, 2048, v22
    v_add_u32 v25, 2048, v23
    v_add_u32 v26, 4096, v22
    v_add_u32 v27, 4096, v23
    s_waitcnt lgkmcnt(0)
    s_add_u32 m0, s78, 0x0
    s_nop 0
    buffer_load_dwordx4 v18, s[4:7], s76 offen lds
    buffer_load_dwordx4 v19, s[4:7], s76 offen offset:1024 lds
    buffer_load_dwordx4 v20, s[4:7], s76 offen offset:2048 lds
    buffer_load_dwordx4 v21, s[4:7], s76 offen offset:3072 lds
    s_add_u32 s76, s76, 128
    s_and_b32 s76, s76, 2047
    s_add_u32 m0, s79, 0x10000
    s_nop 0
    buffer_load_dwordx4 v22, s[8:11], s77 offen lds
    buffer_load_dwordx4 v23, s[8:11], s77 offen offset:1024 lds
    s_add_u32 m0, s79, 0x12000
    s_nop 0
    buffer_load_dwordx4 v24, s[8:11], s77 offen lds
    buffer_load_dwordx4 v25, s[8:11], s77 offen offset:1024 lds
    s_add_u32 m0, s79, 0x14000
    s_nop 0
    buffer_load_dwordx4 v26, s[8:11], s77 offen lds
    buffer_load_dwordx4 v27, s[8:11], s77 offen offset:1024 lds
    s_add_u32 s77, s77, 393216
    s_cmp_ge_u32 s77, 6291456
    s_cselect_b32 s77, 0, s77
    s_add_u32 m0, s78, 0x4000
    s_nop 0
    buffer_load_dwordx4 v18, s[4:7], s76 offen lds
    buffer_load_dwordx4 v19, s[4:7], s76 offen offset:1024 lds
    buffer_load_dwordx4 v20, s[4:7], s76 offen offset:2048 lds
    buffer_load_dwordx4 v21, s[4:7], s76 offen offset:3072 lds
    s_add_u32 s76, s76, 128
    s_and_b32 s76, s76, 2047
    s_add_u32 m0, s79, 0x16000
    s_nop 0
    buffer_load_dwordx4 v22, s[8:11], s77 offen lds
    buffer_load_dwordx4 v23, s[8:11], s77 offen offset:1024 lds
    s_add_u32 m0, s79, 0x18000
    s_nop 0
    buffer_load_dwordx4 v24, s[8:11], s77 offen lds
    buffer_load_dwordx4 v25, s[8:11], s77 offen offset:1024 lds
    s_add_u32 m0, s79, 0x1a000
    s_nop 0
    buffer_load_dwordx4 v26, s[8:11], s77 offen lds
    buffer_load_dwordx4 v27, s[8:11], s77 offen offset:1024 lds
    s_add_u32 s77, s77, 393216
    s_cmp_ge_u32 s77, 6291456
    s_cselect_b32 s77, 0, s77
    s_getpc_b64 s[72:73]
sequential_preLN__sliding_block__dense_activation_gelu__prompt_kernel_pc3:
    s_sub_u32 s72, s72, sequential_preLN__sliding_block__dense_activation_gelu__prompt_kernel_pc3-sequential_preLN__sliding_block__dense_activation_gelu__prompt_kernel
    s_subb_u32 s73, s73, 0
    s_mov_b32 s74, sequential_preLN__sliding_block__dense_activation_gelu__prompt_kernel_end-sequential_preLN__sliding_block__dense_activation_gelu__prompt_kernel
    s_mov_b32 s75, 0x20000
    s_lshr_b32 s68, s2, 3
    s_lshl_b32 s68, s68, 2
    s_add_u32 s68, s68, s47
    s_lshl_b32 s68, s68, 10
    v_and_b32 v5, 7, v1
    v_lshlrev_b32 v5, 7, v5
    buffer_load_dword v6, v5, s[72:75], s68 offen
    s_load_dwordx2 s[24:25], s[0:1], 80
    s_load_dwordx2 s[12:13], s[0:1], 16
    s_load_dwordx2 s[16:17], s[0:1], 32
    s_load_dwordx2 s[36:37], s[0:1], 40
    s_load_dwordx2 s[20:21], s[0:1], 48
    s_load_dwordx2 s[40:41], s[0:1], 56
    s_load_dwordx2 s[28:29], s[0:1], 64
    s_mov_b32 s26, 0x10000000
    s_mov_b32 s27, 0x20000
    s_mov_b32 s14, 0x200000
    s_mov_b32 s15, 0x20000
    s_mov_b32 s18, 0x700000
    s_mov_b32 s19, 0x20000
    s_mov_b32 s38, 0x1c00
    s_mov_b32 s39, 0x20000
    s_mov_b32 s22, 0x700000
    s_mov_b32 s23, 0x20000
    s_mov_b32 s42, 0x800
    s_mov_b32 s43, 0x20000
    s_mov_b32 s30, 0x400000
    s_mov_b32 s31, 0x20000
    s_mov_b32 s53, 0x29f0000
    s_waitcnt lgkmcnt(0)
    s_buffer_load_dword s50, s[24:27], s53
    v_bfe_u32 v3, v1, 1, 3
    v_lshrrev_b32 v4, 4, v1
    v_xor_b32 v3, v3, v4
    v_lshlrev_b32 v3, 4, v3
    v_and_b32 v4, 15, v1
    v_lshl_add_u32 v3, v4, 7, v3
    s_lshl_b32 s53, s47, 12
    v_add_u32 v28, s53, v3
    v_xor_b32 v29, 64, v28
    v_bfe_u32 v3, v1, 3, 2
    v_xor_b32 v3, s47, v3
    v_lshlrev_b32 v3, 5, v3
    v_and_b32 v4, 3, v1
    v_lshl_add_u32 v3, v4, 3, v3
    v_bfe_u32 v4, v1, 2, 2
    v_lshl_add_u32 v3, v4, 7, v3
    v_lshrrev_b32 v4, 4, v1
    v_lshl_add_u32 v30, v4, 10, v3
    v_add_u32 v30, 65536, v30
    s_and_b32 s53, s52, 3
    s_lshl_b32 s54, s53, 14
    s_mul_i32 s53, s53, 24576
    v_add_u32 v28, s54, v28
    v_add_u32 v29, s54, v29
    v_add_u32 v30, s53, v30
    s_waitcnt lgkmcnt(0)
    s_add_u32 s50, s50, 1
    s_branch sequential_preLN__sliding_block__dense_activation_gelu__prompt_kernel_partx5
sequential_preLN__sliding_block__dense_activation_gelu__prompt_kernel_part4:
    ds_read_b128 v[32:35], v28 offset:0
    ds_read_b128 v[36:39], v29 offset:0
    ds_read_b128 v[40:43], v28 offset:2048
    ds_read_b128 v[44:47], v29 offset:2048
    ds_read_b64_tr_b16 v[76:77], v30 offset:0
    ds_read_b64_tr_b16 v[78:79], v30 offset:512
    ds_read_b64_tr_b16 v[80:81], v30 offset:4096
    ds_read_b64_tr_b16 v[82:83], v30 offset:4608
    ds_read_b64_tr_b16 v[84:85], v30 offset:8192
    ds_read_b64_tr_b16 v[86:87], v30 offset:8704
    ds_read_b64_tr_b16 v[88:89], v30 offset:12288
    ds_read_b64_tr_b16 v[90:91], v30 offset:12800
    ds_read_b64_tr_b16 v[92:93], v30 offset:16384
    ds_read_b64_tr_b16 v[94:95], v30 offset:16896
    ds_read_b64_tr_b16 v[96:97], v30 offset:20480
    ds_read_b64_tr_b16 v[98:99], v30 offset:20992
    s_waitcnt lgkmcnt(0)
    s_setpc_b64 s[80:81]
sequential_preLN__sliding_block__dense_activation_gelu__prompt_kernel_partx5:
    s_waitcnt vmcnt(11)
    s_barrier
    s_add_u32 m0, s78, 0x8000
    s_nop 0
    buffer_load_dwordx4 v18, s[4:7], s76 offen lds
    buffer_load_dwordx4 v19, s[4:7], s76 offen offset:1024 lds
    buffer_load_dwordx4 v20, s[4:7], s76 offen offset:2048 lds
    buffer_load_dwordx4 v21, s[4:7], s76 offen offset:3072 lds
    s_add_u32 s76, s76, 128
    s_and_b32 s76, s76, 2047
    s_add_u32 m0, s79, 0x1c000
    s_nop 0
    buffer_load_dwordx4 v22, s[8:11], s77 offen lds
    buffer_load_dwordx4 v23, s[8:11], s77 offen offset:1024 lds
    s_add_u32 m0, s79, 0x1e000
    s_nop 0
    buffer_load_dwordx4 v24, s[8:11], s77 offen lds
    buffer_load_dwordx4 v25, s[8:11], s77 offen offset:1024 lds
    s_add_u32 m0, s79, 0x20000
    s_nop 0
    buffer_load_dwordx4 v26, s[8:11], s77 offen lds
    buffer_load_dwordx4 v27, s[8:11], s77 offen offset:1024 lds
    s_add_u32 s77, s77, 393216
    s_cmp_ge_u32 s77, 6291456
    s_cselect_b32 s77, 0, s77
    s_add_u32 m0, s78, 0xc000
    s_nop 0
    buffer_load_dwordx4 v18, s[4:7], s76 offen lds
    buffer_load_dwordx4 v19, s[4:7], s76 offen offset:1024 lds
    buffer_load_dwordx4 v20, s[4:7], s76 offen offset:2048 lds
    buffer_load_dwordx4 v21, s[4:7], s76 offen offset:3072 lds
    s_add_u32 s76, s76, 128
    s_and_b32 s76, s76, 2047
    s_add_u32 m0, s79, 0x22000
    s_nop 0
    buffer_load_dwordx4 v22, s[8:11], s77 offen lds
    buffer_load_dwordx4 v23, s[8:11], s77 offen offset:1024 lds
    s_add_u32 m0, s79, 0x24000
    s_nop 0
    buffer_load_dwordx4 v24, s[8:11], s77 offen lds
    buffer_load_dwordx4 v25, s[8:11], s77 offen offset:1024 lds
    s_add_u32 m0, s79, 0x26000
    s_nop 0
    buffer_load_dwordx4 v26, s[8:11], s77 offen lds
    buffer_load_dwordx4 v27, s[8:11], s77 offen offset:1024 lds
    s_add_u32 s77, s77, 393216
    s_cmp_ge_u32 s77, 6291456
    s_cselect_b32 s77, 0, s77
    s_waitcnt vmcnt(21)
    s_cmp_lg_u32 s52, 0
    s_cbranch_scc1 sequential_preLN__sliding_block__dense_activation_gelu__prompt_kernel_nocall6
    s_call_b64 s[80:81], sequential_preLN__sliding_block__dense_activation_gelu__prompt_kernel_part4
sequential_preLN__sliding_block__dense_activation_gelu__prompt_kernel_nocall6:
    s_barrier
    s_add_u32 m0, s79, 0x10000
    s_nop 0
    buffer_load_dwordx4 v22, s[8:11], s77 offen lds
    buffer_load_dwordx4 v23, s[8:11], s77 offen offset:1024 lds
    s_add_u32 m0, s79, 0x12000
    s_nop 0
    buffer_load_dwordx4 v24, s[8:11], s77 offen lds
    buffer_load_dwordx4 v25, s[8:11], s77 offen offset:1024 lds
    s_add_u32 m0, s79, 0x14000
    s_nop 0
    buffer_load_dwordx4 v26, s[8:11], s77 offen lds
    buffer_load_dwordx4 v27, s[8:11], s77 offen offset:1024 lds
    s_add_u32 s77, s77, 393216
    s_cmp_ge_u32 s77, 6291456
    s_cselect_b32 s77, 0, s77
    s_add_u32 m0, s78, 0x0
    s_nop 0
    buffer_load_dwordx4 v18, s[4:7], s76 offen lds
    buffer_load_dwordx4 v19, s[4:7], s76 offen offset:1024 lds
    buffer_load_dwordx4 v20, s[4:7], s76 offen offset:2048 lds
    buffer_load_dwordx4 v21, s[4:7], s76 offen offset:3072 lds
    s_add_u32 s76, s76, 128
    s_and_b32 s76, s76, 2047
    s_waitcnt vmcnt(20)
    s_cmp_lg_u32 s52, 1
    s_cbranch_scc1 sequential_preLN__sliding_block__dense_activation_gelu__prompt_kernel_nocall7
    s_call_b64 s[80:81], sequential_preLN__sliding_block__dense_activation_gelu__prompt_kernel_part4
sequential_preLN__sliding_block__dense_activation_gelu__prompt_kernel_nocall7:
    s_barrier
    s_add_u32 m0, s79, 0x16000
    s_nop 0
    buffer_load_dwordx4 v22, s[8:11], s77 offen lds
    v_mov_b32 v68, 0x3f803f80
    s_nop 0
    v_dot2_f32_bf16 v64, v32, v68, 0
    v_dot2_f32_bf16 v65, v32, v32, 0
    v_dot2_f32_bf16 v66, v40, v68, 0
    v_dot2_f32_bf16 v67, v40, v40, 0
    v_dot2_f32_bf16 v64, v33, v68, v64
    v_dot2_f32_bf16 v65, v33, v33, v65
    v_dot2_f32_bf16 v66, v41, v68, v66
    buffer_load_dwordx4 v23, s[8:11], s77 offen offset:1024 lds
    v_dot2_f32_bf16 v67, v41, v41, v67
    v_dot2_f32_bf16 v64, v34, v68, v64
    v_dot2_f32_bf16 v65, v34, v34, v65
    v_dot2_f32_bf16 v66, v42, v68, v66
    v_dot2_f32_bf16 v67, v42, v42, v67
    v_dot2_f32_bf16 v64, v35, v68, v64
    v_dot2_f32_bf16 v65, v35, v35, v65
    v_dot2_f32_bf16 v66, v43, v68, v66
    s_add_u32 m0, s79, 0x18000
    s_nop 0
    buffer_load_dwordx4 v24, s[8:11], s77 offen lds
    s_nop 0
    v_dot2_f32_bf16 v67, v43, v43, v67
    v_dot2_f32_bf16 v64, v36, v68, v64
    v_dot2_f32_bf16 v65, v36, v36, v65
    v_dot2_f32_bf16 v66, v44, v68, v66
    v_dot2_f32_bf16 v67, v44, v44, v67
    v_dot2_f32_bf16 v64, v37, v68, v64
    v_dot2_f32_bf16 v65, v37, v37, v65
    v_dot2_f32_bf16 v66, v45, v68, v66
    buffer_load_dwordx4 v25, s[8:11], s77 offen offset:1024 lds
    v_dot2_f32_bf16 v67, v45, v45, v67
    v_dot2_f32_bf16 v64, v38, v68, v64
    v_dot2_f32_bf16 v65, v38, v38, v65
    v_dot2_f32_bf16 v66, v46, v68, v66
    v_dot2_f32_bf16 v67, v46, v46, v67
    v_dot2_f32_bf16 v64, v39, v68, v64
    v_dot2_f32_bf16 v65, v39, v39, v65
    v_dot2_f32_bf16 v66, v47, v68, v66
    s_add_u32 m0, s79, 0x1a000
    s_nop 0
    buffer_load_dwordx4 v26, s[8:11], s77 offen lds
    v_dot2_f32_bf16 v67, v47, v47, v67
    s_nop 2
    v_permlane32_swap_b32 v64, v66
    v_permlane32_swap_b32 v65, v67
    v_add_f32 v64, v64, v66
    v_add_f32 v65, v65, v67
    s_nop 1
    v_permlane16_swap_b32 v64, v65
    buffer_load_dwordx4 v27, s[8:11], s77 offen offset:1024 lds
    v_add_f32 v64, v64, v65
    v_and_b32 v69, 15, v1
    v_lshlrev_b32 v69, 3, v69
    v_lshrrev_b32 v72, 5, v1
    v_lshl_add_u32 v69, v72, 7, v69
    v_bfe_u32 v72, v1, 4, 1
    v_lshl_add_u32 v69, v72, 2, v69
    s_lshl_b32 s53, s49, 10
    s_add_u32 s77, s77, 393216
    s_cmp_ge_u32 s77, 6291456
    s_cselect_b32 s77, 0, s77
    s_add_u32 m0, s78, 0x4000
    s_nop 0
    buffer_load_dwordx4 v18, s[4:7], s76 offen lds
    s_lshl_b32 s54, s47, 8
    s_add_u32 s53, s53, s54
    s_add_u32 s53, s53, 0x2800000
    buffer_store_dword v64, v69, s[24:27], s53 offen sc1
    s_nop 0
    v_dot2_f32_bf16 v64, v76, v68, 0
    v_dot2_f32_bf16 v65, v84, v68, 0
    v_dot2_f32_bf16 v66, v92, v68, 0
    v_dot2_f32_bf16 v64, v77, v68, v64
    buffer_load_dwordx4 v19, s[4:7], s76 offen offset:1024 lds
    v_dot2_f32_bf16 v65, v85, v68, v65
    v_dot2_f32_bf16 v66, v93, v68, v66
    v_dot2_f32_bf16 v64, v78, v68, v64
    v_dot2_f32_bf16 v65, v86, v68, v65
    v_dot2_f32_bf16 v66, v94, v68, v66
    v_dot2_f32_bf16 v64, v79, v68, v64
    v_dot2_f32_bf16 v65, v87, v68, v65
    v_dot2_f32_bf16 v66, v95, v68, v66
    buffer_load_dwordx4 v20, s[4:7], s76 offen offset:2048 lds
    v_dot2_f32_bf16 v64, v80, v68, v64
    v_dot2_f32_bf16 v65, v88, v68, v65
    v_dot2_f32_bf16 v66, v96, v68, v66
    v_dot2_f32_bf16 v64, v81, v68, v64
    v_dot2_f32_bf16 v65, v89, v68, v65
    v_dot2_f32_bf16 v66, v97, v68, v66
    v_dot2_f32_bf16 v64, v82, v68, v64
    v_dot2_f32_bf16 v65, v90, v68, v65
    buffer_load_dwordx4 v21, s[4:7], s76 offen offset:3072 lds
    v_dot2_f32_bf16 v66, v98, v68, v66
    v_dot2_f32_bf16 v64, v83, v68, v64
    v_dot2_f32_bf16 v65, v91, v68, v65
    v_dot2_f32_bf16 v66, v99, v68, v66
    s_nop 2
    v_permlane32_swap_b32 v64, v66
    v_permlane32_swap_b32 v65, v67
    v_add_f32 v64, v64, v66
    s_add_u32 s76, s76, 128
    s_and_b32 s76, s76, 2047
    s_waitcnt vmcnt(21)
    s_barrier
    s_add_u32 m0, s79, 0x1c000
    s_nop 0
    buffer_load_dwordx4 v22, s[8:11], s77 offen lds
    v_add_f32 v65, v65, v67
    s_nop 1
    v_permlane16_swap_b32 v64, v65
    v_add_f32 v64, v64, v65
    v_and_b32 v69, 15, v1
    v_lshrrev_b32 v72, 4, v1
    v_lshl_add_u32 v69, v72, 6, v69
    v_lshlrev_b32 v69, 2, v69
    buffer_load_dwordx4 v23, s[8:11], s77 offen offset:1024 lds
    s_lshl_b32 s53, s45, 4
    s_add_u32 s53, s53, s44
    s_lshl_b32 s53, s53, 10
    s_lshl_b32 s54, s47, 6
    s_add_u32 s53, s53, s54
    s_add_u32 s53, s53, 0x2840000
    buffer_store_dword v64, v69, s[24:27], s53 offen sc1
    s_add_u32 m0, s79, 0x1e000
    s_nop 0
    buffer_load_dwordx4 v24, s[8:11], s77 offen lds
    buffer_load_dwordx4 v25, s[8:11], s77 offen offset:1024 lds
    s_add_u32 m0, s79, 0x20000
    s_nop 0
    buffer_load_dwordx4 v26, s[8:11], s77 offen lds
    buffer_load_dwordx4 v27, s[8:11], s77 offen offset:1024 lds
    s_add_u32 s77, s77, 393216
    s_cmp_ge_u32 s77, 6291456
    s_cselect_b32 s77, 0, s77
    s_add_u32 m0, s78, 0x8000
    s_nop 0
    buffer_load_dwordx4 v18, s[4:7], s76 offen lds
    buffer_load_dwordx4 v19, s[4:7], s76 offen offset:1024 lds
    buffer_load_dwordx4 v20, s[4:7], s76 offen offset:2048 lds
    buffer_load_dwordx4 v21, s[4:7], s76 offen offset:3072 lds
    s_add_u32 s76, s76, 128
    s_and_b32 s76, s76, 2047
    s_waitcnt vmcnt(22)
    s_barrier
    s_add_u32 m0, s79, 0x22000
    s_nop 0
    buffer_load_dwordx4 v22, s[8:11], s77 offen lds
    buffer_load_dwordx4 v23, s[8:11], s77 offen offset:1024 lds
    s_add_u32 m0, s79, 0x24000
    s_nop 0
    buffer_load_dwordx4 v24, s[8:11], s77 offen lds
    buffer_load_dwordx4 v25, s[8:11], s77 offen offset:1024 lds
    s_add_u32 m0, s79, 0x26000
    s_nop 0
    buffer_load_dwordx4 v26, s[8:11], s77 offen lds
    buffer_load_dwordx4 v27, s[8:11], s77 offen offset:1024 lds
    s_add_u32 s77, s77, 393216
    s_cmp_ge_u32 s77, 6291456
    s_cselect_b32 s77, 0, s77
    s_add_u32 m0, s78, 0xc000
    s_nop 0
    buffer_load_dwordx4 v18, s[4:7], s76 offen lds
    buffer_load_dwordx4 v19, s[4:7], s76 offen offset:1024 lds
    buffer_load_dwordx4 v20, s[4:7], s76 offen offset:2048 lds
    buffer_load_dwordx4 v21, s[4:7], s76 offen offset:3072 lds
    s_add_u32 s76, s76, 128
    s_and_b32 s76, s76, 2047
    s_waitcnt vmcnt(21)
    s_barrier
    s_add_u32 m0, s79, 0x10000
    s_nop 0
    buffer_load_dwordx4 v22, s[8:11], s77 offen lds
    buffer_load_dwordx4 v23, s[8:11], s77 offen offset:1024 lds
    s_add_u32 m0, s79, 0x12000
    s_nop 0
    buffer_load_dwordx4 v24, s[8:11], s77 offen lds
    buffer_load_dwordx4 v25, s[8:11], s77 offen offset:1024 lds
    s_add_u32 m0, s79, 0x14000
    s_nop 0
    buffer_load_dwordx4 v26, s[8:11], s77 offen lds
    buffer_load_dwordx4 v27, s[8:11], s77 offen offset:1024 lds
    s_add_u32 s77, s77, 393216
    s_cmp_ge_u32 s77, 6291456
    s_cselect_b32 s77, 0, s77
    s_add_u32 m0, s78, 0x0
    s_nop 0
    buffer_load_dwordx4 v18, s[4:7], s76 offen lds
    buffer_load_dwordx4 v19, s[4:7], s76 offen offset:1024 lds
    buffer_load_dwordx4 v20, s[4:7], s76 offen offset:2048 lds
    buffer_load_dwordx4 v21, s[4:7], s76 offen offset:3072 lds
    s_add_u32 s76, s76, 128
    s_and_b32 s76, s76, 2047
    s_waitcnt vmcnt(20)
    s_barrier
    s_add_u32 m0, s79, 0x16000
    s_nop 0
    buffer_load_dwordx4 v22, s[8:11], s77 offen lds
    buffer_load_dwordx4 v23, s[8:11], s77 offen offset:1024 lds
    s_add_u32 m0, s79, 0x18000
    s_nop 0
    buffer_load_dwordx4 v24, s[8:11], s77 offen lds
    buffer_load_dwordx4 v25, s[8:11], s77 offen offset:1024 lds
    s_add_u32 m0, s79, 0x1a000
    s_nop 0
    buffer_load_dwordx4 v26, s[8:11], s77 offen lds
    buffer_load_dwordx4 v27, s[8:11], s77 offen offset:1024 lds
    s_add_u32 s77, s77, 393216
    s_cmp_ge_u32 s77, 6291456
    s_cselect_b32 s77, 0, s77
    s_add_u32 m0, s78, 0x4000
    s_nop 0
    buffer_load_dwordx4 v18, s[4:7], s76 offen lds
    buffer_load_dwordx4 v19, s[4:7], s76 offen offset:1024 lds
    buffer_load_dwordx4 v20, s[4:7], s76 offen offset:2048 lds
    buffer_load_dwordx4 v21, s[4:7], s76 offen offset:3072 lds
    s_add_u32 s76, s76, 128
    s_and_b32 s76, s76, 2047
    s_cmp_lg_u32 s47, 0
    s_cbranch_scc1 sequential_preLN__sliding_block__dense_activation_gelu__prompt_kernel_nofl8
    s_lshl_b32 s53, s44, 4
    s_add_u32 s53, s53, s45
    s_lshl_b32 s53, s53, 7
    s_add_u32 s53, s53, 0x2900000
    v_mov_b32 v3, 0
    v_mov_b32 v4, s50
    s_mov_b64 exec, 1
    buffer_store_dword v4, v3, s[24:27], s53 offen sc1
    s_mov_b64 exec, -1
sequential_preLN__sliding_block__dense_activation_gelu__prompt_kernel_nofl8:
    s_waitcnt vmcnt(20)
    s_barrier
    s_add_u32 m0, s79, 0x1c000
    s_nop 0
    buffer_load_dwordx4 v22, s[8:11], s77 offen lds
    buffer_load_dwordx4 v23, s[8:11], s77 offen offset:1024 lds
    s_add_u32 m0, s79, 0x1e000
    s_nop 0
    buffer_load_dwordx4 v24, s[8:11], s77 offen lds
    buffer_load_dwordx4 v25, s[8:11], s77 offen offset:1024 lds
    s_add_u32 m0, s79, 0x20000
    s_nop 0
    buffer_load_dwordx4 v26, s[8:11], s77 offen lds
    buffer_load_dwordx4 v27, s[8:11], s77 offen offset:1024 lds
    s_add_u32 s77, s77, 393216
    s_cmp_ge_u32 s77, 6291456
    s_cselect_b32 s77, 0, s77
    s_add_u32 m0, s78, 0x8000
    s_nop 0
    buffer_load_dwordx4 v18, s[4:7], s76 offen lds
    buffer_load_dwordx4 v19, s[4:7], s76 offen offset:1024 lds
    buffer_load_dwordx4 v20, s[4:7], s76 offen offset:2048 lds
    buffer_load_dwordx4 v21, s[4:7], s76 offen offset:3072 lds
    s_add_u32 s76, s76, 128
    s_and_b32 s76, s76, 2047
    s_waitcnt vmcnt(20)
    s_barrier
    s_add_u32 m0, s79, 0x22000
    s_nop 0
    buffer_load_dwordx4 v22, s[8:11], s77 offen lds
    buffer_load_dwordx4 v23, s[8:11], s77 offen offset:1024 lds
    s_add_u32 m0, s79, 0x24000
    s_nop 0
    buffer_load_dwordx4 v24, s[8:11], s77 offen lds
    buffer_load_dwordx4 v25, s[8:11], s77 offen offset:1024 lds
    s_add_u32 m0, s79, 0x26000
    s_nop 0
    buffer_load_dwordx4 v26, s[8:11], s77 offen lds
    buffer_load_dwordx4 v27, s[8:11], s77 offen offset:1024 lds
    s_add_u32 s77, s77, 393216
    s_cmp_ge_u32 s77, 6291456
    s_cselect_b32 s77, 0, s77
    s_add_u32 m0, s78, 0xc000
    s_nop 0
    buffer_load_dwordx4 v18, s[4:7], s76 offen lds
    buffer_load_dwordx4 v19, s[4:7], s76 offen offset:1024 lds
    buffer_load_dwordx4 v20, s[4:7], s76 offen offset:2048 lds
    buffer_load_dwordx4 v21, s[4:7], s76 offen offset:3072 lds
    s_add_u32 s76, s76, 128
    s_and_b32 s76, s76, 2047
    s_waitcnt vmcnt(20)
    s_barrier
    s_add_u32 m0, s79, 0x10000
    s_nop 0
    buffer_load_dwordx4 v22, s[8:11], s77 offen lds
    buffer_load_dwordx4 v23, s[8:11], s77 offen offset:1024 lds
    s_add_u32 m0, s79, 0x12000
    s_nop 0
    buffer_load_dwordx4 v24, s[8:11], s77 offen lds
    buffer_load_dwordx4 v25, s[8:11], s77 offen offset:1024 lds
    s_add_u32 m0, s79, 0x14000
    s_nop 0
    buffer_load_dwordx4 v26, s[8:11], s77 offen lds
    buffer_load_dwordx4 v27, s[8:11], s77 offen offset:1024 lds
    s_add_u32 s77, s77, 393216
    s_cmp_ge_u32 s77, 6291456
    s_cselect_b32 s77, 0, s77
    s_add_u32 m0, s78, 0x0
    s_nop 0
    buffer_load_dwordx4 v18, s[4:7], s76 offen lds
    buffer_load_dwordx4 v19, s[4:7], s76 offen offset:1024 lds
    buffer_load_dwordx4 v20, s[4:7], s76 offen offset:2048 lds
    buffer_load_dwordx4 v21, s[4:7], s76 offen offset:3072 lds
    s_add_u32 s76, s76, 128
    s_and_b32 s76, s76, 2047
    s_waitcnt vmcnt(20)
    s_barrier
    s_add_u32 m0, s79, 0x16000
    s_nop 0
    buffer_load_dwordx4 v22, s[8:11], s77 offen lds
    buffer_load_dwordx4 v23, s[8:11], s77 offen offset:1024 lds
    s_add_u32 m0, s79, 0x18000
    s_nop 0
    buffer_load_dwordx4 v24, s[8:11], s77 offen lds
    buffer_load_dwordx4 v25, s[8:11], s77 offen offset:1024 lds
    s_add_u32 m0, s79, 0x1a000
    s_nop 0
    buffer_load_dwordx4 v26, s[8:11], s77 offen lds
    buffer_load_dwordx4 v27, s[8:11], s77 offen offset:1024 lds
    s_add_u32 s77, s77, 393216
    s_cmp_ge_u32 s77, 6291456
    s_cselect_b32 s77, 0, s77
    s_add_u32 m0, s78, 0x4000
    s_nop 0
    buffer_load_dwordx4 v18, s[4:7], s76 offen lds
    buffer_load_dwordx4 v19, s[4:7], s76 offen offset:1024 lds
    buffer_load_dwordx4 v20, s[4:7], s76 offen offset:2048 lds
    buffer_load_dwordx4 v21, s[4:7], s76 offen offset:3072 lds
    s_add_u32 s76, s76, 128
    s_and_b32 s76, s76, 2047
    s_waitcnt vmcnt(20)
    s_barrier
    s_add_u32 m0, s79, 0x1c000
    s_nop 0
    buffer_load_dwordx4 v22, s[8:11], s77 offen lds
    buffer_load_dwordx4 v23, s[8:11], s77 offen offset:1024 lds
    s_add_u32 m0, s79, 0x1e000
    s_nop 0
    buffer_load_dwordx4 v24, s[8:11], s77 offen lds
    buffer_load_dwordx4 v25, s[8:11], s77 offen offset:1024 lds
    s_add_u32 m0, s79, 0x20000
    s_nop 0
    buffer_load_dwordx4 v26, s[8:11], s77 offen lds
    buffer_load_dwordx4 v27, s[8:11], s77 offen offset:1024 lds
    s_add_u32 s77, s77, 393216
    s_cmp_ge_u32 s77, 6291456
    s_cselect_b32 s77, 0, s77
    s_add_u32 m0, s78, 0x8000
    s_nop 0
    buffer_load_dwordx4 v18, s[4:7], s76 offen lds
    buffer_load_dwordx4 v19, s[4:7], s76 offen offset:1024 lds
    buffer_load_dwordx4 v20, s[4:7], s76 offen offset:2048 lds
    buffer_load_dwordx4 v21, s[4:7], s76 offen offset:3072 lds
    s_add_u32 s76, s76, 128
    s_and_b32 s76, s76, 2047
    s_waitcnt vmcnt(20)
    s_barrier
    v_and_b32 v69, 15, v1
    v_lshlrev_b32 v64, 7, v69
    s_lshl_b32 s55, s44, 11
    v_add_u32 v64, s55, v64
    s_lshl_b32 s55, s45, 7
    v_lshl_add_u32 v65, v69, 11, s55
    v_and_b32 v72, 16, v1
    v_cmp_eq_u32 vcc, 0, v72
    s_mov_b32 s55, 0x2900000
    s_nop 0
    v_cndmask_b32 v64, v65, v64, vcc
    buffer_load_dword v70, v64, s[24:27], s55 offen sc1
    s_add_u32 m0, s79, 0x22000
    s_nop 0
    buffer_load_dwordx4 v22, s[8:11], s77 offen lds
    buffer_load_dwordx4 v23, s[8:11], s77 offen offset:1024 lds
    s_add_u32 m0, s79, 0x24000
    s_nop 0
    buffer_load_dwordx4 v24, s[8:11], s77 offen lds
    buffer_load_dwordx4 v25, s[8:11], s77 offen offset:1024 lds
    s_add_u32 m0, s79, 0x26000
    s_nop 0
    buffer_load_dwordx4 v26, s[8:11], s77 offen lds
    buffer_load_dwordx4 v27, s[8:11], s77 offen offset:1024 lds
    s_add_u32 s77, s77, 393216
    s_cmp_ge_u32 s77, 6291456
    s_cselect_b32 s77, 0, s77
    s_add_u32 m0, s78, 0xc000
    s_nop 0
    buffer_load_dwordx4 v18, s[4:7], s76 offen lds
    buffer_load_dwordx4 v19, s[4:7], s76 offen offset:1024 lds
    buffer_load_dwordx4 v20, s[4:7], s76 offen offset:2048 lds
    buffer_load_dwordx4 v21, s[4:7], s76 offen offset:3072 lds
    s_add_u32 s76, s76, 128
    s_and_b32 s76, s76, 2047
    s_waitcnt vmcnt(21)
    s_barrier
    s_waitcnt vmcnt(10)
    v_cmp_ne_u32 vcc, s50, v70
    s_cmp_eq_u64 vcc, 0
    s_cbranch_scc1 sequential_preLN__sliding_block__dense_activation_gelu__prompt_kernel_stok9
    s_mov_b32 s61, 0
sequential_preLN__sliding_block__dense_activation_gelu__prompt_kernel_poll10:
    buffer_load_dword v70, v64, s[24:27], s55 offen sc1
    s_waitcnt vmcnt(0)
    v_cmp_ne_u32 vcc, s50, v70
    s_cmp_eq_u64 vcc, 0
    s_cbranch_scc1 sequential_preLN__sliding_block__dense_activation_gelu__prompt_kernel_pdone11
    s_add_u32 s61, s61, 1
    s_cmp_lt_u32 s61, 32768
    s_cbranch_scc1 sequential_preLN__sliding_block__dense_activation_gelu__prompt_kernel_poll10
sequential_preLN__sliding_block__dense_activation_gelu__prompt_kernel_pdone11:
sequential_preLN__sliding_block__dense_activation_gelu__prompt_kernel_stok9:
    s_cmp_ge_u32 s47, 2
    s_cselect_b32 s53, s45, s44
    s_cselect_b32 s54, 0x40000, 0
    s_lshl_b32 s53, s53, 14
    s_add_u32 s53, s53, s54
    s_add_u32 s53, s53, 0x2800000
    s_and_b32 s54, s47, 1
    s_lshl_b32 s54, s54, 9
    s_add_u32 s53, s53, s54
    v_and_b32 v69, 31, v1
    v_lshlrev_b32 v69, 4, v69
    v_lshrrev_b32 v72, 5, v1
    v_lshl_add_u32 v69, v72, 13, v69
    buffer_load_dwordx4 v[32:35], v69, s[24:27], s53 offen offset:0 sc1
    buffer_load_dwordx4 v[36:39], v69, s[24:27], s53 offen offset:1024 sc1
    buffer_load_dwordx4 v[40:43], v69, s[24:27], s53 offen offset:2048 sc1
    buffer_load_dwordx4 v[44:47], v69, s[24:27], s53 offen offset:3072 sc1
    s_add_u32 s53, s53, 4096
    buffer_load_dwordx4 v[48:51], v69, s[24:27], s53 offen offset:0 sc1
    buffer_load_dwordx4 v[52:55], v69, s[24:27], s53 offen offset:1024 sc1
    buffer_load_dwordx4 v[56:59], v69, s[24:27], s53 offen offset:2048 sc1
    buffer_load_dwordx4 v[60:63], v69, s[24:27], s53 offen offset:3072 sc1
    v_and_b32 v69, 31, v1
    v_lshl_add_u32 v69, v69, 1, v72
    v_and_b32 v5, 7, v1
    v_lshlrev_b32 v5, 7, v5
    buffer_load_dword v6, v5, s[72:75], s68 offen
    s_barrier
    v_min_u32 v3, 15, v1
    v_lshlrev_b32 v3, 7, v3
    s_mul_i32 s53, s49, 4
    s_add_u32 s53, s53, s47
    s_mul_i32 s53, s53, 2048
    buffer_load_dword v6, v3, s[12:15], s53 offen
    v_min_u32 v4, 27, v1
    v_lshlrev_b32 v4, 7, v4
    s_mul_i32 s54, s49, 4
    s_add_u32 s54, s54, s47
    s_mul_i32 s54, s54, 3584
    buffer_load_dword v6, v4, s[16:19], s54 offen
    s_waitcnt vmcnt(11)
    s_barrier
    s_barrier
    s_waitcnt vmcnt(3)
    s_nop 0
    v_pk_add_f32 v[32:33], v[32:33], v[48:49]
    v_pk_add_f32 v[34:35], v[34:35], v[50:51]
    v_pk_add_f32 v[36:37], v[36:37], v[52:53]
    v_pk_add_f32 v[38:39], v[38:39], v[54:55]
    v_pk_add_f32 v[40:41], v[40:41], v[56:57]
    v_pk_add_f32 v[42:43], v[42:43], v[58:59]
    v_pk_add_f32 v[44:45], v[44:45], v[60:61]
    v_pk_add_f32 v[46:47], v[46:47], v[62:63]
    v_pk_add_f32 v[32:33], v[32:33], v[40:41]
    v_pk_add_f32 v[34:35], v[34:35], v[42:43]
    v_pk_add_f32 v[36:37], v[36:37], v[44:45]
    v_pk_add_f32 v[38:39], v[38:39], v[46:47]
    v_pk_add_f32 v[32:33], v[32:33], v[36:37]
    v_pk_add_f32 v[34:35], v[34:35], v[38:39]
    s_and_b32 s54, s47, 1
    s_nop 0
    v_permlane32_swap_b32 v32, v34
    v_permlane32_swap_b32 v33, v35
    v_pk_add_f32 v[32:33], v[32:33], v[34:35]
    s_cmp_ge_u32 s47, 2
    s_cbranch_scc1 sequential_preLN__sliding_block__dense_activation_gelu__prompt_kernel_cols12
    v_mul_f32 v32, 0x3a800000, v32
    v_mul_f32 v33, 0x3a800000, v33
    v_fma_f32 v33, -v32, v32, v33
    v_max_f32 v33, 0, v33
    v_add_f32 v33, 0x3727c5ac, v33
    v_rsq_f32 v33, v33
    s_lshl_b32 s54, s54, 8
    s_add_u32 s54, s54, 0
    v_mul_f32 v32, v32, v33
    v_lshl_add_u32 v69, v69, 2, s54
    ds_write_b32 v69, v33
    ds_write_b32 v69, v32 offset:512
    s_branch sequential_preLN__sliding_block__dense_activation_gelu__prompt_kernel_tabs13
sequential_preLN__sliding_block__dense_activation_gelu__prompt_kernel_cols12:
    s_lshl_b32 s54, s54, 9
    s_add_u32 s54, s54, 1024
    v_lshl_add_u32 v69, v69, 3, s54
    ds_write_b64 v69, v[32:33]
sequential_preLN__sliding_block__dense_activation_gelu__prompt_kernel_tabs13:
    s_waitcnt lgkmcnt(0)
    s_barrier
    v_lshrrev_b32 v3, 4, v1
    v_lshlrev_b32 v3, 1, v3
    v_xor_b32 v3, v3, v1
    v_and_b32 v3, 7, v3
    v_lshlrev_b32 v3, 4, v3
    v_lshrrev_b32 v4, 3, v1
    v_lshl_add_u32 v3, v4, 11, v3
    s_lshl_b32 s53, s47, 15
    s_lshl_b32 s54, s45, 7
    s_add_u32 s53, s53, s54
    v_add_u32 v14, s53, v3
    v_add_u32 v15, 15360, v14
    s_mul_i32 s53, s44, 0
    s_mul_i32 s54, s45, 0
    s_add_u32 s53, s53, s54
    s_and_b32 s51, s53, 15
    s_lshl_b32 s66, s51, 17
    s_lshl_b32 s67, s47, 11
    s_mul_i32 s53, s47, 114688
    s_mul_i32 s54, s45, 448
    s_add_u32 s53, s53, s54
    v_add_u32 v3, 0, v1
    v_mul_u32_u24 v4, 2341, v3
    v_lshrrev_b32 v4, 16, v4
    v_mul_u32_u24 v5, 28, v4
    v_sub_u32 v3, v3, v5
    v_bfe_u32 v5, v4, 2, 1
    v_lshlrev_b32 v5, 1, v5
    v_xor_b32 v3, v3, v5
    v_lshlrev_b32 v3, 4, v3
    v_mul_u32_u24 v4, 7168, v4
    v_add3_u32 v7, v3, v4, s53
    v_add_u32 v3, 64, v1
    v_mul_u32_u24 v4, 2341, v3
    v_lshrrev_b32 v4, 16, v4
    v_mul_u32_u24 v5, 28, v4
    v_sub_u32 v3, v3, v5
    v_bfe_u32 v5, v4, 2, 1
    v_lshlrev_b32 v5, 1, v5
    v_xor_b32 v3, v3, v5
    v_lshlrev_b32 v3, 4, v3
    v_mul_u32_u24 v4, 7168, v4
    v_add3_u32 v8, v3, v4, s53
    v_subrev_u32 v8, 1024, v8
    v_add_u32 v3, 128, v1
    v_mul_u32_u24 v4, 2341, v3
    v_lshrrev_b32 v4, 16, v4
    v_mul_u32_u24 v5, 28, v4
    v_sub_u32 v3, v3, v5
    v_bfe_u32 v5, v4, 2, 1
    v_lshlrev_b32 v5, 1, v5
    v_xor_b32 v3, v3, v5
    v_lshlrev_b32 v3, 4, v3
    v_mul_u32_u24 v4, 7168, v4
    v_add3_u32 v9, v3, v4, s53
    v_subrev_u32 v9, 2048, v9
    v_add_u32 v3, 192, v1
    v_mul_u32_u24 v4, 2341, v3
    v_lshrrev_b32 v4, 16, v4
    v_mul_u32_u24 v5, 28, v4
    v_sub_u32 v3, v3, v5
    v_bfe_u32 v5, v4, 2, 1
    v_lshlrev_b32 v5, 1, v5
    v_xor_b32 v3, v3, v5
    v_lshlrev_b32 v3, 4, v3
    v_mul_u32_u24 v4, 7168, v4
    v_add3_u32 v10, v3, v4, s53
    v_subrev_u32 v10, 3072, v10
    v_add_u32 v3, 256, v1
    v_mul_u32_u24 v4, 2341, v3
    v_lshrrev_b32 v4, 16, v4
    v_mul_u32_u24 v5, 28, v4
    v_sub_u32 v3, v3, v5
    v_bfe_u32 v5, v4, 2, 1
    v_lshlrev_b32 v5, 1, v5
    v_xor_b32 v3, v3, v5
    v_lshlrev_b32 v3, 4, v3
    v_mul_u32_u24 v4, 7168, v4
    v_add3_u32 v11, v3, v4, s53
    v_add_u32 v3, 320, v1
    v_mul_u32_u24 v4, 2341, v3
    v_lshrrev_b32 v4, 16, v4
    v_mul_u32_u24 v5, 28, v4
    v_sub_u32 v3, v3, v5
    v_bfe_u32 v5, v4, 2, 1
    v_lshlrev_b32 v5, 1, v5
    v_xor_b32 v3, v3, v5
    v_lshlrev_b32 v3, 4, v3
    v_mul_u32_u24 v4, 7168, v4
    v_add3_u32 v12, v3, v4, s53
    v_subrev_u32 v12, 1024, v12
    v_add_u32 v3, 384, v1
    v_mul_u32_u24 v4, 2341, v3
    v_lshrrev_b32 v4, 16, v4
    v_mul_u32_u24 v5, 28, v4
    v_sub_u32 v3, v3, v5
    v_bfe_u32 v5, v4, 2, 1
    v_lshlrev_b32 v5, 1, v5
    v_xor_b32 v3, v3, v5
    v_lshlrev_b32 v3, 4, v3
    v_mul_u32_u24 v4, 7168, v4
    v_add3_u32 v13, v3, v4, s53
    v_subrev_u32 v13, 2048, v13
    s_mul_i32 s70, s47, 7168
    v_and_b32 v18, 1, v1
    s_sub_u32 s53, s44, 1
    v_sub_u32 v18, s53, v18
    v_max_i32 v18, 0, v18
    v_lshlrev_b32 v18, 11, v18
    s_lshl_b32 s84, s45, 7
    s_add_u32 s84, s84, 0x2920000
    s_lshr_b32 s53, s47, 1
    s_and_b32 s54, s47, 1
    s_add_u32 s55, s44, s53
    s_sub_u32 s82, s55, 2
    s_lshl_b32 s82, s82, 4
    s_add_u32 s82, s82, s45
    s_lshl_b32 s82, s82, 1
    s_add_u32 s82, s82, s54
    s_lshl_b32 s82, s82, 14
    s_cmp_lt_u32 s55, 2
    s_cselect_b32 s82, 0x10000000, s82
    s_mul_i32 s83, s54, 49152
    s_lshl_b32 s53, s53, 13
    s_add_u32 s83, s83, s53
    s_barrier
    s_barrier
    s_cmp_lg_u32 s47, 0
    s_cbranch_scc1 sequential_preLN__sliding_block__dense_activation_gelu__prompt_kernel_notp014
    s_lshl_b32 s53, s44, 4
    s_add_u32 s53, s53, s45
    s_lshl_b32 s53, s53, 7
    s_add_u32 s53, s53, 0x2920000
    v_mov_b32 v3, 0
    v_mov_b32 v4, s50
    s_mov_b64 exec, 1
    buffer_store_dword v4, v3, s[24:27], s53 offen sc1
    s_mov_b64 exec, -1
sequential_preLN__sliding_block__dense_activation_gelu__prompt_kernel_notp014:
    s_add_u32 m0, s67, 0x1c000
    s_nop 0
    buffer_load_dwordx4 v14, s[12:15], s66 offen lds
    buffer_load_dwordx4 v15, s[12:15], s66 offen offset:1024 lds
    s_add_u32 s66, s66, 131072
    s_and_b32 s66, s66, 0x1fffff
    s_add_u32 m0, s67, 0x1e000
    s_nop 0
    buffer_load_dwordx4 v14, s[12:15], s66 offen lds
    buffer_load_dwordx4 v15, s[12:15], s66 offen offset:1024 lds
    s_add_u32 s66, s66, 131072
    s_and_b32 s66, s66, 0x1fffff
    s_add_u32 m0, s67, 0x18000
    s_nop 0
    buffer_load_dwordx4 v14, s[12:15], s66 offen lds
    buffer_load_dwordx4 v15, s[12:15], s66 offen offset:1024 lds
    s_add_u32 s66, s66, 131072
    s_and_b32 s66, s66, 0x1fffff
    s_add_u32 m0, s67, 0x1a000
    s_nop 0
    buffer_load_dwordx4 v14, s[12:15], s66 offen lds
    buffer_load_dwordx4 v15, s[12:15], s66 offen offset:1024 lds
    s_add_u32 s66, s66, 131072
    s_and_b32 s66, s66, 0x1fffff
    s_cmp_lg_u32 s47, 0
    s_cbranch_scc1 sequential_preLN__sliding_block__dense_activation_gelu__prompt_kernel_notp015
    s_mov_b32 s61, 0
sequential_preLN__sliding_block__dense_activation_gelu__prompt_kernel_poll16:
    buffer_load_dword v16, v18, s[24:27], s84 offen sc1
    s_waitcnt vmcnt(0)
    v_cmp_ne_u32 vcc, s50, v16
    s_cmp_eq_u64 vcc, 0
    s_cbranch_scc1 sequential_preLN__sliding_block__dense_activation_gelu__prompt_kernel_pdone17
    s_add_u32 s61, s61, 1
    s_cmp_lt_u32 s61, 32768
    s_cbranch_scc1 sequential_preLN__sliding_block__dense_activation_gelu__prompt_kernel_poll16
sequential_preLN__sliding_block__dense_activation_gelu__prompt_kernel_pdone17:
sequential_preLN__sliding_block__dense_activation_gelu__prompt_kernel_notp015:
    s_barrier
    s_add_u32 m0, s83, 0x0
    s_nop 0
    buffer_load_dwordx4 v2, s[24:27], s82 offen sc1 lds
    buffer_load_dwordx4 v2, s[24:27], s82 offen offset:1024 sc1 lds
    buffer_load_dwordx4 v2, s[24:27], s82 offen offset:2048 sc1 lds
    buffer_load_dwordx4 v2, s[24:27], s82 offen offset:3072 sc1 lds
    s_add_u32 s82, s82, 4096
    s_add_u32 m0, s83, 0x1000
    s_nop 0
    buffer_load_dwordx4 v2, s[24:27], s82 offen sc1 lds
    buffer_load_dwordx4 v2, s[24:27], s82 offen offset:1024 sc1 lds
    buffer_load_dwordx4 v2, s[24:27], s82 offen offset:2048 sc1 lds
    buffer_load_dwordx4 v2, s[24:27], s82 offen offset:3072 sc1 lds
    s_add_u32 s82, s82, 4096
    s_add_u32 m0, s83, 0x6000
    s_nop 0
    buffer_load_dwordx4 v2, s[24:27], s82 offen sc1 lds
    buffer_load_dwordx4 v2, s[24:27], s82 offen offset:1024 sc1 lds
    buffer_load_dwordx4 v2, s[24:27], s82 offen offset:2048 sc1 lds
    buffer_load_dwordx4 v2, s[24:27], s82 offen offset:3072 sc1 lds
    s_add_u32 s82, s82, 4096
    s_add_u32 m0, s83, 0x7000
    s_nop 0
    buffer_load_dwordx4 v2, s[24:27], s82 offen sc1 lds
    buffer_load_dwordx4 v2, s[24:27], s82 offen offset:1024 sc1 lds
    buffer_load_dwordx4 v2, s[24:27], s82 offen offset:2048 sc1 lds
    buffer_load_dwordx4 v2, s[24:27], s82 offen offset:3072 sc1 lds
    s_add_u32 s82, s82, 4096
    s_waitcnt vmcnt(8)
    s_barrier
    s_waitcnt vmcnt(0)
    s_lshl_b32 s53, s47, 2
    s_add_u32 s53, s53, 162832
    v_mov_b32 v3, s53
    v_mov_b32 v4, 1
    ds_write_b32 v3, v4
    s_and_b32 s54, s45, 8
    s_lshl_b32 s54, s54, 7
    s_add_u32 s54, s54, 384
    v_min_u32 v3, 7, v1
    v_lshlrev_b32 v3, 11, v3
    s_lshr_b32 s53, s2, 3
    s_lshl_b32 s53, s53, 2
    s_add_u32 s53, s53, s47
    s_mul_i32 s53, s53, 8
    s_add_u32 s53, s53, 0
    s_lshl_b32 s53, s53, 11
    s_add_u32 s53, s53, s54
    buffer_load_dword v6, v3, s[12:15], s53 offen
    s_mul_i32 s69, s45, 458752
    s_add_u32 m0, s70, 0x20000
    s_nop 0
    buffer_load_dwordx4 v7, s[16:19], s69 offen lds
    buffer_load_dwordx4 v8, s[16:19], s69 offen offset:1024 lds
    buffer_load_dwordx4 v9, s[16:19], s69 offen offset:2048 lds
    buffer_load_dwordx4 v10, s[16:19], s69 offen offset:3072 lds
    s_add_u32 m0, s70, 0x21000
    s_nop 0
    buffer_load_dwordx4 v11, s[16:19], s69 offen lds
    buffer_load_dwordx4 v12, s[16:19], s69 offen offset:1024 lds
    buffer_load_dwordx4 v13, s[16:19], s69 offen offset:2048 lds
    v_lshrrev_b32 v3, 3, v1
    v_mul_u32_u24 v3, 7168, v3
    v_and_b32 v4, 7, v1
    v_lshl_add_u32 v3, v4, 4, v3
    s_lshl_b32 s53, s47, 7
    s_min_u32 s53, s53, 320
    s_mul_i32 s54, s45, 448
    s_add_u32 s53, s53, s54
    s_mul_i32 s54, s44, 458752
    s_add_u32 s53, s53, s54
    buffer_load_dwordx4 v[200:203], v3, s[16:19], s53 offen
    s_add_u32 s53, s53, 57344
    buffer_load_dwordx4 v[204:207], v3, s[16:19], s53 offen
    s_add_u32 s53, s53, 57344
    buffer_load_dwordx4 v[208:211], v3, s[16:19], s53 offen
    s_add_u32 s53, s53, 57344
    buffer_load_dwordx4 v[212:215], v3, s[16:19], s53 offen
    s_add_u32 s53, s53, 57344
    buffer_load_dwordx4 v[216:219], v3, s[16:19], s53 offen
    s_add_u32 s53, s53, 57344
    buffer_load_dwordx4 v[220:223], v3, s[16:19], s53 offen
    s_add_u32 s53, s53, 57344
    buffer_load_dwordx4 v[224:227], v3, s[16:19], s53 offen
    s_add_u32 s53, s53, 57344
    buffer_load_dwordx4 v[228:231], v3, s[16:19], s53 offen
    v_min_u32 v3, 13, v1
    v_lshlrev_b32 v3, 7, v3
    s_mul_i32 s53, s49, 4
    s_add_u32 s53, s53, s47
    s_mul_i32 s53, s53, 1792
    buffer_load_dword v6, v3, s[20:23], s53 offen
    s_lshl_b32 s53, s44, 18
    s_add_u32 s53, s53, 0x800000
    s_add_u32 s77, s53, 262144
    s_lshl_b32 s54, s51, 14
    s_add_u32 s76, s53, s54
    s_lshl_b32 s78, s47, 12
    v_add_u32 v18, s78, v2
    s_barrier
    s_cmp_lg_u32 s47, 0
    s_cbranch_scc1 sequential_preLN__sliding_block__dense_activation_gelu__prompt_kernel_notp018
    s_lshl_b32 s53, s44, 4
    s_add_u32 s53, s53, s45
    s_lshl_b32 s53, s53, 7
    s_add_u32 s53, s53, 0x2940000
    v_mov_b32 v3, 0
    v_mov_b32 v4, s50
    s_mov_b64 exec, 1
    buffer_store_dword v4, v3, s[24:27], s53 offen sc1
    s_mov_b64 exec, -1
sequential_preLN__sliding_block__dense_activation_gelu__prompt_kernel_notp018:
    s_add_u32 m0, s67, 0x14000
    s_nop 0
    buffer_load_dwordx4 v14, s[12:15], s66 offen lds
    buffer_load_dwordx4 v15, s[12:15], s66 offen offset:1024 lds
    s_add_u32 s66, s66, 131072
    s_and_b32 s66, s66, 0x1fffff
    s_add_u32 m0, s67, 0x16000
    s_nop 0
    buffer_load_dwordx4 v14, s[12:15], s66 offen lds
    buffer_load_dwordx4 v15, s[12:15], s66 offen offset:1024 lds
    s_add_u32 s66, s66, 131072
    s_and_b32 s66, s66, 0x1fffff
    s_waitcnt vmcnt(5)
    v_lshlrev_b32 v20, 16, v200
    v_and_b32 v21, 0xffff0000, v200
    v_lshlrev_b32 v22, 16, v201
    v_and_b32 v23, 0xffff0000, v201
    v_lshlrev_b32 v24, 16, v202
    v_and_b32 v25, 0xffff0000, v202
    v_lshlrev_b32 v26, 16, v203
    v_and_b32 v27, 0xffff0000, v203
    v_lshlrev_b32 v28, 16, v204
    v_and_b32 v29, 0xffff0000, v204
    v_pk_add_f32 v[20:21], v[20:21], v[28:29]
    v_lshlrev_b32 v28, 16, v205
    v_and_b32 v29, 0xffff0000, v205
    v_pk_add_f32 v[22:23], v[22:23], v[28:29]
    v_lshlrev_b32 v28, 16, v206
    v_and_b32 v29, 0xffff0000, v206
    v_pk_add_f32 v[24:25], v[24:25], v[28:29]
    v_lshlrev_b32 v28, 16, v207
    v_and_b32 v29, 0xffff0000, v207
    v_pk_add_f32 v[26:27], v[26:27], v[28:29]
    v_lshlrev_b32 v28, 16, v208
    v_and_b32 v29, 0xffff0000, v208
    v_pk_add_f32 v[20:21], v[20:21], v[28:29]
    v_lshlrev_b32 v28, 16, v209
    v_and_b32 v29, 0xffff0000, v209
    v_pk_add_f32 v[22:23], v[22:23], v[28:29]
    v_lshlrev_b32 v28, 16, v210
    v_and_b32 v29, 0xffff0000, v210
    v_pk_add_f32 v[24:25], v[24:25], v[28:29]
    v_lshlrev_b32 v28, 16, v211
    v_and_b32 v29, 0xffff0000, v211
    v_pk_add_f32 v[26:27], v[26:27], v[28:29]
    v_lshlrev_b32 v28, 16, v212
    v_and_b32 v29, 0xffff0000, v212
    v_pk_add_f32 v[20:21], v[20:21], v[28:29]
    v_lshlrev_b32 v28, 16, v213
    v_and_b32 v29, 0xffff0000, v213
    v_pk_add_f32 v[22:23], v[22:23], v[28:29]
    v_lshlrev_b32 v28, 16, v214
    v_and_b32 v29, 0xffff0000, v214
    v_pk_add_f32 v[24:25], v[24:25], v[28:29]
    v_lshlrev_b32 v28, 16, v215
    v_and_b32 v29, 0xffff0000, v215
    v_pk_add_f32 v[26:27], v[26:27], v[28:29]
    v_lshlrev_b32 v28, 16, v216
    v_and_b32 v29, 0xffff0000, v216
    v_pk_add_f32 v[20:21], v[20:21], v[28:29]
    v_lshlrev_b32 v28, 16, v217
    v_and_b32 v29, 0xffff0000, v217
    v_pk_add_f32 v[22:23], v[22:23], v[28:29]
    v_lshlrev_b32 v28, 16, v218
    v_and_b32 v29, 0xffff0000, v218
    v_pk_add_f32 v[24:25], v[24:25], v[28:29]
    v_lshlrev_b32 v28, 16, v219
    v_and_b32 v29, 0xffff0000, v219
    v_pk_add_f32 v[26:27], v[26:27], v[28:29]
    v_lshlrev_b32 v28, 16, v220
    v_and_b32 v29, 0xffff0000, v220
    v_pk_add_f32 v[20:21], v[20:21], v[28:29]
    v_lshlrev_b32 v28, 16, v221
    v_and_b32 v29, 0xffff0000, v221
    v_pk_add_f32 v[22:23], v[22:23], v[28:29]
    v_lshlrev_b32 v28, 16, v222
    v_and_b32 v29, 0xffff0000, v222
    v_pk_add_f32 v[24:25], v[24:25], v[28:29]
    v_lshlrev_b32 v28, 16, v223
    v_and_b32 v29, 0xffff0000, v223
    v_pk_add_f32 v[26:27], v[26:27], v[28:29]
    v_lshlrev_b32 v28, 16, v224
    v_and_b32 v29, 0xffff0000, v224
    v_pk_add_f32 v[20:21], v[20:21], v[28:29]
    v_lshlrev_b32 v28, 16, v225
    v_and_b32 v29, 0xffff0000, v225
    v_pk_add_f32 v[22:23], v[22:23], v[28:29]
    v_lshlrev_b32 v28, 16, v226
    v_and_b32 v29, 0xffff0000, v226
    v_pk_add_f32 v[24:25], v[24:25], v[28:29]
    v_lshlrev_b32 v28, 16, v227
    v_and_b32 v29, 0xffff0000, v227
    v_pk_add_f32 v[26:27], v[26:27], v[28:29]
    v_lshlrev_b32 v28, 16, v228
    v_and_b32 v29, 0xffff0000, v228
    v_pk_add_f32 v[20:21], v[20:21], v[28:29]
    v_lshlrev_b32 v28, 16, v229
    v_and_b32 v29, 0xffff0000, v229
    v_pk_add_f32 v[22:23], v[22:23], v[28:29]
    v_lshlrev_b32 v28, 16, v230
    v_and_b32 v29, 0xffff0000, v230
    v_pk_add_f32 v[24:25], v[24:25], v[28:29]
    v_lshlrev_b32 v28, 16, v231
    v_and_b32 v29, 0xffff0000, v231
    v_pk_add_f32 v[26:27], v[26:27], v[28:29]
    s_nop 1
    v_permlane32_swap_b32 v20, v24
    v_permlane32_swap_b32 v21, v25
    v_permlane32_swap_b32 v22, v26
    v_permlane32_swap_b32 v23, v27
    v_add_f32 v20, v20, v24
    v_add_f32 v21, v21, v25
    v_add_f32 v22, v22, v26
    v_add_f32 v23, v23, v27
    s_nop 0
    v_permlane16_swap_b32 v20, v22
    v_permlane16_swap_b32 v21, v23
    v_add_f32 v20, v20, v22
    v_add_f32 v21, v21, v23
    v_and_b32 v3, 7, v1
    v_lshrrev_b32 v4, 4, v1
    v_lshlrev_b32 v4, 3, v4
    v_lshl_add_u32 v3, v3, 5, v4
    v_add_f32_dpp v20, v20, v20 row_ror:8 row_mask:0xf bank_mask:0xf
    v_add_f32_dpp v21, v21, v21 row_ror:8 row_mask:0xf bank_mask:0xf
    s_lshl_b32 s53, s45, 4
    s_add_u32 s53, s53, s44
    s_lshl_b32 s53, s53, 10
    s_lshl_b32 s54, s47, 8
    s_min_u32 s54, s54, 640
    s_add_u32 s53, s53, s54
    s_add_u32 s53, s53, 0x28c0000
    buffer_store_dwordx2 v[20:21], v3, s[24:27], s53 offen sc1
    s_cmp_lg_u32 s47, 0
    s_cbranch_scc1 sequential_preLN__sliding_block__dense_activation_gelu__prompt_kernel_notp019
    v_and_b32 v5, 15, v1
    v_lshlrev_b32 v5, 7, v5
    s_lshl_b32 s54, s44, 11
    s_add_u32 s54, s54, 0x2940000
    s_mov_b32 s61, 0
sequential_preLN__sliding_block__dense_activation_gelu__prompt_kernel_poll20:
    buffer_load_dword v16, v5, s[24:27], s54 offen sc1
    s_waitcnt vmcnt(0)
    v_cmp_ne_u32 vcc, s50, v16
    s_cmp_eq_u64 vcc, 0
    s_cbranch_scc1 sequential_preLN__sliding_block__dense_activation_gelu__prompt_kernel_pdone21
    s_add_u32 s61, s61, 1
    s_cmp_lt_u32 s61, 32768
    s_cbranch_scc1 sequential_preLN__sliding_block__dense_activation_gelu__prompt_kernel_poll20
sequential_preLN__sliding_block__dense_activation_gelu__prompt_kernel_pdone21:
sequential_preLN__sliding_block__dense_activation_gelu__prompt_kernel_notp019:
    s_barrier
    s_add_u32 m0, s78, 0x0
    s_nop 0
    buffer_load_dwordx4 v18, s[24:27], s76 offen sc1 lds
    buffer_load_dwordx4 v18, s[24:27], s76 offen offset:1024 sc1 lds
    buffer_load_dwordx4 v18, s[24:27], s76 offen offset:2048 sc1 lds
    buffer_load_dwordx4 v18, s[24:27], s76 offen offset:3072 sc1 lds
    s_add_u32 s76, s76, 16384
    s_cmp_ge_u32 s76, s77
    s_cselect_b32 s53, 262144, 0
    s_sub_u32 s76, s76, s53
    s_add_u32 m0, s78, 0x4000
    s_nop 0
    buffer_load_dwordx4 v18, s[24:27], s76 offen sc1 lds
    buffer_load_dwordx4 v18, s[24:27], s76 offen offset:1024 sc1 lds
    buffer_load_dwordx4 v18, s[24:27], s76 offen offset:2048 sc1 lds
    buffer_load_dwordx4 v18, s[24:27], s76 offen offset:3072 sc1 lds
    s_add_u32 s76, s76, 16384
    s_cmp_ge_u32 s76, s77
    s_cselect_b32 s53, 262144, 0
    s_sub_u32 s76, s76, s53
    s_add_u32 m0, s78, 0x8000
    s_nop 0
    buffer_load_dwordx4 v18, s[24:27], s76 offen sc1 lds
    buffer_load_dwordx4 v18, s[24:27], s76 offen offset:1024 sc1 lds
    buffer_load_dwordx4 v18, s[24:27], s76 offen offset:2048 sc1 lds
    buffer_load_dwordx4 v18, s[24:27], s76 offen offset:3072 sc1 lds
    s_add_u32 s76, s76, 16384
    s_cmp_ge_u32 s76, s77
    s_cselect_b32 s53, 262144, 0
    s_sub_u32 s76, s76, s53
    s_waitcnt vmcnt(8)
    s_barrier
    s_add_u32 m0, s78, 0xc000
    s_nop 0
    buffer_load_dwordx4 v18, s[24:27], s76 offen sc1 lds
    buffer_load_dwordx4 v18, s[24:27], s76 offen offset:1024 sc1 lds
    buffer_load_dwordx4 v18, s[24:27], s76 offen offset:2048 sc1 lds
    buffer_load_dwordx4 v18, s[24:27], s76 offen offset:3072 sc1 lds
    s_add_u32 s76, s76, 16384
    s_cmp_ge_u32 s76, s77
    s_cselect_b32 s53, 262144, 0
    s_sub_u32 s76, s76, s53
    s_add_u32 m0, s78, 0x10000
    s_nop 0
    buffer_load_dwordx4 v18, s[24:27], s76 offen sc1 lds
    buffer_load_dwordx4 v18, s[24:27], s76 offen offset:1024 sc1 lds
    buffer_load_dwordx4 v18, s[24:27], s76 offen offset:2048 sc1 lds
    buffer_load_dwordx4 v18, s[24:27], s76 offen offset:3072 sc1 lds
    s_add_u32 s76, s76, 16384
    s_cmp_ge_u32 s76, s77
    s_cselect_b32 s53, 262144, 0
    s_sub_u32 s76, s76, s53
    s_waitcnt vmcnt(12)
    s_barrier
    s_add_u32 m0, s67, 0x1c000
    s_nop 0
    buffer_load_dwordx4 v14, s[12:15], s66 offen lds
    buffer_load_dwordx4 v15, s[12:15], s66 offen offset:1024 lds
    s_add_u32 s66, s66, 131072
    s_and_b32 s66, s66, 0x1fffff
    s_add_u32 m0, s78, 0x0
    s_nop 0
    buffer_load_dwordx4 v18, s[24:27], s76 offen sc1 lds
    buffer_load_dwordx4 v18, s[24:27], s76 offen offset:1024 sc1 lds
    buffer_load_dwordx4 v18, s[24:27], s76 offen offset:2048 sc1 lds
    buffer_load_dwordx4 v18, s[24:27], s76 offen offset:3072 sc1 lds
    s_add_u32 s76, s76, 16384
    s_cmp_ge_u32 s76, s77
    s_cselect_b32 s53, 262144, 0
    s_sub_u32 s76, s76, s53
    s_waitcnt vmcnt(14)
    s_barrier
    s_add_u32 m0, s67, 0x1e000
    s_nop 0
    buffer_load_dwordx4 v14, s[12:15], s66 offen lds
    buffer_load_dwordx4 v15, s[12:15], s66 offen offset:1024 lds
    s_add_u32 s66, s66, 131072
    s_and_b32 s66, s66, 0x1fffff
    s_add_u32 m0, s78, 0x4000
    s_nop 0
    buffer_load_dwordx4 v18, s[24:27], s76 offen sc1 lds
    buffer_load_dwordx4 v18, s[24:27], s76 offen offset:1024 sc1 lds
    buffer_load_dwordx4 v18, s[24:27], s76 offen offset:2048 sc1 lds
    buffer_load_dwordx4 v18, s[24:27], s76 offen offset:3072 sc1 lds
    s_add_u32 s76, s76, 16384
    s_cmp_ge_u32 s76, s77
    s_cselect_b32 s53, 262144, 0
    s_sub_u32 s76, s76, s53
    s_waitcnt vmcnt(16)
    s_barrier
    s_add_u32 m0, s67, 0x18000
    s_nop 0
    buffer_load_dwordx4 v14, s[12:15], s66 offen lds
    buffer_load_dwordx4 v15, s[12:15], s66 offen offset:1024 lds
    s_add_u32 s66, s66, 131072
    s_and_b32 s66, s66, 0x1fffff
    s_add_u32 m0, s78, 0x8000
    s_nop 0
    buffer_load_dwordx4 v18, s[24:27], s76 offen sc1 lds
    buffer_load_dwordx4 v18, s[24:27], s76 offen offset:1024 sc1 lds
    buffer_load_dwordx4 v18, s[24:27], s76 offen offset:2048 sc1 lds
    buffer_load_dwordx4 v18, s[24:27], s76 offen offset:3072 sc1 lds
    s_add_u32 s76, s76, 16384
    s_cmp_ge_u32 s76, s77
    s_cselect_b32 s53, 262144, 0
    s_sub_u32 s76, s76, s53
    s_waitcnt vmcnt(18)
    s_barrier
    s_add_u32 m0, s67, 0x1a000
    s_nop 0
    buffer_load_dwordx4 v14, s[12:15], s66 offen lds
    buffer_load_dwordx4 v15, s[12:15], s66 offen offset:1024 lds
    s_add_u32 s66, s66, 131072
    s_and_b32 s66, s66, 0x1fffff
    s_add_u32 m0, s78, 0xc000
    s_nop 0
    buffer_load_dwordx4 v18, s[24:27], s76 offen sc1 lds
    buffer_load_dwordx4 v18, s[24:27], s76 offen offset:1024 sc1 lds
    buffer_load_dwordx4 v18, s[24:27], s76 offen offset:2048 sc1 lds
    buffer_load_dwordx4 v18, s[24:27], s76 offen offset:3072 sc1 lds
    s_add_u32 s76, s76, 16384
    s_cmp_ge_u32 s76, s77
    s_cselect_b32 s53, 262144, 0
    s_sub_u32 s76, s76, s53
    s_waitcnt vmcnt(18)
    s_barrier
    s_add_u32 m0, s67, 0x14000
    s_nop 0
    buffer_load_dwordx4 v14, s[12:15], s66 offen lds
    buffer_load_dwordx4 v15, s[12:15], s66 offen offset:1024 lds
    s_add_u32 s66, s66, 131072
    s_and_b32 s66, s66, 0x1fffff
    s_add_u32 m0, s78, 0x10000
    s_nop 0
    buffer_load_dwordx4 v18, s[24:27], s76 offen sc1 lds
    buffer_load_dwordx4 v18, s[24:27], s76 offen offset:1024 sc1 lds
    buffer_load_dwordx4 v18, s[24:27], s76 offen offset:2048 sc1 lds
    buffer_load_dwordx4 v18, s[24:27], s76 offen offset:3072 sc1 lds
    s_add_u32 s76, s76, 16384
    s_cmp_ge_u32 s76, s77
    s_cselect_b32 s53, 262144, 0
    s_sub_u32 s76, s76, s53
    s_waitcnt vmcnt(18)
    s_barrier
    s_add_u32 m0, s67, 0x16000
    s_nop 0
    buffer_load_dwordx4 v14, s[12:15], s66 offen lds
    buffer_load_dwordx4 v15, s[12:15], s66 offen offset:1024 lds
    s_add_u32 s66, s66, 131072
    s_and_b32 s66, s66, 0x1fffff
    s_add_u32 m0, s78, 0x0
    s_nop 0
    buffer_load_dwordx4 v18, s[24:27], s76 offen sc1 lds
    buffer_load_dwordx4 v18, s[24:27], s76 offen offset:1024 sc1 lds
    buffer_load_dwordx4 v18, s[24:27], s76 offen offset:2048 sc1 lds
    buffer_load_dwordx4 v18, s[24:27], s76 offen offset:3072 sc1 lds
    s_add_u32 s76, s76, 16384
    s_cmp_ge_u32 s76, s77
    s_cselect_b32 s53, 262144, 0
    s_sub_u32 s76, s76, s53
    s_waitcnt vmcnt(18)
    s_barrier
    s_add_u32 m0, s67, 0x1c000
    s_nop 0
    buffer_load_dwordx4 v14, s[12:15], s66 offen lds
    buffer_load_dwordx4 v15, s[12:15], s66 offen offset:1024 lds
    s_add_u32 s66, s66, 131072
    s_and_b32 s66, s66, 0x1fffff
    s_add_u32 m0, s78, 0x4000
    s_nop 0
    buffer_load_dwordx4 v18, s[24:27], s76 offen sc1 lds
    buffer_load_dwordx4 v18, s[24:27], s76 offen offset:1024 sc1 lds
    buffer_load_dwordx4 v18, s[24:27], s76 offen offset:2048 sc1 lds
    buffer_load_dwordx4 v18, s[24:27], s76 offen offset:3072 sc1 lds
    s_add_u32 s76, s76, 16384
    s_cmp_ge_u32 s76, s77
    s_cselect_b32 s53, 262144, 0
    s_sub_u32 s76, s76, s53
    s_waitcnt vmcnt(18)
    s_barrier
    s_add_u32 m0, s67, 0x1e000
    s_nop 0
    buffer_load_dwordx4 v14, s[12:15], s66 offen lds
    buffer_load_dwordx4 v15, s[12:15], s66 offen offset:1024 lds
    s_add_u32 s66, s66, 131072
    s_and_b32 s66, s66, 0x1fffff
    s_add_u32 m0, s78, 0x8000
    s_nop 0
    buffer_load_dwordx4 v18, s[24:27], s76 offen sc1 lds
    buffer_load_dwordx4 v18, s[24:27], s76 offen offset:1024 sc1 lds
    buffer_load_dwordx4 v18, s[24:27], s76 offen offset:2048 sc1 lds
    buffer_load_dwordx4 v18, s[24:27], s76 offen offset:3072 sc1 lds
    s_add_u32 s76, s76, 16384
    s_cmp_ge_u32 s76, s77
    s_cselect_b32 s53, 262144, 0
    s_sub_u32 s76, s76, s53
    s_waitcnt vmcnt(18)
    s_barrier
    s_add_u32 m0, s67, 0x18000
    s_nop 0
    buffer_load_dwordx4 v14, s[12:15], s66 offen lds
    buffer_load_dwordx4 v15, s[12:15], s66 offen offset:1024 lds
    s_add_u32 s66, s66, 131072
    s_and_b32 s66, s66, 0x1fffff
    s_add_u32 m0, s78, 0xc000
    s_nop 0
    buffer_load_dwordx4 v18, s[24:27], s76 offen sc1 lds
    buffer_load_dwordx4 v18, s[24:27], s76 offen offset:1024 sc1 lds
    buffer_load_dwordx4 v18, s[24:27], s76 offen offset:2048 sc1 lds
    buffer_load_dwordx4 v18, s[24:27], s76 offen offset:3072 sc1 lds
    s_add_u32 s76, s76, 16384
    s_cmp_ge_u32 s76, s77
    s_cselect_b32 s53, 262144, 0
    s_sub_u32 s76, s76, s53
    s_waitcnt vmcnt(18)
    s_barrier
    s_add_u32 m0, s67, 0x1a000
    s_nop 0
    buffer_load_dwordx4 v14, s[12:15], s66 offen lds
    buffer_load_dwordx4 v15, s[12:15], s66 offen offset:1024 lds
    s_add_u32 s66, s66, 131072
    s_and_b32 s66, s66, 0x1fffff
    s_add_u32 m0, s78, 0x10000
    s_nop 0
    buffer_load_dwordx4 v18, s[24:27], s76 offen sc1 lds
    buffer_load_dwordx4 v18, s[24:27], s76 offen offset:1024 sc1 lds
    buffer_load_dwordx4 v18, s[24:27], s76 offen offset:2048 sc1 lds
    buffer_load_dwordx4 v18, s[24:27], s76 offen offset:3072 sc1 lds
    s_add_u32 s76, s76, 16384
    s_cmp_ge_u32 s76, s77
    s_cselect_b32 s53, 262144, 0
    s_sub_u32 s76, s76, s53
    s_waitcnt vmcnt(18)
    s_barrier
    s_add_u32 m0, s78, 0x0
    s_nop 0
    buffer_load_dwordx4 v18, s[24:27], s76 offen sc1 lds
    buffer_load_dwordx4 v18, s[24:27], s76 offen offset:1024 sc1 lds
    buffer_load_dwordx4 v18, s[24:27], s76 offen offset:2048 sc1 lds
    buffer_load_dwordx4 v18, s[24:27], s76 offen offset:3072 sc1 lds
    s_add_u32 s76, s76, 16384
    s_cmp_ge_u32 s76, s77
    s_cselect_b32 s53, 262144, 0
    s_sub_u32 s76, s76, s53
    v_and_b32 v5, 7, v1
    v_lshlrev_b32 v5, 7, v5
    buffer_load_dword v6, v5, s[72:75], s68 offen
    s_waitcnt vmcnt(17)
    s_barrier
    s_waitcnt vmcnt(11)
    s_barrier
    s_waitcnt vmcnt(5)
    s_barrier
    s_waitcnt vmcnt(1)
    s_barrier
    s_barrier
    s_barrier
    s_waitcnt vmcnt(0)
    v_lshrrev_b32 v4, 4, v1
    v_lshlrev_b32 v3, 1, v4
    v_xor_b32 v3, v3, v1
    v_and_b32 v3, 15, v3
    v_lshlrev_b32 v3, 4, v3
    v_lshl_add_u32 v3, v4, 11, v3
    s_lshl_b32 s53, s47, 14
    s_and_b32 s54, s45, 7
    s_lshl_b32 s55, s54, 8
    s_add_u32 s53, s53, s55
    v_add_u32 v18, s53, v3
    v_xor_b32 v19, 128, v18
    v_add_u32 v19, 7168, v19
    s_lshl_b32 s80, s47, 11
    v_add_u32 v20, s80, v2
    s_lshr_b32 s55, s45, 3
    s_lshr_b32 s53, s47, 1
    s_lshl_b32 s53, s53, 1
    s_add_u32 s53, s53, s55
    s_lshl_b32 s53, s53, 1
    s_and_b32 s56, s47, 1
    s_add_u32 s53, s53, s56
    s_lshl_b32 s81, s53, 10
    v_add_u32 v21, s81, v2
    s_mul_i32 s82, s44, 917504
    s_add_u32 s82, s82, 0x1000000
    s_and_b32 s56, s45, 3
    s_and_b32 s55, s45, 8
    s_cmp_le_u32 s56, 0
    s_addc_u32 s83, s55, 0
    s_mul_i32 s83, s83, 7
    s_cmp_le_u32 s56, 1
    s_addc_u32 s84, s55, 1
    s_mul_i32 s84, s84, 7
    s_cmp_le_u32 s56, 2
    s_addc_u32 s85, s55, 2
    s_mul_i32 s85, s85, 7
    s_cmp_le_u32 s56, 3
    s_addc_u32 s86, s55, 3
    s_cmp_le_u32 s56, 0
    s_addc_u32 s86, s86, 0
    s_mul_i32 s86, s86, 7
    s_cmp_le_u32 s56, 4
    s_addc_u32 s87, s55, 4
    s_cmp_le_u32 s56, 1
    s_addc_u32 s87, s87, 0
    s_mul_i32 s87, s87, 7
    s_cmp_le_u32 s56, 5
    s_addc_u32 s88, s55, 5
    s_cmp_le_u32 s56, 2
    s_addc_u32 s88, s88, 0
    s_mul_i32 s88, s88, 7
    s_xor_b32 s54, s54, 4
    s_mul_i32 s89, s54, 7
    s_add_u32 s90, s89, 56
    s_mul_i32 s91, s45, 7
    s_lshl_b32 s93, s44, 18
    s_add_u32 s93, s93, 0xc00000
    s_lshl_b32 s94, s47, 12
    v_add_u32 v22, s94, v2
    s_barrier
    s_cmp_lg_u32 s47, 0
    s_cbranch_scc1 sequential_preLN__sliding_block__dense_activation_gelu__prompt_kernel_notp022
    s_lshl_b32 s53, s44, 4
    s_add_u32 s53, s53, s45
    s_lshl_b32 s53, s53, 7
    s_add_u32 s53, s53, 0x2960000
    v_mov_b32 v3, 0
    v_mov_b32 v4, s50
    s_mov_b64 exec, 1
    buffer_store_dword v4, v3, s[24:27], s53 offen sc1
    s_mov_b64 exec, -1
sequential_preLN__sliding_block__dense_activation_gelu__prompt_kernel_notp022:
    s_cmp_le_u32 s45, 0
    s_cselect_b32 s69, 458752, 0
    s_add_u32 s69, s69, 0
    s_add_u32 m0, s70, 0x10000
    s_nop 0
    buffer_load_dwordx4 v7, s[16:19], s69 offen lds
    buffer_load_dwordx4 v8, s[16:19], s69 offen offset:1024 lds
    buffer_load_dwordx4 v9, s[16:19], s69 offen offset:2048 lds
    buffer_load_dwordx4 v10, s[16:19], s69 offen offset:3072 lds
    s_add_u32 m0, s70, 0x11000
    s_nop 0
    buffer_load_dwordx4 v11, s[16:19], s69 offen lds
    buffer_load_dwordx4 v12, s[16:19], s69 offen offset:1024 lds
    buffer_load_dwordx4 v13, s[16:19], s69 offen offset:2048 lds
    s_cmp_lg_u32 s47, 0
    s_cbranch_scc1 sequential_preLN__sliding_block__dense_activation_gelu__prompt_kernel_notp023
    v_and_b32 v5, 15, v1
    v_lshlrev_b32 v5, 7, v5
    s_lshl_b32 s54, s44, 11
    s_add_u32 s54, s54, 0x2960000
    s_mov_b32 s61, 0
sequential_preLN__sliding_block__dense_activation_gelu__prompt_kernel_poll24:
    buffer_load_dword v16, v5, s[24:27], s54 offen sc1
    s_waitcnt vmcnt(0)
    v_cmp_ne_u32 vcc, s50, v16
    s_cmp_eq_u64 vcc, 0
    s_cbranch_scc1 sequential_preLN__sliding_block__dense_activation_gelu__prompt_kernel_pdone25
    s_add_u32 s61, s61, 1
    s_cmp_lt_u32 s61, 32768
    s_cbranch_scc1 sequential_preLN__sliding_block__dense_activation_gelu__prompt_kernel_poll24
sequential_preLN__sliding_block__dense_activation_gelu__prompt_kernel_pdone25:
sequential_preLN__sliding_block__dense_activation_gelu__prompt_kernel_notp023:
    s_barrier
    s_cmp_le_u32 s45, 0
    s_cselect_b32 s92, 16384, 0
    s_add_u32 s92, s92, 0
    s_add_u32 s92, s92, s93
    s_add_u32 m0, s94, 0x4000
    s_nop 0
    buffer_load_dwordx4 v22, s[24:27], s92 offen sc1 lds
    buffer_load_dwordx4 v22, s[24:27], s92 offen offset:1024 sc1 lds
    buffer_load_dwordx4 v22, s[24:27], s92 offen offset:2048 sc1 lds
    buffer_load_dwordx4 v22, s[24:27], s92 offen offset:3072 sc1 lds
    s_add_u32 s92, s92, 16384
    s_cmp_le_u32 s45, 1
    s_cselect_b32 s92, 16384, 0
    s_add_u32 s92, s92, 16384
    s_add_u32 s92, s92, s93
    s_add_u32 m0, s94, 0x8000
    s_nop 0
    buffer_load_dwordx4 v22, s[24:27], s92 offen sc1 lds
    buffer_load_dwordx4 v22, s[24:27], s92 offen offset:1024 sc1 lds
    buffer_load_dwordx4 v22, s[24:27], s92 offen offset:2048 sc1 lds
    buffer_load_dwordx4 v22, s[24:27], s92 offen offset:3072 sc1 lds
    s_add_u32 s92, s92, 16384
    s_cmp_le_u32 s45, 1
    s_cselect_b32 s69, 458752, 0
    s_add_u32 s69, s69, 458752
    s_add_u32 m0, s70, 0x17000
    s_nop 0
    buffer_load_dwordx4 v7, s[16:19], s69 offen lds
    buffer_load_dwordx4 v8, s[16:19], s69 offen offset:1024 lds
    buffer_load_dwordx4 v9, s[16:19], s69 offen offset:2048 lds
    buffer_load_dwordx4 v10, s[16:19], s69 offen offset:3072 lds
    s_add_u32 m0, s70, 0x18000
    s_nop 0
    buffer_load_dwordx4 v11, s[16:19], s69 offen lds
    buffer_load_dwordx4 v12, s[16:19], s69 offen offset:1024 lds
    buffer_load_dwordx4 v13, s[16:19], s69 offen offset:2048 lds
    s_waitcnt vmcnt(11)
    s_barrier
    s_cmp_le_u32 s45, 2
    s_cselect_b32 s92, 16384, 0
    s_add_u32 s92, s92, 32768
    s_add_u32 s92, s92, s93
    s_add_u32 m0, s94, 0xc000
    s_nop 0
    buffer_load_dwordx4 v22, s[24:27], s92 offen sc1 lds
    buffer_load_dwordx4 v22, s[24:27], s92 offen offset:1024 sc1 lds
    buffer_load_dwordx4 v22, s[24:27], s92 offen offset:2048 sc1 lds
    buffer_load_dwordx4 v22, s[24:27], s92 offen offset:3072 sc1 lds
    s_add_u32 s92, s92, 16384
    s_cmp_le_u32 s45, 2
    s_cselect_b32 s69, 458752, 0
    s_add_u32 s69, s69, 917504
    s_add_u32 m0, s70, 0x20000
    s_nop 0
    buffer_load_dwordx4 v7, s[16:19], s69 offen lds
    buffer_load_dwordx4 v8, s[16:19], s69 offen offset:1024 lds
    buffer_load_dwordx4 v9, s[16:19], s69 offen offset:2048 lds
    buffer_load_dwordx4 v10, s[16:19], s69 offen offset:3072 lds
    s_add_u32 m0, s70, 0x21000
    s_nop 0
    buffer_load_dwordx4 v11, s[16:19], s69 offen lds
    buffer_load_dwordx4 v12, s[16:19], s69 offen offset:1024 lds
    buffer_load_dwordx4 v13, s[16:19], s69 offen offset:2048 lds
    s_cmp_le_u32 s45, 3
    s_cselect_b32 s92, 16384, 0
    s_add_u32 s92, s92, 49152
    s_add_u32 s92, s92, s93
    s_add_u32 m0, s94, 0x0
    s_nop 0
    buffer_load_dwordx4 v22, s[24:27], s92 offen sc1 lds
    buffer_load_dwordx4 v22, s[24:27], s92 offen offset:1024 sc1 lds
    buffer_load_dwordx4 v22, s[24:27], s92 offen offset:2048 sc1 lds
    buffer_load_dwordx4 v22, s[24:27], s92 offen offset:3072 sc1 lds
    s_add_u32 s92, s92, 16384
    s_waitcnt vmcnt(15)
    s_barrier
    s_cmp_le_u32 s45, 3
    s_cselect_b32 s69, 458752, 0
    s_add_u32 s69, s69, 1376256
    s_add_u32 m0, s70, 0x10000
    s_nop 0
    buffer_load_dwordx4 v7, s[16:19], s69 offen lds
    buffer_load_dwordx4 v8, s[16:19], s69 offen offset:1024 lds
    buffer_load_dwordx4 v9, s[16:19], s69 offen offset:2048 lds
    buffer_load_dwordx4 v10, s[16:19], s69 offen offset:3072 lds
    s_add_u32 m0, s70, 0x11000
    s_nop 0
    buffer_load_dwordx4 v11, s[16:19], s69 offen lds
    buffer_load_dwordx4 v12, s[16:19], s69 offen offset:1024 lds
    buffer_load_dwordx4 v13, s[16:19], s69 offen offset:2048 lds
    s_cmp_le_u32 s45, 4
    s_cselect_b32 s92, 16384, 0
    s_add_u32 s92, s92, 65536
    s_add_u32 s92, s92, s93
    s_add_u32 m0, s94, 0x4000
    s_nop 0
    buffer_load_dwordx4 v22, s[24:27], s92 offen sc1 lds
    buffer_load_dwordx4 v22, s[24:27], s92 offen offset:1024 sc1 lds
    buffer_load_dwordx4 v22, s[24:27], s92 offen offset:2048 sc1 lds
    buffer_load_dwordx4 v22, s[24:27], s92 offen offset:3072 sc1 lds
    s_add_u32 s92, s92, 16384
    s_waitcnt vmcnt(15)
    s_barrier
    s_cmp_le_u32 s45, 4
    s_cselect_b32 s69, 458752, 0
    s_add_u32 s69, s69, 1835008
    s_add_u32 m0, s70, 0x17000
    s_nop 0
    buffer_load_dwordx4 v7, s[16:19], s69 offen lds
    buffer_load_dwordx4 v8, s[16:19], s69 offen offset:1024 lds
    buffer_load_dwordx4 v9, s[16:19], s69 offen offset:2048 lds
    buffer_load_dwordx4 v10, s[16:19], s69 offen offset:3072 lds
    s_add_u32 m0, s70, 0x18000
    s_nop 0
    buffer_load_dwordx4 v11, s[16:19], s69 offen lds
    buffer_load_dwordx4 v12, s[16:19], s69 offen offset:1024 lds
    buffer_load_dwordx4 v13, s[16:19], s69 offen offset:2048 lds
    s_cmp_le_u32 s45, 5
    s_cselect_b32 s92, 16384, 0
    s_add_u32 s92, s92, 81920
    s_add_u32 s92, s92, s93
    s_add_u32 m0, s94, 0x8000
    s_nop 0
    buffer_load_dwordx4 v22, s[24:27], s92 offen sc1 lds
    buffer_load_dwordx4 v22, s[24:27], s92 offen offset:1024 sc1 lds
    buffer_load_dwordx4 v22, s[24:27], s92 offen offset:2048 sc1 lds
    buffer_load_dwordx4 v22, s[24:27], s92 offen offset:3072 sc1 lds
    s_add_u32 s92, s92, 16384
    s_waitcnt vmcnt(15)
    s_barrier
    s_cmp_le_u32 s45, 5
    s_cselect_b32 s69, 458752, 0
    s_add_u32 s69, s69, 2293760
    s_add_u32 m0, s70, 0x20000
    s_nop 0
    buffer_load_dwordx4 v7, s[16:19], s69 offen lds
    buffer_load_dwordx4 v8, s[16:19], s69 offen offset:1024 lds
    buffer_load_dwordx4 v9, s[16:19], s69 offen offset:2048 lds
    buffer_load_dwordx4 v10, s[16:19], s69 offen offset:3072 lds
    s_add_u32 m0, s70, 0x21000
    s_nop 0
    buffer_load_dwordx4 v11, s[16:19], s69 offen lds
    buffer_load_dwordx4 v12, s[16:19], s69 offen offset:1024 lds
    buffer_load_dwordx4 v13, s[16:19], s69 offen offset:2048 lds
    s_cmp_le_u32 s45, 6
    s_cselect_b32 s92, 16384, 0
    s_add_u32 s92, s92, 98304
    s_add_u32 s92, s92, s93
    s_add_u32 m0, s94, 0xc000
    s_nop 0
    buffer_load_dwordx4 v22, s[24:27], s92 offen sc1 lds
    buffer_load_dwordx4 v22, s[24:27], s92 offen offset:1024 sc1 lds
    buffer_load_dwordx4 v22, s[24:27], s92 offen offset:2048 sc1 lds
    buffer_load_dwordx4 v22, s[24:27], s92 offen offset:3072 sc1 lds
    s_add_u32 s92, s92, 16384
    s_waitcnt vmcnt(15)
    s_barrier
    s_cmp_le_u32 s45, 6
    s_cselect_b32 s69, 458752, 0
    s_add_u32 s69, s69, 2752512
    s_add_u32 m0, s70, 0x10000
    s_nop 0
    buffer_load_dwordx4 v7, s[16:19], s69 offen lds
    buffer_load_dwordx4 v8, s[16:19], s69 offen offset:1024 lds
    buffer_load_dwordx4 v9, s[16:19], s69 offen offset:2048 lds
    buffer_load_dwordx4 v10, s[16:19], s69 offen offset:3072 lds
    s_add_u32 m0, s70, 0x11000
    s_nop 0
    buffer_load_dwordx4 v11, s[16:19], s69 offen lds
    buffer_load_dwordx4 v12, s[16:19], s69 offen offset:1024 lds
    buffer_load_dwordx4 v13, s[16:19], s69 offen offset:2048 lds
    s_cmp_le_u32 s45, 7
    s_cselect_b32 s92, 16384, 0
    s_add_u32 s92, s92, 114688
    s_add_u32 s92, s92, s93
    s_add_u32 m0, s94, 0x0
    s_nop 0
    buffer_load_dwordx4 v22, s[24:27], s92 offen sc1 lds
    buffer_load_dwordx4 v22, s[24:27], s92 offen offset:1024 sc1 lds
    buffer_load_dwordx4 v22, s[24:27], s92 offen offset:2048 sc1 lds
    buffer_load_dwordx4 v22, s[24:27], s92 offen offset:3072 sc1 lds
    s_add_u32 s92, s92, 16384
    v_lshlrev_b32 v3, 2, v1
    v_add_u32 v3, 162816, v3
    v_mov_b32 v4, 0
    ds_write_b32 v3, v4
    s_waitcnt vmcnt(15)
    s_barrier
    s_cmp_le_u32 s45, 7
    s_cselect_b32 s69, 458752, 0
    s_add_u32 s69, s69, 3211264
    s_add_u32 m0, s70, 0x17000
    s_nop 0
    buffer_load_dwordx4 v7, s[16:19], s69 offen lds
    buffer_load_dwordx4 v8, s[16:19], s69 offen offset:1024 lds
    buffer_load_dwordx4 v9, s[16:19], s69 offen offset:2048 lds
    buffer_load_dwordx4 v10, s[16:19], s69 offen offset:3072 lds
    s_add_u32 m0, s70, 0x18000
    s_nop 0
    buffer_load_dwordx4 v11, s[16:19], s69 offen lds
    buffer_load_dwordx4 v12, s[16:19], s69 offen offset:1024 lds
    buffer_load_dwordx4 v13, s[16:19], s69 offen offset:2048 lds
    s_cmp_le_u32 s45, 8
    s_cselect_b32 s92, 16384, 0
    s_add_u32 s92, s92, 131072
    s_add_u32 s92, s92, s93
    s_add_u32 m0, s94, 0x4000
    s_nop 0
    buffer_load_dwordx4 v22, s[24:27], s92 offen sc1 lds
    buffer_load_dwordx4 v22, s[24:27], s92 offen offset:1024 sc1 lds
    buffer_load_dwordx4 v22, s[24:27], s92 offen offset:2048 sc1 lds
    buffer_load_dwordx4 v22, s[24:27], s92 offen offset:3072 sc1 lds
    s_add_u32 s92, s92, 16384
    s_waitcnt vmcnt(15)
    s_barrier
    s_cmp_le_u32 s45, 8
    s_cselect_b32 s69, 458752, 0
    s_add_u32 s69, s69, 3670016
    s_add_u32 m0, s70, 0x20000
    s_nop 0
    buffer_load_dwordx4 v7, s[16:19], s69 offen lds
    buffer_load_dwordx4 v8, s[16:19], s69 offen offset:1024 lds
    buffer_load_dwordx4 v9, s[16:19], s69 offen offset:2048 lds
    buffer_load_dwordx4 v10, s[16:19], s69 offen offset:3072 lds
    s_add_u32 m0, s70, 0x21000
    s_nop 0
    buffer_load_dwordx4 v11, s[16:19], s69 offen lds
    buffer_load_dwordx4 v12, s[16:19], s69 offen offset:1024 lds
    buffer_load_dwordx4 v13, s[16:19], s69 offen offset:2048 lds
    s_cmp_le_u32 s45, 9
    s_cselect_b32 s92, 16384, 0
    s_add_u32 s92, s92, 147456
    s_add_u32 s92, s92, s93
    s_add_u32 m0, s94, 0x8000
    s_nop 0
    buffer_load_dwordx4 v22, s[24:27], s92 offen sc1 lds
    buffer_load_dwordx4 v22, s[24:27], s92 offen offset:1024 sc1 lds
    buffer_load_dwordx4 v22, s[24:27], s92 offen offset:2048 sc1 lds
    buffer_load_dwordx4 v22, s[24:27], s92 offen offset:3072 sc1 lds
    s_add_u32 s92, s92, 16384
    s_waitcnt vmcnt(15)
    s_barrier
    s_cmp_le_u32 s45, 9
    s_cselect_b32 s69, 458752, 0
    s_add_u32 s69, s69, 4128768
    s_add_u32 m0, s70, 0x10000
    s_nop 0
    buffer_load_dwordx4 v7, s[16:19], s69 offen lds
    buffer_load_dwordx4 v8, s[16:19], s69 offen offset:1024 lds
    buffer_load_dwordx4 v9, s[16:19], s69 offen offset:2048 lds
    buffer_load_dwordx4 v10, s[16:19], s69 offen offset:3072 lds
    s_add_u32 m0, s70, 0x11000
    s_nop 0
    buffer_load_dwordx4 v11, s[16:19], s69 offen lds
    buffer_load_dwordx4 v12, s[16:19], s69 offen offset:1024 lds
    buffer_load_dwordx4 v13, s[16:19], s69 offen offset:2048 lds
    s_cmp_le_u32 s45, 10
    s_cselect_b32 s92, 16384, 0
    s_add_u32 s92, s92, 163840
    s_add_u32 s92, s92, s93
    s_add_u32 m0, s94, 0xc000
    s_nop 0
    buffer_load_dwordx4 v22, s[24:27], s92 offen sc1 lds
    buffer_load_dwordx4 v22, s[24:27], s92 offen offset:1024 sc1 lds
    buffer_load_dwordx4 v22, s[24:27], s92 offen offset:2048 sc1 lds
    buffer_load_dwordx4 v22, s[24:27], s92 offen offset:3072 sc1 lds
    s_add_u32 s92, s92, 16384
    s_waitcnt vmcnt(15)
    s_barrier
    s_cmp_le_u32 s45, 10
    s_cselect_b32 s69, 458752, 0
    s_add_u32 s69, s69, 4587520
    s_add_u32 m0, s70, 0x17000
    s_nop 0
    buffer_load_dwordx4 v7, s[16:19], s69 offen lds
    buffer_load_dwordx4 v8, s[16:19], s69 offen offset:1024 lds
    buffer_load_dwordx4 v9, s[16:19], s69 offen offset:2048 lds
    buffer_load_dwordx4 v10, s[16:19], s69 offen offset:3072 lds
    s_add_u32 m0, s70, 0x18000
    s_nop 0
    buffer_load_dwordx4 v11, s[16:19], s69 offen lds
    buffer_load_dwordx4 v12, s[16:19], s69 offen offset:1024 lds
    buffer_load_dwordx4 v13, s[16:19], s69 offen offset:2048 lds
    s_cmp_le_u32 s45, 11
    s_cselect_b32 s92, 16384, 0
    s_add_u32 s92, s92, 180224
    s_add_u32 s92, s92, s93
    s_add_u32 m0, s94, 0x0
    s_nop 0
    buffer_load_dwordx4 v22, s[24:27], s92 offen sc1 lds
    buffer_load_dwordx4 v22, s[24:27], s92 offen offset:1024 sc1 lds
    buffer_load_dwordx4 v22, s[24:27], s92 offen offset:2048 sc1 lds
    buffer_load_dwordx4 v22, s[24:27], s92 offen offset:3072 sc1 lds
    s_add_u32 s92, s92, 16384
    s_waitcnt vmcnt(15)
    s_barrier
    s_cmp_le_u32 s45, 11
    s_cselect_b32 s69, 458752, 0
    s_add_u32 s69, s69, 5046272
    s_add_u32 m0, s70, 0x20000
    s_nop 0
    buffer_load_dwordx4 v7, s[16:19], s69 offen lds
    buffer_load_dwordx4 v8, s[16:19], s69 offen offset:1024 lds
    buffer_load_dwordx4 v9, s[16:19], s69 offen offset:2048 lds
    buffer_load_dwordx4 v10, s[16:19], s69 offen offset:3072 lds
    s_add_u32 m0, s70, 0x21000
    s_nop 0
    buffer_load_dwordx4 v11, s[16:19], s69 offen lds
    buffer_load_dwordx4 v12, s[16:19], s69 offen offset:1024 lds
    buffer_load_dwordx4 v13, s[16:19], s69 offen offset:2048 lds
    s_cmp_le_u32 s45, 12
    s_cselect_b32 s92, 16384, 0
    s_add_u32 s92, s92, 196608
    s_add_u32 s92, s92, s93
    s_add_u32 m0, s94, 0x4000
    s_nop 0
    buffer_load_dwordx4 v22, s[24:27], s92 offen sc1 lds
    buffer_load_dwordx4 v22, s[24:27], s92 offen offset:1024 sc1 lds
    buffer_load_dwordx4 v22, s[24:27], s92 offen offset:2048 sc1 lds
    buffer_load_dwordx4 v22, s[24:27], s92 offen offset:3072 sc1 lds
    s_add_u32 s92, s92, 16384
    s_waitcnt vmcnt(15)
    s_barrier
    s_cmp_le_u32 s45, 12
    s_cselect_b32 s69, 458752, 0
    s_add_u32 s69, s69, 5505024
    s_add_u32 m0, s70, 0x10000
    s_nop 0
    buffer_load_dwordx4 v7, s[16:19], s69 offen lds
    buffer_load_dwordx4 v8, s[16:19], s69 offen offset:1024 lds
    buffer_load_dwordx4 v9, s[16:19], s69 offen offset:2048 lds
    buffer_load_dwordx4 v10, s[16:19], s69 offen offset:3072 lds
    s_add_u32 m0, s70, 0x11000
    s_nop 0
    buffer_load_dwordx4 v11, s[16:19], s69 offen lds
    buffer_load_dwordx4 v12, s[16:19], s69 offen offset:1024 lds
    buffer_load_dwordx4 v13, s[16:19], s69 offen offset:2048 lds
    s_cmp_le_u32 s45, 13
    s_cselect_b32 s92, 16384, 0
    s_add_u32 s92, s92, 212992
    s_add_u32 s92, s92, s93
    s_add_u32 m0, s94, 0x8000
    s_nop 0
    buffer_load_dwordx4 v22, s[24:27], s92 offen sc1 lds
    buffer_load_dwordx4 v22, s[24:27], s92 offen offset:1024 sc1 lds
    buffer_load_dwordx4 v22, s[24:27], s92 offen offset:2048 sc1 lds
    buffer_load_dwordx4 v22, s[24:27], s92 offen offset:3072 sc1 lds
    s_add_u32 s92, s92, 16384
    s_waitcnt vmcnt(15)
    s_barrier
    v_and_b32 v61, 15, v1
    v_lshlrev_b32 v56, 7, v61
    s_lshl_b32 s55, s44, 11
    v_add_u32 v56, s55, v56
    s_lshl_b32 s55, s45, 7
    v_lshl_add_u32 v57, v61, 11, s55
    v_and_b32 v64, 16, v1
    v_cmp_eq_u32 vcc, 0, v64
    s_mov_b32 s55, 0x2960000
    s_nop 0
    v_cndmask_b32 v56, v57, v56, vcc
    buffer_load_dword v62, v56, s[24:27], s55 offen sc1
    s_cmp_le_u32 s45, 13
    s_cselect_b32 s69, 458752, 0
    s_add_u32 s69, s69, 5963776
    s_add_u32 m0, s70, 0x17000
    s_nop 0
    buffer_load_dwordx4 v7, s[16:19], s69 offen lds
    buffer_load_dwordx4 v8, s[16:19], s69 offen offset:1024 lds
    buffer_load_dwordx4 v9, s[16:19], s69 offen offset:2048 lds
    buffer_load_dwordx4 v10, s[16:19], s69 offen offset:3072 lds
    s_add_u32 m0, s70, 0x18000
    s_nop 0
    buffer_load_dwordx4 v11, s[16:19], s69 offen lds
    buffer_load_dwordx4 v12, s[16:19], s69 offen offset:1024 lds
    buffer_load_dwordx4 v13, s[16:19], s69 offen offset:2048 lds
    s_cmp_le_u32 s45, 14
    s_cselect_b32 s92, 16384, 0
    s_add_u32 s92, s92, 229376
    s_add_u32 s92, s92, s93
    s_add_u32 m0, s94, 0xc000
    s_nop 0
    buffer_load_dwordx4 v22, s[24:27], s92 offen sc1 lds
    buffer_load_dwordx4 v22, s[24:27], s92 offen offset:1024 sc1 lds
    buffer_load_dwordx4 v22, s[24:27], s92 offen offset:2048 sc1 lds
    buffer_load_dwordx4 v22, s[24:27], s92 offen offset:3072 sc1 lds
    s_add_u32 s92, s92, 16384
    s_waitcnt vmcnt(16)
    s_barrier
    s_cmp_le_u32 s45, 14
    s_cselect_b32 s69, 458752, 0
    s_add_u32 s69, s69, 6422528
    s_add_u32 m0, s70, 0x20000
    s_nop 0
    buffer_load_dwordx4 v7, s[16:19], s69 offen lds
    buffer_load_dwordx4 v8, s[16:19], s69 offen offset:1024 lds
    buffer_load_dwordx4 v9, s[16:19], s69 offen offset:2048 lds
    buffer_load_dwordx4 v10, s[16:19], s69 offen offset:3072 lds
    s_add_u32 m0, s70, 0x21000
    s_nop 0
    buffer_load_dwordx4 v11, s[16:19], s69 offen lds
    buffer_load_dwordx4 v12, s[16:19], s69 offen offset:1024 lds
    buffer_load_dwordx4 v13, s[16:19], s69 offen offset:2048 lds
    v_and_b32 v5, 7, v1
    v_lshlrev_b32 v5, 7, v5
    buffer_load_dword v6, v5, s[72:75], s68 offen
    s_waitcnt vmcnt(12)
    s_barrier
    v_cmp_ne_u32 vcc, s50, v62
    s_cmp_eq_u64 vcc, 0
    s_cbranch_scc1 sequential_preLN__sliding_block__dense_activation_gelu__prompt_kernel_stok26
    s_mov_b32 s61, 0
sequential_preLN__sliding_block__dense_activation_gelu__prompt_kernel_poll27:
    buffer_load_dword v62, v56, s[24:27], s55 offen sc1
    s_waitcnt vmcnt(0)
    v_cmp_ne_u32 vcc, s50, v62
    s_cmp_eq_u64 vcc, 0
    s_cbranch_scc1 sequential_preLN__sliding_block__dense_activation_gelu__prompt_kernel_pdone28
    s_add_u32 s61, s61, 1
    s_cmp_lt_u32 s61, 32768
    s_cbranch_scc1 sequential_preLN__sliding_block__dense_activation_gelu__prompt_kernel_poll27
sequential_preLN__sliding_block__dense_activation_gelu__prompt_kernel_pdone28:
sequential_preLN__sliding_block__dense_activation_gelu__prompt_kernel_stok26:
    s_cmp_ge_u32 s47, 2
    s_cselect_b32 s53, s45, s44
    s_cselect_b32 s54, 0x40000, 0
    s_lshl_b32 s53, s53, 14
    s_add_u32 s53, s53, s54
    s_add_u32 s53, s53, 0x2880000
    s_and_b32 s54, s47, 1
    s_lshl_b32 s54, s54, 9
    s_add_u32 s53, s53, s54
    v_and_b32 v61, 31, v1
    v_lshlrev_b32 v61, 4, v61
    v_lshrrev_b32 v64, 5, v1
    v_lshl_add_u32 v61, v64, 13, v61
    buffer_load_dwordx4 v[24:27], v61, s[24:27], s53 offen offset:0 sc1
    buffer_load_dwordx4 v[28:31], v61, s[24:27], s53 offen offset:1024 sc1
    buffer_load_dwordx4 v[32:35], v61, s[24:27], s53 offen offset:2048 sc1
    buffer_load_dwordx4 v[36:39], v61, s[24:27], s53 offen offset:3072 sc1
    s_add_u32 s53, s53, 4096
    buffer_load_dwordx4 v[40:43], v61, s[24:27], s53 offen offset:0 sc1
    buffer_load_dwordx4 v[44:47], v61, s[24:27], s53 offen offset:1024 sc1
    buffer_load_dwordx4 v[48:51], v61, s[24:27], s53 offen offset:2048 sc1
    buffer_load_dwordx4 v[52:55], v61, s[24:27], s53 offen offset:3072 sc1
    v_and_b32 v61, 31, v1
    v_lshl_add_u32 v61, v61, 1, v64
    s_mul_i32 s53, s45, 448
    s_lshr_b32 s54, s54, 1
    s_add_u32 s53, s53, s54
    v_lshlrev_b32 v64, 2, v61
    buffer_load_dword v62, v64, s[36:39], s53 offen
    s_add_u32 s79, s91, 0
    s_lshl_b32 s79, s79, 16
    s_add_u32 m0, s80, 0x0
    s_nop 0
    buffer_load_dwordx4 v18, s[20:23], s79 offen lds
    buffer_load_dwordx4 v19, s[20:23], s79 offen offset:1024 lds
    s_add_u32 s79, s91, 1
    s_lshl_b32 s79, s79, 16
    s_add_u32 m0, s80, 0x2000
    s_nop 0
    buffer_load_dwordx4 v18, s[20:23], s79 offen lds
    buffer_load_dwordx4 v19, s[20:23], s79 offen offset:1024 lds
    s_waitcnt vmcnt(14)
    s_barrier
    s_add_u32 s79, s91, 2
    s_lshl_b32 s79, s79, 16
    s_add_u32 m0, s80, 0x4000
    s_nop 0
    buffer_load_dwordx4 v18, s[20:23], s79 offen lds
    buffer_load_dwordx4 v19, s[20:23], s79 offen offset:1024 lds
    s_add_u32 s79, s91, 3
    s_lshl_b32 s79, s79, 16
    s_add_u32 m0, s80, 0x6000
    s_nop 0
    buffer_load_dwordx4 v18, s[20:23], s79 offen lds
    buffer_load_dwordx4 v19, s[20:23], s79 offen offset:1024 lds
    s_add_u32 s79, s91, 4
    s_lshl_b32 s79, s79, 16
    s_add_u32 m0, s80, 0x8000
    s_nop 0
    buffer_load_dwordx4 v18, s[20:23], s79 offen lds
    buffer_load_dwordx4 v19, s[20:23], s79 offen offset:1024 lds
    s_add_u32 s79, s91, 5
    s_lshl_b32 s79, s79, 16
    s_add_u32 m0, s80, 0xa000
    s_nop 0
    buffer_load_dwordx4 v18, s[20:23], s79 offen lds
    buffer_load_dwordx4 v19, s[20:23], s79 offen offset:1024 lds
    v_min_u32 v3, 41, v1
    v_lshlrev_b32 v3, 7, v3
    s_mul_i32 s53, s49, 4
    s_add_u32 s53, s53, s47
    s_mul_i32 s53, s53, 5376
    s_add_u32 s53, s53, 1835008
    buffer_load_dword v6, v3, s[20:23], s53 offen
    s_barrier
    s_waitcnt vmcnt(13)
    v_pk_add_f32 v[24:25], v[24:25], v[40:41]
    v_pk_add_f32 v[26:27], v[26:27], v[42:43]
    v_pk_add_f32 v[28:29], v[28:29], v[44:45]
    v_pk_add_f32 v[30:31], v[30:31], v[46:47]
    v_pk_add_f32 v[32:33], v[32:33], v[48:49]
    v_pk_add_f32 v[34:35], v[34:35], v[50:51]
    v_pk_add_f32 v[36:37], v[36:37], v[52:53]
    v_pk_add_f32 v[38:39], v[38:39], v[54:55]
    v_pk_add_f32 v[24:25], v[24:25], v[32:33]
    v_pk_add_f32 v[26:27], v[26:27], v[34:35]
    v_pk_add_f32 v[28:29], v[28:29], v[36:37]
    v_pk_add_f32 v[30:31], v[30:31], v[38:39]
    v_pk_add_f32 v[24:25], v[24:25], v[28:29]
    v_pk_add_f32 v[26:27], v[26:27], v[30:31]
    s_and_b32 s54, s47, 1
    s_nop 0
    v_permlane32_swap_b32 v24, v26
    v_permlane32_swap_b32 v25, v27
    v_pk_add_f32 v[24:25], v[24:25], v[26:27]
    s_cmp_ge_u32 s47, 2
    s_cbranch_scc1 sequential_preLN__sliding_block__dense_activation_gelu__prompt_kernel_cols29
    v_mul_f32 v24, 0x3a800000, v24
    v_mul_f32 v25, 0x3a800000, v25
    v_fma_f32 v25, -v24, v24, v25
    v_max_f32 v25, 0, v25
    v_add_f32 v25, 0x3727c5ac, v25
    v_rsq_f32 v25, v25
    s_lshl_b32 s54, s54, 8
    s_add_u32 s54, s54, 159744
    v_mul_f32 v24, v24, v25
    v_lshl_add_u32 v61, v61, 2, s54
    ds_write_b32 v61, v25
    ds_write_b32 v61, v24 offset:512
    s_branch sequential_preLN__sliding_block__dense_activation_gelu__prompt_kernel_tabs30
sequential_preLN__sliding_block__dense_activation_gelu__prompt_kernel_cols29:
    s_lshl_b32 s54, s54, 9
    s_add_u32 s54, s54, 160768
    v_lshl_add_u32 v61, v61, 3, s54
    ds_write_b64 v61, v[24:25]
    v_lshlrev_b32 v26, 16, v62
    v_and_b32 v27, 0xffff0000, v62
    ds_write_b64 v61, v[26:27] offset:1024
sequential_preLN__sliding_block__dense_activation_gelu__prompt_kernel_tabs30:
    s_waitcnt lgkmcnt(0)
    s_barrier
    s_add_u32 s79, s91, 6
    s_lshl_b32 s79, s79, 16
    s_add_u32 m0, s80, 0xc000
    s_nop 0
    buffer_load_dwordx4 v18, s[20:23], s79 offen lds
    buffer_load_dwordx4 v19, s[20:23], s79 offen offset:1024 lds
    s_add_u32 s79, s83, 0
    s_lshl_b32 s79, s79, 16
    s_add_u32 m0, s80, 0x1e000
    s_nop 0
    buffer_load_dwordx4 v18, s[20:23], s79 offen lds
    buffer_load_dwordx4 v19, s[20:23], s79 offen offset:1024 lds
    s_add_u32 s79, s83, 1
    s_lshl_b32 s79, s79, 16
    s_add_u32 m0, s80, 0x20000
    s_nop 0
    buffer_load_dwordx4 v18, s[20:23], s79 offen lds
    buffer_load_dwordx4 v19, s[20:23], s79 offen offset:1024 lds
    s_add_u32 s79, s83, 2
    s_lshl_b32 s79, s79, 16
    s_add_u32 m0, s80, 0x22000
    s_nop 0
    buffer_load_dwordx4 v18, s[20:23], s79 offen lds
    buffer_load_dwordx4 v19, s[20:23], s79 offen offset:1024 lds
    s_add_u32 s79, s83, 3
    s_lshl_b32 s79, s79, 16
    s_add_u32 m0, s80, 0x24000
    s_nop 0
    buffer_load_dwordx4 v18, s[20:23], s79 offen lds
    buffer_load_dwordx4 v19, s[20:23], s79 offen offset:1024 lds
    s_or_b32 s53, s49, s47
    s_cmp_lg_u32 s53, 0
    s_cbranch_scc1 sequential_preLN__sliding_block__dense_activation_gelu__prompt_kernel_noep31
    v_mov_b32 v3, 0
    v_mov_b32 v4, s50
    s_mov_b32 s53, 0x29f0000
    s_mov_b64 exec, 1
    buffer_store_dword v4, v3, s[24:27], s53 offen sc1
    s_mov_b64 exec, -1
sequential_preLN__sliding_block__dense_activation_gelu__prompt_kernel_noep31:
    s_and_b32 s53, s47, 1
    s_lshl_b32 s53, s53, 15
    s_lshr_b32 s54, s47, 1
    s_lshl_b32 s54, s54, 12
    s_add_u32 s53, s53, s54
    s_lshl_b32 s56, s91, 13
    s_add_u32 s56, s56, s82
    s_add_u32 s55, s56, s53
    s_add_u32 s53, s53, 65536
    v_add_u32 v56, s53, v2
    s_add_u32 s56, s56, s80
    s_add_u32 s56, s56, 24576
    v_add_u32 v57, 90112, v20
    s_lshl_b32 s53, s47, 2
    s_add_u32 s53, s53, 162816
    v_mov_b32 v58, s53
    v_and_b32 v59, 3, v1
    v_lshlrev_b32 v59, 2, v59
    v_add_u32 v59, 162816, v59
    s_mov_b32 s61, 0
sequential_preLN__sliding_block__dense_activation_gelu__prompt_kernel_lw32:
    ds_read_b32 v3, v59
    s_waitcnt lgkmcnt(0)
    v_cmp_gt_u32 vcc, 1, v3
    s_cmp_eq_u64 vcc, 0
    s_cbranch_scc1 sequential_preLN__sliding_block__dense_activation_gelu__prompt_kernel_lwd33
    s_sleep 2
    s_add_u32 s61, s61, 1
    s_cmp_lt_u32 s61, 262144
    s_cbranch_scc1 sequential_preLN__sliding_block__dense_activation_gelu__prompt_kernel_lw32
sequential_preLN__sliding_block__dense_activation_gelu__prompt_kernel_lwd33:
    ds_read_b128 v[48:51], v57 offset:0
    ds_read_b128 v[52:55], v57 offset:1024
    s_waitcnt lgkmcnt(1)
    buffer_store_dwordx4 v[48:51], v2, s[24:27], s56 offen offset:0 sc1
    s_waitcnt lgkmcnt(0)
    buffer_store_dwordx4 v[52:55], v2, s[24:27], s56 offen offset:1024 sc1
    s_mov_b32 s61, 0
sequential_preLN__sliding_block__dense_activation_gelu__prompt_kernel_lw34:
    ds_read_b32 v3, v58
    s_waitcnt lgkmcnt(0)
    v_cmp_gt_u32 vcc, 3, v3
    s_cmp_eq_u64 vcc, 0
    s_cbranch_scc1 sequential_preLN__sliding_block__dense_activation_gelu__prompt_kernel_lwd35
    s_sleep 2
    s_add_u32 s61, s61, 1
    s_cmp_lt_u32 s61, 262144
    s_cbranch_scc1 sequential_preLN__sliding_block__dense_activation_gelu__prompt_kernel_lw34
sequential_preLN__sliding_block__dense_activation_gelu__prompt_kernel_lwd35:
    ds_read_b128 v[24:27], v56 offset:0
    ds_read_b128 v[28:31], v56 offset:1024
    s_waitcnt lgkmcnt(1)
    buffer_store_dwordx4 v[24:27], v2, s[24:27], s55 offen offset:0 sc1
    s_waitcnt lgkmcnt(0)
    buffer_store_dwordx4 v[28:31], v2, s[24:27], s55 offen offset:1024 sc1
    s_mov_b32 s61, 0
sequential_preLN__sliding_block__dense_activation_gelu__prompt_kernel_lw36:
    ds_read_b32 v3, v58
    s_waitcnt lgkmcnt(0)
    v_cmp_gt_u32 vcc, 5, v3
    s_cmp_eq_u64 vcc, 0
    s_cbranch_scc1 sequential_preLN__sliding_block__dense_activation_gelu__prompt_kernel_lwd37
    s_sleep 2
    s_add_u32 s61, s61, 1
    s_cmp_lt_u32 s61, 262144
    s_cbranch_scc1 sequential_preLN__sliding_block__dense_activation_gelu__prompt_kernel_lw36
sequential_preLN__sliding_block__dense_activation_gelu__prompt_kernel_lwd37:
    ds_read_b128 v[32:35], v56 offset:2048
    ds_read_b128 v[36:39], v56 offset:3072
    s_waitcnt lgkmcnt(1)
    buffer_store_dwordx4 v[32:35], v2, s[24:27], s55 offen offset:2048 sc1
    s_waitcnt lgkmcnt(0)
    buffer_store_dwordx4 v[36:39], v2, s[24:27], s55 offen offset:3072 sc1
    s_add_u32 s55, s55, 8192
    s_waitcnt vmcnt(14)
    v_mov_b32 v4, 13
    ds_write_b32 v58, v4 offset:16
    s_mov_b32 s61, 0
sequential_preLN__sliding_block__dense_activation_gelu__prompt_kernel_lw38:
    ds_read_b32 v3, v58
    s_waitcnt lgkmcnt(0)
    v_cmp_gt_u32 vcc, 7, v3
    s_cmp_eq_u64 vcc, 0
    s_cbranch_scc1 sequential_preLN__sliding_block__dense_activation_gelu__prompt_kernel_lwd39
    s_sleep 2
    s_add_u32 s61, s61, 1
    s_cmp_lt_u32 s61, 262144
    s_cbranch_scc1 sequential_preLN__sliding_block__dense_activation_gelu__prompt_kernel_lw38
sequential_preLN__sliding_block__dense_activation_gelu__prompt_kernel_lwd39:
    ds_read_b128 v[40:43], v56 offset:8192
    ds_read_b128 v[44:47], v56 offset:9216
    s_waitcnt lgkmcnt(1)
    buffer_store_dwordx4 v[40:43], v2, s[24:27], s55 offen offset:0 sc1
    s_waitcnt lgkmcnt(0)
    buffer_store_dwordx4 v[44:47], v2, s[24:27], s55 offen offset:1024 sc1
    s_mov_b32 s61, 0
sequential_preLN__sliding_block__dense_activation_gelu__prompt_kernel_lw40:
    ds_read_b32 v3, v58
    s_waitcnt lgkmcnt(0)
    v_cmp_gt_u32 vcc, 9, v3
    s_cmp_eq_u64 vcc, 0
    s_cbranch_scc1 sequential_preLN__sliding_block__dense_activation_gelu__prompt_kernel_lwd41
    s_sleep 2
    s_add_u32 s61, s61, 1
    s_cmp_lt_u32 s61, 262144
    s_cbranch_scc1 sequential_preLN__sliding_block__dense_activation_gelu__prompt_kernel_lw40
sequential_preLN__sliding_block__dense_activation_gelu__prompt_kernel_lwd41:
    ds_read_b128 v[24:27], v56 offset:10240
    ds_read_b128 v[28:31], v56 offset:11264
    s_waitcnt lgkmcnt(1)
    buffer_store_dwordx4 v[24:27], v2, s[24:27], s55 offen offset:2048 sc1
    s_waitcnt lgkmcnt(0)
    buffer_store_dwordx4 v[28:31], v2, s[24:27], s55 offen offset:3072 sc1
    s_add_u32 s55, s55, 8192
    s_mov_b32 s61, 0
sequential_preLN__sliding_block__dense_activation_gelu__prompt_kernel_lw42:
    ds_read_b32 v3, v58
    s_waitcnt lgkmcnt(0)
    v_cmp_gt_u32 vcc, 10, v3
    s_cmp_eq_u64 vcc, 0
    s_cbranch_scc1 sequential_preLN__sliding_block__dense_activation_gelu__prompt_kernel_lwd43
    s_sleep 2
    s_add_u32 s61, s61, 1
    s_cmp_lt_u32 s61, 262144
    s_cbranch_scc1 sequential_preLN__sliding_block__dense_activation_gelu__prompt_kernel_lw42
sequential_preLN__sliding_block__dense_activation_gelu__prompt_kernel_lwd43:
    ds_read_b128 v[32:35], v56 offset:16384
    s_waitcnt lgkmcnt(0)
    buffer_store_dwordx4 v[32:35], v2, s[24:27], s55 offen offset:0 sc1
    s_mov_b32 s61, 0
sequential_preLN__sliding_block__dense_activation_gelu__prompt_kernel_lw44:
    ds_read_b32 v3, v58
    s_waitcnt lgkmcnt(0)
    v_cmp_gt_u32 vcc, 11, v3
    s_cmp_eq_u64 vcc, 0
    s_cbranch_scc1 sequential_preLN__sliding_block__dense_activation_gelu__prompt_kernel_lwd45
    s_sleep 2
    s_add_u32 s61, s61, 1
    s_cmp_lt_u32 s61, 262144
    s_cbranch_scc1 sequential_preLN__sliding_block__dense_activation_gelu__prompt_kernel_lw44
sequential_preLN__sliding_block__dense_activation_gelu__prompt_kernel_lwd45:
    ds_read_b128 v[36:39], v56 offset:17408
    s_waitcnt lgkmcnt(0)
    buffer_store_dwordx4 v[36:39], v2, s[24:27], s55 offen offset:1024 sc1
    s_mov_b32 s61, 0
sequential_preLN__sliding_block__dense_activation_gelu__prompt_kernel_lw46:
    ds_read_b32 v3, v58
    s_waitcnt lgkmcnt(0)
    v_cmp_gt_u32 vcc, 12, v3
    s_cmp_eq_u64 vcc, 0
    s_cbranch_scc1 sequential_preLN__sliding_block__dense_activation_gelu__prompt_kernel_lwd47
    s_add_u32 s61, s61, 1
    s_cmp_lt_u32 s61, 262144
    s_cbranch_scc1 sequential_preLN__sliding_block__dense_activation_gelu__prompt_kernel_lw46
sequential_preLN__sliding_block__dense_activation_gelu__prompt_kernel_lwd47:
    ds_read_b128 v[40:43], v56 offset:18432
    s_waitcnt lgkmcnt(0)
    buffer_store_dwordx4 v[40:43], v2, s[24:27], s55 offen offset:2048 sc1
    s_mov_b32 s61, 0
sequential_preLN__sliding_block__dense_activation_gelu__prompt_kernel_lw48:
    ds_read_b32 v3, v58
    s_waitcnt lgkmcnt(0)
    v_cmp_gt_u32 vcc, 13, v3
    s_cmp_eq_u64 vcc, 0
    s_cbranch_scc1 sequential_preLN__sliding_block__dense_activation_gelu__prompt_kernel_lwd49
    s_add_u32 s61, s61, 1
    s_cmp_lt_u32 s61, 262144
    s_cbranch_scc1 sequential_preLN__sliding_block__dense_activation_gelu__prompt_kernel_lw48
sequential_preLN__sliding_block__dense_activation_gelu__prompt_kernel_lwd49:
    ds_read_b128 v[44:47], v56 offset:19456
    s_waitcnt lgkmcnt(0)
    buffer_store_dwordx4 v[44:47], v2, s[24:27], s55 offen offset:3072 sc1
    s_add_u32 s55, s55, 8192
    s_waitcnt vmcnt(0)
    v_mov_b32 v4, 14
    ds_write_b32 v58, v4 offset:16
    s_cmp_lg_u32 s47, 0
    s_cbranch_scc1 sequential_preLN__sliding_block__dense_activation_gelu__prompt_kernel_notp050
    v_add_u32 v59, 16, v59
    s_mov_b32 s61, 0
sequential_preLN__sliding_block__dense_activation_gelu__prompt_kernel_lw51:
    ds_read_b32 v3, v59
    s_waitcnt lgkmcnt(0)
    v_cmp_gt_u32 vcc, 14, v3
    s_cmp_eq_u64 vcc, 0
    s_cbranch_scc1 sequential_preLN__sliding_block__dense_activation_gelu__prompt_kernel_lwd52
    s_add_u32 s61, s61, 1
    s_cmp_lt_u32 s61, 262144
    s_cbranch_scc1 sequential_preLN__sliding_block__dense_activation_gelu__prompt_kernel_lw51
sequential_preLN__sliding_block__dense_activation_gelu__prompt_kernel_lwd52:
    s_lshl_b32 s53, s44, 4
    s_add_u32 s53, s53, s45
    s_lshl_b32 s53, s53, 7
    s_add_u32 s53, s53, 0x2980000
    v_mov_b32 v3, 0
    v_mov_b32 v4, s50
    s_mov_b64 exec, 1
    buffer_store_dword v4, v3, s[24:27], s53 offen sc1
    s_mov_b64 exec, -1
sequential_preLN__sliding_block__dense_activation_gelu__prompt_kernel_notp050:
    v_and_b32 v56, 7, v1
    v_lshlrev_b32 v56, 2, v56
    v_add_u32 v56, 162816, v56
    s_mov_b32 s61, 0
sequential_preLN__sliding_block__dense_activation_gelu__prompt_kernel_lw53:
    ds_read_b32 v3, v56
    s_waitcnt lgkmcnt(0)
    v_cmp_gt_u32 vcc, 14, v3
    s_cmp_eq_u64 vcc, 0
    s_cbranch_scc1 sequential_preLN__sliding_block__dense_activation_gelu__prompt_kernel_lwd54
    s_sleep 1
    s_add_u32 s61, s61, 1
    s_cmp_lt_u32 s61, 262144
    s_cbranch_scc1 sequential_preLN__sliding_block__dense_activation_gelu__prompt_kernel_lw53
sequential_preLN__sliding_block__dense_activation_gelu__prompt_kernel_lwd54:
    s_add_u32 s79, s83, 4
    s_lshl_b32 s79, s79, 16
    s_add_u32 m0, s80, 0x14000
    s_nop 0
    buffer_load_dwordx4 v18, s[20:23], s79 offen lds
    buffer_load_dwordx4 v19, s[20:23], s79 offen offset:1024 lds
    s_add_u32 s79, s83, 5
    s_lshl_b32 s79, s79, 16
    s_add_u32 m0, s80, 0x16000
    s_nop 0
    buffer_load_dwordx4 v18, s[20:23], s79 offen lds
    buffer_load_dwordx4 v19, s[20:23], s79 offen offset:1024 lds
    s_add_u32 s79, s83, 6
    s_lshl_b32 s79, s79, 16
    s_add_u32 m0, s80, 0x18000
    s_nop 0
    buffer_load_dwordx4 v18, s[20:23], s79 offen lds
    buffer_load_dwordx4 v19, s[20:23], s79 offen offset:1024 lds
    s_add_u32 s79, s84, 0
    s_lshl_b32 s79, s79, 16
    s_add_u32 m0, s80, 0x1a000
    s_nop 0
    buffer_load_dwordx4 v18, s[20:23], s79 offen lds
    buffer_load_dwordx4 v19, s[20:23], s79 offen offset:1024 lds
    s_cmp_lg_u32 s47, 0
    s_cbranch_scc1 sequential_preLN__sliding_block__dense_activation_gelu__prompt_kernel_notp055
    v_and_b32 v5, 15, v1
    v_lshlrev_b32 v5, 7, v5
    s_lshl_b32 s54, s44, 11
    s_add_u32 s54, s54, 0x2980000
    s_mov_b32 s61, 0
sequential_preLN__sliding_block__dense_activation_gelu__prompt_kernel_poll56:
    buffer_load_dword v16, v5, s[24:27], s54 offen sc1
    s_waitcnt vmcnt(0)
    v_cmp_ne_u32 vcc, s50, v16
    s_cmp_eq_u64 vcc, 0
    s_cbranch_scc1 sequential_preLN__sliding_block__dense_activation_gelu__prompt_kernel_pdone57
    s_add_u32 s61, s61, 1
    s_cmp_lt_u32 s61, 32768
    s_cbranch_scc1 sequential_preLN__sliding_block__dense_activation_gelu__prompt_kernel_poll56
sequential_preLN__sliding_block__dense_activation_gelu__prompt_kernel_pdone57:
sequential_preLN__sliding_block__dense_activation_gelu__prompt_kernel_notp055:
    s_barrier
    s_add_u32 s79, s83, 0
    s_lshl_b32 s79, s79, 13
    s_add_u32 s79, s79, s82
    s_add_u32 m0, s80, 0x0
    s_nop 0
    buffer_load_dwordx4 v20, s[24:27], s79 offen sc1 lds
    buffer_load_dwordx4 v20, s[24:27], s79 offen offset:1024 sc1 lds
    s_add_u32 s79, s83, 1
    s_lshl_b32 s79, s79, 13
    s_add_u32 s79, s79, s82
    s_add_u32 m0, s80, 0x2000
    s_nop 0
    buffer_load_dwordx4 v20, s[24:27], s79 offen sc1 lds
    buffer_load_dwordx4 v20, s[24:27], s79 offen offset:1024 sc1 lds
    s_add_u32 s79, s83, 2
    s_lshl_b32 s79, s79, 13
    s_add_u32 s79, s79, s82
    s_add_u32 m0, s80, 0x4000
    s_nop 0
    buffer_load_dwordx4 v20, s[24:27], s79 offen sc1 lds
    buffer_load_dwordx4 v20, s[24:27], s79 offen offset:1024 sc1 lds
    s_add_u32 s79, s83, 3
    s_lshl_b32 s79, s79, 13
    s_add_u32 s79, s79, s82
    s_add_u32 m0, s80, 0x6000
    s_nop 0
    buffer_load_dwordx4 v20, s[24:27], s79 offen sc1 lds
    buffer_load_dwordx4 v20, s[24:27], s79 offen offset:1024 sc1 lds
    s_add_u32 s79, s83, 4
    s_lshl_b32 s79, s79, 13
    s_add_u32 s79, s79, s82
    s_add_u32 m0, s80, 0x8000
    s_nop 0
    buffer_load_dwordx4 v20, s[24:27], s79 offen sc1 lds
    buffer_load_dwordx4 v20, s[24:27], s79 offen offset:1024 sc1 lds
    s_add_u32 s79, s83, 5
    s_lshl_b32 s79, s79, 13
    s_add_u32 s79, s79, s82
    s_add_u32 m0, s80, 0xa000
    s_nop 0
    buffer_load_dwordx4 v20, s[24:27], s79 offen sc1 lds
    buffer_load_dwordx4 v20, s[24:27], s79 offen offset:1024 sc1 lds
    s_waitcnt vmcnt(8)
    s_barrier
    s_add_u32 s79, s83, 6
    s_lshl_b32 s79, s79, 13
    s_add_u32 s79, s79, s82
    s_add_u32 m0, s80, 0xc000
    s_nop 0
    buffer_load_dwordx4 v20, s[24:27], s79 offen sc1 lds
    buffer_load_dwordx4 v20, s[24:27], s79 offen offset:1024 sc1 lds
    s_add_u32 s79, s84, 0
    s_lshl_b32 s79, s79, 13
    s_add_u32 s79, s79, s82
    s_add_u32 m0, s80, 0xe000
    s_nop 0
    buffer_load_dwordx4 v20, s[24:27], s79 offen sc1 lds
    buffer_load_dwordx4 v20, s[24:27], s79 offen offset:1024 sc1 lds
    s_add_u32 s79, s84, 1
    s_lshl_b32 s79, s79, 13
    s_add_u32 s79, s79, s82
    s_add_u32 m0, s80, 0x10000
    s_nop 0
    buffer_load_dwordx4 v20, s[24:27], s79 offen sc1 lds
    buffer_load_dwordx4 v20, s[24:27], s79 offen offset:1024 sc1 lds
    s_add_u32 s79, s84, 2
    s_lshl_b32 s79, s79, 13
    s_add_u32 s79, s79, s82
    s_add_u32 m0, s80, 0x12000
    s_nop 0
    buffer_load_dwordx4 v20, s[24:27], s79 offen sc1 lds
    buffer_load_dwordx4 v20, s[24:27], s79 offen offset:1024 sc1 lds
    s_waitcnt vmcnt(12)
    s_barrier
    s_add_u32 s79, s84, 1
    s_lshl_b32 s79, s79, 16
    s_add_u32 m0, s80, 0x1e000
    s_nop 0
    buffer_load_dwordx4 v18, s[20:23], s79 offen lds
    buffer_load_dwordx4 v19, s[20:23], s79 offen offset:1024 lds
    s_add_u32 s79, s84, 2
    s_lshl_b32 s79, s79, 16
    s_add_u32 m0, s80, 0x20000
    s_nop 0
    buffer_load_dwordx4 v18, s[20:23], s79 offen lds
    buffer_load_dwordx4 v19, s[20:23], s79 offen offset:1024 lds
    s_add_u32 s79, s84, 3
    s_lshl_b32 s79, s79, 13
    s_add_u32 s79, s79, s82
    s_add_u32 m0, s80, 0x0
    s_nop 0
    buffer_load_dwordx4 v20, s[24:27], s79 offen sc1 lds
    buffer_load_dwordx4 v20, s[24:27], s79 offen offset:1024 sc1 lds
    s_add_u32 s79, s84, 4
    s_lshl_b32 s79, s79, 13
    s_add_u32 s79, s79, s82
    s_add_u32 m0, s80, 0x2000
    s_nop 0
    buffer_load_dwordx4 v20, s[24:27], s79 offen sc1 lds
    buffer_load_dwordx4 v20, s[24:27], s79 offen offset:1024 sc1 lds
    s_waitcnt vmcnt(16)
    s_barrier
    s_add_u32 s79, s84, 3
    s_lshl_b32 s79, s79, 16
    s_add_u32 m0, s80, 0x22000
    s_nop 0
    buffer_load_dwordx4 v18, s[20:23], s79 offen lds
    buffer_load_dwordx4 v19, s[20:23], s79 offen offset:1024 lds
    s_add_u32 s79, s84, 4
    s_lshl_b32 s79, s79, 16
    s_add_u32 m0, s80, 0x24000
    s_nop 0
    buffer_load_dwordx4 v18, s[20:23], s79 offen lds
    buffer_load_dwordx4 v19, s[20:23], s79 offen offset:1024 lds
    s_add_u32 s79, s84, 5
    s_lshl_b32 s79, s79, 13
    s_add_u32 s79, s79, s82
    s_add_u32 m0, s80, 0x4000
    s_nop 0
    buffer_load_dwordx4 v20, s[24:27], s79 offen sc1 lds
    buffer_load_dwordx4 v20, s[24:27], s79 offen offset:1024 sc1 lds
    s_add_u32 s79, s84, 6
    s_lshl_b32 s79, s79, 13
    s_add_u32 s79, s79, s82
    s_add_u32 m0, s80, 0x6000
    s_nop 0
    buffer_load_dwordx4 v20, s[24:27], s79 offen sc1 lds
    buffer_load_dwordx4 v20, s[24:27], s79 offen offset:1024 sc1 lds
    s_waitcnt vmcnt(20)
    s_barrier
    s_add_u32 s79, s84, 5
    s_lshl_b32 s79, s79, 16
    s_add_u32 m0, s80, 0x14000
    s_nop 0
    buffer_load_dwordx4 v18, s[20:23], s79 offen lds
    buffer_load_dwordx4 v19, s[20:23], s79 offen offset:1024 lds
    s_add_u32 s79, s84, 6
    s_lshl_b32 s79, s79, 16
    s_add_u32 m0, s80, 0x16000
    s_nop 0
    buffer_load_dwordx4 v18, s[20:23], s79 offen lds
    buffer_load_dwordx4 v19, s[20:23], s79 offen offset:1024 lds
    s_add_u32 s79, s85, 0
    s_lshl_b32 s79, s79, 13
    s_add_u32 s79, s79, s82
    s_add_u32 m0, s80, 0x8000
    s_nop 0
    buffer_load_dwordx4 v20, s[24:27], s79 offen sc1 lds
    buffer_load_dwordx4 v20, s[24:27], s79 offen offset:1024 sc1 lds
    s_add_u32 s79, s85, 1
    s_lshl_b32 s79, s79, 13
    s_add_u32 s79, s79, s82
    s_add_u32 m0, s80, 0xa000
    s_nop 0
    buffer_load_dwordx4 v20, s[24:27], s79 offen sc1 lds
    buffer_load_dwordx4 v20, s[24:27], s79 offen offset:1024 sc1 lds
    s_waitcnt vmcnt(20)
    s_barrier
    s_add_u32 s79, s85, 0
    s_lshl_b32 s79, s79, 16
    s_add_u32 m0, s80, 0x18000
    s_nop 0
    buffer_load_dwordx4 v18, s[20:23], s79 offen lds
    buffer_load_dwordx4 v19, s[20:23], s79 offen offset:1024 lds
    s_add_u32 s79, s85, 1
    s_lshl_b32 s79, s79, 16
    s_add_u32 m0, s80, 0x1a000
    s_nop 0
    buffer_load_dwordx4 v18, s[20:23], s79 offen lds
    buffer_load_dwordx4 v19, s[20:23], s79 offen offset:1024 lds
    s_add_u32 s79, s85, 2
    s_lshl_b32 s79, s79, 13
    s_add_u32 s79, s79, s82
    s_add_u32 m0, s80, 0xc000
    s_nop 0
    buffer_load_dwordx4 v20, s[24:27], s79 offen sc1 lds
    buffer_load_dwordx4 v20, s[24:27], s79 offen offset:1024 sc1 lds
    s_add_u32 s79, s85, 3
    s_lshl_b32 s79, s79, 13
    s_add_u32 s79, s79, s82
    s_add_u32 m0, s80, 0xe000
    s_nop 0
    buffer_load_dwordx4 v20, s[24:27], s79 offen sc1 lds
    buffer_load_dwordx4 v20, s[24:27], s79 offen offset:1024 sc1 lds
    s_waitcnt vmcnt(20)
    s_barrier
    s_add_u32 s79, s85, 2
    s_lshl_b32 s79, s79, 16
    s_add_u32 m0, s80, 0x1e000
    s_nop 0
    buffer_load_dwordx4 v18, s[20:23], s79 offen lds
    buffer_load_dwordx4 v19, s[20:23], s79 offen offset:1024 lds
    s_add_u32 s79, s85, 3
    s_lshl_b32 s79, s79, 16
    s_add_u32 m0, s80, 0x20000
    s_nop 0
    buffer_load_dwordx4 v18, s[20:23], s79 offen lds
    buffer_load_dwordx4 v19, s[20:23], s79 offen offset:1024 lds
    s_add_u32 s79, s85, 4
    s_lshl_b32 s79, s79, 13
    s_add_u32 s79, s79, s82
    s_add_u32 m0, s80, 0x10000
    s_nop 0
    buffer_load_dwordx4 v20, s[24:27], s79 offen sc1 lds
    buffer_load_dwordx4 v20, s[24:27], s79 offen offset:1024 sc1 lds
    s_add_u32 s79, s85, 5
    s_lshl_b32 s79, s79, 13
    s_add_u32 s79, s79, s82
    s_add_u32 m0, s80, 0x12000
    s_nop 0
    buffer_load_dwordx4 v20, s[24:27], s79 offen sc1 lds
    buffer_load_dwordx4 v20, s[24:27], s79 offen offset:1024 sc1 lds
    s_waitcnt vmcnt(20)
    s_barrier
    s_add_u32 s79, s85, 4
    s_lshl_b32 s79, s79, 16
    s_add_u32 m0, s80, 0x22000
    s_nop 0
    buffer_load_dwordx4 v18, s[20:23], s79 offen lds
    buffer_load_dwordx4 v19, s[20:23], s79 offen offset:1024 lds
    s_add_u32 s79, s85, 5
    s_lshl_b32 s79, s79, 16
    s_add_u32 m0, s80, 0x24000
    s_nop 0
    buffer_load_dwordx4 v18, s[20:23], s79 offen lds
    buffer_load_dwordx4 v19, s[20:23], s79 offen offset:1024 lds
    s_add_u32 s79, s85, 6
    s_lshl_b32 s79, s79, 13
    s_add_u32 s79, s79, s82
    s_add_u32 m0, s80, 0x0
    s_nop 0
    buffer_load_dwordx4 v20, s[24:27], s79 offen sc1 lds
    buffer_load_dwordx4 v20, s[24:27], s79 offen offset:1024 sc1 lds
    s_add_u32 s79, s86, 0
    s_lshl_b32 s79, s79, 13
    s_add_u32 s79, s79, s82
    s_add_u32 m0, s80, 0x2000
    s_nop 0
    buffer_load_dwordx4 v20, s[24:27], s79 offen sc1 lds
    buffer_load_dwordx4 v20, s[24:27], s79 offen offset:1024 sc1 lds
    s_waitcnt vmcnt(20)
    s_barrier
    s_add_u32 s79, s85, 6
    s_lshl_b32 s79, s79, 16
    s_add_u32 m0, s80, 0x14000
    s_nop 0
    buffer_load_dwordx4 v18, s[20:23], s79 offen lds
    buffer_load_dwordx4 v19, s[20:23], s79 offen offset:1024 lds
    s_add_u32 s79, s86, 0
    s_lshl_b32 s79, s79, 16
    s_add_u32 m0, s80, 0x16000
    s_nop 0
    buffer_load_dwordx4 v18, s[20:23], s79 offen lds
    buffer_load_dwordx4 v19, s[20:23], s79 offen offset:1024 lds
    s_add_u32 s79, s86, 1
    s_lshl_b32 s79, s79, 13
    s_add_u32 s79, s79, s82
    s_add_u32 m0, s80, 0x4000
    s_nop 0
    buffer_load_dwordx4 v20, s[24:27], s79 offen sc1 lds
    buffer_load_dwordx4 v20, s[24:27], s79 offen offset:1024 sc1 lds
    s_add_u32 s79, s86, 2
    s_lshl_b32 s79, s79, 13
    s_add_u32 s79, s79, s82
    s_add_u32 m0, s80, 0x6000
    s_nop 0
    buffer_load_dwordx4 v20, s[24:27], s79 offen sc1 lds
    buffer_load_dwordx4 v20, s[24:27], s79 offen offset:1024 sc1 lds
    s_waitcnt vmcnt(20)
    s_barrier
    s_add_u32 s79, s86, 1
    s_lshl_b32 s79, s79, 16
    s_add_u32 m0, s80, 0x18000
    s_nop 0
    buffer_load_dwordx4 v18, s[20:23], s79 offen lds
    buffer_load_dwordx4 v19, s[20:23], s79 offen offset:1024 lds
    s_add_u32 s79, s86, 2
    s_lshl_b32 s79, s79, 16
    s_add_u32 m0, s80, 0x1a000
    s_nop 0
    buffer_load_dwordx4 v18, s[20:23], s79 offen lds
    buffer_load_dwordx4 v19, s[20:23], s79 offen offset:1024 lds
    s_add_u32 s79, s86, 3
    s_lshl_b32 s79, s79, 13
    s_add_u32 s79, s79, s82
    s_add_u32 m0, s80, 0x8000
    s_nop 0
    buffer_load_dwordx4 v20, s[24:27], s79 offen sc1 lds
    buffer_load_dwordx4 v20, s[24:27], s79 offen offset:1024 sc1 lds
    s_add_u32 s79, s86, 4
    s_lshl_b32 s79, s79, 13
    s_add_u32 s79, s79, s82
    s_add_u32 m0, s80, 0xa000
    s_nop 0
    buffer_load_dwordx4 v20, s[24:27], s79 offen sc1 lds
    buffer_load_dwordx4 v20, s[24:27], s79 offen offset:1024 sc1 lds
    s_waitcnt vmcnt(20)
    s_barrier
    s_add_u32 s79, s86, 3
    s_lshl_b32 s79, s79, 16
    s_add_u32 m0, s80, 0x1e000
    s_nop 0
    buffer_load_dwordx4 v18, s[20:23], s79 offen lds
    buffer_load_dwordx4 v19, s[20:23], s79 offen offset:1024 lds
    s_add_u32 s79, s86, 4
    s_lshl_b32 s79, s79, 16
    s_add_u32 m0, s80, 0x20000
    s_nop 0
    buffer_load_dwordx4 v18, s[20:23], s79 offen lds
    buffer_load_dwordx4 v19, s[20:23], s79 offen offset:1024 lds
    s_add_u32 s79, s86, 5
    s_lshl_b32 s79, s79, 13
    s_add_u32 s79, s79, s82
    s_add_u32 m0, s80, 0xc000
    s_nop 0
    buffer_load_dwordx4 v20, s[24:27], s79 offen sc1 lds
    buffer_load_dwordx4 v20, s[24:27], s79 offen offset:1024 sc1 lds
    s_add_u32 s79, s86, 6
    s_lshl_b32 s79, s79, 13
    s_add_u32 s79, s79, s82
    s_add_u32 m0, s80, 0xe000
    s_nop 0
    buffer_load_dwordx4 v20, s[24:27], s79 offen sc1 lds
    buffer_load_dwordx4 v20, s[24:27], s79 offen offset:1024 sc1 lds
    s_waitcnt vmcnt(20)
    s_barrier
    s_add_u32 s79, s86, 5
    s_lshl_b32 s79, s79, 16
    s_add_u32 m0, s80, 0x22000
    s_nop 0
    buffer_load_dwordx4 v18, s[20:23], s79 offen lds
    buffer_load_dwordx4 v19, s[20:23], s79 offen offset:1024 lds
    s_add_u32 s79, s86, 6
    s_lshl_b32 s79, s79, 16
    s_add_u32 m0, s80, 0x24000
    s_nop 0
    buffer_load_dwordx4 v18, s[20:23], s79 offen lds
    buffer_load_dwordx4 v19, s[20:23], s79 offen offset:1024 lds
    s_add_u32 s79, s87, 0
    s_lshl_b32 s79, s79, 13
    s_add_u32 s79, s79, s82
    s_add_u32 m0, s80, 0x10000
    s_nop 0
    buffer_load_dwordx4 v20, s[24:27], s79 offen sc1 lds
    buffer_load_dwordx4 v20, s[24:27], s79 offen offset:1024 sc1 lds
    s_add_u32 s79, s87, 1
    s_lshl_b32 s79, s79, 13
    s_add_u32 s79, s79, s82
    s_add_u32 m0, s80, 0x12000
    s_nop 0
    buffer_load_dwordx4 v20, s[24:27], s79 offen sc1 lds
    buffer_load_dwordx4 v20, s[24:27], s79 offen offset:1024 sc1 lds
    s_waitcnt vmcnt(20)
    s_barrier
    s_add_u32 s79, s87, 0
    s_lshl_b32 s79, s79, 16
    s_add_u32 m0, s80, 0x14000
    s_nop 0
    buffer_load_dwordx4 v18, s[20:23], s79 offen lds
    buffer_load_dwordx4 v19, s[20:23], s79 offen offset:1024 lds
    s_add_u32 s79, s87, 1
    s_lshl_b32 s79, s79, 16
    s_add_u32 m0, s80, 0x16000
    s_nop 0
    buffer_load_dwordx4 v18, s[20:23], s79 offen lds
    buffer_load_dwordx4 v19, s[20:23], s79 offen offset:1024 lds
    s_add_u32 s79, s87, 2
    s_lshl_b32 s79, s79, 13
    s_add_u32 s79, s79, s82
    s_add_u32 m0, s80, 0x0
    s_nop 0
    buffer_load_dwordx4 v20, s[24:27], s79 offen sc1 lds
    buffer_load_dwordx4 v20, s[24:27], s79 offen offset:1024 sc1 lds
    s_add_u32 s79, s87, 3
    s_lshl_b32 s79, s79, 13
    s_add_u32 s79, s79, s82
    s_add_u32 m0, s80, 0x2000
    s_nop 0
    buffer_load_dwordx4 v20, s[24:27], s79 offen sc1 lds
    buffer_load_dwordx4 v20, s[24:27], s79 offen offset:1024 sc1 lds
    s_waitcnt vmcnt(20)
    s_barrier
    s_add_u32 s79, s87, 2
    s_lshl_b32 s79, s79, 16
    s_add_u32 m0, s80, 0x18000
    s_nop 0
    buffer_load_dwordx4 v18, s[20:23], s79 offen lds
    buffer_load_dwordx4 v19, s[20:23], s79 offen offset:1024 lds
    s_add_u32 s79, s87, 3
    s_lshl_b32 s79, s79, 16
    s_add_u32 m0, s80, 0x1a000
    s_nop 0
    buffer_load_dwordx4 v18, s[20:23], s79 offen lds
    buffer_load_dwordx4 v19, s[20:23], s79 offen offset:1024 lds
    s_add_u32 s79, s87, 4
    s_lshl_b32 s79, s79, 13
    s_add_u32 s79, s79, s82
    s_add_u32 m0, s80, 0x4000
    s_nop 0
    buffer_load_dwordx4 v20, s[24:27], s79 offen sc1 lds
    buffer_load_dwordx4 v20, s[24:27], s79 offen offset:1024 sc1 lds
    s_add_u32 s79, s87, 5
    s_lshl_b32 s79, s79, 13
    s_add_u32 s79, s79, s82
    s_add_u32 m0, s80, 0x6000
    s_nop 0
    buffer_load_dwordx4 v20, s[24:27], s79 offen sc1 lds
    buffer_load_dwordx4 v20, s[24:27], s79 offen offset:1024 sc1 lds
    s_waitcnt vmcnt(20)
    s_barrier
    s_add_u32 s79, s87, 4
    s_lshl_b32 s79, s79, 16
    s_add_u32 m0, s80, 0x1e000
    s_nop 0
    buffer_load_dwordx4 v18, s[20:23], s79 offen lds
    buffer_load_dwordx4 v19, s[20:23], s79 offen offset:1024 lds
    s_add_u32 s79, s87, 5
    s_lshl_b32 s79, s79, 16
    s_add_u32 m0, s80, 0x20000
    s_nop 0
    buffer_load_dwordx4 v18, s[20:23], s79 offen lds
    buffer_load_dwordx4 v19, s[20:23], s79 offen offset:1024 lds
    s_add_u32 s79, s87, 6
    s_lshl_b32 s79, s79, 13
    s_add_u32 s79, s79, s82
    s_add_u32 m0, s80, 0x8000
    s_nop 0
    buffer_load_dwordx4 v20, s[24:27], s79 offen sc1 lds
    buffer_load_dwordx4 v20, s[24:27], s79 offen offset:1024 sc1 lds
    s_add_u32 s79, s88, 0
    s_lshl_b32 s79, s79, 13
    s_add_u32 s79, s79, s82
    s_add_u32 m0, s80, 0xa000
    s_nop 0
    buffer_load_dwordx4 v20, s[24:27], s79 offen sc1 lds
    buffer_load_dwordx4 v20, s[24:27], s79 offen offset:1024 sc1 lds
    s_waitcnt vmcnt(20)
    s_barrier
    s_add_u32 s79, s87, 6
    s_lshl_b32 s79, s79, 16
    s_add_u32 m0, s80, 0x22000
    s_nop 0
    buffer_load_dwordx4 v18, s[20:23], s79 offen lds
    buffer_load_dwordx4 v19, s[20:23], s79 offen offset:1024 lds
    s_add_u32 s79, s88, 0
    s_lshl_b32 s79, s79, 16
    s_add_u32 m0, s80, 0x24000
    s_nop 0
    buffer_load_dwordx4 v18, s[20:23], s79 offen lds
    buffer_load_dwordx4 v19, s[20:23], s79 offen offset:1024 lds
    s_add_u32 s79, s88, 1
    s_lshl_b32 s79, s79, 13
    s_add_u32 s79, s79, s82
    s_add_u32 m0, s80, 0xc000
    s_nop 0
    buffer_load_dwordx4 v20, s[24:27], s79 offen sc1 lds
    buffer_load_dwordx4 v20, s[24:27], s79 offen offset:1024 sc1 lds
    s_add_u32 s79, s88, 2
    s_lshl_b32 s79, s79, 13
    s_add_u32 s79, s79, s82
    s_add_u32 m0, s80, 0xe000
    s_nop 0
    buffer_load_dwordx4 v20, s[24:27], s79 offen sc1 lds
    buffer_load_dwordx4 v20, s[24:27], s79 offen offset:1024 sc1 lds
    s_waitcnt vmcnt(20)
    s_barrier
    s_add_u32 s79, s88, 1
    s_lshl_b32 s79, s79, 16
    s_add_u32 m0, s80, 0x14000
    s_nop 0
    buffer_load_dwordx4 v18, s[20:23], s79 offen lds
    buffer_load_dwordx4 v19, s[20:23], s79 offen offset:1024 lds
    s_add_u32 s79, s88, 2
    s_lshl_b32 s79, s79, 16
    s_add_u32 m0, s80, 0x16000
    s_nop 0
    buffer_load_dwordx4 v18, s[20:23], s79 offen lds
    buffer_load_dwordx4 v19, s[20:23], s79 offen offset:1024 lds
    s_add_u32 s79, s88, 3
    s_lshl_b32 s79, s79, 13
    s_add_u32 s79, s79, s82
    s_add_u32 m0, s80, 0x10000
    s_nop 0
    buffer_load_dwordx4 v20, s[24:27], s79 offen sc1 lds
    buffer_load_dwordx4 v20, s[24:27], s79 offen offset:1024 sc1 lds
    s_add_u32 s79, s88, 4
    s_lshl_b32 s79, s79, 13
    s_add_u32 s79, s79, s82
    s_add_u32 m0, s80, 0x12000
    s_nop 0
    buffer_load_dwordx4 v20, s[24:27], s79 offen sc1 lds
    buffer_load_dwordx4 v20, s[24:27], s79 offen offset:1024 sc1 lds
    s_waitcnt vmcnt(20)
    s_barrier
    s_add_u32 s79, s88, 3
    s_lshl_b32 s79, s79, 16
    s_add_u32 m0, s80, 0x18000
    s_nop 0
    buffer_load_dwordx4 v18, s[20:23], s79 offen lds
    buffer_load_dwordx4 v19, s[20:23], s79 offen offset:1024 lds
    s_add_u32 s79, s88, 4
    s_lshl_b32 s79, s79, 16
    s_add_u32 m0, s80, 0x1a000
    s_nop 0
    buffer_load_dwordx4 v18, s[20:23], s79 offen lds
    buffer_load_dwordx4 v19, s[20:23], s79 offen offset:1024 lds
    s_add_u32 s79, s88, 5
    s_lshl_b32 s79, s79, 13
    s_add_u32 s79, s79, s82
    s_add_u32 m0, s80, 0x0
    s_nop 0
    buffer_load_dwordx4 v20, s[24:27], s79 offen sc1 lds
    buffer_load_dwordx4 v20, s[24:27], s79 offen offset:1024 sc1 lds
    s_add_u32 s79, s88, 6
    s_lshl_b32 s79, s79, 13
    s_add_u32 s79, s79, s82
    s_add_u32 m0, s80, 0x2000
    s_nop 0
    buffer_load_dwordx4 v20, s[24:27], s79 offen sc1 lds
    buffer_load_dwordx4 v20, s[24:27], s79 offen offset:1024 sc1 lds
    s_waitcnt vmcnt(20)
    s_barrier
    s_add_u32 s79, s88, 5
    s_lshl_b32 s79, s79, 16
    s_add_u32 m0, s80, 0x1e000
    s_nop 0
    buffer_load_dwordx4 v18, s[20:23], s79 offen lds
    buffer_load_dwordx4 v19, s[20:23], s79 offen offset:1024 lds
    s_add_u32 s79, s88, 6
    s_lshl_b32 s79, s79, 16
    s_add_u32 m0, s80, 0x20000
    s_nop 0
    buffer_load_dwordx4 v18, s[20:23], s79 offen lds
    buffer_load_dwordx4 v19, s[20:23], s79 offen offset:1024 lds
    s_add_u32 s79, s89, 0
    s_lshl_b32 s79, s79, 13
    s_add_u32 s79, s79, s82
    s_add_u32 m0, s81, 0x4000
    s_nop 0
    buffer_load_dwordx4 v21, s[24:27], s79 offen sc1 lds
    s_add_u32 s79, s89, 1
    s_lshl_b32 s79, s79, 13
    s_add_u32 s79, s79, s82
    s_add_u32 m0, s81, 0x6000
    s_nop 0
    buffer_load_dwordx4 v21, s[24:27], s79 offen sc1 lds
    s_waitcnt vmcnt(18)
    s_barrier
    s_add_u32 s79, s89, 0
    s_lshl_b32 s79, s79, 16
    s_add_u32 m0, s80, 0x22000
    s_nop 0
    buffer_load_dwordx4 v18, s[20:23], s79 offen lds
    buffer_load_dwordx4 v19, s[20:23], s79 offen offset:1024 lds
    s_add_u32 s79, s89, 1
    s_lshl_b32 s79, s79, 16
    s_add_u32 m0, s80, 0x24000
    s_nop 0
    buffer_load_dwordx4 v18, s[20:23], s79 offen lds
    buffer_load_dwordx4 v19, s[20:23], s79 offen offset:1024 lds
    s_add_u32 s79, s89, 2
    s_lshl_b32 s79, s79, 13
    s_add_u32 s79, s79, s82
    s_add_u32 m0, s81, 0x8000
    s_nop 0
    buffer_load_dwordx4 v21, s[24:27], s79 offen sc1 lds
    s_add_u32 s79, s89, 3
    s_lshl_b32 s79, s79, 13
    s_add_u32 s79, s79, s82
    s_add_u32 m0, s81, 0xa000
    s_nop 0
    buffer_load_dwordx4 v21, s[24:27], s79 offen sc1 lds
    v_and_b32 v5, 7, v1
    v_lshlrev_b32 v5, 7, v5
    buffer_load_dword v6, v5, s[72:75], s68 offen
    s_waitcnt vmcnt(17)
    s_barrier
    s_add_u32 s79, s89, 2
    s_lshl_b32 s79, s79, 16
    s_add_u32 m0, s80, 0x14000
    s_nop 0
    buffer_load_dwordx4 v18, s[20:23], s79 offen lds
    buffer_load_dwordx4 v19, s[20:23], s79 offen offset:1024 lds
    s_add_u32 s79, s89, 3
    s_lshl_b32 s79, s79, 16
    s_add_u32 m0, s80, 0x16000
    s_nop 0
    buffer_load_dwordx4 v18, s[20:23], s79 offen lds
    buffer_load_dwordx4 v19, s[20:23], s79 offen offset:1024 lds
    s_add_u32 s79, s89, 4
    s_lshl_b32 s79, s79, 13
    s_add_u32 s79, s79, s82
    s_add_u32 m0, s81, 0xc000
    s_nop 0
    buffer_load_dwordx4 v21, s[24:27], s79 offen sc1 lds
    s_add_u32 s79, s89, 5
    s_lshl_b32 s79, s79, 13
    s_add_u32 s79, s79, s82
    s_add_u32 m0, s81, 0xe000
    s_nop 0
    buffer_load_dwordx4 v21, s[24:27], s79 offen sc1 lds
    s_waitcnt vmcnt(15)
    s_barrier
    s_add_u32 s79, s89, 4
    s_lshl_b32 s79, s79, 16
    s_add_u32 m0, s80, 0x18000
    s_nop 0
    buffer_load_dwordx4 v18, s[20:23], s79 offen lds
    buffer_load_dwordx4 v19, s[20:23], s79 offen offset:1024 lds
    s_add_u32 s79, s89, 5
    s_lshl_b32 s79, s79, 16
    s_add_u32 m0, s80, 0x1a000
    s_nop 0
    buffer_load_dwordx4 v18, s[20:23], s79 offen lds
    buffer_load_dwordx4 v19, s[20:23], s79 offen offset:1024 lds
    s_add_u32 s79, s89, 6
    s_lshl_b32 s79, s79, 13
    s_add_u32 s79, s79, s82
    s_add_u32 m0, s81, 0x10000
    s_nop 0
    buffer_load_dwordx4 v21, s[24:27], s79 offen sc1 lds
    s_add_u32 s79, s90, 0
    s_lshl_b32 s79, s79, 13
    s_add_u32 s79, s79, s82
    s_add_u32 m0, s81, 0x12000
    s_nop 0
    buffer_load_dwordx4 v21, s[24:27], s79 offen sc1 lds
    s_waitcnt vmcnt(15)
    s_barrier
    s_add_u32 s79, s89, 6
    s_lshl_b32 s79, s79, 16
    s_add_u32 m0, s80, 0x1e000
    s_nop 0
    buffer_load_dwordx4 v18, s[20:23], s79 offen lds
    buffer_load_dwordx4 v19, s[20:23], s79 offen offset:1024 lds
    s_add_u32 s79, s90, 0
    s_lshl_b32 s79, s79, 16
    s_add_u32 m0, s80, 0x20000
    s_nop 0
    buffer_load_dwordx4 v18, s[20:23], s79 offen lds
    buffer_load_dwordx4 v19, s[20:23], s79 offen offset:1024 lds
    s_add_u32 s79, s90, 1
    s_lshl_b32 s79, s79, 13
    s_add_u32 s79, s79, s82
    s_add_u32 m0, s81, 0x0
    s_nop 0
    buffer_load_dwordx4 v21, s[24:27], s79 offen sc1 lds
    s_add_u32 s79, s90, 2
    s_lshl_b32 s79, s79, 13
    s_add_u32 s79, s79, s82
    s_add_u32 m0, s81, 0x2000
    s_nop 0
    buffer_load_dwordx4 v21, s[24:27], s79 offen sc1 lds
    s_waitcnt vmcnt(14)
    s_barrier
    s_add_u32 s79, s90, 1
    s_lshl_b32 s79, s79, 16
    s_add_u32 m0, s80, 0x22000
    s_nop 0
    buffer_load_dwordx4 v18, s[20:23], s79 offen lds
    buffer_load_dwordx4 v19, s[20:23], s79 offen offset:1024 lds
    s_add_u32 s79, s90, 2
    s_lshl_b32 s79, s79, 16
    s_add_u32 m0, s80, 0x24000
    s_nop 0
    buffer_load_dwordx4 v18, s[20:23], s79 offen lds
    buffer_load_dwordx4 v19, s[20:23], s79 offen offset:1024 lds
    s_add_u32 s79, s90, 3
    s_lshl_b32 s79, s79, 13
    s_add_u32 s79, s79, s82
    s_add_u32 m0, s81, 0x4000
    s_nop 0
    buffer_load_dwordx4 v21, s[24:27], s79 offen sc1 lds
    s_add_u32 s79, s90, 4
    s_lshl_b32 s79, s79, 13
    s_add_u32 s79, s79, s82
    s_add_u32 m0, s81, 0x6000
    s_nop 0
    buffer_load_dwordx4 v21, s[24:27], s79 offen sc1 lds
    s_waitcnt vmcnt(14)
    s_barrier
    s_add_u32 s79, s90, 3
    s_lshl_b32 s79, s79, 16
    s_add_u32 m0, s80, 0x14000
    s_nop 0
    buffer_load_dwordx4 v18, s[20:23], s79 offen lds
    buffer_load_dwordx4 v19, s[20:23], s79 offen offset:1024 lds
    s_add_u32 s79, s90, 4
    s_lshl_b32 s79, s79, 16
    s_add_u32 m0, s80, 0x16000
    s_nop 0
    buffer_load_dwordx4 v18, s[20:23], s79 offen lds
    buffer_load_dwordx4 v19, s[20:23], s79 offen offset:1024 lds
    s_add_u32 s79, s90, 5
    s_lshl_b32 s79, s79, 13
    s_add_u32 s79, s79, s82
    s_add_u32 m0, s81, 0x8000
    s_nop 0
    buffer_load_dwordx4 v21, s[24:27], s79 offen sc1 lds
    s_add_u32 s79, s90, 6
    s_lshl_b32 s79, s79, 13
    s_add_u32 s79, s79, s82
    s_add_u32 m0, s81, 0xa000
    s_nop 0
    buffer_load_dwordx4 v21, s[24:27], s79 offen sc1 lds
    s_waitcnt vmcnt(14)
    s_barrier
    s_add_u32 s79, s90, 5
    s_lshl_b32 s79, s79, 16
    s_add_u32 m0, s80, 0x18000
    s_nop 0
    buffer_load_dwordx4 v18, s[20:23], s79 offen lds
    buffer_load_dwordx4 v19, s[20:23], s79 offen offset:1024 lds
    s_add_u32 s79, s90, 6
    s_lshl_b32 s79, s79, 16
    s_add_u32 m0, s80, 0x1a000
    s_nop 0
    buffer_load_dwordx4 v18, s[20:23], s79 offen lds
    buffer_load_dwordx4 v19, s[20:23], s79 offen offset:1024 lds
    s_waitcnt vmcnt(12)
    s_barrier
    s_waitcnt vmcnt(6)
    s_barrier
    s_waitcnt vmcnt(0)
    s_barrier
    s_barrier
    s_endpgm
sequential_preLN__sliding_block__dense_activation_gelu__prompt_kernel_consumer2:
    s_waitcnt lgkmcnt(0)
    s_and_b32 s53, s45, 4
    s_cmp_lg_u32 s53, 0
    s_cbranch_scc1 sequential_preLN__sliding_block__dense_activation_gelu__prompt_kernel_noc358
    v_min_u32 v3, 23, v1
    v_lshlrev_b32 v3, 11, v3
    s_lshr_b32 s53, s2, 3
    s_lshl_b32 s53, s53, 2
    s_add_u32 s53, s53, s47
    s_mul_i32 s53, s53, 49152
    s_and_b32 s54, s45, 8
    s_or_b32 s54, s54, 3
    s_lshl_b32 s54, s54, 7
    s_add_u32 s53, s53, s54
    buffer_load_dword v6, v3, s[8:11], s53 offen
sequential_preLN__sliding_block__dense_activation_gelu__prompt_kernel_noc358:
    s_load_dwordx2 s[24:25], s[0:1], 80
    s_load_dwordx2 s[12:13], s[0:1], 16
    s_load_dwordx2 s[16:17], s[0:1], 32
    s_load_dwordx2 s[36:37], s[0:1], 40
    s_load_dwordx2 s[20:21], s[0:1], 48
    s_load_dwordx2 s[40:41], s[0:1], 56
    s_load_dwordx2 s[28:29], s[0:1], 64
    s_mov_b32 s26, 0x10000000
    s_mov_b32 s27, 0x20000
    s_mov_b32 s14, 0x200000
    s_mov_b32 s15, 0x20000
    s_mov_b32 s18, 0x700000
    s_mov_b32 s19, 0x20000
    s_mov_b32 s38, 0x1c00
    s_mov_b32 s39, 0x20000
    s_mov_b32 s22, 0x700000
    s_mov_b32 s23, 0x20000
    s_mov_b32 s42, 0x800
    s_mov_b32 s43, 0x20000
    s_mov_b32 s30, 0x400000
    s_mov_b32 s31, 0x20000
    s_mov_b32 s53, 0x29f0000
    s_waitcnt lgkmcnt(0)
    s_buffer_load_dword s50, s[24:27], s53
    s_lshr_b32 s66, s47, 1
    s_and_b32 s67, s47, 1
    s_waitcnt lgkmcnt(0)
    s_add_u32 s50, s50, 1
    v_bfe_u32 v3, v1, 1, 3
    v_lshrrev_b32 v4, 4, v1
    v_xor_b32 v3, v3, v4
    v_lshlrev_b32 v3, 4, v3
    v_and_b32 v4, 15, v1
    v_lshl_add_u32 v3, v4, 7, v3
    s_lshl_b32 s53, s66, 13
    v_add_u32 v104, s53, v3
    v_xor_b32 v105, 64, v104
    s_lshl_b32 s54, s67, 1
    s_add_u32 s54, s54, 0
    v_bfe_u32 v3, v1, 3, 2
    v_xor_b32 v3, s54, v3
    v_lshlrev_b32 v3, 5, v3
    v_and_b32 v4, 3, v1
    v_lshl_add_u32 v3, v4, 3, v3
    v_bfe_u32 v4, v1, 2, 2
    v_lshl_add_u32 v3, v4, 7, v3
    v_lshrrev_b32 v4, 4, v1
    v_lshl_add_u32 v106, v4, 10, v3
    v_add_u32 v107, 0x10000, v106
    v_add_u32 v108, 0x20000, v106
    s_lshl_b32 s54, s67, 1
    s_add_u32 s54, s54, 1
    v_bfe_u32 v3, v1, 3, 2
    v_xor_b32 v3, s54, v3
    v_lshlrev_b32 v3, 5, v3
    v_and_b32 v4, 3, v1
    v_lshl_add_u32 v3, v4, 3, v3
    v_bfe_u32 v4, v1, 2, 2
    v_lshl_add_u32 v3, v4, 7, v3
    v_lshrrev_b32 v4, 4, v1
    v_lshl_add_u32 v109, v4, 10, v3
    v_add_u32 v110, 0x10000, v109
    v_add_u32 v111, 0x20000, v109
    s_barrier
    ds_read_b128 v[112:115], v104 offset:0
    ds_read_b64_tr_b16 v[144:145], v107 offset:0
    ds_read_b64_tr_b16 v[146:147], v107 offset:512
    ds_read_b128 v[116:119], v104 offset:2048
    ds_read_b128 v[120:123], v104 offset:4096
    ds_read_b128 v[124:127], v104 offset:6144
    ds_read_b64_tr_b16 v[148:149], v110 offset:0
    ds_read_b64_tr_b16 v[150:151], v110 offset:512
    ds_read_b64_tr_b16 v[152:153], v107 offset:8192
    ds_read_b64_tr_b16 v[154:155], v107 offset:8704
    ds_read_b64_tr_b16 v[156:157], v110 offset:8192
    ds_read_b64_tr_b16 v[158:159], v110 offset:8704
    ds_read_b64_tr_b16 v[160:161], v107 offset:16384
    ds_read_b64_tr_b16 v[162:163], v107 offset:16896
    ds_read_b64_tr_b16 v[164:165], v110 offset:16384
    ds_read_b64_tr_b16 v[166:167], v110 offset:16896
    s_waitcnt lgkmcnt(8)
    v_mfma_f32_16x16x32_bf16 v[8:11], v[144:147], v[112:115], 0
    ds_read_b128 v[128:131], v105 offset:0
    v_mfma_f32_16x16x32_bf16 v[12:15], v[144:147], v[116:119], 0
    ds_read_b64_tr_b16 v[168:169], v107 offset:4096
    v_mfma_f32_16x16x32_bf16 v[16:19], v[144:147], v[120:123], 0
    ds_read_b64_tr_b16 v[170:171], v107 offset:4608
    v_mfma_f32_16x16x32_bf16 v[20:23], v[144:147], v[124:127], 0
    ds_read_b128 v[132:135], v105 offset:2048
    v_mfma_f32_16x16x32_bf16 v[36:39], v[148:151], v[124:127], 0
    ds_read_b128 v[136:139], v105 offset:4096
    v_mfma_f32_16x16x32_bf16 v[32:35], v[148:151], v[120:123], 0
    ds_read_b128 v[140:143], v105 offset:6144
    v_mfma_f32_16x16x32_bf16 v[28:31], v[148:151], v[116:119], 0
    ds_read_b64_tr_b16 v[172:173], v110 offset:4096
    v_mfma_f32_16x16x32_bf16 v[24:27], v[148:151], v[112:115], 0
    ds_read_b64_tr_b16 v[174:175], v110 offset:4608
    s_waitcnt lgkmcnt(12)
    v_mfma_f32_16x16x32_bf16 v[40:43], v[152:155], v[112:115], 0
    ds_read_b64_tr_b16 v[176:177], v107 offset:12288
    v_mfma_f32_16x16x32_bf16 v[44:47], v[152:155], v[116:119], 0
    ds_read_b64_tr_b16 v[178:179], v107 offset:12800
    v_mfma_f32_16x16x32_bf16 v[48:51], v[152:155], v[120:123], 0
    ds_read_b64_tr_b16 v[180:181], v110 offset:12288
    v_mfma_f32_16x16x32_bf16 v[52:55], v[152:155], v[124:127], 0
    ds_read_b64_tr_b16 v[182:183], v110 offset:12800
    v_mfma_f32_16x16x32_bf16 v[68:71], v[156:159], v[124:127], 0
    ds_read_b64_tr_b16 v[184:185], v107 offset:20480
    v_mfma_f32_16x16x32_bf16 v[64:67], v[156:159], v[120:123], 0
    ds_read_b64_tr_b16 v[186:187], v107 offset:20992
    v_mfma_f32_16x16x32_bf16 v[60:63], v[156:159], v[116:119], 0
    ds_read_b64_tr_b16 v[188:189], v110 offset:20480
    v_mfma_f32_16x16x32_bf16 v[56:59], v[156:159], v[112:115], 0
    ds_read_b64_tr_b16 v[190:191], v110 offset:20992
    s_waitcnt lgkmcnt(15)
    v_mfma_f32_16x16x32_bf16 v[72:75], v[112:115], v[160:163], 0
    v_mfma_f32_16x16x32_bf16 v[76:79], v[116:119], v[160:163], 0
    v_mfma_f32_16x16x32_bf16 v[80:83], v[120:123], v[160:163], 0
    v_mfma_f32_16x16x32_bf16 v[84:87], v[124:127], v[160:163], 0
    v_mfma_f32_16x16x32_bf16 v[100:103], v[124:127], v[164:167], 0
    v_mfma_f32_16x16x32_bf16 v[96:99], v[120:123], v[164:167], 0
    v_mfma_f32_16x16x32_bf16 v[92:95], v[116:119], v[164:167], 0
    v_mfma_f32_16x16x32_bf16 v[88:91], v[112:115], v[164:167], 0
    s_waitcnt lgkmcnt(8)
    v_mfma_f32_16x16x32_bf16 v[8:11], v[168:171], v[128:131], v[8:11]
    v_mfma_f32_16x16x32_bf16 v[12:15], v[168:171], v[132:135], v[12:15]
    v_mfma_f32_16x16x32_bf16 v[16:19], v[168:171], v[136:139], v[16:19]
    v_mfma_f32_16x16x32_bf16 v[20:23], v[168:171], v[140:143], v[20:23]
    s_waitcnt lgkmcnt(0)
    s_barrier
    v_mfma_f32_16x16x32_bf16 v[36:39], v[172:175], v[140:143], v[36:39]
    ds_read_b128 v[112:115], v104 offset:16384
    v_mfma_f32_16x16x32_bf16 v[32:35], v[172:175], v[136:139], v[32:35]
    ds_read_b64_tr_b16 v[144:145], v107 offset:24576
    v_mfma_f32_16x16x32_bf16 v[28:31], v[172:175], v[132:135], v[28:31]
    ds_read_b64_tr_b16 v[146:147], v107 offset:25088
    v_mfma_f32_16x16x32_bf16 v[24:27], v[172:175], v[128:131], v[24:27]
    ds_read_b128 v[116:119], v104 offset:18432
    v_mfma_f32_16x16x32_bf16 v[40:43], v[176:179], v[128:131], v[40:43]
    ds_read_b128 v[120:123], v104 offset:20480
    v_mfma_f32_16x16x32_bf16 v[44:47], v[176:179], v[132:135], v[44:47]
    ds_read_b128 v[124:127], v104 offset:22528
    v_mfma_f32_16x16x32_bf16 v[48:51], v[176:179], v[136:139], v[48:51]
    ds_read_b64_tr_b16 v[148:149], v110 offset:24576
    v_mfma_f32_16x16x32_bf16 v[52:55], v[176:179], v[140:143], v[52:55]
    ds_read_b64_tr_b16 v[150:151], v110 offset:25088
    v_mfma_f32_16x16x32_bf16 v[68:71], v[180:183], v[140:143], v[68:71]
    ds_read_b64_tr_b16 v[152:153], v107 offset:32768
    v_mfma_f32_16x16x32_bf16 v[64:67], v[180:183], v[136:139], v[64:67]
    ds_read_b64_tr_b16 v[154:155], v107 offset:33280
    v_mfma_f32_16x16x32_bf16 v[60:63], v[180:183], v[132:135], v[60:63]
    ds_read_b64_tr_b16 v[156:157], v110 offset:32768
    v_mfma_f32_16x16x32_bf16 v[56:59], v[180:183], v[128:131], v[56:59]
    ds_read_b64_tr_b16 v[158:159], v110 offset:33280
    v_mfma_f32_16x16x32_bf16 v[72:75], v[128:131], v[184:187], v[72:75]
    ds_read_b64_tr_b16 v[160:161], v107 offset:40960
    v_mfma_f32_16x16x32_bf16 v[76:79], v[132:135], v[184:187], v[76:79]
    ds_read_b64_tr_b16 v[162:163], v107 offset:41472
    v_mfma_f32_16x16x32_bf16 v[80:83], v[136:139], v[184:187], v[80:83]
    ds_read_b64_tr_b16 v[164:165], v110 offset:40960
    v_mfma_f32_16x16x32_bf16 v[84:87], v[140:143], v[184:187], v[84:87]
    ds_read_b64_tr_b16 v[166:167], v110 offset:41472
    v_mfma_f32_16x16x32_bf16 v[100:103], v[140:143], v[188:191], v[100:103]
    v_mfma_f32_16x16x32_bf16 v[96:99], v[136:139], v[188:191], v[96:99]
    v_mfma_f32_16x16x32_bf16 v[92:95], v[132:135], v[188:191], v[92:95]
    v_mfma_f32_16x16x32_bf16 v[88:91], v[128:131], v[188:191], v[88:91]
    s_waitcnt lgkmcnt(8)
    v_mfma_f32_16x16x32_bf16 v[8:11], v[144:147], v[112:115], v[8:11]
    ds_read_b128 v[128:131], v105 offset:16384
    v_mfma_f32_16x16x32_bf16 v[12:15], v[144:147], v[116:119], v[12:15]
    ds_read_b64_tr_b16 v[168:169], v107 offset:28672
    v_mfma_f32_16x16x32_bf16 v[16:19], v[144:147], v[120:123], v[16:19]
    ds_read_b64_tr_b16 v[170:171], v107 offset:29184
    v_mfma_f32_16x16x32_bf16 v[20:23], v[144:147], v[124:127], v[20:23]
    ds_read_b128 v[132:135], v105 offset:18432
    v_mfma_f32_16x16x32_bf16 v[36:39], v[148:151], v[124:127], v[36:39]
    ds_read_b128 v[136:139], v105 offset:20480
    v_mfma_f32_16x16x32_bf16 v[32:35], v[148:151], v[120:123], v[32:35]
    ds_read_b128 v[140:143], v105 offset:22528
    v_mfma_f32_16x16x32_bf16 v[28:31], v[148:151], v[116:119], v[28:31]
    ds_read_b64_tr_b16 v[172:173], v110 offset:28672
    v_mfma_f32_16x16x32_bf16 v[24:27], v[148:151], v[112:115], v[24:27]
    ds_read_b64_tr_b16 v[174:175], v110 offset:29184
    s_waitcnt lgkmcnt(12)
    v_mfma_f32_16x16x32_bf16 v[40:43], v[152:155], v[112:115], v[40:43]
    ds_read_b64_tr_b16 v[176:177], v107 offset:36864
    v_mfma_f32_16x16x32_bf16 v[44:47], v[152:155], v[116:119], v[44:47]
    ds_read_b64_tr_b16 v[178:179], v107 offset:37376
    v_mfma_f32_16x16x32_bf16 v[48:51], v[152:155], v[120:123], v[48:51]
    ds_read_b64_tr_b16 v[180:181], v110 offset:36864
    v_mfma_f32_16x16x32_bf16 v[52:55], v[152:155], v[124:127], v[52:55]
    ds_read_b64_tr_b16 v[182:183], v110 offset:37376
    v_mfma_f32_16x16x32_bf16 v[68:71], v[156:159], v[124:127], v[68:71]
    ds_read_b64_tr_b16 v[184:185], v107 offset:45056
    v_mfma_f32_16x16x32_bf16 v[64:67], v[156:159], v[120:123], v[64:67]
    ds_read_b64_tr_b16 v[186:187], v107 offset:45568
    v_mfma_f32_16x16x32_bf16 v[60:63], v[156:159], v[116:119], v[60:63]
    ds_read_b64_tr_b16 v[188:189], v110 offset:45056
    v_mfma_f32_16x16x32_bf16 v[56:59], v[156:159], v[112:115], v[56:59]
    ds_read_b64_tr_b16 v[190:191], v110 offset:45568
    s_waitcnt lgkmcnt(15)
    v_mfma_f32_16x16x32_bf16 v[72:75], v[112:115], v[160:163], v[72:75]
    v_mfma_f32_16x16x32_bf16 v[76:79], v[116:119], v[160:163], v[76:79]
    v_mfma_f32_16x16x32_bf16 v[80:83], v[120:123], v[160:163], v[80:83]
    v_mfma_f32_16x16x32_bf16 v[84:87], v[124:127], v[160:163], v[84:87]
    v_mfma_f32_16x16x32_bf16 v[100:103], v[124:127], v[164:167], v[100:103]
    v_mfma_f32_16x16x32_bf16 v[96:99], v[120:123], v[164:167], v[96:99]
    v_mfma_f32_16x16x32_bf16 v[92:95], v[116:119], v[164:167], v[92:95]
    v_mfma_f32_16x16x32_bf16 v[88:91], v[112:115], v[164:167], v[88:91]
    s_waitcnt lgkmcnt(8)
    v_mfma_f32_16x16x32_bf16 v[8:11], v[168:171], v[128:131], v[8:11]
    v_mfma_f32_16x16x32_bf16 v[12:15], v[168:171], v[132:135], v[12:15]
    v_mfma_f32_16x16x32_bf16 v[16:19], v[168:171], v[136:139], v[16:19]
    v_mfma_f32_16x16x32_bf16 v[20:23], v[168:171], v[140:143], v[20:23]
    s_waitcnt lgkmcnt(0)
    s_barrier
    v_mfma_f32_16x16x32_bf16 v[36:39], v[172:175], v[140:143], v[36:39]
    ds_read_b128 v[112:115], v104 offset:32768
    v_mfma_f32_16x16x32_bf16 v[32:35], v[172:175], v[136:139], v[32:35]
    ds_read_b64_tr_b16 v[144:145], v107 offset:49152
    v_mfma_f32_16x16x32_bf16 v[28:31], v[172:175], v[132:135], v[28:31]
    ds_read_b64_tr_b16 v[146:147], v107 offset:49664
    v_mfma_f32_16x16x32_bf16 v[24:27], v[172:175], v[128:131], v[24:27]
    ds_read_b128 v[116:119], v104 offset:34816
    v_mfma_f32_16x16x32_bf16 v[40:43], v[176:179], v[128:131], v[40:43]
    ds_read_b128 v[120:123], v104 offset:36864
    v_mfma_f32_16x16x32_bf16 v[44:47], v[176:179], v[132:135], v[44:47]
    ds_read_b128 v[124:127], v104 offset:38912
    v_mfma_f32_16x16x32_bf16 v[48:51], v[176:179], v[136:139], v[48:51]
    ds_read_b64_tr_b16 v[148:149], v110 offset:49152
    v_mfma_f32_16x16x32_bf16 v[52:55], v[176:179], v[140:143], v[52:55]
    ds_read_b64_tr_b16 v[150:151], v110 offset:49664
    v_mfma_f32_16x16x32_bf16 v[68:71], v[180:183], v[140:143], v[68:71]
    ds_read_b64_tr_b16 v[152:153], v107 offset:57344
    v_mfma_f32_16x16x32_bf16 v[64:67], v[180:183], v[136:139], v[64:67]
    ds_read_b64_tr_b16 v[154:155], v107 offset:57856
    v_mfma_f32_16x16x32_bf16 v[60:63], v[180:183], v[132:135], v[60:63]
    ds_read_b64_tr_b16 v[156:157], v110 offset:57344
    v_mfma_f32_16x16x32_bf16 v[56:59], v[180:183], v[128:131], v[56:59]
    ds_read_b64_tr_b16 v[158:159], v110 offset:57856
    v_mfma_f32_16x16x32_bf16 v[72:75], v[128:131], v[184:187], v[72:75]
    ds_read_b64_tr_b16 v[160:161], v108 offset:0
    v_mfma_f32_16x16x32_bf16 v[76:79], v[132:135], v[184:187], v[76:79]
    ds_read_b64_tr_b16 v[162:163], v108 offset:512
    v_mfma_f32_16x16x32_bf16 v[80:83], v[136:139], v[184:187], v[80:83]
    ds_read_b64_tr_b16 v[164:165], v111 offset:0
    v_mfma_f32_16x16x32_bf16 v[84:87], v[140:143], v[184:187], v[84:87]
    ds_read_b64_tr_b16 v[166:167], v111 offset:512
    v_mfma_f32_16x16x32_bf16 v[100:103], v[140:143], v[188:191], v[100:103]
    v_mfma_f32_16x16x32_bf16 v[96:99], v[136:139], v[188:191], v[96:99]
    v_mfma_f32_16x16x32_bf16 v[92:95], v[132:135], v[188:191], v[92:95]
    v_mfma_f32_16x16x32_bf16 v[88:91], v[128:131], v[188:191], v[88:91]
    s_waitcnt lgkmcnt(8)
    v_mfma_f32_16x16x32_bf16 v[8:11], v[144:147], v[112:115], v[8:11]
    ds_read_b128 v[128:131], v105 offset:32768
    v_mfma_f32_16x16x32_bf16 v[12:15], v[144:147], v[116:119], v[12:15]
    ds_read_b64_tr_b16 v[168:169], v107 offset:53248
    v_mfma_f32_16x16x32_bf16 v[16:19], v[144:147], v[120:123], v[16:19]
    ds_read_b64_tr_b16 v[170:171], v107 offset:53760
    v_mfma_f32_16x16x32_bf16 v[20:23], v[144:147], v[124:127], v[20:23]
    ds_read_b128 v[132:135], v105 offset:34816
    v_mfma_f32_16x16x32_bf16 v[36:39], v[148:151], v[124:127], v[36:39]
    ds_read_b128 v[136:139], v105 offset:36864
    v_mfma_f32_16x16x32_bf16 v[32:35], v[148:151], v[120:123], v[32:35]
    ds_read_b128 v[140:143], v105 offset:38912
    v_mfma_f32_16x16x32_bf16 v[28:31], v[148:151], v[116:119], v[28:31]
    ds_read_b64_tr_b16 v[172:173], v110 offset:53248
    v_mfma_f32_16x16x32_bf16 v[24:27], v[148:151], v[112:115], v[24:27]
    ds_read_b64_tr_b16 v[174:175], v110 offset:53760
    s_waitcnt lgkmcnt(12)
    v_mfma_f32_16x16x32_bf16 v[40:43], v[152:155], v[112:115], v[40:43]
    ds_read_b64_tr_b16 v[176:177], v107 offset:61440
    v_mfma_f32_16x16x32_bf16 v[44:47], v[152:155], v[116:119], v[44:47]
    ds_read_b64_tr_b16 v[178:179], v107 offset:61952
    v_mfma_f32_16x16x32_bf16 v[48:51], v[152:155], v[120:123], v[48:51]
    ds_read_b64_tr_b16 v[180:181], v110 offset:61440
    v_mfma_f32_16x16x32_bf16 v[52:55], v[152:155], v[124:127], v[52:55]
    ds_read_b64_tr_b16 v[182:183], v110 offset:61952
    v_mfma_f32_16x16x32_bf16 v[68:71], v[156:159], v[124:127], v[68:71]
    ds_read_b64_tr_b16 v[184:185], v108 offset:4096
    v_mfma_f32_16x16x32_bf16 v[64:67], v[156:159], v[120:123], v[64:67]
    ds_read_b64_tr_b16 v[186:187], v108 offset:4608
    v_mfma_f32_16x16x32_bf16 v[60:63], v[156:159], v[116:119], v[60:63]
    ds_read_b64_tr_b16 v[188:189], v111 offset:4096
    v_mfma_f32_16x16x32_bf16 v[56:59], v[156:159], v[112:115], v[56:59]
    ds_read_b64_tr_b16 v[190:191], v111 offset:4608
    s_waitcnt lgkmcnt(15)
    v_mfma_f32_16x16x32_bf16 v[72:75], v[112:115], v[160:163], v[72:75]
    v_mfma_f32_16x16x32_bf16 v[76:79], v[116:119], v[160:163], v[76:79]
    v_mfma_f32_16x16x32_bf16 v[80:83], v[120:123], v[160:163], v[80:83]
    v_mfma_f32_16x16x32_bf16 v[84:87], v[124:127], v[160:163], v[84:87]
    v_mfma_f32_16x16x32_bf16 v[100:103], v[124:127], v[164:167], v[100:103]
    v_mfma_f32_16x16x32_bf16 v[96:99], v[120:123], v[164:167], v[96:99]
    v_mfma_f32_16x16x32_bf16 v[92:95], v[116:119], v[164:167], v[92:95]
    v_mfma_f32_16x16x32_bf16 v[88:91], v[112:115], v[164:167], v[88:91]
    s_waitcnt lgkmcnt(8)
    v_mfma_f32_16x16x32_bf16 v[8:11], v[168:171], v[128:131], v[8:11]
    v_mfma_f32_16x16x32_bf16 v[12:15], v[168:171], v[132:135], v[12:15]
    v_mfma_f32_16x16x32_bf16 v[16:19], v[168:171], v[136:139], v[16:19]
    v_mfma_f32_16x16x32_bf16 v[20:23], v[168:171], v[140:143], v[20:23]
    s_waitcnt lgkmcnt(0)
    s_barrier
    v_mfma_f32_16x16x32_bf16 v[36:39], v[172:175], v[140:143], v[36:39]
    ds_read_b128 v[112:115], v104 offset:49152
    v_mfma_f32_16x16x32_bf16 v[32:35], v[172:175], v[136:139], v[32:35]
    ds_read_b64_tr_b16 v[144:145], v108 offset:8192
    v_mfma_f32_16x16x32_bf16 v[28:31], v[172:175], v[132:135], v[28:31]
    ds_read_b64_tr_b16 v[146:147], v108 offset:8704
    v_mfma_f32_16x16x32_bf16 v[24:27], v[172:175], v[128:131], v[24:27]
    ds_read_b128 v[116:119], v104 offset:51200
    v_mfma_f32_16x16x32_bf16 v[40:43], v[176:179], v[128:131], v[40:43]
    ds_read_b128 v[120:123], v104 offset:53248
    v_mfma_f32_16x16x32_bf16 v[44:47], v[176:179], v[132:135], v[44:47]
    ds_read_b128 v[124:127], v104 offset:55296
    v_mfma_f32_16x16x32_bf16 v[48:51], v[176:179], v[136:139], v[48:51]
    ds_read_b64_tr_b16 v[148:149], v111 offset:8192
    v_mfma_f32_16x16x32_bf16 v[52:55], v[176:179], v[140:143], v[52:55]
    ds_read_b64_tr_b16 v[150:151], v111 offset:8704
    v_mfma_f32_16x16x32_bf16 v[68:71], v[180:183], v[140:143], v[68:71]
    ds_read_b64_tr_b16 v[152:153], v108 offset:16384
    v_mfma_f32_16x16x32_bf16 v[64:67], v[180:183], v[136:139], v[64:67]
    ds_read_b64_tr_b16 v[154:155], v108 offset:16896
    v_mfma_f32_16x16x32_bf16 v[60:63], v[180:183], v[132:135], v[60:63]
    ds_read_b64_tr_b16 v[156:157], v111 offset:16384
    v_mfma_f32_16x16x32_bf16 v[56:59], v[180:183], v[128:131], v[56:59]
    ds_read_b64_tr_b16 v[158:159], v111 offset:16896
    v_mfma_f32_16x16x32_bf16 v[72:75], v[128:131], v[184:187], v[72:75]
    ds_read_b64_tr_b16 v[160:161], v108 offset:24576
    v_mfma_f32_16x16x32_bf16 v[76:79], v[132:135], v[184:187], v[76:79]
    ds_read_b64_tr_b16 v[162:163], v108 offset:25088
    v_mfma_f32_16x16x32_bf16 v[80:83], v[136:139], v[184:187], v[80:83]
    ds_read_b64_tr_b16 v[164:165], v111 offset:24576
    v_mfma_f32_16x16x32_bf16 v[84:87], v[140:143], v[184:187], v[84:87]
    ds_read_b64_tr_b16 v[166:167], v111 offset:25088
    v_mfma_f32_16x16x32_bf16 v[100:103], v[140:143], v[188:191], v[100:103]
    v_mfma_f32_16x16x32_bf16 v[96:99], v[136:139], v[188:191], v[96:99]
    v_mfma_f32_16x16x32_bf16 v[92:95], v[132:135], v[188:191], v[92:95]
    v_mfma_f32_16x16x32_bf16 v[88:91], v[128:131], v[188:191], v[88:91]
    s_waitcnt lgkmcnt(8)
    v_mfma_f32_16x16x32_bf16 v[8:11], v[144:147], v[112:115], v[8:11]
    ds_read_b128 v[128:131], v105 offset:49152
    v_mfma_f32_16x16x32_bf16 v[12:15], v[144:147], v[116:119], v[12:15]
    ds_read_b64_tr_b16 v[168:169], v108 offset:12288
    v_mfma_f32_16x16x32_bf16 v[16:19], v[144:147], v[120:123], v[16:19]
    ds_read_b64_tr_b16 v[170:171], v108 offset:12800
    v_mfma_f32_16x16x32_bf16 v[20:23], v[144:147], v[124:127], v[20:23]
    ds_read_b128 v[132:135], v105 offset:51200
    v_mfma_f32_16x16x32_bf16 v[36:39], v[148:151], v[124:127], v[36:39]
    ds_read_b128 v[136:139], v105 offset:53248
    v_mfma_f32_16x16x32_bf16 v[32:35], v[148:151], v[120:123], v[32:35]
    ds_read_b128 v[140:143], v105 offset:55296
    v_mfma_f32_16x16x32_bf16 v[28:31], v[148:151], v[116:119], v[28:31]
    ds_read_b64_tr_b16 v[172:173], v111 offset:12288
    v_mfma_f32_16x16x32_bf16 v[24:27], v[148:151], v[112:115], v[24:27]
    ds_read_b64_tr_b16 v[174:175], v111 offset:12800
    s_waitcnt lgkmcnt(12)
    v_mfma_f32_16x16x32_bf16 v[40:43], v[152:155], v[112:115], v[40:43]
    ds_read_b64_tr_b16 v[176:177], v108 offset:20480
    v_mfma_f32_16x16x32_bf16 v[44:47], v[152:155], v[116:119], v[44:47]
    ds_read_b64_tr_b16 v[178:179], v108 offset:20992
    v_mfma_f32_16x16x32_bf16 v[48:51], v[152:155], v[120:123], v[48:51]
    ds_read_b64_tr_b16 v[180:181], v111 offset:20480
    v_mfma_f32_16x16x32_bf16 v[52:55], v[152:155], v[124:127], v[52:55]
    ds_read_b64_tr_b16 v[182:183], v111 offset:20992
    v_mfma_f32_16x16x32_bf16 v[68:71], v[156:159], v[124:127], v[68:71]
    ds_read_b64_tr_b16 v[184:185], v108 offset:28672
    v_mfma_f32_16x16x32_bf16 v[64:67], v[156:159], v[120:123], v[64:67]
    ds_read_b64_tr_b16 v[186:187], v108 offset:29184
    v_mfma_f32_16x16x32_bf16 v[60:63], v[156:159], v[116:119], v[60:63]
    ds_read_b64_tr_b16 v[188:189], v111 offset:28672
    v_mfma_f32_16x16x32_bf16 v[56:59], v[156:159], v[112:115], v[56:59]
    ds_read_b64_tr_b16 v[190:191], v111 offset:29184
    s_waitcnt lgkmcnt(15)
    v_mfma_f32_16x16x32_bf16 v[72:75], v[112:115], v[160:163], v[72:75]
    v_mfma_f32_16x16x32_bf16 v[76:79], v[116:119], v[160:163], v[76:79]
    v_mfma_f32_16x16x32_bf16 v[80:83], v[120:123], v[160:163], v[80:83]
    v_mfma_f32_16x16x32_bf16 v[84:87], v[124:127], v[160:163], v[84:87]
    v_mfma_f32_16x16x32_bf16 v[100:103], v[124:127], v[164:167], v[100:103]
    v_mfma_f32_16x16x32_bf16 v[96:99], v[120:123], v[164:167], v[96:99]
    v_mfma_f32_16x16x32_bf16 v[92:95], v[116:119], v[164:167], v[92:95]
    v_mfma_f32_16x16x32_bf16 v[88:91], v[112:115], v[164:167], v[88:91]
    s_waitcnt lgkmcnt(8)
    v_mfma_f32_16x16x32_bf16 v[8:11], v[168:171], v[128:131], v[8:11]
    v_mfma_f32_16x16x32_bf16 v[12:15], v[168:171], v[132:135], v[12:15]
    v_mfma_f32_16x16x32_bf16 v[16:19], v[168:171], v[136:139], v[16:19]
    v_mfma_f32_16x16x32_bf16 v[20:23], v[168:171], v[140:143], v[20:23]
    s_waitcnt lgkmcnt(0)
    s_barrier
    v_mfma_f32_16x16x32_bf16 v[36:39], v[172:175], v[140:143], v[36:39]
    ds_read_b128 v[112:115], v104 offset:0
    v_mfma_f32_16x16x32_bf16 v[32:35], v[172:175], v[136:139], v[32:35]
    ds_read_b64_tr_b16 v[144:145], v107 offset:0
    v_mfma_f32_16x16x32_bf16 v[28:31], v[172:175], v[132:135], v[28:31]
    ds_read_b64_tr_b16 v[146:147], v107 offset:512
    v_mfma_f32_16x16x32_bf16 v[24:27], v[172:175], v[128:131], v[24:27]
    ds_read_b128 v[116:119], v104 offset:2048
    v_mfma_f32_16x16x32_bf16 v[40:43], v[176:179], v[128:131], v[40:43]
    ds_read_b128 v[120:123], v104 offset:4096
    v_mfma_f32_16x16x32_bf16 v[44:47], v[176:179], v[132:135], v[44:47]
    ds_read_b128 v[124:127], v104 offset:6144
    v_mfma_f32_16x16x32_bf16 v[48:51], v[176:179], v[136:139], v[48:51]
    ds_read_b64_tr_b16 v[148:149], v110 offset:0
    v_mfma_f32_16x16x32_bf16 v[52:55], v[176:179], v[140:143], v[52:55]
    ds_read_b64_tr_b16 v[150:151], v110 offset:512
    v_mfma_f32_16x16x32_bf16 v[68:71], v[180:183], v[140:143], v[68:71]
    ds_read_b64_tr_b16 v[152:153], v107 offset:8192
    v_mfma_f32_16x16x32_bf16 v[64:67], v[180:183], v[136:139], v[64:67]
    ds_read_b64_tr_b16 v[154:155], v107 offset:8704
    v_mfma_f32_16x16x32_bf16 v[60:63], v[180:183], v[132:135], v[60:63]
    ds_read_b64_tr_b16 v[156:157], v110 offset:8192
    v_mfma_f32_16x16x32_bf16 v[56:59], v[180:183], v[128:131], v[56:59]
    ds_read_b64_tr_b16 v[158:159], v110 offset:8704
    v_mfma_f32_16x16x32_bf16 v[72:75], v[128:131], v[184:187], v[72:75]
    ds_read_b64_tr_b16 v[160:161], v107 offset:16384
    v_mfma_f32_16x16x32_bf16 v[76:79], v[132:135], v[184:187], v[76:79]
    ds_read_b64_tr_b16 v[162:163], v107 offset:16896
    v_mfma_f32_16x16x32_bf16 v[80:83], v[136:139], v[184:187], v[80:83]
    ds_read_b64_tr_b16 v[164:165], v110 offset:16384
    v_mfma_f32_16x16x32_bf16 v[84:87], v[140:143], v[184:187], v[84:87]
    ds_read_b64_tr_b16 v[166:167], v110 offset:16896
    v_mfma_f32_16x16x32_bf16 v[100:103], v[140:143], v[188:191], v[100:103]
    v_mfma_f32_16x16x32_bf16 v[96:99], v[136:139], v[188:191], v[96:99]
    v_mfma_f32_16x16x32_bf16 v[92:95], v[132:135], v[188:191], v[92:95]
    v_mfma_f32_16x16x32_bf16 v[88:91], v[128:131], v[188:191], v[88:91]
    s_waitcnt lgkmcnt(8)
    v_mfma_f32_16x16x32_bf16 v[8:11], v[144:147], v[112:115], v[8:11]
    ds_read_b128 v[128:131], v105 offset:0
    v_mfma_f32_16x16x32_bf16 v[12:15], v[144:147], v[116:119], v[12:15]
    ds_read_b64_tr_b16 v[168:169], v107 offset:4096
    v_mfma_f32_16x16x32_bf16 v[16:19], v[144:147], v[120:123], v[16:19]
    ds_read_b64_tr_b16 v[170:171], v107 offset:4608
    v_mfma_f32_16x16x32_bf16 v[20:23], v[144:147], v[124:127], v[20:23]
    ds_read_b128 v[132:135], v105 offset:2048
    v_mfma_f32_16x16x32_bf16 v[36:39], v[148:151], v[124:127], v[36:39]
    ds_read_b128 v[136:139], v105 offset:4096
    v_mfma_f32_16x16x32_bf16 v[32:35], v[148:151], v[120:123], v[32:35]
    ds_read_b128 v[140:143], v105 offset:6144
    v_mfma_f32_16x16x32_bf16 v[28:31], v[148:151], v[116:119], v[28:31]
    ds_read_b64_tr_b16 v[172:173], v110 offset:4096
    v_mfma_f32_16x16x32_bf16 v[24:27], v[148:151], v[112:115], v[24:27]
    ds_read_b64_tr_b16 v[174:175], v110 offset:4608
    s_waitcnt lgkmcnt(12)
    v_mfma_f32_16x16x32_bf16 v[40:43], v[152:155], v[112:115], v[40:43]
    ds_read_b64_tr_b16 v[176:177], v107 offset:12288
    v_mfma_f32_16x16x32_bf16 v[44:47], v[152:155], v[116:119], v[44:47]
    ds_read_b64_tr_b16 v[178:179], v107 offset:12800
    v_mfma_f32_16x16x32_bf16 v[48:51], v[152:155], v[120:123], v[48:51]
    ds_read_b64_tr_b16 v[180:181], v110 offset:12288
    v_mfma_f32_16x16x32_bf16 v[52:55], v[152:155], v[124:127], v[52:55]
    ds_read_b64_tr_b16 v[182:183], v110 offset:12800
    v_mfma_f32_16x16x32_bf16 v[68:71], v[156:159], v[124:127], v[68:71]
    ds_read_b64_tr_b16 v[184:185], v107 offset:20480
    v_mfma_f32_16x16x32_bf16 v[64:67], v[156:159], v[120:123], v[64:67]
    ds_read_b64_tr_b16 v[186:187], v107 offset:20992
    v_mfma_f32_16x16x32_bf16 v[60:63], v[156:159], v[116:119], v[60:63]
    ds_read_b64_tr_b16 v[188:189], v110 offset:20480
    v_mfma_f32_16x16x32_bf16 v[56:59], v[156:159], v[112:115], v[56:59]
    ds_read_b64_tr_b16 v[190:191], v110 offset:20992
    s_waitcnt lgkmcnt(15)
    v_mfma_f32_16x16x32_bf16 v[72:75], v[112:115], v[160:163], v[72:75]
    v_mfma_f32_16x16x32_bf16 v[76:79], v[116:119], v[160:163], v[76:79]
    v_mfma_f32_16x16x32_bf16 v[80:83], v[120:123], v[160:163], v[80:83]
    v_mfma_f32_16x16x32_bf16 v[84:87], v[124:127], v[160:163], v[84:87]
    v_mfma_f32_16x16x32_bf16 v[100:103], v[124:127], v[164:167], v[100:103]
    v_mfma_f32_16x16x32_bf16 v[96:99], v[120:123], v[164:167], v[96:99]
    v_mfma_f32_16x16x32_bf16 v[92:95], v[116:119], v[164:167], v[92:95]
    v_mfma_f32_16x16x32_bf16 v[88:91], v[112:115], v[164:167], v[88:91]
    s_waitcnt lgkmcnt(8)
    v_mfma_f32_16x16x32_bf16 v[8:11], v[168:171], v[128:131], v[8:11]
    v_mfma_f32_16x16x32_bf16 v[12:15], v[168:171], v[132:135], v[12:15]
    v_mfma_f32_16x16x32_bf16 v[16:19], v[168:171], v[136:139], v[16:19]
    v_mfma_f32_16x16x32_bf16 v[20:23], v[168:171], v[140:143], v[20:23]
    s_waitcnt lgkmcnt(0)
    s_barrier
    v_mfma_f32_16x16x32_bf16 v[36:39], v[172:175], v[140:143], v[36:39]
    ds_read_b128 v[112:115], v104 offset:16384
    v_mfma_f32_16x16x32_bf16 v[32:35], v[172:175], v[136:139], v[32:35]
    ds_read_b64_tr_b16 v[144:145], v107 offset:24576
    v_mfma_f32_16x16x32_bf16 v[28:31], v[172:175], v[132:135], v[28:31]
    ds_read_b64_tr_b16 v[146:147], v107 offset:25088
    v_mfma_f32_16x16x32_bf16 v[24:27], v[172:175], v[128:131], v[24:27]
    ds_read_b128 v[116:119], v104 offset:18432
    v_mfma_f32_16x16x32_bf16 v[40:43], v[176:179], v[128:131], v[40:43]
    ds_read_b128 v[120:123], v104 offset:20480
    v_mfma_f32_16x16x32_bf16 v[44:47], v[176:179], v[132:135], v[44:47]
    ds_read_b128 v[124:127], v104 offset:22528
    v_mfma_f32_16x16x32_bf16 v[48:51], v[176:179], v[136:139], v[48:51]
    ds_read_b64_tr_b16 v[148:149], v110 offset:24576
    v_mfma_f32_16x16x32_bf16 v[52:55], v[176:179], v[140:143], v[52:55]
    ds_read_b64_tr_b16 v[150:151], v110 offset:25088
    v_mfma_f32_16x16x32_bf16 v[68:71], v[180:183], v[140:143], v[68:71]
    ds_read_b64_tr_b16 v[152:153], v107 offset:32768
    v_mfma_f32_16x16x32_bf16 v[64:67], v[180:183], v[136:139], v[64:67]
    ds_read_b64_tr_b16 v[154:155], v107 offset:33280
    v_mfma_f32_16x16x32_bf16 v[60:63], v[180:183], v[132:135], v[60:63]
    ds_read_b64_tr_b16 v[156:157], v110 offset:32768
    v_mfma_f32_16x16x32_bf16 v[56:59], v[180:183], v[128:131], v[56:59]
    ds_read_b64_tr_b16 v[158:159], v110 offset:33280
    v_mfma_f32_16x16x32_bf16 v[72:75], v[128:131], v[184:187], v[72:75]
    ds_read_b64_tr_b16 v[160:161], v107 offset:40960
    v_mfma_f32_16x16x32_bf16 v[76:79], v[132:135], v[184:187], v[76:79]
    ds_read_b64_tr_b16 v[162:163], v107 offset:41472
    v_mfma_f32_16x16x32_bf16 v[80:83], v[136:139], v[184:187], v[80:83]
    ds_read_b64_tr_b16 v[164:165], v110 offset:40960
    v_mfma_f32_16x16x32_bf16 v[84:87], v[140:143], v[184:187], v[84:87]
    ds_read_b64_tr_b16 v[166:167], v110 offset:41472
    v_mfma_f32_16x16x32_bf16 v[100:103], v[140:143], v[188:191], v[100:103]
    v_mfma_f32_16x16x32_bf16 v[96:99], v[136:139], v[188:191], v[96:99]
    v_mfma_f32_16x16x32_bf16 v[92:95], v[132:135], v[188:191], v[92:95]
    v_mfma_f32_16x16x32_bf16 v[88:91], v[128:131], v[188:191], v[88:91]
    s_waitcnt lgkmcnt(8)
    v_mfma_f32_16x16x32_bf16 v[8:11], v[144:147], v[112:115], v[8:11]
    ds_read_b128 v[128:131], v105 offset:16384
    v_mfma_f32_16x16x32_bf16 v[12:15], v[144:147], v[116:119], v[12:15]
    ds_read_b64_tr_b16 v[168:169], v107 offset:28672
    v_mfma_f32_16x16x32_bf16 v[16:19], v[144:147], v[120:123], v[16:19]
    ds_read_b64_tr_b16 v[170:171], v107 offset:29184
    v_mfma_f32_16x16x32_bf16 v[20:23], v[144:147], v[124:127], v[20:23]
    ds_read_b128 v[132:135], v105 offset:18432
    v_mfma_f32_16x16x32_bf16 v[36:39], v[148:151], v[124:127], v[36:39]
    ds_read_b128 v[136:139], v105 offset:20480
    v_mfma_f32_16x16x32_bf16 v[32:35], v[148:151], v[120:123], v[32:35]
    ds_read_b128 v[140:143], v105 offset:22528
    v_mfma_f32_16x16x32_bf16 v[28:31], v[148:151], v[116:119], v[28:31]
    ds_read_b64_tr_b16 v[172:173], v110 offset:28672
    v_mfma_f32_16x16x32_bf16 v[24:27], v[148:151], v[112:115], v[24:27]
    ds_read_b64_tr_b16 v[174:175], v110 offset:29184
    s_waitcnt lgkmcnt(12)
    v_mfma_f32_16x16x32_bf16 v[40:43], v[152:155], v[112:115], v[40:43]
    ds_read_b64_tr_b16 v[176:177], v107 offset:36864
    v_mfma_f32_16x16x32_bf16 v[44:47], v[152:155], v[116:119], v[44:47]
    ds_read_b64_tr_b16 v[178:179], v107 offset:37376
    v_mfma_f32_16x16x32_bf16 v[48:51], v[152:155], v[120:123], v[48:51]
    ds_read_b64_tr_b16 v[180:181], v110 offset:36864
    v_mfma_f32_16x16x32_bf16 v[52:55], v[152:155], v[124:127], v[52:55]
    ds_read_b64_tr_b16 v[182:183], v110 offset:37376
    v_mfma_f32_16x16x32_bf16 v[68:71], v[156:159], v[124:127], v[68:71]
    ds_read_b64_tr_b16 v[184:185], v107 offset:45056
    v_mfma_f32_16x16x32_bf16 v[64:67], v[156:159], v[120:123], v[64:67]
    ds_read_b64_tr_b16 v[186:187], v107 offset:45568
    v_mfma_f32_16x16x32_bf16 v[60:63], v[156:159], v[116:119], v[60:63]
    ds_read_b64_tr_b16 v[188:189], v110 offset:45056
    v_mfma_f32_16x16x32_bf16 v[56:59], v[156:159], v[112:115], v[56:59]
    ds_read_b64_tr_b16 v[190:191], v110 offset:45568
    s_waitcnt lgkmcnt(15)
    v_mfma_f32_16x16x32_bf16 v[72:75], v[112:115], v[160:163], v[72:75]
    v_mfma_f32_16x16x32_bf16 v[76:79], v[116:119], v[160:163], v[76:79]
    v_mfma_f32_16x16x32_bf16 v[80:83], v[120:123], v[160:163], v[80:83]
    v_mfma_f32_16x16x32_bf16 v[84:87], v[124:127], v[160:163], v[84:87]
    v_mfma_f32_16x16x32_bf16 v[100:103], v[124:127], v[164:167], v[100:103]
    v_mfma_f32_16x16x32_bf16 v[96:99], v[120:123], v[164:167], v[96:99]
    v_mfma_f32_16x16x32_bf16 v[92:95], v[116:119], v[164:167], v[92:95]
    v_mfma_f32_16x16x32_bf16 v[88:91], v[112:115], v[164:167], v[88:91]
    s_waitcnt lgkmcnt(8)
    v_mfma_f32_16x16x32_bf16 v[8:11], v[168:171], v[128:131], v[8:11]
    v_mfma_f32_16x16x32_bf16 v[12:15], v[168:171], v[132:135], v[12:15]
    v_mfma_f32_16x16x32_bf16 v[16:19], v[168:171], v[136:139], v[16:19]
    v_mfma_f32_16x16x32_bf16 v[20:23], v[168:171], v[140:143], v[20:23]
    s_waitcnt lgkmcnt(0)
    s_barrier
    v_mfma_f32_16x16x32_bf16 v[36:39], v[172:175], v[140:143], v[36:39]
    ds_read_b128 v[112:115], v104 offset:32768
    v_mfma_f32_16x16x32_bf16 v[32:35], v[172:175], v[136:139], v[32:35]
    ds_read_b64_tr_b16 v[144:145], v107 offset:49152
    v_mfma_f32_16x16x32_bf16 v[28:31], v[172:175], v[132:135], v[28:31]
    ds_read_b64_tr_b16 v[146:147], v107 offset:49664
    v_mfma_f32_16x16x32_bf16 v[24:27], v[172:175], v[128:131], v[24:27]
    ds_read_b128 v[116:119], v104 offset:34816
    v_mfma_f32_16x16x32_bf16 v[40:43], v[176:179], v[128:131], v[40:43]
    ds_read_b128 v[120:123], v104 offset:36864
    v_mfma_f32_16x16x32_bf16 v[44:47], v[176:179], v[132:135], v[44:47]
    ds_read_b128 v[124:127], v104 offset:38912
    v_mfma_f32_16x16x32_bf16 v[48:51], v[176:179], v[136:139], v[48:51]
    ds_read_b64_tr_b16 v[148:149], v110 offset:49152
    v_mfma_f32_16x16x32_bf16 v[52:55], v[176:179], v[140:143], v[52:55]
    ds_read_b64_tr_b16 v[150:151], v110 offset:49664
    v_mfma_f32_16x16x32_bf16 v[68:71], v[180:183], v[140:143], v[68:71]
    ds_read_b64_tr_b16 v[152:153], v107 offset:57344
    v_mfma_f32_16x16x32_bf16 v[64:67], v[180:183], v[136:139], v[64:67]
    ds_read_b64_tr_b16 v[154:155], v107 offset:57856
    v_mfma_f32_16x16x32_bf16 v[60:63], v[180:183], v[132:135], v[60:63]
    ds_read_b64_tr_b16 v[156:157], v110 offset:57344
    v_mfma_f32_16x16x32_bf16 v[56:59], v[180:183], v[128:131], v[56:59]
    ds_read_b64_tr_b16 v[158:159], v110 offset:57856
    v_mfma_f32_16x16x32_bf16 v[72:75], v[128:131], v[184:187], v[72:75]
    ds_read_b64_tr_b16 v[160:161], v108 offset:0
    v_mfma_f32_16x16x32_bf16 v[76:79], v[132:135], v[184:187], v[76:79]
    ds_read_b64_tr_b16 v[162:163], v108 offset:512
    v_mfma_f32_16x16x32_bf16 v[80:83], v[136:139], v[184:187], v[80:83]
    ds_read_b64_tr_b16 v[164:165], v111 offset:0
    v_mfma_f32_16x16x32_bf16 v[84:87], v[140:143], v[184:187], v[84:87]
    ds_read_b64_tr_b16 v[166:167], v111 offset:512
    v_mfma_f32_16x16x32_bf16 v[100:103], v[140:143], v[188:191], v[100:103]
    v_mfma_f32_16x16x32_bf16 v[96:99], v[136:139], v[188:191], v[96:99]
    v_mfma_f32_16x16x32_bf16 v[92:95], v[132:135], v[188:191], v[92:95]
    v_mfma_f32_16x16x32_bf16 v[88:91], v[128:131], v[188:191], v[88:91]
    s_waitcnt lgkmcnt(8)
    v_mfma_f32_16x16x32_bf16 v[8:11], v[144:147], v[112:115], v[8:11]
    ds_read_b128 v[128:131], v105 offset:32768
    v_mfma_f32_16x16x32_bf16 v[12:15], v[144:147], v[116:119], v[12:15]
    ds_read_b64_tr_b16 v[168:169], v107 offset:53248
    v_mfma_f32_16x16x32_bf16 v[16:19], v[144:147], v[120:123], v[16:19]
    ds_read_b64_tr_b16 v[170:171], v107 offset:53760
    v_mfma_f32_16x16x32_bf16 v[20:23], v[144:147], v[124:127], v[20:23]
    ds_read_b128 v[132:135], v105 offset:34816
    v_mfma_f32_16x16x32_bf16 v[36:39], v[148:151], v[124:127], v[36:39]
    ds_read_b128 v[136:139], v105 offset:36864
    v_mfma_f32_16x16x32_bf16 v[32:35], v[148:151], v[120:123], v[32:35]
    ds_read_b128 v[140:143], v105 offset:38912
    v_mfma_f32_16x16x32_bf16 v[28:31], v[148:151], v[116:119], v[28:31]
    ds_read_b64_tr_b16 v[172:173], v110 offset:53248
    v_mfma_f32_16x16x32_bf16 v[24:27], v[148:151], v[112:115], v[24:27]
    ds_read_b64_tr_b16 v[174:175], v110 offset:53760
    s_waitcnt lgkmcnt(12)
    v_mfma_f32_16x16x32_bf16 v[40:43], v[152:155], v[112:115], v[40:43]
    ds_read_b64_tr_b16 v[176:177], v107 offset:61440
    v_mfma_f32_16x16x32_bf16 v[44:47], v[152:155], v[116:119], v[44:47]
    ds_read_b64_tr_b16 v[178:179], v107 offset:61952
    v_mfma_f32_16x16x32_bf16 v[48:51], v[152:155], v[120:123], v[48:51]
    ds_read_b64_tr_b16 v[180:181], v110 offset:61440
    v_mfma_f32_16x16x32_bf16 v[52:55], v[152:155], v[124:127], v[52:55]
    ds_read_b64_tr_b16 v[182:183], v110 offset:61952
    v_mfma_f32_16x16x32_bf16 v[68:71], v[156:159], v[124:127], v[68:71]
    ds_read_b64_tr_b16 v[184:185], v108 offset:4096
    v_mfma_f32_16x16x32_bf16 v[64:67], v[156:159], v[120:123], v[64:67]
    ds_read_b64_tr_b16 v[186:187], v108 offset:4608
    v_mfma_f32_16x16x32_bf16 v[60:63], v[156:159], v[116:119], v[60:63]
    ds_read_b64_tr_b16 v[188:189], v111 offset:4096
    v_mfma_f32_16x16x32_bf16 v[56:59], v[156:159], v[112:115], v[56:59]
    ds_read_b64_tr_b16 v[190:191], v111 offset:4608
    s_waitcnt lgkmcnt(15)
    v_mfma_f32_16x16x32_bf16 v[72:75], v[112:115], v[160:163], v[72:75]
    v_mfma_f32_16x16x32_bf16 v[76:79], v[116:119], v[160:163], v[76:79]
    v_mfma_f32_16x16x32_bf16 v[80:83], v[120:123], v[160:163], v[80:83]
    v_mfma_f32_16x16x32_bf16 v[84:87], v[124:127], v[160:163], v[84:87]
    v_mfma_f32_16x16x32_bf16 v[100:103], v[124:127], v[164:167], v[100:103]
    v_mfma_f32_16x16x32_bf16 v[96:99], v[120:123], v[164:167], v[96:99]
    v_mfma_f32_16x16x32_bf16 v[92:95], v[116:119], v[164:167], v[92:95]
    v_mfma_f32_16x16x32_bf16 v[88:91], v[112:115], v[164:167], v[88:91]
    s_waitcnt lgkmcnt(8)
    v_mfma_f32_16x16x32_bf16 v[8:11], v[168:171], v[128:131], v[8:11]
    v_mfma_f32_16x16x32_bf16 v[12:15], v[168:171], v[132:135], v[12:15]
    v_mfma_f32_16x16x32_bf16 v[16:19], v[168:171], v[136:139], v[16:19]
    v_mfma_f32_16x16x32_bf16 v[20:23], v[168:171], v[140:143], v[20:23]
    s_waitcnt lgkmcnt(0)
    s_barrier
    v_mfma_f32_16x16x32_bf16 v[36:39], v[172:175], v[140:143], v[36:39]
    ds_read_b128 v[112:115], v104 offset:49152
    v_mfma_f32_16x16x32_bf16 v[32:35], v[172:175], v[136:139], v[32:35]
    ds_read_b64_tr_b16 v[144:145], v108 offset:8192
    v_mfma_f32_16x16x32_bf16 v[28:31], v[172:175], v[132:135], v[28:31]
    ds_read_b64_tr_b16 v[146:147], v108 offset:8704
    v_mfma_f32_16x16x32_bf16 v[24:27], v[172:175], v[128:131], v[24:27]
    ds_read_b128 v[116:119], v104 offset:51200
    v_mfma_f32_16x16x32_bf16 v[40:43], v[176:179], v[128:131], v[40:43]
    ds_read_b128 v[120:123], v104 offset:53248
    v_mfma_f32_16x16x32_bf16 v[44:47], v[176:179], v[132:135], v[44:47]
    ds_read_b128 v[124:127], v104 offset:55296
    v_mfma_f32_16x16x32_bf16 v[48:51], v[176:179], v[136:139], v[48:51]
    ds_read_b64_tr_b16 v[148:149], v111 offset:8192
    v_mfma_f32_16x16x32_bf16 v[52:55], v[176:179], v[140:143], v[52:55]
    ds_read_b64_tr_b16 v[150:151], v111 offset:8704
    v_mfma_f32_16x16x32_bf16 v[68:71], v[180:183], v[140:143], v[68:71]
    ds_read_b64_tr_b16 v[152:153], v108 offset:16384
    v_mfma_f32_16x16x32_bf16 v[64:67], v[180:183], v[136:139], v[64:67]
    ds_read_b64_tr_b16 v[154:155], v108 offset:16896
    v_mfma_f32_16x16x32_bf16 v[60:63], v[180:183], v[132:135], v[60:63]
    ds_read_b64_tr_b16 v[156:157], v111 offset:16384
    v_mfma_f32_16x16x32_bf16 v[56:59], v[180:183], v[128:131], v[56:59]
    ds_read_b64_tr_b16 v[158:159], v111 offset:16896
    v_mfma_f32_16x16x32_bf16 v[72:75], v[128:131], v[184:187], v[72:75]
    ds_read_b64_tr_b16 v[160:161], v108 offset:24576
    v_mfma_f32_16x16x32_bf16 v[76:79], v[132:135], v[184:187], v[76:79]
    ds_read_b64_tr_b16 v[162:163], v108 offset:25088
    v_mfma_f32_16x16x32_bf16 v[80:83], v[136:139], v[184:187], v[80:83]
    ds_read_b64_tr_b16 v[164:165], v111 offset:24576
    v_mfma_f32_16x16x32_bf16 v[84:87], v[140:143], v[184:187], v[84:87]
    ds_read_b64_tr_b16 v[166:167], v111 offset:25088
    v_mfma_f32_16x16x32_bf16 v[100:103], v[140:143], v[188:191], v[100:103]
    v_mfma_f32_16x16x32_bf16 v[96:99], v[136:139], v[188:191], v[96:99]
    v_mfma_f32_16x16x32_bf16 v[92:95], v[132:135], v[188:191], v[92:95]
    v_mfma_f32_16x16x32_bf16 v[88:91], v[128:131], v[188:191], v[88:91]
    s_waitcnt lgkmcnt(8)
    v_mfma_f32_16x16x32_bf16 v[8:11], v[144:147], v[112:115], v[8:11]
    ds_read_b128 v[128:131], v105 offset:49152
    v_mfma_f32_16x16x32_bf16 v[12:15], v[144:147], v[116:119], v[12:15]
    ds_read_b64_tr_b16 v[168:169], v108 offset:12288
    v_mfma_f32_16x16x32_bf16 v[16:19], v[144:147], v[120:123], v[16:19]
    ds_read_b64_tr_b16 v[170:171], v108 offset:12800
    v_mfma_f32_16x16x32_bf16 v[20:23], v[144:147], v[124:127], v[20:23]
    ds_read_b128 v[132:135], v105 offset:51200
    v_mfma_f32_16x16x32_bf16 v[36:39], v[148:151], v[124:127], v[36:39]
    ds_read_b128 v[136:139], v105 offset:53248
    v_mfma_f32_16x16x32_bf16 v[32:35], v[148:151], v[120:123], v[32:35]
    ds_read_b128 v[140:143], v105 offset:55296
    v_mfma_f32_16x16x32_bf16 v[28:31], v[148:151], v[116:119], v[28:31]
    ds_read_b64_tr_b16 v[172:173], v111 offset:12288
    v_mfma_f32_16x16x32_bf16 v[24:27], v[148:151], v[112:115], v[24:27]
    ds_read_b64_tr_b16 v[174:175], v111 offset:12800
    s_waitcnt lgkmcnt(12)
    v_mfma_f32_16x16x32_bf16 v[40:43], v[152:155], v[112:115], v[40:43]
    ds_read_b64_tr_b16 v[176:177], v108 offset:20480
    v_mfma_f32_16x16x32_bf16 v[44:47], v[152:155], v[116:119], v[44:47]
    ds_read_b64_tr_b16 v[178:179], v108 offset:20992
    v_mfma_f32_16x16x32_bf16 v[48:51], v[152:155], v[120:123], v[48:51]
    ds_read_b64_tr_b16 v[180:181], v111 offset:20480
    v_mfma_f32_16x16x32_bf16 v[52:55], v[152:155], v[124:127], v[52:55]
    ds_read_b64_tr_b16 v[182:183], v111 offset:20992
    v_mfma_f32_16x16x32_bf16 v[68:71], v[156:159], v[124:127], v[68:71]
    ds_read_b64_tr_b16 v[184:185], v108 offset:28672
    v_mfma_f32_16x16x32_bf16 v[64:67], v[156:159], v[120:123], v[64:67]
    ds_read_b64_tr_b16 v[186:187], v108 offset:29184
    v_mfma_f32_16x16x32_bf16 v[60:63], v[156:159], v[116:119], v[60:63]
    ds_read_b64_tr_b16 v[188:189], v111 offset:28672
    v_mfma_f32_16x16x32_bf16 v[56:59], v[156:159], v[112:115], v[56:59]
    ds_read_b64_tr_b16 v[190:191], v111 offset:29184
    s_waitcnt lgkmcnt(15)
    v_mfma_f32_16x16x32_bf16 v[72:75], v[112:115], v[160:163], v[72:75]
    v_mfma_f32_16x16x32_bf16 v[76:79], v[116:119], v[160:163], v[76:79]
    v_mfma_f32_16x16x32_bf16 v[80:83], v[120:123], v[160:163], v[80:83]
    v_mfma_f32_16x16x32_bf16 v[84:87], v[124:127], v[160:163], v[84:87]
    v_mfma_f32_16x16x32_bf16 v[100:103], v[124:127], v[164:167], v[100:103]
    v_mfma_f32_16x16x32_bf16 v[96:99], v[120:123], v[164:167], v[96:99]
    v_mfma_f32_16x16x32_bf16 v[92:95], v[116:119], v[164:167], v[92:95]
    v_mfma_f32_16x16x32_bf16 v[88:91], v[112:115], v[164:167], v[88:91]
    s_waitcnt lgkmcnt(8)
    v_mfma_f32_16x16x32_bf16 v[8:11], v[168:171], v[128:131], v[8:11]
    v_mfma_f32_16x16x32_bf16 v[12:15], v[168:171], v[132:135], v[12:15]
    v_mfma_f32_16x16x32_bf16 v[16:19], v[168:171], v[136:139], v[16:19]
    v_mfma_f32_16x16x32_bf16 v[20:23], v[168:171], v[140:143], v[20:23]
    s_waitcnt lgkmcnt(0)
    s_barrier
    v_mfma_f32_16x16x32_bf16 v[36:39], v[172:175], v[140:143], v[36:39]
    ds_read_b128 v[112:115], v104 offset:0
    v_mfma_f32_16x16x32_bf16 v[32:35], v[172:175], v[136:139], v[32:35]
    ds_read_b64_tr_b16 v[144:145], v107 offset:0
    v_mfma_f32_16x16x32_bf16 v[28:31], v[172:175], v[132:135], v[28:31]
    ds_read_b64_tr_b16 v[146:147], v107 offset:512
    v_mfma_f32_16x16x32_bf16 v[24:27], v[172:175], v[128:131], v[24:27]
    ds_read_b128 v[116:119], v104 offset:2048
    v_mfma_f32_16x16x32_bf16 v[40:43], v[176:179], v[128:131], v[40:43]
    ds_read_b128 v[120:123], v104 offset:4096
    v_mfma_f32_16x16x32_bf16 v[44:47], v[176:179], v[132:135], v[44:47]
    ds_read_b128 v[124:127], v104 offset:6144
    v_mfma_f32_16x16x32_bf16 v[48:51], v[176:179], v[136:139], v[48:51]
    ds_read_b64_tr_b16 v[148:149], v110 offset:0
    v_mfma_f32_16x16x32_bf16 v[52:55], v[176:179], v[140:143], v[52:55]
    ds_read_b64_tr_b16 v[150:151], v110 offset:512
    v_mfma_f32_16x16x32_bf16 v[68:71], v[180:183], v[140:143], v[68:71]
    ds_read_b64_tr_b16 v[152:153], v107 offset:8192
    v_mfma_f32_16x16x32_bf16 v[64:67], v[180:183], v[136:139], v[64:67]
    ds_read_b64_tr_b16 v[154:155], v107 offset:8704
    v_mfma_f32_16x16x32_bf16 v[60:63], v[180:183], v[132:135], v[60:63]
    ds_read_b64_tr_b16 v[156:157], v110 offset:8192
    v_mfma_f32_16x16x32_bf16 v[56:59], v[180:183], v[128:131], v[56:59]
    ds_read_b64_tr_b16 v[158:159], v110 offset:8704
    v_mfma_f32_16x16x32_bf16 v[72:75], v[128:131], v[184:187], v[72:75]
    ds_read_b64_tr_b16 v[160:161], v107 offset:16384
    v_mfma_f32_16x16x32_bf16 v[76:79], v[132:135], v[184:187], v[76:79]
    ds_read_b64_tr_b16 v[162:163], v107 offset:16896
    v_mfma_f32_16x16x32_bf16 v[80:83], v[136:139], v[184:187], v[80:83]
    ds_read_b64_tr_b16 v[164:165], v110 offset:16384
    v_mfma_f32_16x16x32_bf16 v[84:87], v[140:143], v[184:187], v[84:87]
    ds_read_b64_tr_b16 v[166:167], v110 offset:16896
    v_mfma_f32_16x16x32_bf16 v[100:103], v[140:143], v[188:191], v[100:103]
    v_mfma_f32_16x16x32_bf16 v[96:99], v[136:139], v[188:191], v[96:99]
    v_mfma_f32_16x16x32_bf16 v[92:95], v[132:135], v[188:191], v[92:95]
    v_mfma_f32_16x16x32_bf16 v[88:91], v[128:131], v[188:191], v[88:91]
    s_waitcnt lgkmcnt(8)
    v_mfma_f32_16x16x32_bf16 v[8:11], v[144:147], v[112:115], v[8:11]
    ds_read_b128 v[128:131], v105 offset:0
    v_mfma_f32_16x16x32_bf16 v[12:15], v[144:147], v[116:119], v[12:15]
    ds_read_b64_tr_b16 v[168:169], v107 offset:4096
    v_mfma_f32_16x16x32_bf16 v[16:19], v[144:147], v[120:123], v[16:19]
    ds_read_b64_tr_b16 v[170:171], v107 offset:4608
    v_mfma_f32_16x16x32_bf16 v[20:23], v[144:147], v[124:127], v[20:23]
    ds_read_b128 v[132:135], v105 offset:2048
    v_mfma_f32_16x16x32_bf16 v[36:39], v[148:151], v[124:127], v[36:39]
    ds_read_b128 v[136:139], v105 offset:4096
    v_mfma_f32_16x16x32_bf16 v[32:35], v[148:151], v[120:123], v[32:35]
    ds_read_b128 v[140:143], v105 offset:6144
    v_mfma_f32_16x16x32_bf16 v[28:31], v[148:151], v[116:119], v[28:31]
    ds_read_b64_tr_b16 v[172:173], v110 offset:4096
    v_mfma_f32_16x16x32_bf16 v[24:27], v[148:151], v[112:115], v[24:27]
    ds_read_b64_tr_b16 v[174:175], v110 offset:4608
    s_waitcnt lgkmcnt(12)
    v_mfma_f32_16x16x32_bf16 v[40:43], v[152:155], v[112:115], v[40:43]
    ds_read_b64_tr_b16 v[176:177], v107 offset:12288
    v_mfma_f32_16x16x32_bf16 v[44:47], v[152:155], v[116:119], v[44:47]
    ds_read_b64_tr_b16 v[178:179], v107 offset:12800
    v_mfma_f32_16x16x32_bf16 v[48:51], v[152:155], v[120:123], v[48:51]
    ds_read_b64_tr_b16 v[180:181], v110 offset:12288
    v_mfma_f32_16x16x32_bf16 v[52:55], v[152:155], v[124:127], v[52:55]
    ds_read_b64_tr_b16 v[182:183], v110 offset:12800
    v_mfma_f32_16x16x32_bf16 v[68:71], v[156:159], v[124:127], v[68:71]
    ds_read_b64_tr_b16 v[184:185], v107 offset:20480
    v_mfma_f32_16x16x32_bf16 v[64:67], v[156:159], v[120:123], v[64:67]
    ds_read_b64_tr_b16 v[186:187], v107 offset:20992
    v_mfma_f32_16x16x32_bf16 v[60:63], v[156:159], v[116:119], v[60:63]
    ds_read_b64_tr_b16 v[188:189], v110 offset:20480
    v_mfma_f32_16x16x32_bf16 v[56:59], v[156:159], v[112:115], v[56:59]
    ds_read_b64_tr_b16 v[190:191], v110 offset:20992
    s_waitcnt lgkmcnt(15)
    v_mfma_f32_16x16x32_bf16 v[72:75], v[112:115], v[160:163], v[72:75]
    v_mfma_f32_16x16x32_bf16 v[76:79], v[116:119], v[160:163], v[76:79]
    v_mfma_f32_16x16x32_bf16 v[80:83], v[120:123], v[160:163], v[80:83]
    v_mfma_f32_16x16x32_bf16 v[84:87], v[124:127], v[160:163], v[84:87]
    v_mfma_f32_16x16x32_bf16 v[100:103], v[124:127], v[164:167], v[100:103]
    v_mfma_f32_16x16x32_bf16 v[96:99], v[120:123], v[164:167], v[96:99]
    v_mfma_f32_16x16x32_bf16 v[92:95], v[116:119], v[164:167], v[92:95]
    v_mfma_f32_16x16x32_bf16 v[88:91], v[112:115], v[164:167], v[88:91]
    s_waitcnt lgkmcnt(8)
    v_mfma_f32_16x16x32_bf16 v[8:11], v[168:171], v[128:131], v[8:11]
    v_mfma_f32_16x16x32_bf16 v[12:15], v[168:171], v[132:135], v[12:15]
    v_mfma_f32_16x16x32_bf16 v[16:19], v[168:171], v[136:139], v[16:19]
    v_mfma_f32_16x16x32_bf16 v[20:23], v[168:171], v[140:143], v[20:23]
    s_waitcnt lgkmcnt(0)
    s_barrier
    v_mfma_f32_16x16x32_bf16 v[36:39], v[172:175], v[140:143], v[36:39]
    ds_read_b128 v[112:115], v104 offset:16384
    v_mfma_f32_16x16x32_bf16 v[32:35], v[172:175], v[136:139], v[32:35]
    ds_read_b64_tr_b16 v[144:145], v107 offset:24576
    v_mfma_f32_16x16x32_bf16 v[28:31], v[172:175], v[132:135], v[28:31]
    ds_read_b64_tr_b16 v[146:147], v107 offset:25088
    v_mfma_f32_16x16x32_bf16 v[24:27], v[172:175], v[128:131], v[24:27]
    ds_read_b128 v[116:119], v104 offset:18432
    v_mfma_f32_16x16x32_bf16 v[40:43], v[176:179], v[128:131], v[40:43]
    ds_read_b128 v[120:123], v104 offset:20480
    v_mfma_f32_16x16x32_bf16 v[44:47], v[176:179], v[132:135], v[44:47]
    ds_read_b128 v[124:127], v104 offset:22528
    v_mfma_f32_16x16x32_bf16 v[48:51], v[176:179], v[136:139], v[48:51]
    ds_read_b64_tr_b16 v[148:149], v110 offset:24576
    v_mfma_f32_16x16x32_bf16 v[52:55], v[176:179], v[140:143], v[52:55]
    ds_read_b64_tr_b16 v[150:151], v110 offset:25088
    v_mfma_f32_16x16x32_bf16 v[68:71], v[180:183], v[140:143], v[68:71]
    ds_read_b64_tr_b16 v[152:153], v107 offset:32768
    v_mfma_f32_16x16x32_bf16 v[64:67], v[180:183], v[136:139], v[64:67]
    ds_read_b64_tr_b16 v[154:155], v107 offset:33280
    v_mfma_f32_16x16x32_bf16 v[60:63], v[180:183], v[132:135], v[60:63]
    ds_read_b64_tr_b16 v[156:157], v110 offset:32768
    v_mfma_f32_16x16x32_bf16 v[56:59], v[180:183], v[128:131], v[56:59]
    ds_read_b64_tr_b16 v[158:159], v110 offset:33280
    v_mfma_f32_16x16x32_bf16 v[72:75], v[128:131], v[184:187], v[72:75]
    ds_read_b64_tr_b16 v[160:161], v107 offset:40960
    v_mfma_f32_16x16x32_bf16 v[76:79], v[132:135], v[184:187], v[76:79]
    ds_read_b64_tr_b16 v[162:163], v107 offset:41472
    v_mfma_f32_16x16x32_bf16 v[80:83], v[136:139], v[184:187], v[80:83]
    ds_read_b64_tr_b16 v[164:165], v110 offset:40960
    v_mfma_f32_16x16x32_bf16 v[84:87], v[140:143], v[184:187], v[84:87]
    ds_read_b64_tr_b16 v[166:167], v110 offset:41472
    v_mfma_f32_16x16x32_bf16 v[100:103], v[140:143], v[188:191], v[100:103]
    v_mfma_f32_16x16x32_bf16 v[96:99], v[136:139], v[188:191], v[96:99]
    v_mfma_f32_16x16x32_bf16 v[92:95], v[132:135], v[188:191], v[92:95]
    v_mfma_f32_16x16x32_bf16 v[88:91], v[128:131], v[188:191], v[88:91]
    s_waitcnt lgkmcnt(8)
    v_mfma_f32_16x16x32_bf16 v[8:11], v[144:147], v[112:115], v[8:11]
    ds_read_b128 v[128:131], v105 offset:16384
    v_mfma_f32_16x16x32_bf16 v[12:15], v[144:147], v[116:119], v[12:15]
    ds_read_b64_tr_b16 v[168:169], v107 offset:28672
    v_mfma_f32_16x16x32_bf16 v[16:19], v[144:147], v[120:123], v[16:19]
    ds_read_b64_tr_b16 v[170:171], v107 offset:29184
    v_mfma_f32_16x16x32_bf16 v[20:23], v[144:147], v[124:127], v[20:23]
    ds_read_b128 v[132:135], v105 offset:18432
    v_mfma_f32_16x16x32_bf16 v[36:39], v[148:151], v[124:127], v[36:39]
    ds_read_b128 v[136:139], v105 offset:20480
    v_mfma_f32_16x16x32_bf16 v[32:35], v[148:151], v[120:123], v[32:35]
    ds_read_b128 v[140:143], v105 offset:22528
    v_mfma_f32_16x16x32_bf16 v[28:31], v[148:151], v[116:119], v[28:31]
    ds_read_b64_tr_b16 v[172:173], v110 offset:28672
    v_mfma_f32_16x16x32_bf16 v[24:27], v[148:151], v[112:115], v[24:27]
    ds_read_b64_tr_b16 v[174:175], v110 offset:29184
    s_waitcnt lgkmcnt(12)
    v_mfma_f32_16x16x32_bf16 v[40:43], v[152:155], v[112:115], v[40:43]
    ds_read_b64_tr_b16 v[176:177], v107 offset:36864
    v_mfma_f32_16x16x32_bf16 v[44:47], v[152:155], v[116:119], v[44:47]
    ds_read_b64_tr_b16 v[178:179], v107 offset:37376
    v_mfma_f32_16x16x32_bf16 v[48:51], v[152:155], v[120:123], v[48:51]
    ds_read_b64_tr_b16 v[180:181], v110 offset:36864
    v_mfma_f32_16x16x32_bf16 v[52:55], v[152:155], v[124:127], v[52:55]
    ds_read_b64_tr_b16 v[182:183], v110 offset:37376
    v_mfma_f32_16x16x32_bf16 v[68:71], v[156:159], v[124:127], v[68:71]
    ds_read_b64_tr_b16 v[184:185], v107 offset:45056
    v_mfma_f32_16x16x32_bf16 v[64:67], v[156:159], v[120:123], v[64:67]
    ds_read_b64_tr_b16 v[186:187], v107 offset:45568
    v_mfma_f32_16x16x32_bf16 v[60:63], v[156:159], v[116:119], v[60:63]
    ds_read_b64_tr_b16 v[188:189], v110 offset:45056
    v_mfma_f32_16x16x32_bf16 v[56:59], v[156:159], v[112:115], v[56:59]
    ds_read_b64_tr_b16 v[190:191], v110 offset:45568
    s_waitcnt lgkmcnt(15)
    v_mfma_f32_16x16x32_bf16 v[72:75], v[112:115], v[160:163], v[72:75]
    v_mfma_f32_16x16x32_bf16 v[76:79], v[116:119], v[160:163], v[76:79]
    v_mfma_f32_16x16x32_bf16 v[80:83], v[120:123], v[160:163], v[80:83]
    v_mfma_f32_16x16x32_bf16 v[84:87], v[124:127], v[160:163], v[84:87]
    v_mfma_f32_16x16x32_bf16 v[100:103], v[124:127], v[164:167], v[100:103]
    v_mfma_f32_16x16x32_bf16 v[96:99], v[120:123], v[164:167], v[96:99]
    v_mfma_f32_16x16x32_bf16 v[92:95], v[116:119], v[164:167], v[92:95]
    v_mfma_f32_16x16x32_bf16 v[88:91], v[112:115], v[164:167], v[88:91]
    s_waitcnt lgkmcnt(8)
    v_mfma_f32_16x16x32_bf16 v[8:11], v[168:171], v[128:131], v[8:11]
    v_mfma_f32_16x16x32_bf16 v[12:15], v[168:171], v[132:135], v[12:15]
    v_mfma_f32_16x16x32_bf16 v[16:19], v[168:171], v[136:139], v[16:19]
    v_mfma_f32_16x16x32_bf16 v[20:23], v[168:171], v[140:143], v[20:23]
    s_waitcnt lgkmcnt(0)
    s_barrier
    v_mfma_f32_16x16x32_bf16 v[36:39], v[172:175], v[140:143], v[36:39]
    ds_read_b128 v[112:115], v104 offset:32768
    v_mfma_f32_16x16x32_bf16 v[32:35], v[172:175], v[136:139], v[32:35]
    ds_read_b64_tr_b16 v[144:145], v107 offset:49152
    v_mfma_f32_16x16x32_bf16 v[28:31], v[172:175], v[132:135], v[28:31]
    ds_read_b64_tr_b16 v[146:147], v107 offset:49664
    v_mfma_f32_16x16x32_bf16 v[24:27], v[172:175], v[128:131], v[24:27]
    ds_read_b128 v[116:119], v104 offset:34816
    v_mfma_f32_16x16x32_bf16 v[40:43], v[176:179], v[128:131], v[40:43]
    ds_read_b128 v[120:123], v104 offset:36864
    v_mfma_f32_16x16x32_bf16 v[44:47], v[176:179], v[132:135], v[44:47]
    ds_read_b128 v[124:127], v104 offset:38912
    v_mfma_f32_16x16x32_bf16 v[48:51], v[176:179], v[136:139], v[48:51]
    ds_read_b64_tr_b16 v[148:149], v110 offset:49152
    v_mfma_f32_16x16x32_bf16 v[52:55], v[176:179], v[140:143], v[52:55]
    ds_read_b64_tr_b16 v[150:151], v110 offset:49664
    v_mfma_f32_16x16x32_bf16 v[68:71], v[180:183], v[140:143], v[68:71]
    ds_read_b64_tr_b16 v[152:153], v107 offset:57344
    v_mfma_f32_16x16x32_bf16 v[64:67], v[180:183], v[136:139], v[64:67]
    ds_read_b64_tr_b16 v[154:155], v107 offset:57856
    v_mfma_f32_16x16x32_bf16 v[60:63], v[180:183], v[132:135], v[60:63]
    ds_read_b64_tr_b16 v[156:157], v110 offset:57344
    v_mfma_f32_16x16x32_bf16 v[56:59], v[180:183], v[128:131], v[56:59]
    ds_read_b64_tr_b16 v[158:159], v110 offset:57856
    v_mfma_f32_16x16x32_bf16 v[72:75], v[128:131], v[184:187], v[72:75]
    ds_read_b64_tr_b16 v[160:161], v108 offset:0
    v_mfma_f32_16x16x32_bf16 v[76:79], v[132:135], v[184:187], v[76:79]
    ds_read_b64_tr_b16 v[162:163], v108 offset:512
    v_mfma_f32_16x16x32_bf16 v[80:83], v[136:139], v[184:187], v[80:83]
    ds_read_b64_tr_b16 v[164:165], v111 offset:0
    v_mfma_f32_16x16x32_bf16 v[84:87], v[140:143], v[184:187], v[84:87]
    ds_read_b64_tr_b16 v[166:167], v111 offset:512
    v_mfma_f32_16x16x32_bf16 v[100:103], v[140:143], v[188:191], v[100:103]
    v_mfma_f32_16x16x32_bf16 v[96:99], v[136:139], v[188:191], v[96:99]
    v_mfma_f32_16x16x32_bf16 v[92:95], v[132:135], v[188:191], v[92:95]
    v_mfma_f32_16x16x32_bf16 v[88:91], v[128:131], v[188:191], v[88:91]
    s_waitcnt lgkmcnt(8)
    v_mfma_f32_16x16x32_bf16 v[8:11], v[144:147], v[112:115], v[8:11]
    ds_read_b128 v[128:131], v105 offset:32768
    v_mfma_f32_16x16x32_bf16 v[12:15], v[144:147], v[116:119], v[12:15]
    ds_read_b64_tr_b16 v[168:169], v107 offset:53248
    v_mfma_f32_16x16x32_bf16 v[16:19], v[144:147], v[120:123], v[16:19]
    ds_read_b64_tr_b16 v[170:171], v107 offset:53760
    v_mfma_f32_16x16x32_bf16 v[20:23], v[144:147], v[124:127], v[20:23]
    ds_read_b128 v[132:135], v105 offset:34816
    v_mfma_f32_16x16x32_bf16 v[36:39], v[148:151], v[124:127], v[36:39]
    ds_read_b128 v[136:139], v105 offset:36864
    v_mfma_f32_16x16x32_bf16 v[32:35], v[148:151], v[120:123], v[32:35]
    ds_read_b128 v[140:143], v105 offset:38912
    v_mfma_f32_16x16x32_bf16 v[28:31], v[148:151], v[116:119], v[28:31]
    ds_read_b64_tr_b16 v[172:173], v110 offset:53248
    v_mfma_f32_16x16x32_bf16 v[24:27], v[148:151], v[112:115], v[24:27]
    ds_read_b64_tr_b16 v[174:175], v110 offset:53760
    s_waitcnt lgkmcnt(12)
    v_mfma_f32_16x16x32_bf16 v[40:43], v[152:155], v[112:115], v[40:43]
    ds_read_b64_tr_b16 v[176:177], v107 offset:61440
    v_mfma_f32_16x16x32_bf16 v[44:47], v[152:155], v[116:119], v[44:47]
    ds_read_b64_tr_b16 v[178:179], v107 offset:61952
    v_mfma_f32_16x16x32_bf16 v[48:51], v[152:155], v[120:123], v[48:51]
    ds_read_b64_tr_b16 v[180:181], v110 offset:61440
    v_mfma_f32_16x16x32_bf16 v[52:55], v[152:155], v[124:127], v[52:55]
    ds_read_b64_tr_b16 v[182:183], v110 offset:61952
    v_mfma_f32_16x16x32_bf16 v[68:71], v[156:159], v[124:127], v[68:71]
    ds_read_b64_tr_b16 v[184:185], v108 offset:4096
    v_mfma_f32_16x16x32_bf16 v[64:67], v[156:159], v[120:123], v[64:67]
    ds_read_b64_tr_b16 v[186:187], v108 offset:4608
    v_mfma_f32_16x16x32_bf16 v[60:63], v[156:159], v[116:119], v[60:63]
    ds_read_b64_tr_b16 v[188:189], v111 offset:4096
    v_mfma_f32_16x16x32_bf16 v[56:59], v[156:159], v[112:115], v[56:59]
    ds_read_b64_tr_b16 v[190:191], v111 offset:4608
    s_waitcnt lgkmcnt(15)
    v_mfma_f32_16x16x32_bf16 v[72:75], v[112:115], v[160:163], v[72:75]
    v_mfma_f32_16x16x32_bf16 v[76:79], v[116:119], v[160:163], v[76:79]
    v_mfma_f32_16x16x32_bf16 v[80:83], v[120:123], v[160:163], v[80:83]
    v_mfma_f32_16x16x32_bf16 v[84:87], v[124:127], v[160:163], v[84:87]
    v_mfma_f32_16x16x32_bf16 v[100:103], v[124:127], v[164:167], v[100:103]
    v_mfma_f32_16x16x32_bf16 v[96:99], v[120:123], v[164:167], v[96:99]
    v_mfma_f32_16x16x32_bf16 v[92:95], v[116:119], v[164:167], v[92:95]
    v_mfma_f32_16x16x32_bf16 v[88:91], v[112:115], v[164:167], v[88:91]
    s_waitcnt lgkmcnt(8)
    v_mfma_f32_16x16x32_bf16 v[8:11], v[168:171], v[128:131], v[8:11]
    v_mfma_f32_16x16x32_bf16 v[12:15], v[168:171], v[132:135], v[12:15]
    v_mfma_f32_16x16x32_bf16 v[16:19], v[168:171], v[136:139], v[16:19]
    v_mfma_f32_16x16x32_bf16 v[20:23], v[168:171], v[140:143], v[20:23]
    s_waitcnt lgkmcnt(0)
    s_barrier
    v_mfma_f32_16x16x32_bf16 v[36:39], v[172:175], v[140:143], v[36:39]
    ds_read_b128 v[112:115], v104 offset:49152
    v_mfma_f32_16x16x32_bf16 v[32:35], v[172:175], v[136:139], v[32:35]
    ds_read_b64_tr_b16 v[144:145], v108 offset:8192
    v_mfma_f32_16x16x32_bf16 v[28:31], v[172:175], v[132:135], v[28:31]
    ds_read_b64_tr_b16 v[146:147], v108 offset:8704
    v_mfma_f32_16x16x32_bf16 v[24:27], v[172:175], v[128:131], v[24:27]
    ds_read_b128 v[116:119], v104 offset:51200
    v_mfma_f32_16x16x32_bf16 v[40:43], v[176:179], v[128:131], v[40:43]
    ds_read_b128 v[120:123], v104 offset:53248
    v_mfma_f32_16x16x32_bf16 v[44:47], v[176:179], v[132:135], v[44:47]
    ds_read_b128 v[124:127], v104 offset:55296
    v_mfma_f32_16x16x32_bf16 v[48:51], v[176:179], v[136:139], v[48:51]
    ds_read_b64_tr_b16 v[148:149], v111 offset:8192
    v_mfma_f32_16x16x32_bf16 v[52:55], v[176:179], v[140:143], v[52:55]
    ds_read_b64_tr_b16 v[150:151], v111 offset:8704
    v_mfma_f32_16x16x32_bf16 v[68:71], v[180:183], v[140:143], v[68:71]
    ds_read_b64_tr_b16 v[152:153], v108 offset:16384
    v_mfma_f32_16x16x32_bf16 v[64:67], v[180:183], v[136:139], v[64:67]
    ds_read_b64_tr_b16 v[154:155], v108 offset:16896
    v_mfma_f32_16x16x32_bf16 v[60:63], v[180:183], v[132:135], v[60:63]
    ds_read_b64_tr_b16 v[156:157], v111 offset:16384
    v_mfma_f32_16x16x32_bf16 v[56:59], v[180:183], v[128:131], v[56:59]
    ds_read_b64_tr_b16 v[158:159], v111 offset:16896
    v_mfma_f32_16x16x32_bf16 v[72:75], v[128:131], v[184:187], v[72:75]
    ds_read_b64_tr_b16 v[160:161], v108 offset:24576
    v_mfma_f32_16x16x32_bf16 v[76:79], v[132:135], v[184:187], v[76:79]
    ds_read_b64_tr_b16 v[162:163], v108 offset:25088
    v_mfma_f32_16x16x32_bf16 v[80:83], v[136:139], v[184:187], v[80:83]
    ds_read_b64_tr_b16 v[164:165], v111 offset:24576
    v_mfma_f32_16x16x32_bf16 v[84:87], v[140:143], v[184:187], v[84:87]
    ds_read_b64_tr_b16 v[166:167], v111 offset:25088
    v_mfma_f32_16x16x32_bf16 v[100:103], v[140:143], v[188:191], v[100:103]
    v_mfma_f32_16x16x32_bf16 v[96:99], v[136:139], v[188:191], v[96:99]
    v_mfma_f32_16x16x32_bf16 v[92:95], v[132:135], v[188:191], v[92:95]
    v_mfma_f32_16x16x32_bf16 v[88:91], v[128:131], v[188:191], v[88:91]
    s_waitcnt lgkmcnt(8)
    v_mfma_f32_16x16x32_bf16 v[8:11], v[144:147], v[112:115], v[8:11]
    ds_read_b128 v[128:131], v105 offset:49152
    v_mfma_f32_16x16x32_bf16 v[12:15], v[144:147], v[116:119], v[12:15]
    ds_read_b64_tr_b16 v[168:169], v108 offset:12288
    v_mfma_f32_16x16x32_bf16 v[16:19], v[144:147], v[120:123], v[16:19]
    ds_read_b64_tr_b16 v[170:171], v108 offset:12800
    v_mfma_f32_16x16x32_bf16 v[20:23], v[144:147], v[124:127], v[20:23]
    ds_read_b128 v[132:135], v105 offset:51200
    v_mfma_f32_16x16x32_bf16 v[36:39], v[148:151], v[124:127], v[36:39]
    ds_read_b128 v[136:139], v105 offset:53248
    v_mfma_f32_16x16x32_bf16 v[32:35], v[148:151], v[120:123], v[32:35]
    ds_read_b128 v[140:143], v105 offset:55296
    v_mfma_f32_16x16x32_bf16 v[28:31], v[148:151], v[116:119], v[28:31]
    ds_read_b64_tr_b16 v[172:173], v111 offset:12288
    v_mfma_f32_16x16x32_bf16 v[24:27], v[148:151], v[112:115], v[24:27]
    ds_read_b64_tr_b16 v[174:175], v111 offset:12800
    s_waitcnt lgkmcnt(12)
    v_mfma_f32_16x16x32_bf16 v[40:43], v[152:155], v[112:115], v[40:43]
    ds_read_b64_tr_b16 v[176:177], v108 offset:20480
    v_mfma_f32_16x16x32_bf16 v[44:47], v[152:155], v[116:119], v[44:47]
    ds_read_b64_tr_b16 v[178:179], v108 offset:20992
    v_mfma_f32_16x16x32_bf16 v[48:51], v[152:155], v[120:123], v[48:51]
    ds_read_b64_tr_b16 v[180:181], v111 offset:20480
    v_mfma_f32_16x16x32_bf16 v[52:55], v[152:155], v[124:127], v[52:55]
    ds_read_b64_tr_b16 v[182:183], v111 offset:20992
    v_mfma_f32_16x16x32_bf16 v[68:71], v[156:159], v[124:127], v[68:71]
    ds_read_b64_tr_b16 v[184:185], v108 offset:28672
    v_mfma_f32_16x16x32_bf16 v[64:67], v[156:159], v[120:123], v[64:67]
    ds_read_b64_tr_b16 v[186:187], v108 offset:29184
    v_mfma_f32_16x16x32_bf16 v[60:63], v[156:159], v[116:119], v[60:63]
    ds_read_b64_tr_b16 v[188:189], v111 offset:28672
    v_mfma_f32_16x16x32_bf16 v[56:59], v[156:159], v[112:115], v[56:59]
    ds_read_b64_tr_b16 v[190:191], v111 offset:29184
    s_waitcnt lgkmcnt(15)
    v_mfma_f32_16x16x32_bf16 v[72:75], v[112:115], v[160:163], v[72:75]
    v_mfma_f32_16x16x32_bf16 v[76:79], v[116:119], v[160:163], v[76:79]
    v_mfma_f32_16x16x32_bf16 v[80:83], v[120:123], v[160:163], v[80:83]
    v_mfma_f32_16x16x32_bf16 v[84:87], v[124:127], v[160:163], v[84:87]
    v_mfma_f32_16x16x32_bf16 v[100:103], v[124:127], v[164:167], v[100:103]
    v_mfma_f32_16x16x32_bf16 v[96:99], v[120:123], v[164:167], v[96:99]
    v_mfma_f32_16x16x32_bf16 v[92:95], v[116:119], v[164:167], v[92:95]
    v_mfma_f32_16x16x32_bf16 v[88:91], v[112:115], v[164:167], v[88:91]
    s_waitcnt lgkmcnt(8)
    v_mfma_f32_16x16x32_bf16 v[8:11], v[168:171], v[128:131], v[8:11]
    v_mfma_f32_16x16x32_bf16 v[12:15], v[168:171], v[132:135], v[12:15]
    v_mfma_f32_16x16x32_bf16 v[16:19], v[168:171], v[136:139], v[16:19]
    v_mfma_f32_16x16x32_bf16 v[20:23], v[168:171], v[140:143], v[20:23]
    s_waitcnt lgkmcnt(0)
    s_barrier
    v_mfma_f32_16x16x32_bf16 v[36:39], v[172:175], v[140:143], v[36:39]
    ds_read_b128 v[112:115], v104 offset:0
    v_mfma_f32_16x16x32_bf16 v[32:35], v[172:175], v[136:139], v[32:35]
    ds_read_b64_tr_b16 v[144:145], v107 offset:0
    v_mfma_f32_16x16x32_bf16 v[28:31], v[172:175], v[132:135], v[28:31]
    ds_read_b64_tr_b16 v[146:147], v107 offset:512
    v_mfma_f32_16x16x32_bf16 v[24:27], v[172:175], v[128:131], v[24:27]
    ds_read_b128 v[116:119], v104 offset:2048
    v_mfma_f32_16x16x32_bf16 v[40:43], v[176:179], v[128:131], v[40:43]
    ds_read_b128 v[120:123], v104 offset:4096
    v_mfma_f32_16x16x32_bf16 v[44:47], v[176:179], v[132:135], v[44:47]
    ds_read_b128 v[124:127], v104 offset:6144
    v_mfma_f32_16x16x32_bf16 v[48:51], v[176:179], v[136:139], v[48:51]
    ds_read_b64_tr_b16 v[148:149], v110 offset:0
    v_mfma_f32_16x16x32_bf16 v[52:55], v[176:179], v[140:143], v[52:55]
    ds_read_b64_tr_b16 v[150:151], v110 offset:512
    v_mfma_f32_16x16x32_bf16 v[68:71], v[180:183], v[140:143], v[68:71]
    ds_read_b64_tr_b16 v[152:153], v107 offset:8192
    v_mfma_f32_16x16x32_bf16 v[64:67], v[180:183], v[136:139], v[64:67]
    ds_read_b64_tr_b16 v[154:155], v107 offset:8704
    v_mfma_f32_16x16x32_bf16 v[60:63], v[180:183], v[132:135], v[60:63]
    ds_read_b64_tr_b16 v[156:157], v110 offset:8192
    v_mfma_f32_16x16x32_bf16 v[56:59], v[180:183], v[128:131], v[56:59]
    ds_read_b64_tr_b16 v[158:159], v110 offset:8704
    v_mfma_f32_16x16x32_bf16 v[72:75], v[128:131], v[184:187], v[72:75]
    ds_read_b64_tr_b16 v[160:161], v107 offset:16384
    v_mfma_f32_16x16x32_bf16 v[76:79], v[132:135], v[184:187], v[76:79]
    ds_read_b64_tr_b16 v[162:163], v107 offset:16896
    v_mfma_f32_16x16x32_bf16 v[80:83], v[136:139], v[184:187], v[80:83]
    ds_read_b64_tr_b16 v[164:165], v110 offset:16384
    v_mfma_f32_16x16x32_bf16 v[84:87], v[140:143], v[184:187], v[84:87]
    ds_read_b64_tr_b16 v[166:167], v110 offset:16896
    v_mfma_f32_16x16x32_bf16 v[100:103], v[140:143], v[188:191], v[100:103]
    v_mfma_f32_16x16x32_bf16 v[96:99], v[136:139], v[188:191], v[96:99]
    v_mfma_f32_16x16x32_bf16 v[92:95], v[132:135], v[188:191], v[92:95]
    v_mfma_f32_16x16x32_bf16 v[88:91], v[128:131], v[188:191], v[88:91]
    s_waitcnt lgkmcnt(8)
    v_mfma_f32_16x16x32_bf16 v[8:11], v[144:147], v[112:115], v[8:11]
    ds_read_b128 v[128:131], v105 offset:0
    v_mfma_f32_16x16x32_bf16 v[12:15], v[144:147], v[116:119], v[12:15]
    ds_read_b64_tr_b16 v[168:169], v107 offset:4096
    v_mfma_f32_16x16x32_bf16 v[16:19], v[144:147], v[120:123], v[16:19]
    ds_read_b64_tr_b16 v[170:171], v107 offset:4608
    v_mfma_f32_16x16x32_bf16 v[20:23], v[144:147], v[124:127], v[20:23]
    ds_read_b128 v[132:135], v105 offset:2048
    v_mfma_f32_16x16x32_bf16 v[36:39], v[148:151], v[124:127], v[36:39]
    ds_read_b128 v[136:139], v105 offset:4096
    v_mfma_f32_16x16x32_bf16 v[32:35], v[148:151], v[120:123], v[32:35]
    ds_read_b128 v[140:143], v105 offset:6144
    v_mfma_f32_16x16x32_bf16 v[28:31], v[148:151], v[116:119], v[28:31]
    ds_read_b64_tr_b16 v[172:173], v110 offset:4096
    v_mfma_f32_16x16x32_bf16 v[24:27], v[148:151], v[112:115], v[24:27]
    ds_read_b64_tr_b16 v[174:175], v110 offset:4608
    s_waitcnt lgkmcnt(12)
    v_mfma_f32_16x16x32_bf16 v[40:43], v[152:155], v[112:115], v[40:43]
    ds_read_b64_tr_b16 v[176:177], v107 offset:12288
    v_mfma_f32_16x16x32_bf16 v[44:47], v[152:155], v[116:119], v[44:47]
    ds_read_b64_tr_b16 v[178:179], v107 offset:12800
    v_mfma_f32_16x16x32_bf16 v[48:51], v[152:155], v[120:123], v[48:51]
    ds_read_b64_tr_b16 v[180:181], v110 offset:12288
    v_mfma_f32_16x16x32_bf16 v[52:55], v[152:155], v[124:127], v[52:55]
    ds_read_b64_tr_b16 v[182:183], v110 offset:12800
    v_mfma_f32_16x16x32_bf16 v[68:71], v[156:159], v[124:127], v[68:71]
    ds_read_b64_tr_b16 v[184:185], v107 offset:20480
    v_mfma_f32_16x16x32_bf16 v[64:67], v[156:159], v[120:123], v[64:67]
    ds_read_b64_tr_b16 v[186:187], v107 offset:20992
    v_mfma_f32_16x16x32_bf16 v[60:63], v[156:159], v[116:119], v[60:63]
    ds_read_b64_tr_b16 v[188:189], v110 offset:20480
    v_mfma_f32_16x16x32_bf16 v[56:59], v[156:159], v[112:115], v[56:59]
    ds_read_b64_tr_b16 v[190:191], v110 offset:20992
    s_waitcnt lgkmcnt(15)
    v_mfma_f32_16x16x32_bf16 v[72:75], v[112:115], v[160:163], v[72:75]
    v_mfma_f32_16x16x32_bf16 v[76:79], v[116:119], v[160:163], v[76:79]
    v_mfma_f32_16x16x32_bf16 v[80:83], v[120:123], v[160:163], v[80:83]
    v_mfma_f32_16x16x32_bf16 v[84:87], v[124:127], v[160:163], v[84:87]
    v_mfma_f32_16x16x32_bf16 v[100:103], v[124:127], v[164:167], v[100:103]
    v_mfma_f32_16x16x32_bf16 v[96:99], v[120:123], v[164:167], v[96:99]
    v_mfma_f32_16x16x32_bf16 v[92:95], v[116:119], v[164:167], v[92:95]
    v_mfma_f32_16x16x32_bf16 v[88:91], v[112:115], v[164:167], v[88:91]
    s_waitcnt lgkmcnt(8)
    v_mfma_f32_16x16x32_bf16 v[8:11], v[168:171], v[128:131], v[8:11]
    v_mfma_f32_16x16x32_bf16 v[12:15], v[168:171], v[132:135], v[12:15]
    v_mfma_f32_16x16x32_bf16 v[16:19], v[168:171], v[136:139], v[16:19]
    v_mfma_f32_16x16x32_bf16 v[20:23], v[168:171], v[140:143], v[20:23]
    s_waitcnt lgkmcnt(0)
    s_barrier
    v_mfma_f32_16x16x32_bf16 v[36:39], v[172:175], v[140:143], v[36:39]
    ds_read_b128 v[112:115], v104 offset:16384
    v_mfma_f32_16x16x32_bf16 v[32:35], v[172:175], v[136:139], v[32:35]
    ds_read_b64_tr_b16 v[144:145], v107 offset:24576
    v_mfma_f32_16x16x32_bf16 v[28:31], v[172:175], v[132:135], v[28:31]
    ds_read_b64_tr_b16 v[146:147], v107 offset:25088
    v_mfma_f32_16x16x32_bf16 v[24:27], v[172:175], v[128:131], v[24:27]
    ds_read_b128 v[116:119], v104 offset:18432
    v_mfma_f32_16x16x32_bf16 v[40:43], v[176:179], v[128:131], v[40:43]
    ds_read_b128 v[120:123], v104 offset:20480
    v_mfma_f32_16x16x32_bf16 v[44:47], v[176:179], v[132:135], v[44:47]
    ds_read_b128 v[124:127], v104 offset:22528
    v_mfma_f32_16x16x32_bf16 v[48:51], v[176:179], v[136:139], v[48:51]
    ds_read_b64_tr_b16 v[148:149], v110 offset:24576
    v_mfma_f32_16x16x32_bf16 v[52:55], v[176:179], v[140:143], v[52:55]
    ds_read_b64_tr_b16 v[150:151], v110 offset:25088
    v_mfma_f32_16x16x32_bf16 v[68:71], v[180:183], v[140:143], v[68:71]
    ds_read_b64_tr_b16 v[152:153], v107 offset:32768
    v_mfma_f32_16x16x32_bf16 v[64:67], v[180:183], v[136:139], v[64:67]
    ds_read_b64_tr_b16 v[154:155], v107 offset:33280
    v_mfma_f32_16x16x32_bf16 v[60:63], v[180:183], v[132:135], v[60:63]
    ds_read_b64_tr_b16 v[156:157], v110 offset:32768
    v_mfma_f32_16x16x32_bf16 v[56:59], v[180:183], v[128:131], v[56:59]
    ds_read_b64_tr_b16 v[158:159], v110 offset:33280
    v_mfma_f32_16x16x32_bf16 v[72:75], v[128:131], v[184:187], v[72:75]
    ds_read_b64_tr_b16 v[160:161], v107 offset:40960
    v_mfma_f32_16x16x32_bf16 v[76:79], v[132:135], v[184:187], v[76:79]
    ds_read_b64_tr_b16 v[162:163], v107 offset:41472
    v_mfma_f32_16x16x32_bf16 v[80:83], v[136:139], v[184:187], v[80:83]
    ds_read_b64_tr_b16 v[164:165], v110 offset:40960
    v_mfma_f32_16x16x32_bf16 v[84:87], v[140:143], v[184:187], v[84:87]
    ds_read_b64_tr_b16 v[166:167], v110 offset:41472
    v_mfma_f32_16x16x32_bf16 v[100:103], v[140:143], v[188:191], v[100:103]
    v_mfma_f32_16x16x32_bf16 v[96:99], v[136:139], v[188:191], v[96:99]
    v_mfma_f32_16x16x32_bf16 v[92:95], v[132:135], v[188:191], v[92:95]
    v_mfma_f32_16x16x32_bf16 v[88:91], v[128:131], v[188:191], v[88:91]
    s_waitcnt lgkmcnt(8)
    v_mfma_f32_16x16x32_bf16 v[8:11], v[144:147], v[112:115], v[8:11]
    ds_read_b128 v[128:131], v105 offset:16384
    v_mfma_f32_16x16x32_bf16 v[12:15], v[144:147], v[116:119], v[12:15]
    ds_read_b64_tr_b16 v[168:169], v107 offset:28672
    v_mfma_f32_16x16x32_bf16 v[16:19], v[144:147], v[120:123], v[16:19]
    ds_read_b64_tr_b16 v[170:171], v107 offset:29184
    v_mfma_f32_16x16x32_bf16 v[20:23], v[144:147], v[124:127], v[20:23]
    ds_read_b128 v[132:135], v105 offset:18432
    v_mfma_f32_16x16x32_bf16 v[36:39], v[148:151], v[124:127], v[36:39]
    ds_read_b128 v[136:139], v105 offset:20480
    v_mfma_f32_16x16x32_bf16 v[32:35], v[148:151], v[120:123], v[32:35]
    ds_read_b128 v[140:143], v105 offset:22528
    v_mfma_f32_16x16x32_bf16 v[28:31], v[148:151], v[116:119], v[28:31]
    ds_read_b64_tr_b16 v[172:173], v110 offset:28672
    v_mfma_f32_16x16x32_bf16 v[24:27], v[148:151], v[112:115], v[24:27]
    ds_read_b64_tr_b16 v[174:175], v110 offset:29184
    s_waitcnt lgkmcnt(12)
    v_mfma_f32_16x16x32_bf16 v[40:43], v[152:155], v[112:115], v[40:43]
    ds_read_b64_tr_b16 v[176:177], v107 offset:36864
    v_mfma_f32_16x16x32_bf16 v[44:47], v[152:155], v[116:119], v[44:47]
    ds_read_b64_tr_b16 v[178:179], v107 offset:37376
    v_mfma_f32_16x16x32_bf16 v[48:51], v[152:155], v[120:123], v[48:51]
    ds_read_b64_tr_b16 v[180:181], v110 offset:36864
    v_mfma_f32_16x16x32_bf16 v[52:55], v[152:155], v[124:127], v[52:55]
    ds_read_b64_tr_b16 v[182:183], v110 offset:37376
    v_mfma_f32_16x16x32_bf16 v[68:71], v[156:159], v[124:127], v[68:71]
    ds_read_b64_tr_b16 v[184:185], v107 offset:45056
    v_mfma_f32_16x16x32_bf16 v[64:67], v[156:159], v[120:123], v[64:67]
    ds_read_b64_tr_b16 v[186:187], v107 offset:45568
    v_mfma_f32_16x16x32_bf16 v[60:63], v[156:159], v[116:119], v[60:63]
    ds_read_b64_tr_b16 v[188:189], v110 offset:45056
    v_mfma_f32_16x16x32_bf16 v[56:59], v[156:159], v[112:115], v[56:59]
    ds_read_b64_tr_b16 v[190:191], v110 offset:45568
    s_waitcnt lgkmcnt(15)
    v_mfma_f32_16x16x32_bf16 v[72:75], v[112:115], v[160:163], v[72:75]
    v_mfma_f32_16x16x32_bf16 v[76:79], v[116:119], v[160:163], v[76:79]
    v_mfma_f32_16x16x32_bf16 v[80:83], v[120:123], v[160:163], v[80:83]
    v_mfma_f32_16x16x32_bf16 v[84:87], v[124:127], v[160:163], v[84:87]
    v_mfma_f32_16x16x32_bf16 v[100:103], v[124:127], v[164:167], v[100:103]
    v_mfma_f32_16x16x32_bf16 v[96:99], v[120:123], v[164:167], v[96:99]
    v_mfma_f32_16x16x32_bf16 v[92:95], v[116:119], v[164:167], v[92:95]
    v_mfma_f32_16x16x32_bf16 v[88:91], v[112:115], v[164:167], v[88:91]
    s_waitcnt lgkmcnt(8)
    v_mfma_f32_16x16x32_bf16 v[8:11], v[168:171], v[128:131], v[8:11]
    v_mfma_f32_16x16x32_bf16 v[12:15], v[168:171], v[132:135], v[12:15]
    v_mfma_f32_16x16x32_bf16 v[16:19], v[168:171], v[136:139], v[16:19]
    v_mfma_f32_16x16x32_bf16 v[20:23], v[168:171], v[140:143], v[20:23]
    s_waitcnt lgkmcnt(0)
    s_barrier
    v_mfma_f32_16x16x32_bf16 v[36:39], v[172:175], v[140:143], v[36:39]
    ds_read_b128 v[112:115], v104 offset:32768
    v_mfma_f32_16x16x32_bf16 v[32:35], v[172:175], v[136:139], v[32:35]
    ds_read_b64_tr_b16 v[144:145], v107 offset:49152
    v_mfma_f32_16x16x32_bf16 v[28:31], v[172:175], v[132:135], v[28:31]
    ds_read_b64_tr_b16 v[146:147], v107 offset:49664
    v_mfma_f32_16x16x32_bf16 v[24:27], v[172:175], v[128:131], v[24:27]
    ds_read_b128 v[116:119], v104 offset:34816
    v_mfma_f32_16x16x32_bf16 v[40:43], v[176:179], v[128:131], v[40:43]
    ds_read_b128 v[120:123], v104 offset:36864
    v_mfma_f32_16x16x32_bf16 v[44:47], v[176:179], v[132:135], v[44:47]
    ds_read_b128 v[124:127], v104 offset:38912
    v_mfma_f32_16x16x32_bf16 v[48:51], v[176:179], v[136:139], v[48:51]
    ds_read_b64_tr_b16 v[148:149], v110 offset:49152
    v_mfma_f32_16x16x32_bf16 v[52:55], v[176:179], v[140:143], v[52:55]
    ds_read_b64_tr_b16 v[150:151], v110 offset:49664
    v_mfma_f32_16x16x32_bf16 v[68:71], v[180:183], v[140:143], v[68:71]
    ds_read_b64_tr_b16 v[152:153], v107 offset:57344
    v_mfma_f32_16x16x32_bf16 v[64:67], v[180:183], v[136:139], v[64:67]
    ds_read_b64_tr_b16 v[154:155], v107 offset:57856
    v_mfma_f32_16x16x32_bf16 v[60:63], v[180:183], v[132:135], v[60:63]
    ds_read_b64_tr_b16 v[156:157], v110 offset:57344
    v_mfma_f32_16x16x32_bf16 v[56:59], v[180:183], v[128:131], v[56:59]
    ds_read_b64_tr_b16 v[158:159], v110 offset:57856
    v_mfma_f32_16x16x32_bf16 v[72:75], v[128:131], v[184:187], v[72:75]
    ds_read_b64_tr_b16 v[160:161], v108 offset:0
    v_mfma_f32_16x16x32_bf16 v[76:79], v[132:135], v[184:187], v[76:79]
    ds_read_b64_tr_b16 v[162:163], v108 offset:512
    v_mfma_f32_16x16x32_bf16 v[80:83], v[136:139], v[184:187], v[80:83]
    ds_read_b64_tr_b16 v[164:165], v111 offset:0
    v_mfma_f32_16x16x32_bf16 v[84:87], v[140:143], v[184:187], v[84:87]
    ds_read_b64_tr_b16 v[166:167], v111 offset:512
    v_mfma_f32_16x16x32_bf16 v[100:103], v[140:143], v[188:191], v[100:103]
    v_mfma_f32_16x16x32_bf16 v[96:99], v[136:139], v[188:191], v[96:99]
    v_mfma_f32_16x16x32_bf16 v[92:95], v[132:135], v[188:191], v[92:95]
    v_mfma_f32_16x16x32_bf16 v[88:91], v[128:131], v[188:191], v[88:91]
    s_waitcnt lgkmcnt(8)
    v_mfma_f32_16x16x32_bf16 v[8:11], v[144:147], v[112:115], v[8:11]
    ds_read_b128 v[128:131], v105 offset:32768
    v_mfma_f32_16x16x32_bf16 v[12:15], v[144:147], v[116:119], v[12:15]
    ds_read_b64_tr_b16 v[168:169], v107 offset:53248
    v_mfma_f32_16x16x32_bf16 v[16:19], v[144:147], v[120:123], v[16:19]
    ds_read_b64_tr_b16 v[170:171], v107 offset:53760
    v_mfma_f32_16x16x32_bf16 v[20:23], v[144:147], v[124:127], v[20:23]
    ds_read_b128 v[132:135], v105 offset:34816
    v_mfma_f32_16x16x32_bf16 v[36:39], v[148:151], v[124:127], v[36:39]
    ds_read_b128 v[136:139], v105 offset:36864
    v_mfma_f32_16x16x32_bf16 v[32:35], v[148:151], v[120:123], v[32:35]
    ds_read_b128 v[140:143], v105 offset:38912
    v_mfma_f32_16x16x32_bf16 v[28:31], v[148:151], v[116:119], v[28:31]
    ds_read_b64_tr_b16 v[172:173], v110 offset:53248
    v_mfma_f32_16x16x32_bf16 v[24:27], v[148:151], v[112:115], v[24:27]
    ds_read_b64_tr_b16 v[174:175], v110 offset:53760
    s_waitcnt lgkmcnt(12)
    v_mfma_f32_16x16x32_bf16 v[40:43], v[152:155], v[112:115], v[40:43]
    ds_read_b64_tr_b16 v[176:177], v107 offset:61440
    v_mfma_f32_16x16x32_bf16 v[44:47], v[152:155], v[116:119], v[44:47]
    ds_read_b64_tr_b16 v[178:179], v107 offset:61952
    v_mfma_f32_16x16x32_bf16 v[48:51], v[152:155], v[120:123], v[48:51]
    ds_read_b64_tr_b16 v[180:181], v110 offset:61440
    v_mfma_f32_16x16x32_bf16 v[52:55], v[152:155], v[124:127], v[52:55]
    ds_read_b64_tr_b16 v[182:183], v110 offset:61952
    v_mfma_f32_16x16x32_bf16 v[68:71], v[156:159], v[124:127], v[68:71]
    ds_read_b64_tr_b16 v[184:185], v108 offset:4096
    v_mfma_f32_16x16x32_bf16 v[64:67], v[156:159], v[120:123], v[64:67]
    ds_read_b64_tr_b16 v[186:187], v108 offset:4608
    v_mfma_f32_16x16x32_bf16 v[60:63], v[156:159], v[116:119], v[60:63]
    ds_read_b64_tr_b16 v[188:189], v111 offset:4096
    v_mfma_f32_16x16x32_bf16 v[56:59], v[156:159], v[112:115], v[56:59]
    ds_read_b64_tr_b16 v[190:191], v111 offset:4608
    s_waitcnt lgkmcnt(15)
    v_mfma_f32_16x16x32_bf16 v[72:75], v[112:115], v[160:163], v[72:75]
    v_mfma_f32_16x16x32_bf16 v[76:79], v[116:119], v[160:163], v[76:79]
    v_mfma_f32_16x16x32_bf16 v[80:83], v[120:123], v[160:163], v[80:83]
    v_mfma_f32_16x16x32_bf16 v[84:87], v[124:127], v[160:163], v[84:87]
    v_mfma_f32_16x16x32_bf16 v[100:103], v[124:127], v[164:167], v[100:103]
    v_mfma_f32_16x16x32_bf16 v[96:99], v[120:123], v[164:167], v[96:99]
    v_mfma_f32_16x16x32_bf16 v[92:95], v[116:119], v[164:167], v[92:95]
    v_mfma_f32_16x16x32_bf16 v[88:91], v[112:115], v[164:167], v[88:91]
    s_waitcnt lgkmcnt(8)
    v_mfma_f32_16x16x32_bf16 v[8:11], v[168:171], v[128:131], v[8:11]
    v_mfma_f32_16x16x32_bf16 v[12:15], v[168:171], v[132:135], v[12:15]
    v_mfma_f32_16x16x32_bf16 v[16:19], v[168:171], v[136:139], v[16:19]
    v_mfma_f32_16x16x32_bf16 v[20:23], v[168:171], v[140:143], v[20:23]
    s_waitcnt lgkmcnt(0)
    s_barrier
    v_mfma_f32_16x16x32_bf16 v[36:39], v[172:175], v[140:143], v[36:39]
    ds_read_b128 v[112:115], v104 offset:49152
    v_mfma_f32_16x16x32_bf16 v[32:35], v[172:175], v[136:139], v[32:35]
    ds_read_b64_tr_b16 v[144:145], v108 offset:8192
    v_mfma_f32_16x16x32_bf16 v[28:31], v[172:175], v[132:135], v[28:31]
    ds_read_b64_tr_b16 v[146:147], v108 offset:8704
    v_mfma_f32_16x16x32_bf16 v[24:27], v[172:175], v[128:131], v[24:27]
    ds_read_b128 v[116:119], v104 offset:51200
    v_mfma_f32_16x16x32_bf16 v[40:43], v[176:179], v[128:131], v[40:43]
    ds_read_b128 v[120:123], v104 offset:53248
    v_mfma_f32_16x16x32_bf16 v[44:47], v[176:179], v[132:135], v[44:47]
    ds_read_b128 v[124:127], v104 offset:55296
    v_mfma_f32_16x16x32_bf16 v[48:51], v[176:179], v[136:139], v[48:51]
    ds_read_b64_tr_b16 v[148:149], v111 offset:8192
    v_mfma_f32_16x16x32_bf16 v[52:55], v[176:179], v[140:143], v[52:55]
    ds_read_b64_tr_b16 v[150:151], v111 offset:8704
    v_mfma_f32_16x16x32_bf16 v[68:71], v[180:183], v[140:143], v[68:71]
    ds_read_b64_tr_b16 v[152:153], v108 offset:16384
    v_mfma_f32_16x16x32_bf16 v[64:67], v[180:183], v[136:139], v[64:67]
    ds_read_b64_tr_b16 v[154:155], v108 offset:16896
    v_mfma_f32_16x16x32_bf16 v[60:63], v[180:183], v[132:135], v[60:63]
    ds_read_b64_tr_b16 v[156:157], v111 offset:16384
    v_mfma_f32_16x16x32_bf16 v[56:59], v[180:183], v[128:131], v[56:59]
    ds_read_b64_tr_b16 v[158:159], v111 offset:16896
    v_mfma_f32_16x16x32_bf16 v[72:75], v[128:131], v[184:187], v[72:75]
    ds_read_b64_tr_b16 v[160:161], v108 offset:24576
    v_mfma_f32_16x16x32_bf16 v[76:79], v[132:135], v[184:187], v[76:79]
    ds_read_b64_tr_b16 v[162:163], v108 offset:25088
    v_mfma_f32_16x16x32_bf16 v[80:83], v[136:139], v[184:187], v[80:83]
    ds_read_b64_tr_b16 v[164:165], v111 offset:24576
    v_mfma_f32_16x16x32_bf16 v[84:87], v[140:143], v[184:187], v[84:87]
    ds_read_b64_tr_b16 v[166:167], v111 offset:25088
    v_mfma_f32_16x16x32_bf16 v[100:103], v[140:143], v[188:191], v[100:103]
    v_mfma_f32_16x16x32_bf16 v[96:99], v[136:139], v[188:191], v[96:99]
    v_mfma_f32_16x16x32_bf16 v[92:95], v[132:135], v[188:191], v[92:95]
    v_mfma_f32_16x16x32_bf16 v[88:91], v[128:131], v[188:191], v[88:91]
    s_waitcnt lgkmcnt(8)
    v_mfma_f32_16x16x32_bf16 v[8:11], v[144:147], v[112:115], v[8:11]
    ds_read_b128 v[128:131], v105 offset:49152
    v_mfma_f32_16x16x32_bf16 v[12:15], v[144:147], v[116:119], v[12:15]
    ds_read_b64_tr_b16 v[168:169], v108 offset:12288
    v_mfma_f32_16x16x32_bf16 v[16:19], v[144:147], v[120:123], v[16:19]
    ds_read_b64_tr_b16 v[170:171], v108 offset:12800
    v_mfma_f32_16x16x32_bf16 v[20:23], v[144:147], v[124:127], v[20:23]
    ds_read_b128 v[132:135], v105 offset:51200
    v_mfma_f32_16x16x32_bf16 v[36:39], v[148:151], v[124:127], v[36:39]
    ds_read_b128 v[136:139], v105 offset:53248
    v_mfma_f32_16x16x32_bf16 v[32:35], v[148:151], v[120:123], v[32:35]
    ds_read_b128 v[140:143], v105 offset:55296
    v_mfma_f32_16x16x32_bf16 v[28:31], v[148:151], v[116:119], v[28:31]
    ds_read_b64_tr_b16 v[172:173], v111 offset:12288
    v_mfma_f32_16x16x32_bf16 v[24:27], v[148:151], v[112:115], v[24:27]
    ds_read_b64_tr_b16 v[174:175], v111 offset:12800
    s_waitcnt lgkmcnt(12)
    v_mfma_f32_16x16x32_bf16 v[40:43], v[152:155], v[112:115], v[40:43]
    ds_read_b64_tr_b16 v[176:177], v108 offset:20480
    v_mfma_f32_16x16x32_bf16 v[44:47], v[152:155], v[116:119], v[44:47]
    ds_read_b64_tr_b16 v[178:179], v108 offset:20992
    v_mfma_f32_16x16x32_bf16 v[48:51], v[152:155], v[120:123], v[48:51]
    ds_read_b64_tr_b16 v[180:181], v111 offset:20480
    v_mfma_f32_16x16x32_bf16 v[52:55], v[152:155], v[124:127], v[52:55]
    ds_read_b64_tr_b16 v[182:183], v111 offset:20992
    v_mfma_f32_16x16x32_bf16 v[68:71], v[156:159], v[124:127], v[68:71]
    ds_read_b64_tr_b16 v[184:185], v108 offset:28672
    v_mfma_f32_16x16x32_bf16 v[64:67], v[156:159], v[120:123], v[64:67]
    ds_read_b64_tr_b16 v[186:187], v108 offset:29184
    v_mfma_f32_16x16x32_bf16 v[60:63], v[156:159], v[116:119], v[60:63]
    ds_read_b64_tr_b16 v[188:189], v111 offset:28672
    v_mfma_f32_16x16x32_bf16 v[56:59], v[156:159], v[112:115], v[56:59]
    ds_read_b64_tr_b16 v[190:191], v111 offset:29184
    s_waitcnt lgkmcnt(15)
    v_mfma_f32_16x16x32_bf16 v[72:75], v[112:115], v[160:163], v[72:75]
    v_mfma_f32_16x16x32_bf16 v[76:79], v[116:119], v[160:163], v[76:79]
    v_mfma_f32_16x16x32_bf16 v[80:83], v[120:123], v[160:163], v[80:83]
    v_mfma_f32_16x16x32_bf16 v[84:87], v[124:127], v[160:163], v[84:87]
    v_mfma_f32_16x16x32_bf16 v[100:103], v[124:127], v[164:167], v[100:103]
    v_mfma_f32_16x16x32_bf16 v[96:99], v[120:123], v[164:167], v[96:99]
    v_mfma_f32_16x16x32_bf16 v[92:95], v[116:119], v[164:167], v[92:95]
    v_mfma_f32_16x16x32_bf16 v[88:91], v[112:115], v[164:167], v[88:91]
    s_waitcnt lgkmcnt(8)
    v_mfma_f32_16x16x32_bf16 v[8:11], v[168:171], v[128:131], v[8:11]
    v_mfma_f32_16x16x32_bf16 v[12:15], v[168:171], v[132:135], v[12:15]
    v_mfma_f32_16x16x32_bf16 v[16:19], v[168:171], v[136:139], v[16:19]
    v_mfma_f32_16x16x32_bf16 v[20:23], v[168:171], v[140:143], v[20:23]
    s_waitcnt lgkmcnt(0)
    s_barrier
    v_mfma_f32_16x16x32_bf16 v[36:39], v[172:175], v[140:143], v[36:39]
    v_mfma_f32_16x16x32_bf16 v[32:35], v[172:175], v[136:139], v[32:35]
    v_mfma_f32_16x16x32_bf16 v[28:31], v[172:175], v[132:135], v[28:31]
    v_mfma_f32_16x16x32_bf16 v[24:27], v[172:175], v[128:131], v[24:27]
    v_mfma_f32_16x16x32_bf16 v[40:43], v[176:179], v[128:131], v[40:43]
    v_mfma_f32_16x16x32_bf16 v[44:47], v[176:179], v[132:135], v[44:47]
    v_mfma_f32_16x16x32_bf16 v[48:51], v[176:179], v[136:139], v[48:51]
    v_mfma_f32_16x16x32_bf16 v[52:55], v[176:179], v[140:143], v[52:55]
    v_mfma_f32_16x16x32_bf16 v[68:71], v[180:183], v[140:143], v[68:71]
    v_mfma_f32_16x16x32_bf16 v[64:67], v[180:183], v[136:139], v[64:67]
    v_mfma_f32_16x16x32_bf16 v[60:63], v[180:183], v[132:135], v[60:63]
    v_mfma_f32_16x16x32_bf16 v[56:59], v[180:183], v[128:131], v[56:59]
    v_mfma_f32_16x16x32_bf16 v[72:75], v[128:131], v[184:187], v[72:75]
    v_mfma_f32_16x16x32_bf16 v[76:79], v[132:135], v[184:187], v[76:79]
    v_mfma_f32_16x16x32_bf16 v[80:83], v[136:139], v[184:187], v[80:83]
    v_mfma_f32_16x16x32_bf16 v[84:87], v[140:143], v[184:187], v[84:87]
    v_mfma_f32_16x16x32_bf16 v[100:103], v[140:143], v[188:191], v[100:103]
    v_mfma_f32_16x16x32_bf16 v[96:99], v[136:139], v[188:191], v[96:99]
    v_mfma_f32_16x16x32_bf16 v[92:95], v[132:135], v[188:191], v[92:95]
    v_mfma_f32_16x16x32_bf16 v[88:91], v[128:131], v[188:191], v[88:91]
    s_barrier
    v_and_b32 v3, 15, v1
    s_lshl_b32 s53, s66, 8
    s_add_u32 s53, s53, 0
    v_lshl_add_u32 v184, v3, 2, s53
    s_lshl_b32 s54, s67, 7
    s_add_u32 s54, s54, 1024
    v_lshl_add_u32 v186, v3, 2, s54
    v_and_b32 v3, 48, v1
    v_add_u32 v185, s54, v3
    v_add_u32 v3, s53, v3
    ds_read2_b32 v[104:105], v184 offset0:0 offset1:128
    ds_read2_b32 v[106:107], v184 offset0:16 offset1:144
    ds_read2_b32 v[108:109], v184 offset0:32 offset1:160
    ds_read2_b32 v[110:111], v184 offset0:48 offset1:176
    ds_read_b128 v[112:115], v185 offset:0
    ds_read_b128 v[116:119], v185 offset:64
    ds_read_b128 v[120:123], v185 offset:256
    ds_read_b128 v[124:127], v185 offset:320
    ds_read2_b32 v[128:129], v186 offset0:128 offset1:144
    ds_read_b128 v[132:135], v3 offset:0
    ds_read_b128 v[148:151], v3 offset:512
    ds_read_b128 v[136:139], v3 offset:64
    ds_read_b128 v[152:155], v3 offset:576
    ds_read_b128 v[140:143], v3 offset:128
    ds_read_b128 v[156:159], v3 offset:640
    ds_read_b128 v[144:147], v3 offset:192
    ds_read_b128 v[160:163], v3 offset:704
    s_mul_i32 s53, s67, 49152
    s_lshl_b32 s54, s66, 12
    s_add_u32 s53, s53, s54
    v_add_u32 v187, s53, v2
    s_lshl_b32 s55, s49, 1
    s_add_u32 s55, s55, s67
    s_lshl_b32 s55, s55, 14
    s_add_u32 s55, s55, s54
    s_add_u32 s56, s55, 8192
    s_waitcnt lgkmcnt(0)
    s_nop 0
    v_pk_mul_f32 v[164:165], v[120:121], v[104:105] op_sel:[0,1] op_sel_hi:[1,1]
    v_pk_mul_f32 v[166:167], v[122:123], v[104:105] op_sel:[0,1] op_sel_hi:[1,1]
    v_pk_fma_f32 v[164:165], v[40:41], v[104:105], v[164:165] op_sel_hi:[1,0,1] neg_lo:[0,0,1] neg_hi:[0,0,1]
    v_pk_fma_f32 v[166:167], v[42:43], v[104:105], v[166:167] op_sel_hi:[1,0,1] neg_lo:[0,0,1] neg_hi:[0,0,1]
    v_cvt_pk_bf16_f32 v168, v164, v165
    v_cvt_pk_bf16_f32 v169, v166, v167
    v_pk_mul_f32 v[164:165], v[124:125], v[104:105] op_sel:[0,1] op_sel_hi:[1,1]
    v_pk_mul_f32 v[166:167], v[126:127], v[104:105] op_sel:[0,1] op_sel_hi:[1,1]
    v_pk_fma_f32 v[164:165], v[56:57], v[104:105], v[164:165] op_sel_hi:[1,0,1] neg_lo:[0,0,1] neg_hi:[0,0,1]
    v_pk_fma_f32 v[166:167], v[58:59], v[104:105], v[166:167] op_sel_hi:[1,0,1] neg_lo:[0,0,1] neg_hi:[0,0,1]
    v_cvt_pk_bf16_f32 v170, v164, v165
    v_cvt_pk_bf16_f32 v171, v166, v167
    buffer_store_dwordx4 v[168:171], v2, s[24:27], s55 offen offset:0 sc1
    ds_write_b128 v187, v[168:171] offset:16384
    v_pk_mul_f32 v[164:165], v[120:121], v[106:107] op_sel:[0,1] op_sel_hi:[1,1]
    v_pk_mul_f32 v[166:167], v[122:123], v[106:107] op_sel:[0,1] op_sel_hi:[1,1]
    v_pk_fma_f32 v[164:165], v[44:45], v[106:107], v[164:165] op_sel_hi:[1,0,1] neg_lo:[0,0,1] neg_hi:[0,0,1]
    v_pk_fma_f32 v[166:167], v[46:47], v[106:107], v[166:167] op_sel_hi:[1,0,1] neg_lo:[0,0,1] neg_hi:[0,0,1]
    v_cvt_pk_bf16_f32 v172, v164, v165
    v_cvt_pk_bf16_f32 v173, v166, v167
    v_pk_mul_f32 v[164:165], v[124:125], v[106:107] op_sel:[0,1] op_sel_hi:[1,1]
    v_pk_mul_f32 v[166:167], v[126:127], v[106:107] op_sel:[0,1] op_sel_hi:[1,1]
    v_pk_fma_f32 v[164:165], v[60:61], v[106:107], v[164:165] op_sel_hi:[1,0,1] neg_lo:[0,0,1] neg_hi:[0,0,1]
    v_pk_fma_f32 v[166:167], v[62:63], v[106:107], v[166:167] op_sel_hi:[1,0,1] neg_lo:[0,0,1] neg_hi:[0,0,1]
    v_cvt_pk_bf16_f32 v174, v164, v165
    v_cvt_pk_bf16_f32 v175, v166, v167
    buffer_store_dwordx4 v[172:175], v2, s[24:27], s55 offen offset:1024 sc1
    ds_write_b128 v187, v[172:175] offset:17408
    v_pk_mul_f32 v[164:165], v[120:121], v[108:109] op_sel:[0,1] op_sel_hi:[1,1]
    v_pk_mul_f32 v[166:167], v[122:123], v[108:109] op_sel:[0,1] op_sel_hi:[1,1]
    v_pk_fma_f32 v[164:165], v[48:49], v[108:109], v[164:165] op_sel_hi:[1,0,1] neg_lo:[0,0,1] neg_hi:[0,0,1]
    v_pk_fma_f32 v[166:167], v[50:51], v[108:109], v[166:167] op_sel_hi:[1,0,1] neg_lo:[0,0,1] neg_hi:[0,0,1]
    v_cvt_pk_bf16_f32 v176, v164, v165
    v_cvt_pk_bf16_f32 v177, v166, v167
    v_pk_mul_f32 v[164:165], v[124:125], v[108:109] op_sel:[0,1] op_sel_hi:[1,1]
    v_pk_mul_f32 v[166:167], v[126:127], v[108:109] op_sel:[0,1] op_sel_hi:[1,1]
    v_pk_fma_f32 v[164:165], v[64:65], v[108:109], v[164:165] op_sel_hi:[1,0,1] neg_lo:[0,0,1] neg_hi:[0,0,1]
    v_pk_fma_f32 v[166:167], v[66:67], v[108:109], v[166:167] op_sel_hi:[1,0,1] neg_lo:[0,0,1] neg_hi:[0,0,1]
    v_cvt_pk_bf16_f32 v178, v164, v165
    v_cvt_pk_bf16_f32 v179, v166, v167
    buffer_store_dwordx4 v[176:179], v2, s[24:27], s55 offen offset:2048 sc1
    ds_write_b128 v187, v[176:179] offset:18432
    v_pk_mul_f32 v[164:165], v[120:121], v[110:111] op_sel:[0,1] op_sel_hi:[1,1]
    v_pk_mul_f32 v[166:167], v[122:123], v[110:111] op_sel:[0,1] op_sel_hi:[1,1]
    v_pk_fma_f32 v[164:165], v[52:53], v[110:111], v[164:165] op_sel_hi:[1,0,1] neg_lo:[0,0,1] neg_hi:[0,0,1]
    v_pk_fma_f32 v[166:167], v[54:55], v[110:111], v[166:167] op_sel_hi:[1,0,1] neg_lo:[0,0,1] neg_hi:[0,0,1]
    v_cvt_pk_bf16_f32 v180, v164, v165
    v_cvt_pk_bf16_f32 v181, v166, v167
    v_pk_mul_f32 v[164:165], v[124:125], v[110:111] op_sel:[0,1] op_sel_hi:[1,1]
    v_pk_mul_f32 v[166:167], v[126:127], v[110:111] op_sel:[0,1] op_sel_hi:[1,1]
    v_pk_fma_f32 v[164:165], v[68:69], v[110:111], v[164:165] op_sel_hi:[1,0,1] neg_lo:[0,0,1] neg_hi:[0,0,1]
    v_pk_fma_f32 v[166:167], v[70:71], v[110:111], v[166:167] op_sel_hi:[1,0,1] neg_lo:[0,0,1] neg_hi:[0,0,1]
    v_cvt_pk_bf16_f32 v182, v164, v165
    v_cvt_pk_bf16_f32 v183, v166, v167
    buffer_store_dwordx4 v[180:183], v2, s[24:27], s55 offen offset:3072 sc1
    ds_write_b128 v187, v[180:183] offset:19456
    v_pk_mul_f32 v[164:165], v[148:149], v[128:129] op_sel_hi:[1,0]
    v_pk_mul_f32 v[166:167], v[150:151], v[128:129] op_sel_hi:[1,0]
    v_pk_fma_f32 v[164:165], v[72:73], v[132:133], v[164:165] neg_lo:[0,0,1] neg_hi:[0,0,1]
    v_pk_fma_f32 v[166:167], v[74:75], v[134:135], v[166:167] neg_lo:[0,0,1] neg_hi:[0,0,1]
    v_cvt_pk_bf16_f32 v168, v164, v165
    v_cvt_pk_bf16_f32 v169, v166, v167
    v_pk_mul_f32 v[164:165], v[152:153], v[128:129] op_sel_hi:[1,0]
    v_pk_mul_f32 v[166:167], v[154:155], v[128:129] op_sel_hi:[1,0]
    v_pk_fma_f32 v[164:165], v[76:77], v[136:137], v[164:165] neg_lo:[0,0,1] neg_hi:[0,0,1]
    v_pk_fma_f32 v[166:167], v[78:79], v[138:139], v[166:167] neg_lo:[0,0,1] neg_hi:[0,0,1]
    v_cvt_pk_bf16_f32 v170, v164, v165
    v_cvt_pk_bf16_f32 v171, v166, v167
    buffer_store_dwordx4 v[168:171], v2, s[24:27], s56 offen offset:0 sc1
    ds_write_b128 v187, v[168:171] offset:40960
    v_pk_mul_f32 v[164:165], v[148:149], v[128:129] op_sel:[0,1] op_sel_hi:[1,1]
    v_pk_mul_f32 v[166:167], v[150:151], v[128:129] op_sel:[0,1] op_sel_hi:[1,1]
    v_pk_fma_f32 v[164:165], v[88:89], v[132:133], v[164:165] neg_lo:[0,0,1] neg_hi:[0,0,1]
    v_pk_fma_f32 v[166:167], v[90:91], v[134:135], v[166:167] neg_lo:[0,0,1] neg_hi:[0,0,1]
    v_cvt_pk_bf16_f32 v172, v164, v165
    v_cvt_pk_bf16_f32 v173, v166, v167
    v_pk_mul_f32 v[164:165], v[152:153], v[128:129] op_sel:[0,1] op_sel_hi:[1,1]
    v_pk_mul_f32 v[166:167], v[154:155], v[128:129] op_sel:[0,1] op_sel_hi:[1,1]
    v_pk_fma_f32 v[164:165], v[92:93], v[136:137], v[164:165] neg_lo:[0,0,1] neg_hi:[0,0,1]
    v_pk_fma_f32 v[166:167], v[94:95], v[138:139], v[166:167] neg_lo:[0,0,1] neg_hi:[0,0,1]
    v_cvt_pk_bf16_f32 v174, v164, v165
    v_cvt_pk_bf16_f32 v175, v166, v167
    buffer_store_dwordx4 v[172:175], v2, s[24:27], s56 offen offset:1024 sc1
    ds_write_b128 v187, v[172:175] offset:41984
    v_pk_mul_f32 v[164:165], v[156:157], v[128:129] op_sel_hi:[1,0]
    v_pk_mul_f32 v[166:167], v[158:159], v[128:129] op_sel_hi:[1,0]
    v_pk_fma_f32 v[164:165], v[80:81], v[140:141], v[164:165] neg_lo:[0,0,1] neg_hi:[0,0,1]
    v_pk_fma_f32 v[166:167], v[82:83], v[142:143], v[166:167] neg_lo:[0,0,1] neg_hi:[0,0,1]
    v_cvt_pk_bf16_f32 v176, v164, v165
    v_cvt_pk_bf16_f32 v177, v166, v167
    v_pk_mul_f32 v[164:165], v[160:161], v[128:129] op_sel_hi:[1,0]
    v_pk_mul_f32 v[166:167], v[162:163], v[128:129] op_sel_hi:[1,0]
    v_pk_fma_f32 v[164:165], v[84:85], v[144:145], v[164:165] neg_lo:[0,0,1] neg_hi:[0,0,1]
    v_pk_fma_f32 v[166:167], v[86:87], v[146:147], v[166:167] neg_lo:[0,0,1] neg_hi:[0,0,1]
    v_cvt_pk_bf16_f32 v178, v164, v165
    v_cvt_pk_bf16_f32 v179, v166, v167
    buffer_store_dwordx4 v[176:179], v2, s[24:27], s56 offen offset:2048 sc1
    ds_write_b128 v187, v[176:179] offset:43008
    v_pk_mul_f32 v[164:165], v[156:157], v[128:129] op_sel:[0,1] op_sel_hi:[1,1]
    v_pk_mul_f32 v[166:167], v[158:159], v[128:129] op_sel:[0,1] op_sel_hi:[1,1]
    v_pk_fma_f32 v[164:165], v[96:97], v[140:141], v[164:165] neg_lo:[0,0,1] neg_hi:[0,0,1]
    v_pk_fma_f32 v[166:167], v[98:99], v[142:143], v[166:167] neg_lo:[0,0,1] neg_hi:[0,0,1]
    v_cvt_pk_bf16_f32 v180, v164, v165
    v_cvt_pk_bf16_f32 v181, v166, v167
    v_pk_mul_f32 v[164:165], v[160:161], v[128:129] op_sel:[0,1] op_sel_hi:[1,1]
    v_pk_mul_f32 v[166:167], v[162:163], v[128:129] op_sel:[0,1] op_sel_hi:[1,1]
    v_pk_fma_f32 v[164:165], v[100:101], v[144:145], v[164:165] neg_lo:[0,0,1] neg_hi:[0,0,1]
    v_pk_fma_f32 v[166:167], v[102:103], v[146:147], v[166:167] neg_lo:[0,0,1] neg_hi:[0,0,1]
    v_cvt_pk_bf16_f32 v182, v164, v165
    v_cvt_pk_bf16_f32 v183, v166, v167
    buffer_store_dwordx4 v[180:183], v2, s[24:27], s56 offen offset:3072 sc1
    ds_write_b128 v187, v[180:183] offset:44032
    s_mov_b32 s53, 0x3e8293ee
    v_mul_f32 v104, s53, v104
    v_mul_f32 v105, s53, v105
    v_mul_f32 v106, s53, v106
    v_mul_f32 v107, s53, v107
    v_mul_f32 v108, s53, v108
    v_mul_f32 v109, s53, v109
    v_mul_f32 v110, s53, v110
    v_mul_f32 v111, s53, v111
    s_lshl_b32 s53, s67, 13
    s_add_u32 s53, s53, s54
    s_add_u32 s53, s53, 98304
    v_add_u32 v187, s53, v2
    s_nop 0
    v_pk_mul_f32 v[164:165], v[112:113], v[104:105] op_sel:[0,1] op_sel_hi:[1,1]
    v_pk_mul_f32 v[166:167], v[114:115], v[104:105] op_sel:[0,1] op_sel_hi:[1,1]
    v_pk_fma_f32 v[164:165], v[8:9], v[104:105], v[164:165] op_sel_hi:[1,0,1] neg_lo:[0,0,1] neg_hi:[0,0,1]
    v_pk_fma_f32 v[166:167], v[10:11], v[104:105], v[166:167] op_sel_hi:[1,0,1] neg_lo:[0,0,1] neg_hi:[0,0,1]
    v_cvt_pk_bf16_f32 v132, v164, v165
    v_cvt_pk_bf16_f32 v133, v166, v167
    v_pk_mul_f32 v[164:165], v[116:117], v[104:105] op_sel:[0,1] op_sel_hi:[1,1]
    v_pk_mul_f32 v[166:167], v[118:119], v[104:105] op_sel:[0,1] op_sel_hi:[1,1]
    v_pk_fma_f32 v[164:165], v[24:25], v[104:105], v[164:165] op_sel_hi:[1,0,1] neg_lo:[0,0,1] neg_hi:[0,0,1]
    v_pk_fma_f32 v[166:167], v[26:27], v[104:105], v[166:167] op_sel_hi:[1,0,1] neg_lo:[0,0,1] neg_hi:[0,0,1]
    v_cvt_pk_bf16_f32 v134, v164, v165
    v_cvt_pk_bf16_f32 v135, v166, v167
    ds_write_b128 v187, v[132:135] offset:0
    v_pk_mul_f32 v[164:165], v[112:113], v[106:107] op_sel:[0,1] op_sel_hi:[1,1]
    v_pk_mul_f32 v[166:167], v[114:115], v[106:107] op_sel:[0,1] op_sel_hi:[1,1]
    v_pk_fma_f32 v[164:165], v[12:13], v[106:107], v[164:165] op_sel_hi:[1,0,1] neg_lo:[0,0,1] neg_hi:[0,0,1]
    v_pk_fma_f32 v[166:167], v[14:15], v[106:107], v[166:167] op_sel_hi:[1,0,1] neg_lo:[0,0,1] neg_hi:[0,0,1]
    v_cvt_pk_bf16_f32 v136, v164, v165
    v_cvt_pk_bf16_f32 v137, v166, v167
    v_pk_mul_f32 v[164:165], v[116:117], v[106:107] op_sel:[0,1] op_sel_hi:[1,1]
    v_pk_mul_f32 v[166:167], v[118:119], v[106:107] op_sel:[0,1] op_sel_hi:[1,1]
    v_pk_fma_f32 v[164:165], v[28:29], v[106:107], v[164:165] op_sel_hi:[1,0,1] neg_lo:[0,0,1] neg_hi:[0,0,1]
    v_pk_fma_f32 v[166:167], v[30:31], v[106:107], v[166:167] op_sel_hi:[1,0,1] neg_lo:[0,0,1] neg_hi:[0,0,1]
    v_cvt_pk_bf16_f32 v138, v164, v165
    v_cvt_pk_bf16_f32 v139, v166, v167
    ds_write_b128 v187, v[136:139] offset:1024
    v_pk_mul_f32 v[164:165], v[112:113], v[108:109] op_sel:[0,1] op_sel_hi:[1,1]
    v_pk_mul_f32 v[166:167], v[114:115], v[108:109] op_sel:[0,1] op_sel_hi:[1,1]
    v_pk_fma_f32 v[164:165], v[16:17], v[108:109], v[164:165] op_sel_hi:[1,0,1] neg_lo:[0,0,1] neg_hi:[0,0,1]
    v_pk_fma_f32 v[166:167], v[18:19], v[108:109], v[166:167] op_sel_hi:[1,0,1] neg_lo:[0,0,1] neg_hi:[0,0,1]
    v_cvt_pk_bf16_f32 v140, v164, v165
    v_cvt_pk_bf16_f32 v141, v166, v167
    v_pk_mul_f32 v[164:165], v[116:117], v[108:109] op_sel:[0,1] op_sel_hi:[1,1]
    v_pk_mul_f32 v[166:167], v[118:119], v[108:109] op_sel:[0,1] op_sel_hi:[1,1]
    v_pk_fma_f32 v[164:165], v[32:33], v[108:109], v[164:165] op_sel_hi:[1,0,1] neg_lo:[0,0,1] neg_hi:[0,0,1]
    v_pk_fma_f32 v[166:167], v[34:35], v[108:109], v[166:167] op_sel_hi:[1,0,1] neg_lo:[0,0,1] neg_hi:[0,0,1]
    v_cvt_pk_bf16_f32 v142, v164, v165
    v_cvt_pk_bf16_f32 v143, v166, v167
    ds_write_b128 v187, v[140:143] offset:2048
    v_pk_mul_f32 v[164:165], v[112:113], v[110:111] op_sel:[0,1] op_sel_hi:[1,1]
    v_pk_mul_f32 v[166:167], v[114:115], v[110:111] op_sel:[0,1] op_sel_hi:[1,1]
    v_pk_fma_f32 v[164:165], v[20:21], v[110:111], v[164:165] op_sel_hi:[1,0,1] neg_lo:[0,0,1] neg_hi:[0,0,1]
    v_pk_fma_f32 v[166:167], v[22:23], v[110:111], v[166:167] op_sel_hi:[1,0,1] neg_lo:[0,0,1] neg_hi:[0,0,1]
    v_cvt_pk_bf16_f32 v144, v164, v165
    v_cvt_pk_bf16_f32 v145, v166, v167
    v_pk_mul_f32 v[164:165], v[116:117], v[110:111] op_sel:[0,1] op_sel_hi:[1,1]
    v_pk_mul_f32 v[166:167], v[118:119], v[110:111] op_sel:[0,1] op_sel_hi:[1,1]
    v_pk_fma_f32 v[164:165], v[36:37], v[110:111], v[164:165] op_sel_hi:[1,0,1] neg_lo:[0,0,1] neg_hi:[0,0,1]
    v_pk_fma_f32 v[166:167], v[38:39], v[110:111], v[166:167] op_sel_hi:[1,0,1] neg_lo:[0,0,1] neg_hi:[0,0,1]
    v_cvt_pk_bf16_f32 v146, v164, v165
    v_cvt_pk_bf16_f32 v147, v166, v167
    ds_write_b128 v187, v[144:147] offset:3072
    v_lshlrev_b32 v3, 2, v1
    v_add_u32 v3, 162816, v3
    v_mov_b32 v4, 0
    ds_write_b32 v3, v4
    s_mul_i32 s53, s67, 49152
    v_add_u32 v248, s53, v2
    s_lshl_b32 s53, s67, 13
    s_add_u32 s53, s53, 98304
    v_add_u32 v249, s53, v2
    s_lshl_b32 s68, s49, 1
    s_add_u32 s68, s68, s67
    s_lshl_b32 s68, s68, 13
    s_add_u32 s68, s68, 0x800000
    v_lshrrev_b32 v3, 4, v1
    v_lshlrev_b32 v3, 2, v3
    v_and_b32 v4, 15, v1
    v_sub_u32 v3, v4, v3
    v_mov_b32 v4, 0xf149f2ca
    v_cmp_le_i32 vcc, 0, v3
    v_mov_b32 v232, 0x3f803f80
    s_nop 0
    v_cndmask_b32_e64 v224, v4, 0, vcc
    v_cndmask_b32_e64 v228, 0, v4, vcc
    v_cmp_le_i32 vcc, 1, v3
    v_mov_b32 v233, 0x3f803f80
    s_nop 0
    v_cndmask_b32_e64 v225, v4, 0, vcc
    v_cndmask_b32_e64 v229, 0, v4, vcc
    v_cmp_le_i32 vcc, 2, v3
    v_mov_b32 v234, 0x3f803f80
    s_nop 0
    v_cndmask_b32_e64 v226, v4, 0, vcc
    v_cndmask_b32_e64 v230, 0, v4, vcc
    v_cmp_le_i32 vcc, 3, v3
    v_mov_b32 v235, 0x3f803f80
    s_nop 0
    v_cndmask_b32_e64 v227, v4, 0, vcc
    v_cndmask_b32_e64 v231, 0, v4, vcc
    v_and_b32 v250, 3, v1
    v_lshlrev_b32 v250, 2, v250
    v_add_u32 v250, 162832, v250
    s_waitcnt lgkmcnt(0)
    s_barrier
    s_cmp_eq_u32 s66, 1
    s_cbranch_scc1 sequential_preLN__sliding_block__dense_activation_gelu__prompt_kernel_att159
    ds_read_b128 v[136:139], v249 offset:0
    ds_read_b128 v[140:143], v249 offset:1024
    ds_read_b128 v[144:147], v249 offset:6144
    ds_read_b128 v[148:151], v249 offset:7168
    ds_read_b128 v[152:155], v248 offset:16384
    ds_read_b128 v[156:159], v248 offset:17408
    ds_read_b128 v[160:163], v248 offset:16384
    ds_read_b128 v[164:167], v248 offset:17408
    ds_read_b128 v[168:171], v248 offset:18432
    ds_read_b128 v[172:175], v248 offset:19456
    s_waitcnt lgkmcnt(4)
    v_mfma_f32_16x16x32_bf16 v[8:11], v[152:155], v[136:139], v[224:227]
    v_mfma_f32_16x16x32_bf16 v[12:15], v[152:155], v[140:143], 0
    v_mfma_f32_16x16x32_bf16 v[16:19], v[156:159], v[140:143], v[224:227]
    ds_read_b128 v[152:155], v248 offset:20480
    ds_read_b128 v[156:159], v248 offset:21504
    s_waitcnt lgkmcnt(4)
    v_mfma_f32_16x16x32_bf16 v[20:23], v[160:163], v[144:147], 0
    v_mfma_f32_16x16x32_bf16 v[28:31], v[160:163], v[148:151], 0
    v_mfma_f32_16x16x32_bf16 v[24:27], v[164:167], v[144:147], 0
    v_max3_f32 v236, v8, v9, v10
    v_max_f32 v236, v236, v11
    v_mfma_f32_16x16x32_bf16 v[32:35], v[164:167], v[148:151], 0
    v_max3_f32 v238, v12, v13, v14
    v_max_f32 v238, v238, v15
    ds_read_b128 v[160:163], v248 offset:22528
    ds_read_b128 v[164:167], v248 offset:23552
    s_waitcnt lgkmcnt(4)
    v_mfma_f32_16x16x32_bf16 v[36:39], v[168:171], v[144:147], 0
    v_max3_f32 v238, v238, v16, v17
    v_max3_f32 v238, v238, v18, v19
    v_mfma_f32_16x16x32_bf16 v[44:47], v[168:171], v[148:151], 0
    v_max3_f32 v240, v20, v21, v22
    v_max_f32 v240, v240, v23
    v_mfma_f32_16x16x32_bf16 v[40:43], v[172:175], v[144:147], 0
    v_max3_f32 v242, v28, v29, v30
    v_max_f32 v242, v242, v31
    v_mfma_f32_16x16x32_bf16 v[48:51], v[172:175], v[148:151], 0
    v_max3_f32 v240, v240, v24, v25
    v_max3_f32 v240, v240, v26, v27
    s_waitcnt lgkmcnt(2)
    v_mfma_f32_16x16x32_bf16 v[52:55], v[152:155], v[144:147], 0
    v_max3_f32 v242, v242, v32, v33
    v_max3_f32 v242, v242, v34, v35
    v_mfma_f32_16x16x32_bf16 v[60:63], v[152:155], v[148:151], 0
    v_max3_f32 v240, v240, v36, v37
    v_max3_f32 v240, v240, v38, v39
    v_mfma_f32_16x16x32_bf16 v[56:59], v[156:159], v[144:147], 0
    v_max3_f32 v242, v242, v44, v45
    v_max3_f32 v242, v242, v46, v47
    v_mfma_f32_16x16x32_bf16 v[64:67], v[156:159], v[148:151], 0
    v_max3_f32 v240, v240, v40, v41
    v_max3_f32 v240, v240, v42, v43
    s_waitcnt lgkmcnt(0)
    v_mfma_f32_16x16x32_bf16 v[68:71], v[160:163], v[144:147], v[224:227]
    v_max3_f32 v242, v242, v48, v49
    v_max3_f32 v242, v242, v50, v51
    v_mfma_f32_16x16x32_bf16 v[72:75], v[160:163], v[148:151], 0
    v_max3_f32 v240, v240, v52, v53
    v_max3_f32 v240, v240, v54, v55
    v_mfma_f32_16x16x32_bf16 v[76:79], v[164:167], v[148:151], v[224:227]
    v_max3_f32 v242, v242, v60, v61
    v_max3_f32 v242, v242, v62, v63
    s_nop 7
    v_max3_f32 v240, v240, v56, v57
    v_max3_f32 v240, v240, v58, v59
    v_max3_f32 v242, v242, v64, v65
    v_max3_f32 v242, v242, v66, v67
    v_max3_f32 v240, v240, v68, v69
    v_max3_f32 v240, v240, v70, v71
    v_max3_f32 v242, v242, v72, v73
    v_max3_f32 v242, v242, v74, v75
    v_max3_f32 v242, v242, v76, v77
    v_max3_f32 v242, v242, v78, v79
    ds_read_b128 v[152:155], v248 offset:40960
    ds_read_b128 v[156:159], v248 offset:41984
    ds_read_b128 v[160:163], v248 offset:40960
    ds_read_b128 v[164:167], v248 offset:41984
    v_mov_b32 v237, v236
    v_mov_b32 v239, v238
    v_mov_b32 v241, v240
    v_mov_b32 v243, v242
    s_nop 0
    v_permlane32_swap_b32 v236, v237
    v_permlane32_swap_b32 v238, v239
    v_permlane32_swap_b32 v240, v241
    v_permlane32_swap_b32 v242, v243
    v_max_f32 v236, v236, v237
    v_max_f32 v238, v238, v239
    v_max_f32 v240, v240, v241
    v_max_f32 v242, v242, v243
    v_mov_b32 v237, v236
    v_mov_b32 v239, v238
    v_mov_b32 v241, v240
    v_mov_b32 v243, v242
    s_nop 0
    v_permlane16_swap_b32 v236, v237
    v_permlane16_swap_b32 v238, v239
    v_permlane16_swap_b32 v240, v241
    v_permlane16_swap_b32 v242, v243
    v_max_f32 v236, v236, v237
    v_max_f32 v238, v238, v239
    v_max_f32 v240, v240, v241
    v_max_f32 v242, v242, v243
    s_waitcnt vmcnt(0)
    s_barrier
    v_pk_add_f32 v[8:9], v[8:9], v[236:237] op_sel_hi:[1,0] neg_lo:[0,1] neg_hi:[0,1]
    v_pk_add_f32 v[10:11], v[10:11], v[236:237] op_sel_hi:[1,0] neg_lo:[0,1] neg_hi:[0,1]
    v_exp_f32 v8, v8
    v_exp_f32 v9, v9
    v_exp_f32 v10, v10
    v_exp_f32 v11, v11
    v_cvt_pk_bf16_f32 v8, v8, v9
    v_cvt_pk_bf16_f32 v9, v10, v11
    v_mov_b32 v10, 0
    v_mov_b32 v11, 0
    v_pk_add_f32 v[12:13], v[12:13], v[238:239] op_sel_hi:[1,0] neg_lo:[0,1] neg_hi:[0,1]
    v_pk_add_f32 v[14:15], v[14:15], v[238:239] op_sel_hi:[1,0] neg_lo:[0,1] neg_hi:[0,1]
    v_exp_f32 v12, v12
    v_exp_f32 v13, v13
    v_exp_f32 v14, v14
    v_exp_f32 v15, v15
    v_cvt_pk_bf16_f32 v12, v12, v13
    v_cvt_pk_bf16_f32 v13, v14, v15
    v_pk_add_f32 v[16:17], v[16:17], v[238:239] op_sel_hi:[1,0] neg_lo:[0,1] neg_hi:[0,1]
    v_pk_add_f32 v[18:19], v[18:19], v[238:239] op_sel_hi:[1,0] neg_lo:[0,1] neg_hi:[0,1]
    v_exp_f32 v16, v16
    v_exp_f32 v17, v17
    v_exp_f32 v18, v18
    v_exp_f32 v19, v19
    v_cvt_pk_bf16_f32 v14, v16, v17
    v_cvt_pk_bf16_f32 v15, v18, v19
    s_waitcnt lgkmcnt(2)
    v_pk_add_f32 v[20:21], v[20:21], v[240:241] op_sel_hi:[1,0] neg_lo:[0,1] neg_hi:[0,1]
    v_pk_add_f32 v[22:23], v[22:23], v[240:241] op_sel_hi:[1,0] neg_lo:[0,1] neg_hi:[0,1]
    v_mfma_f32_16x16x32_bf16 v[176:179], v[152:155], v[8:11], 0
    v_exp_f32 v20, v20
    v_exp_f32 v21, v21
    v_mfma_f32_16x16x32_bf16 v[180:183], v[156:159], v[8:11], 0
    v_exp_f32 v22, v22
    v_exp_f32_e64 v23, v23
    v_cvt_pk_bf16_f32 v20, v20, v21
    v_cvt_pk_bf16_f32 v21, v22, v23
    v_pk_add_f32 v[24:25], v[24:25], v[240:241] op_sel_hi:[1,0] neg_lo:[0,1] neg_hi:[0,1]
    v_pk_add_f32 v[26:27], v[26:27], v[240:241] op_sel_hi:[1,0] neg_lo:[0,1] neg_hi:[0,1]
    v_mfma_f32_16x16x32_bf16 v[184:187], v[232:235], v[8:11], 0
    v_exp_f32 v24, v24
    v_exp_f32 v25, v25
    v_exp_f32 v26, v26
    v_exp_f32 v27, v27
    v_cvt_pk_bf16_f32 v22, v24, v25
    v_cvt_pk_bf16_f32 v23, v26, v27
    v_pk_add_f32 v[28:29], v[28:29], v[242:243] op_sel_hi:[1,0] neg_lo:[0,1] neg_hi:[0,1]
    v_pk_add_f32 v[30:31], v[30:31], v[242:243] op_sel_hi:[1,0] neg_lo:[0,1] neg_hi:[0,1]
    v_mfma_f32_16x16x32_bf16 v[188:191], v[152:155], v[12:15], 0
    v_exp_f32 v28, v28
    v_exp_f32 v29, v29
    v_mfma_f32_16x16x32_bf16 v[192:195], v[156:159], v[12:15], 0
    v_exp_f32 v30, v30
    v_exp_f32 v31, v31
    v_cvt_pk_bf16_f32 v28, v28, v29
    v_cvt_pk_bf16_f32 v29, v30, v31
    v_pk_add_f32 v[32:33], v[32:33], v[242:243] op_sel_hi:[1,0] neg_lo:[0,1] neg_hi:[0,1]
    v_pk_add_f32 v[34:35], v[34:35], v[242:243] op_sel_hi:[1,0] neg_lo:[0,1] neg_hi:[0,1]
    v_mfma_f32_16x16x32_bf16 v[196:199], v[232:235], v[12:15], 0
    v_exp_f32 v32, v32
    v_exp_f32 v33, v33
    v_exp_f32 v34, v34
    v_exp_f32 v35, v35
    v_cvt_pk_bf16_f32 v30, v32, v33
    v_cvt_pk_bf16_f32 v31, v34, v35
    ds_read_b128 v[152:155], v248 offset:43008
    ds_read_b128 v[156:159], v248 offset:44032
    s_waitcnt lgkmcnt(2)
    v_pk_add_f32 v[36:37], v[36:37], v[240:241] op_sel_hi:[1,0] neg_lo:[0,1] neg_hi:[0,1]
    v_pk_add_f32 v[38:39], v[38:39], v[240:241] op_sel_hi:[1,0] neg_lo:[0,1] neg_hi:[0,1]
    v_mfma_f32_16x16x32_bf16 v[200:203], v[160:163], v[20:23], 0
    v_exp_f32 v36, v36
    v_exp_f32 v37, v37
    v_mfma_f32_16x16x32_bf16 v[204:207], v[164:167], v[20:23], 0
    v_exp_f32 v38, v38
    v_exp_f32_e64 v39, v39
    v_cvt_pk_bf16_f32 v36, v36, v37
    v_cvt_pk_bf16_f32 v37, v38, v39
    v_pk_add_f32 v[40:41], v[40:41], v[240:241] op_sel_hi:[1,0] neg_lo:[0,1] neg_hi:[0,1]
    v_pk_add_f32 v[42:43], v[42:43], v[240:241] op_sel_hi:[1,0] neg_lo:[0,1] neg_hi:[0,1]
    v_mfma_f32_16x16x32_bf16 v[208:211], v[232:235], v[20:23], 0
    v_exp_f32 v40, v40
    v_exp_f32 v41, v41
    v_exp_f32 v42, v42
    v_exp_f32 v43, v43
    v_cvt_pk_bf16_f32 v38, v40, v41
    v_cvt_pk_bf16_f32 v39, v42, v43
    v_pk_add_f32 v[44:45], v[44:45], v[242:243] op_sel_hi:[1,0] neg_lo:[0,1] neg_hi:[0,1]
    v_pk_add_f32 v[46:47], v[46:47], v[242:243] op_sel_hi:[1,0] neg_lo:[0,1] neg_hi:[0,1]
    v_mfma_f32_16x16x32_bf16 v[212:215], v[160:163], v[28:31], 0
    v_exp_f32 v44, v44
    v_exp_f32 v45, v45
    v_mfma_f32_16x16x32_bf16 v[216:219], v[164:167], v[28:31], 0
    v_exp_f32 v46, v46
    v_exp_f32 v47, v47
    v_cvt_pk_bf16_f32 v44, v44, v45
    v_cvt_pk_bf16_f32 v45, v46, v47
    v_pk_add_f32 v[48:49], v[48:49], v[242:243] op_sel_hi:[1,0] neg_lo:[0,1] neg_hi:[0,1]
    v_pk_add_f32 v[50:51], v[50:51], v[242:243] op_sel_hi:[1,0] neg_lo:[0,1] neg_hi:[0,1]
    v_mfma_f32_16x16x32_bf16 v[220:223], v[232:235], v[28:31], 0
    v_exp_f32 v48, v48
    v_exp_f32 v49, v49
    v_exp_f32 v50, v50
    v_exp_f32 v51, v51
    v_cvt_pk_bf16_f32 v46, v48, v49
    v_cvt_pk_bf16_f32 v47, v50, v51
    ds_read_b128 v[160:163], v248 offset:45056
    ds_read_b128 v[164:167], v248 offset:46080
    s_waitcnt lgkmcnt(2)
    v_pk_add_f32 v[52:53], v[52:53], v[240:241] op_sel_hi:[1,0] neg_lo:[0,1] neg_hi:[0,1]
    v_pk_add_f32 v[54:55], v[54:55], v[240:241] op_sel_hi:[1,0] neg_lo:[0,1] neg_hi:[0,1]
    v_mfma_f32_16x16x32_bf16 v[200:203], v[152:155], v[36:39], v[200:203]
    v_exp_f32 v52, v52
    v_exp_f32 v53, v53
    v_mfma_f32_16x16x32_bf16 v[204:207], v[156:159], v[36:39], v[204:207]
    v_exp_f32 v54, v54
    v_exp_f32_e64 v55, v55
    v_cvt_pk_bf16_f32 v52, v52, v53
    v_cvt_pk_bf16_f32 v53, v54, v55
    v_pk_add_f32 v[56:57], v[56:57], v[240:241] op_sel_hi:[1,0] neg_lo:[0,1] neg_hi:[0,1]
    v_pk_add_f32 v[58:59], v[58:59], v[240:241] op_sel_hi:[1,0] neg_lo:[0,1] neg_hi:[0,1]
    v_mfma_f32_16x16x32_bf16 v[208:211], v[232:235], v[36:39], v[208:211]
    v_exp_f32 v56, v56
    v_exp_f32 v57, v57
    v_exp_f32 v58, v58
    v_exp_f32 v59, v59
    v_cvt_pk_bf16_f32 v54, v56, v57
    v_cvt_pk_bf16_f32 v55, v58, v59
    v_pk_add_f32 v[60:61], v[60:61], v[242:243] op_sel_hi:[1,0] neg_lo:[0,1] neg_hi:[0,1]
    v_pk_add_f32 v[62:63], v[62:63], v[242:243] op_sel_hi:[1,0] neg_lo:[0,1] neg_hi:[0,1]
    v_mfma_f32_16x16x32_bf16 v[212:215], v[152:155], v[44:47], v[212:215]
    v_exp_f32 v60, v60
    v_exp_f32 v61, v61
    v_mfma_f32_16x16x32_bf16 v[216:219], v[156:159], v[44:47], v[216:219]
    v_exp_f32 v62, v62
    v_exp_f32 v63, v63
    v_cvt_pk_bf16_f32 v60, v60, v61
    v_cvt_pk_bf16_f32 v61, v62, v63
    v_pk_add_f32 v[64:65], v[64:65], v[242:243] op_sel_hi:[1,0] neg_lo:[0,1] neg_hi:[0,1]
    v_pk_add_f32 v[66:67], v[66:67], v[242:243] op_sel_hi:[1,0] neg_lo:[0,1] neg_hi:[0,1]
    v_mfma_f32_16x16x32_bf16 v[220:223], v[232:235], v[44:47], v[220:223]
    v_exp_f32 v64, v64
    v_exp_f32 v65, v65
    v_exp_f32 v66, v66
    v_exp_f32 v67, v67
    v_cvt_pk_bf16_f32 v62, v64, v65
    v_cvt_pk_bf16_f32 v63, v66, v67
    ds_read_b128 v[152:155], v248 offset:47104
    ds_read_b128 v[156:159], v248 offset:48128
    s_waitcnt lgkmcnt(2)
    v_pk_add_f32 v[68:69], v[68:69], v[240:241] op_sel_hi:[1,0] neg_lo:[0,1] neg_hi:[0,1]
    v_pk_add_f32 v[70:71], v[70:71], v[240:241] op_sel_hi:[1,0] neg_lo:[0,1] neg_hi:[0,1]
    v_mfma_f32_16x16x32_bf16 v[200:203], v[160:163], v[52:55], v[200:203]
    v_exp_f32 v68, v68
    v_exp_f32 v69, v69
    v_mfma_f32_16x16x32_bf16 v[204:207], v[164:167], v[52:55], v[204:207]
    v_exp_f32 v70, v70
    v_exp_f32 v71, v71
    v_cvt_pk_bf16_f32 v68, v68, v69
    v_cvt_pk_bf16_f32 v69, v70, v71
    v_mov_b32 v70, 0
    v_mov_b32 v71, 0
    v_pk_add_f32 v[72:73], v[72:73], v[242:243] op_sel_hi:[1,0] neg_lo:[0,1] neg_hi:[0,1]
    v_pk_add_f32 v[74:75], v[74:75], v[242:243] op_sel_hi:[1,0] neg_lo:[0,1] neg_hi:[0,1]
    v_mfma_f32_16x16x32_bf16 v[208:211], v[232:235], v[52:55], v[208:211]
    v_exp_f32 v72, v72
    v_exp_f32 v73, v73
    v_exp_f32 v74, v74
    v_exp_f32_e64 v75, v75
    v_cvt_pk_bf16_f32 v72, v72, v73
    v_cvt_pk_bf16_f32 v73, v74, v75
    v_pk_add_f32 v[76:77], v[76:77], v[242:243] op_sel_hi:[1,0] neg_lo:[0,1] neg_hi:[0,1]
    v_pk_add_f32 v[78:79], v[78:79], v[242:243] op_sel_hi:[1,0] neg_lo:[0,1] neg_hi:[0,1]
    v_mfma_f32_16x16x32_bf16 v[212:215], v[160:163], v[60:63], v[212:215]
    v_exp_f32 v76, v76
    v_exp_f32 v77, v77
    v_mfma_f32_16x16x32_bf16 v[216:219], v[164:167], v[60:63], v[216:219]
    v_exp_f32 v78, v78
    v_exp_f32 v79, v79
    v_cvt_pk_bf16_f32 v74, v76, v77
    v_cvt_pk_bf16_f32 v75, v78, v79
    v_mfma_f32_16x16x32_bf16 v[220:223], v[232:235], v[60:63], v[220:223]
    s_waitcnt lgkmcnt(0)
    s_nop 1
    v_mfma_f32_16x16x32_bf16 v[200:203], v[152:155], v[68:71], v[200:203]
    v_mfma_f32_16x16x32_bf16 v[204:207], v[156:159], v[68:71], v[204:207]
    v_mfma_f32_16x16x32_bf16 v[208:211], v[232:235], v[68:71], v[208:211]
    v_mfma_f32_16x16x32_bf16 v[212:215], v[152:155], v[72:75], v[212:215]
    v_mfma_f32_16x16x32_bf16 v[216:219], v[156:159], v[72:75], v[216:219]
    v_mfma_f32_16x16x32_bf16 v[220:223], v[232:235], v[72:75], v[220:223]
    s_barrier
    s_barrier
    ds_read_b128 v[152:155], v248 offset:0
    ds_read_b128 v[156:159], v248 offset:1024
    ds_read_b128 v[160:163], v248 offset:2048
    ds_read_b128 v[164:167], v248 offset:3072
    ds_read_b128 v[168:171], v248 offset:4096
    ds_read_b128 v[172:175], v248 offset:5120
    s_waitcnt lgkmcnt(4)
    v_mfma_f32_16x16x32_bf16 v[8:11], v[152:155], v[136:139], v[228:231]
    v_mfma_f32_16x16x32_bf16 v[12:15], v[156:159], v[136:139], 0
    v_mfma_f32_16x16x32_bf16 v[20:23], v[156:159], v[140:143], v[228:231]
    ds_read_b128 v[152:155], v248 offset:6144
    ds_read_b128 v[156:159], v248 offset:7168
    s_waitcnt lgkmcnt(4)
    v_mfma_f32_16x16x32_bf16 v[24:27], v[160:163], v[136:139], 0
    v_mfma_f32_16x16x32_bf16 v[32:35], v[160:163], v[140:143], 0
    v_mfma_f32_16x16x32_bf16 v[28:31], v[164:167], v[136:139], 0
    v_max3_f32 v244, v8, v9, v10
    v_max_f32 v244, v244, v11
    v_mfma_f32_16x16x32_bf16 v[36:39], v[164:167], v[140:143], 0
    s_nop 0
    v_max3_f32 v244, v244, v12, v13
    v_max3_f32 v244, v244, v14, v15
    ds_read_b128 v[160:163], v248 offset:8192
    ds_read_b128 v[164:167], v248 offset:9216
    s_waitcnt lgkmcnt(4)
    v_mfma_f32_16x16x32_bf16 v[40:43], v[168:171], v[136:139], 0
    v_max3_f32 v246, v20, v21, v22
    v_max_f32 v246, v246, v23
    v_mfma_f32_16x16x32_bf16 v[48:51], v[168:171], v[140:143], 0
    v_max3_f32 v244, v244, v24, v25
    v_max3_f32 v244, v244, v26, v27
    v_mfma_f32_16x16x32_bf16 v[44:47], v[172:175], v[136:139], 0
    v_max3_f32 v246, v246, v32, v33
    v_max3_f32 v246, v246, v34, v35
    v_mfma_f32_16x16x32_bf16 v[52:55], v[172:175], v[140:143], 0
    v_max3_f32 v244, v244, v28, v29
    v_max3_f32 v244, v244, v30, v31
    ds_read_b128 v[168:171], v248 offset:10240
    ds_read_b128 v[172:175], v248 offset:11264
    s_waitcnt lgkmcnt(4)
    v_mfma_f32_16x16x32_bf16 v[56:59], v[152:155], v[136:139], 0
    v_max3_f32 v246, v246, v36, v37
    v_max3_f32 v246, v246, v38, v39
    v_mfma_f32_16x16x32_bf16 v[64:67], v[152:155], v[140:143], 0
    v_max3_f32 v244, v244, v40, v41
    v_max3_f32 v244, v244, v42, v43
    v_mfma_f32_16x16x32_bf16 v[60:63], v[156:159], v[136:139], 0
    v_max3_f32 v246, v246, v48, v49
    v_max3_f32 v246, v246, v50, v51
    v_mfma_f32_16x16x32_bf16 v[68:71], v[156:159], v[140:143], 0
    s_nop 0
    v_max3_f32 v244, v244, v44, v45
    v_max3_f32 v244, v244, v46, v47
    ds_read_b128 v[152:155], v248 offset:12288
    ds_read_b128 v[156:159], v248 offset:13312
    s_waitcnt lgkmcnt(4)
    v_mfma_f32_16x16x32_bf16 v[72:75], v[160:163], v[136:139], 0
    v_max3_f32 v246, v246, v52, v53
    v_max3_f32 v246, v246, v54, v55
    v_mfma_f32_16x16x32_bf16 v[80:83], v[160:163], v[140:143], 0
    v_max3_f32 v244, v244, v56, v57
    v_max3_f32 v244, v244, v58, v59
    v_mfma_f32_16x16x32_bf16 v[76:79], v[164:167], v[136:139], 0
    v_max3_f32 v246, v246, v64, v65
    v_max3_f32 v246, v246, v66, v67
    v_mfma_f32_16x16x32_bf16 v[84:87], v[164:167], v[140:143], 0
    s_nop 0
    v_max3_f32 v244, v244, v60, v61
    v_max3_f32 v244, v244, v62, v63
    ds_read_b128 v[160:163], v248 offset:14336
    ds_read_b128 v[164:167], v248 offset:15360
    s_waitcnt lgkmcnt(4)
    v_mfma_f32_16x16x32_bf16 v[88:91], v[168:171], v[136:139], 0
    v_max3_f32 v246, v246, v68, v69
    v_max3_f32 v246, v246, v70, v71
    v_mfma_f32_16x16x32_bf16 v[96:99], v[168:171], v[140:143], 0
    v_max3_f32 v244, v244, v72, v73
    v_max3_f32 v244, v244, v74, v75
    v_mfma_f32_16x16x32_bf16 v[92:95], v[172:175], v[136:139], 0
    v_max3_f32 v246, v246, v80, v81
    v_max3_f32 v246, v246, v82, v83
    v_mfma_f32_16x16x32_bf16 v[100:103], v[172:175], v[140:143], 0
    v_max3_f32 v244, v244, v76, v77
    v_max3_f32 v244, v244, v78, v79
    s_waitcnt lgkmcnt(2)
    v_mfma_f32_16x16x32_bf16 v[104:107], v[152:155], v[136:139], 0
    v_max3_f32 v246, v246, v84, v85
    v_max3_f32 v246, v246, v86, v87
    v_mfma_f32_16x16x32_bf16 v[112:115], v[152:155], v[140:143], 0
    v_max3_f32 v244, v244, v88, v89
    v_max3_f32 v244, v244, v90, v91
    v_mfma_f32_16x16x32_bf16 v[108:111], v[156:159], v[136:139], 0
    v_max3_f32 v246, v246, v96, v97
    v_max3_f32 v246, v246, v98, v99
    v_mfma_f32_16x16x32_bf16 v[116:119], v[156:159], v[140:143], 0
    v_max3_f32 v244, v244, v92, v93
    v_max3_f32 v244, v244, v94, v95
    s_waitcnt lgkmcnt(0)
    v_mfma_f32_16x16x32_bf16 v[120:123], v[160:163], v[136:139], 0
    v_max3_f32 v246, v246, v100, v101
    v_max3_f32 v246, v246, v102, v103
    v_mfma_f32_16x16x32_bf16 v[128:131], v[160:163], v[140:143], 0
    v_max3_f32 v244, v244, v104, v105
    v_max3_f32 v244, v244, v106, v107
    v_mfma_f32_16x16x32_bf16 v[124:127], v[164:167], v[136:139], 0
    v_max3_f32 v246, v246, v112, v113
    v_max3_f32 v246, v246, v114, v115
    v_mfma_f32_16x16x32_bf16 v[132:135], v[164:167], v[140:143], 0
    v_max3_f32 v244, v244, v108, v109
    v_max3_f32 v244, v244, v110, v111
    s_nop 7
    v_max3_f32 v246, v246, v116, v117
    v_max3_f32 v246, v246, v118, v119
    v_max3_f32 v244, v244, v120, v121
    v_max3_f32 v244, v244, v122, v123
    v_max3_f32 v246, v246, v128, v129
    v_max3_f32 v246, v246, v130, v131
    v_max3_f32 v244, v244, v124, v125
    v_max3_f32 v244, v244, v126, v127
    v_max3_f32 v246, v246, v132, v133
    v_max3_f32 v246, v246, v134, v135
    s_cmp_lt_u32 s44, 2
    s_cbranch_scc1 sequential_preLN__sliding_block__dense_activation_gelu__prompt_kernel_bound61
sequential_preLN__sliding_block__dense_activation_gelu__prompt_kernel_nobound62:
    v_max_f32 v244, v244, v236
    v_max_f32 v246, v246, v238
    v_mov_b32 v245, v244
    v_mov_b32 v247, v246
    s_nop 0
    v_permlane32_swap_b32 v244, v245
    v_permlane32_swap_b32 v246, v247
    v_max_f32 v244, v244, v245
    v_max_f32 v246, v246, v247
    v_mov_b32 v245, v244
    v_mov_b32 v247, v246
    s_nop 0
    v_permlane16_swap_b32 v244, v245
    v_permlane16_swap_b32 v246, v247
    v_max_f32 v244, v244, v245
    v_max_f32 v246, v246, v247
    v_sub_f32 v236, v236, v244
    v_sub_f32 v238, v238, v246
    v_exp_f32 v236, v236
    v_exp_f32 v238, v238
    s_nop 0
    s_nop 0
    v_pk_mul_f32 v[176:177], v[176:177], v[236:237] op_sel_hi:[1,0]
    v_pk_mul_f32 v[178:179], v[178:179], v[236:237] op_sel_hi:[1,0]
    v_pk_mul_f32 v[180:181], v[180:181], v[236:237] op_sel_hi:[1,0]
    v_pk_mul_f32 v[182:183], v[182:183], v[236:237] op_sel_hi:[1,0]
    v_pk_mul_f32 v[184:185], v[184:185], v[236:237] op_sel_hi:[1,0]
    v_pk_mul_f32 v[186:187], v[186:187], v[236:237] op_sel_hi:[1,0]
    v_pk_mul_f32 v[188:189], v[188:189], v[238:239] op_sel_hi:[1,0]
    v_pk_mul_f32 v[190:191], v[190:191], v[238:239] op_sel_hi:[1,0]
    v_pk_mul_f32 v[192:193], v[192:193], v[238:239] op_sel_hi:[1,0]
    v_pk_mul_f32 v[194:195], v[194:195], v[238:239] op_sel_hi:[1,0]
    v_pk_mul_f32 v[196:197], v[196:197], v[238:239] op_sel_hi:[1,0]
    v_pk_mul_f32 v[198:199], v[198:199], v[238:239] op_sel_hi:[1,0]
    v_pk_add_f32 v[8:9], v[8:9], v[244:245] op_sel_hi:[1,0] neg_lo:[0,1] neg_hi:[0,1]
    v_pk_add_f32 v[10:11], v[10:11], v[244:245] op_sel_hi:[1,0] neg_lo:[0,1] neg_hi:[0,1]
    v_exp_f32 v8, v8
    v_exp_f32 v9, v9
    v_exp_f32 v10, v10
    v_exp_f32 v11, v11
    v_cvt_pk_bf16_f32 v8, v8, v9
    v_cvt_pk_bf16_f32 v9, v10, v11
    v_pk_add_f32 v[12:13], v[12:13], v[244:245] op_sel_hi:[1,0] neg_lo:[0,1] neg_hi:[0,1]
    v_pk_add_f32 v[14:15], v[14:15], v[244:245] op_sel_hi:[1,0] neg_lo:[0,1] neg_hi:[0,1]
    v_exp_f32 v12, v12
    v_exp_f32 v13, v13
    v_exp_f32 v14, v14
    v_exp_f32 v15, v15
    v_cvt_pk_bf16_f32 v10, v12, v13
    v_cvt_pk_bf16_f32 v11, v14, v15
    v_mov_b32 v16, 0
    v_mov_b32 v17, 0
    v_pk_add_f32 v[20:21], v[20:21], v[246:247] op_sel_hi:[1,0] neg_lo:[0,1] neg_hi:[0,1]
    v_pk_add_f32 v[22:23], v[22:23], v[246:247] op_sel_hi:[1,0] neg_lo:[0,1] neg_hi:[0,1]
    v_exp_f32 v20, v20
    v_exp_f32 v21, v21
    v_exp_f32 v22, v22
    v_exp_f32 v23, v23
    v_cvt_pk_bf16_f32 v18, v20, v21
    v_cvt_pk_bf16_f32 v19, v22, v23
    ds_read_b32 v4, v250
    s_waitcnt lgkmcnt(0)
    v_cmp_gt_u32 vcc, 1, v4
    s_cmp_eq_u64 vcc, 0
    s_cbranch_scc0 sequential_preLN__sliding_block__dense_activation_gelu__prompt_kernel_vspin63
sequential_preLN__sliding_block__dense_activation_gelu__prompt_kernel_vok64:
    ds_read_b128 v[152:155], v248 offset:24576
    ds_read_b128 v[156:159], v248 offset:25600
    ds_read_b128 v[160:163], v248 offset:26624
    ds_read_b128 v[164:167], v248 offset:27648
    s_waitcnt lgkmcnt(2)
    v_pk_add_f32 v[24:25], v[24:25], v[244:245] op_sel_hi:[1,0] neg_lo:[0,1] neg_hi:[0,1]
    v_pk_add_f32 v[26:27], v[26:27], v[244:245] op_sel_hi:[1,0] neg_lo:[0,1] neg_hi:[0,1]
    v_mfma_f32_16x16x32_bf16 v[176:179], v[152:155], v[8:11], v[176:179]
    v_exp_f32 v24, v24
    v_exp_f32 v25, v25
    v_mfma_f32_16x16x32_bf16 v[180:183], v[156:159], v[8:11], v[180:183]
    v_exp_f32 v26, v26
    v_exp_f32_e64 v27, v27
    v_cvt_pk_bf16_f32 v24, v24, v25
    v_cvt_pk_bf16_f32 v25, v26, v27
    v_pk_add_f32 v[28:29], v[28:29], v[244:245] op_sel_hi:[1,0] neg_lo:[0,1] neg_hi:[0,1]
    v_pk_add_f32 v[30:31], v[30:31], v[244:245] op_sel_hi:[1,0] neg_lo:[0,1] neg_hi:[0,1]
    v_mfma_f32_16x16x32_bf16 v[184:187], v[232:235], v[8:11], v[184:187]
    v_exp_f32 v28, v28
    v_exp_f32 v29, v29
    v_exp_f32 v30, v30
    v_exp_f32 v31, v31
    v_cvt_pk_bf16_f32 v26, v28, v29
    v_cvt_pk_bf16_f32 v27, v30, v31
    v_pk_add_f32 v[32:33], v[32:33], v[246:247] op_sel_hi:[1,0] neg_lo:[0,1] neg_hi:[0,1]
    v_pk_add_f32 v[34:35], v[34:35], v[246:247] op_sel_hi:[1,0] neg_lo:[0,1] neg_hi:[0,1]
    v_mfma_f32_16x16x32_bf16 v[188:191], v[152:155], v[16:19], v[188:191]
    v_exp_f32 v32, v32
    v_exp_f32 v33, v33
    v_mfma_f32_16x16x32_bf16 v[192:195], v[156:159], v[16:19], v[192:195]
    v_exp_f32 v34, v34
    v_exp_f32 v35, v35
    v_cvt_pk_bf16_f32 v32, v32, v33
    v_cvt_pk_bf16_f32 v33, v34, v35
    v_pk_add_f32 v[36:37], v[36:37], v[246:247] op_sel_hi:[1,0] neg_lo:[0,1] neg_hi:[0,1]
    v_pk_add_f32 v[38:39], v[38:39], v[246:247] op_sel_hi:[1,0] neg_lo:[0,1] neg_hi:[0,1]
    v_mfma_f32_16x16x32_bf16 v[196:199], v[232:235], v[16:19], v[196:199]
    v_exp_f32 v36, v36
    v_exp_f32 v37, v37
    v_exp_f32 v38, v38
    v_exp_f32 v39, v39
    v_cvt_pk_bf16_f32 v34, v36, v37
    v_cvt_pk_bf16_f32 v35, v38, v39
    ds_read_b128 v[152:155], v248 offset:28672
    ds_read_b128 v[156:159], v248 offset:29696
    s_waitcnt lgkmcnt(2)
    v_pk_add_f32 v[40:41], v[40:41], v[244:245] op_sel_hi:[1,0] neg_lo:[0,1] neg_hi:[0,1]
    v_pk_add_f32 v[42:43], v[42:43], v[244:245] op_sel_hi:[1,0] neg_lo:[0,1] neg_hi:[0,1]
    v_mfma_f32_16x16x32_bf16 v[176:179], v[160:163], v[24:27], v[176:179]
    v_exp_f32 v40, v40
    v_exp_f32 v41, v41
    v_mfma_f32_16x16x32_bf16 v[180:183], v[164:167], v[24:27], v[180:183]
    v_exp_f32 v42, v42
    v_exp_f32_e64 v43, v43
    v_cvt_pk_bf16_f32 v40, v40, v41
    v_cvt_pk_bf16_f32 v41, v42, v43
    v_pk_add_f32 v[44:45], v[44:45], v[244:245] op_sel_hi:[1,0] neg_lo:[0,1] neg_hi:[0,1]
    v_pk_add_f32 v[46:47], v[46:47], v[244:245] op_sel_hi:[1,0] neg_lo:[0,1] neg_hi:[0,1]
    v_mfma_f32_16x16x32_bf16 v[184:187], v[232:235], v[24:27], v[184:187]
    v_exp_f32 v44, v44
    v_exp_f32 v45, v45
    v_exp_f32 v46, v46
    v_exp_f32 v47, v47
    v_cvt_pk_bf16_f32 v42, v44, v45
    v_cvt_pk_bf16_f32 v43, v46, v47
    v_pk_add_f32 v[48:49], v[48:49], v[246:247] op_sel_hi:[1,0] neg_lo:[0,1] neg_hi:[0,1]
    v_pk_add_f32 v[50:51], v[50:51], v[246:247] op_sel_hi:[1,0] neg_lo:[0,1] neg_hi:[0,1]
    v_mfma_f32_16x16x32_bf16 v[188:191], v[160:163], v[32:35], v[188:191]
    v_exp_f32 v48, v48
    v_exp_f32 v49, v49
    v_mfma_f32_16x16x32_bf16 v[192:195], v[164:167], v[32:35], v[192:195]
    v_exp_f32 v50, v50
    v_exp_f32 v51, v51
    v_cvt_pk_bf16_f32 v48, v48, v49
    v_cvt_pk_bf16_f32 v49, v50, v51
    v_pk_add_f32 v[52:53], v[52:53], v[246:247] op_sel_hi:[1,0] neg_lo:[0,1] neg_hi:[0,1]
    v_pk_add_f32 v[54:55], v[54:55], v[246:247] op_sel_hi:[1,0] neg_lo:[0,1] neg_hi:[0,1]
    v_mfma_f32_16x16x32_bf16 v[196:199], v[232:235], v[32:35], v[196:199]
    v_exp_f32 v52, v52
    v_exp_f32 v53, v53
    v_exp_f32 v54, v54
    v_exp_f32 v55, v55
    v_cvt_pk_bf16_f32 v50, v52, v53
    v_cvt_pk_bf16_f32 v51, v54, v55
    ds_read_b128 v[160:163], v248 offset:30720
    ds_read_b128 v[164:167], v248 offset:31744
    s_waitcnt lgkmcnt(2)
    v_pk_add_f32 v[56:57], v[56:57], v[244:245] op_sel_hi:[1,0] neg_lo:[0,1] neg_hi:[0,1]
    v_pk_add_f32 v[58:59], v[58:59], v[244:245] op_sel_hi:[1,0] neg_lo:[0,1] neg_hi:[0,1]
    v_mfma_f32_16x16x32_bf16 v[176:179], v[152:155], v[40:43], v[176:179]
    v_exp_f32 v56, v56
    v_exp_f32 v57, v57
    v_mfma_f32_16x16x32_bf16 v[180:183], v[156:159], v[40:43], v[180:183]
    v_exp_f32 v58, v58
    v_exp_f32_e64 v59, v59
    v_cvt_pk_bf16_f32 v56, v56, v57
    v_cvt_pk_bf16_f32 v57, v58, v59
    v_pk_add_f32 v[60:61], v[60:61], v[244:245] op_sel_hi:[1,0] neg_lo:[0,1] neg_hi:[0,1]
    v_pk_add_f32 v[62:63], v[62:63], v[244:245] op_sel_hi:[1,0] neg_lo:[0,1] neg_hi:[0,1]
    v_mfma_f32_16x16x32_bf16 v[184:187], v[232:235], v[40:43], v[184:187]
    v_exp_f32 v60, v60
    v_exp_f32 v61, v61
    v_exp_f32 v62, v62
    v_exp_f32 v63, v63
    v_cvt_pk_bf16_f32 v58, v60, v61
    v_cvt_pk_bf16_f32 v59, v62, v63
    v_pk_add_f32 v[64:65], v[64:65], v[246:247] op_sel_hi:[1,0] neg_lo:[0,1] neg_hi:[0,1]
    v_pk_add_f32 v[66:67], v[66:67], v[246:247] op_sel_hi:[1,0] neg_lo:[0,1] neg_hi:[0,1]
    v_mfma_f32_16x16x32_bf16 v[188:191], v[152:155], v[48:51], v[188:191]
    v_exp_f32 v64, v64
    v_exp_f32 v65, v65
    v_mfma_f32_16x16x32_bf16 v[192:195], v[156:159], v[48:51], v[192:195]
    v_exp_f32 v66, v66
    v_exp_f32 v67, v67
    v_cvt_pk_bf16_f32 v64, v64, v65
    v_cvt_pk_bf16_f32 v65, v66, v67
    v_pk_add_f32 v[68:69], v[68:69], v[246:247] op_sel_hi:[1,0] neg_lo:[0,1] neg_hi:[0,1]
    v_pk_add_f32 v[70:71], v[70:71], v[246:247] op_sel_hi:[1,0] neg_lo:[0,1] neg_hi:[0,1]
    v_mfma_f32_16x16x32_bf16 v[196:199], v[232:235], v[48:51], v[196:199]
    v_exp_f32 v68, v68
    v_exp_f32 v69, v69
    v_exp_f32 v70, v70
    v_exp_f32 v71, v71
    v_cvt_pk_bf16_f32 v66, v68, v69
    v_cvt_pk_bf16_f32 v67, v70, v71
    ds_read_b128 v[152:155], v248 offset:32768
    ds_read_b128 v[156:159], v248 offset:33792
    s_waitcnt lgkmcnt(2)
    v_pk_add_f32 v[72:73], v[72:73], v[244:245] op_sel_hi:[1,0] neg_lo:[0,1] neg_hi:[0,1]
    v_pk_add_f32 v[74:75], v[74:75], v[244:245] op_sel_hi:[1,0] neg_lo:[0,1] neg_hi:[0,1]
    v_mfma_f32_16x16x32_bf16 v[176:179], v[160:163], v[56:59], v[176:179]
    v_exp_f32 v72, v72
    v_exp_f32 v73, v73
    v_mfma_f32_16x16x32_bf16 v[180:183], v[164:167], v[56:59], v[180:183]
    v_exp_f32 v74, v74
    v_exp_f32_e64 v75, v75
    v_cvt_pk_bf16_f32 v72, v72, v73
    v_cvt_pk_bf16_f32 v73, v74, v75
    v_pk_add_f32 v[76:77], v[76:77], v[244:245] op_sel_hi:[1,0] neg_lo:[0,1] neg_hi:[0,1]
    v_pk_add_f32 v[78:79], v[78:79], v[244:245] op_sel_hi:[1,0] neg_lo:[0,1] neg_hi:[0,1]
    v_mfma_f32_16x16x32_bf16 v[184:187], v[232:235], v[56:59], v[184:187]
    v_exp_f32 v76, v76
    v_exp_f32 v77, v77
    v_exp_f32 v78, v78
    v_exp_f32 v79, v79
    v_cvt_pk_bf16_f32 v74, v76, v77
    v_cvt_pk_bf16_f32 v75, v78, v79
    v_pk_add_f32 v[80:81], v[80:81], v[246:247] op_sel_hi:[1,0] neg_lo:[0,1] neg_hi:[0,1]
    v_pk_add_f32 v[82:83], v[82:83], v[246:247] op_sel_hi:[1,0] neg_lo:[0,1] neg_hi:[0,1]
    v_mfma_f32_16x16x32_bf16 v[188:191], v[160:163], v[64:67], v[188:191]
    v_exp_f32 v80, v80
    v_exp_f32 v81, v81
    v_mfma_f32_16x16x32_bf16 v[192:195], v[164:167], v[64:67], v[192:195]
    v_exp_f32 v82, v82
    v_exp_f32 v83, v83
    v_cvt_pk_bf16_f32 v80, v80, v81
    v_cvt_pk_bf16_f32 v81, v82, v83
    v_pk_add_f32 v[84:85], v[84:85], v[246:247] op_sel_hi:[1,0] neg_lo:[0,1] neg_hi:[0,1]
    v_pk_add_f32 v[86:87], v[86:87], v[246:247] op_sel_hi:[1,0] neg_lo:[0,1] neg_hi:[0,1]
    v_mfma_f32_16x16x32_bf16 v[196:199], v[232:235], v[64:67], v[196:199]
    v_exp_f32 v84, v84
    v_exp_f32 v85, v85
    v_exp_f32 v86, v86
    v_exp_f32 v87, v87
    v_cvt_pk_bf16_f32 v82, v84, v85
    v_cvt_pk_bf16_f32 v83, v86, v87
    ds_read_b128 v[160:163], v248 offset:34816
    ds_read_b128 v[164:167], v248 offset:35840
    s_waitcnt lgkmcnt(2)
    v_pk_add_f32 v[88:89], v[88:89], v[244:245] op_sel_hi:[1,0] neg_lo:[0,1] neg_hi:[0,1]
    v_pk_add_f32 v[90:91], v[90:91], v[244:245] op_sel_hi:[1,0] neg_lo:[0,1] neg_hi:[0,1]
    v_mfma_f32_16x16x32_bf16 v[176:179], v[152:155], v[72:75], v[176:179]
    v_exp_f32 v88, v88
    v_exp_f32 v89, v89
    v_mfma_f32_16x16x32_bf16 v[180:183], v[156:159], v[72:75], v[180:183]
    v_exp_f32 v90, v90
    v_exp_f32_e64 v91, v91
    v_cvt_pk_bf16_f32 v88, v88, v89
    v_cvt_pk_bf16_f32 v89, v90, v91
    v_pk_add_f32 v[92:93], v[92:93], v[244:245] op_sel_hi:[1,0] neg_lo:[0,1] neg_hi:[0,1]
    v_pk_add_f32 v[94:95], v[94:95], v[244:245] op_sel_hi:[1,0] neg_lo:[0,1] neg_hi:[0,1]
    v_mfma_f32_16x16x32_bf16 v[184:187], v[232:235], v[72:75], v[184:187]
    v_exp_f32 v92, v92
    v_exp_f32 v93, v93
    v_exp_f32 v94, v94
    v_exp_f32 v95, v95
    v_cvt_pk_bf16_f32 v90, v92, v93
    v_cvt_pk_bf16_f32 v91, v94, v95
    v_pk_add_f32 v[96:97], v[96:97], v[246:247] op_sel_hi:[1,0] neg_lo:[0,1] neg_hi:[0,1]
    v_pk_add_f32 v[98:99], v[98:99], v[246:247] op_sel_hi:[1,0] neg_lo:[0,1] neg_hi:[0,1]
    v_mfma_f32_16x16x32_bf16 v[188:191], v[152:155], v[80:83], v[188:191]
    v_exp_f32 v96, v96
    v_exp_f32 v97, v97
    v_mfma_f32_16x16x32_bf16 v[192:195], v[156:159], v[80:83], v[192:195]
    v_exp_f32 v98, v98
    v_exp_f32 v99, v99
    v_cvt_pk_bf16_f32 v96, v96, v97
    v_cvt_pk_bf16_f32 v97, v98, v99
    v_pk_add_f32 v[100:101], v[100:101], v[246:247] op_sel_hi:[1,0] neg_lo:[0,1] neg_hi:[0,1]
    v_pk_add_f32 v[102:103], v[102:103], v[246:247] op_sel_hi:[1,0] neg_lo:[0,1] neg_hi:[0,1]
    v_mfma_f32_16x16x32_bf16 v[196:199], v[232:235], v[80:83], v[196:199]
    v_exp_f32 v100, v100
    v_exp_f32 v101, v101
    v_exp_f32 v102, v102
    v_exp_f32 v103, v103
    v_cvt_pk_bf16_f32 v98, v100, v101
    v_cvt_pk_bf16_f32 v99, v102, v103
    ds_read_b128 v[152:155], v248 offset:36864
    ds_read_b128 v[156:159], v248 offset:37888
    s_waitcnt lgkmcnt(2)
    v_pk_add_f32 v[104:105], v[104:105], v[244:245] op_sel_hi:[1,0] neg_lo:[0,1] neg_hi:[0,1]
    v_pk_add_f32 v[106:107], v[106:107], v[244:245] op_sel_hi:[1,0] neg_lo:[0,1] neg_hi:[0,1]
    v_mfma_f32_16x16x32_bf16 v[176:179], v[160:163], v[88:91], v[176:179]
    v_exp_f32 v104, v104
    v_exp_f32 v105, v105
    v_mfma_f32_16x16x32_bf16 v[180:183], v[164:167], v[88:91], v[180:183]
    v_exp_f32 v106, v106
    v_exp_f32_e64 v107, v107
    v_cvt_pk_bf16_f32 v104, v104, v105
    v_cvt_pk_bf16_f32 v105, v106, v107
    v_pk_add_f32 v[108:109], v[108:109], v[244:245] op_sel_hi:[1,0] neg_lo:[0,1] neg_hi:[0,1]
    v_pk_add_f32 v[110:111], v[110:111], v[244:245] op_sel_hi:[1,0] neg_lo:[0,1] neg_hi:[0,1]
    v_mfma_f32_16x16x32_bf16 v[184:187], v[232:235], v[88:91], v[184:187]
    v_exp_f32 v108, v108
    v_exp_f32 v109, v109
    v_exp_f32 v110, v110
    v_exp_f32 v111, v111
    v_cvt_pk_bf16_f32 v106, v108, v109
    v_cvt_pk_bf16_f32 v107, v110, v111
    v_pk_add_f32 v[112:113], v[112:113], v[246:247] op_sel_hi:[1,0] neg_lo:[0,1] neg_hi:[0,1]
    v_pk_add_f32 v[114:115], v[114:115], v[246:247] op_sel_hi:[1,0] neg_lo:[0,1] neg_hi:[0,1]
    v_mfma_f32_16x16x32_bf16 v[188:191], v[160:163], v[96:99], v[188:191]
    v_exp_f32 v112, v112
    v_exp_f32 v113, v113
    v_mfma_f32_16x16x32_bf16 v[192:195], v[164:167], v[96:99], v[192:195]
    v_exp_f32 v114, v114
    v_exp_f32 v115, v115
    v_cvt_pk_bf16_f32 v112, v112, v113
    v_cvt_pk_bf16_f32 v113, v114, v115
    v_pk_add_f32 v[116:117], v[116:117], v[246:247] op_sel_hi:[1,0] neg_lo:[0,1] neg_hi:[0,1]
    v_pk_add_f32 v[118:119], v[118:119], v[246:247] op_sel_hi:[1,0] neg_lo:[0,1] neg_hi:[0,1]
    v_mfma_f32_16x16x32_bf16 v[196:199], v[232:235], v[96:99], v[196:199]
    v_exp_f32 v116, v116
    v_exp_f32 v117, v117
    v_exp_f32 v118, v118
    v_exp_f32 v119, v119
    v_cvt_pk_bf16_f32 v114, v116, v117
    v_cvt_pk_bf16_f32 v115, v118, v119
    ds_read_b128 v[160:163], v248 offset:38912
    ds_read_b128 v[164:167], v248 offset:39936
    s_waitcnt lgkmcnt(2)
    v_pk_add_f32 v[120:121], v[120:121], v[244:245] op_sel_hi:[1,0] neg_lo:[0,1] neg_hi:[0,1]
    v_pk_add_f32 v[122:123], v[122:123], v[244:245] op_sel_hi:[1,0] neg_lo:[0,1] neg_hi:[0,1]
    v_mfma_f32_16x16x32_bf16 v[176:179], v[152:155], v[104:107], v[176:179]
    v_exp_f32 v120, v120
    v_exp_f32 v121, v121
    v_mfma_f32_16x16x32_bf16 v[180:183], v[156:159], v[104:107], v[180:183]
    v_exp_f32 v122, v122
    v_exp_f32_e64 v123, v123
    v_cvt_pk_bf16_f32 v120, v120, v121
    v_cvt_pk_bf16_f32 v121, v122, v123
    v_pk_add_f32 v[124:125], v[124:125], v[244:245] op_sel_hi:[1,0] neg_lo:[0,1] neg_hi:[0,1]
    v_pk_add_f32 v[126:127], v[126:127], v[244:245] op_sel_hi:[1,0] neg_lo:[0,1] neg_hi:[0,1]
    v_mfma_f32_16x16x32_bf16 v[184:187], v[232:235], v[104:107], v[184:187]
    v_exp_f32 v124, v124
    v_exp_f32 v125, v125
    v_exp_f32 v126, v126
    v_exp_f32 v127, v127
    v_cvt_pk_bf16_f32 v122, v124, v125
    v_cvt_pk_bf16_f32 v123, v126, v127
    v_pk_add_f32 v[128:129], v[128:129], v[246:247] op_sel_hi:[1,0] neg_lo:[0,1] neg_hi:[0,1]
    v_pk_add_f32 v[130:131], v[130:131], v[246:247] op_sel_hi:[1,0] neg_lo:[0,1] neg_hi:[0,1]
    v_mfma_f32_16x16x32_bf16 v[188:191], v[152:155], v[112:115], v[188:191]
    v_exp_f32 v128, v128
    v_exp_f32 v129, v129
    v_mfma_f32_16x16x32_bf16 v[192:195], v[156:159], v[112:115], v[192:195]
    v_exp_f32 v130, v130
    v_exp_f32 v131, v131
    v_cvt_pk_bf16_f32 v128, v128, v129
    v_cvt_pk_bf16_f32 v129, v130, v131
    v_pk_add_f32 v[132:133], v[132:133], v[246:247] op_sel_hi:[1,0] neg_lo:[0,1] neg_hi:[0,1]
    v_pk_add_f32 v[134:135], v[134:135], v[246:247] op_sel_hi:[1,0] neg_lo:[0,1] neg_hi:[0,1]
    v_mfma_f32_16x16x32_bf16 v[196:199], v[232:235], v[112:115], v[196:199]
    v_exp_f32 v132, v132
    v_exp_f32 v133, v133
    v_exp_f32 v134, v134
    v_exp_f32 v135, v135
    v_cvt_pk_bf16_f32 v130, v132, v133
    v_cvt_pk_bf16_f32 v131, v134, v135
    s_waitcnt lgkmcnt(0)
    s_nop 1
    v_mfma_f32_16x16x32_bf16 v[176:179], v[160:163], v[120:123], v[176:179]
    v_mfma_f32_16x16x32_bf16 v[180:183], v[164:167], v[120:123], v[180:183]
    v_mfma_f32_16x16x32_bf16 v[184:187], v[232:235], v[120:123], v[184:187]
    v_mfma_f32_16x16x32_bf16 v[188:191], v[160:163], v[128:131], v[188:191]
    v_mfma_f32_16x16x32_bf16 v[192:195], v[164:167], v[128:131], v[192:195]
    v_mfma_f32_16x16x32_bf16 v[196:199], v[232:235], v[128:131], v[196:199]
    ds_read_b128 v[152:155], v248 offset:6144
    ds_read_b128 v[156:159], v248 offset:7168
    ds_read_b128 v[160:163], v248 offset:8192
    ds_read_b128 v[164:167], v248 offset:9216
    ds_read_b128 v[168:171], v248 offset:10240
    ds_read_b128 v[172:175], v248 offset:11264
    s_waitcnt lgkmcnt(4)
    s_nop 3
    s_add_u32 s53, s68, 0
    v_rcp_f32 v236, v184
    v_rcp_f32 v238, v196
    s_nop 0
    v_mul_f32 v176, v176, v236
    v_mul_f32 v177, v177, v236
    v_mul_f32 v178, v178, v236
    v_mfma_f32_16x16x32_bf16 v[8:11], v[152:155], v[144:147], v[228:231]
    v_mfma_f32_16x16x32_bf16 v[12:15], v[156:159], v[144:147], 0
    v_mfma_f32_16x16x32_bf16 v[20:23], v[156:159], v[148:151], v[228:231]
    ds_read_b128 v[152:155], v248 offset:12288
    ds_read_b128 v[156:159], v248 offset:13312
    s_waitcnt lgkmcnt(4)
    v_mul_f32 v179, v179, v236
    v_mul_f32 v180, v180, v236
    v_mul_f32 v181, v181, v236
    v_mul_f32 v182, v182, v236
    v_mul_f32 v183, v183, v236
    v_cvt_pk_bf16_f32 v136, v176, v177
    v_cvt_pk_bf16_f32 v137, v178, v179
    v_cvt_pk_bf16_f32 v138, v180, v181
    v_mfma_f32_16x16x32_bf16 v[24:27], v[160:163], v[144:147], 0
    v_mfma_f32_16x16x32_bf16 v[32:35], v[160:163], v[148:151], 0
    v_mfma_f32_16x16x32_bf16 v[28:31], v[164:167], v[144:147], 0
    v_max3_f32 v244, v8, v9, v10
    v_max_f32 v244, v244, v11
    v_mfma_f32_16x16x32_bf16 v[36:39], v[164:167], v[148:151], 0
    v_max3_f32 v244, v244, v12, v13
    v_max3_f32 v244, v244, v14, v15
    ds_read_b128 v[160:163], v248 offset:14336
    ds_read_b128 v[164:167], v248 offset:15360
    s_waitcnt lgkmcnt(4)
    v_cvt_pk_bf16_f32 v139, v182, v183
    buffer_store_dwordx4 v[136:139], v2, s[24:27], s53 offen offset:0 sc1
    v_mul_f32 v188, v188, v238
    v_mul_f32 v189, v189, v238
    v_mul_f32 v190, v190, v238
    v_mul_f32 v191, v191, v238
    v_mul_f32 v192, v192, v238
    v_mul_f32 v193, v193, v238
    v_mfma_f32_16x16x32_bf16 v[40:43], v[168:171], v[144:147], 0
    v_max3_f32 v246, v20, v21, v22
    v_max_f32 v246, v246, v23
    v_mfma_f32_16x16x32_bf16 v[48:51], v[168:171], v[148:151], 0
    v_max3_f32 v244, v244, v24, v25
    v_max3_f32 v244, v244, v26, v27
    v_mfma_f32_16x16x32_bf16 v[44:47], v[172:175], v[144:147], 0
    v_max3_f32 v246, v246, v32, v33
    v_max3_f32 v246, v246, v34, v35
    v_mfma_f32_16x16x32_bf16 v[52:55], v[172:175], v[148:151], 0
    v_max3_f32 v244, v244, v28, v29
    v_max3_f32 v244, v244, v30, v31
    s_waitcnt lgkmcnt(2)
    v_mul_f32 v194, v194, v238
    v_mul_f32_e64 v195, v195, v238
    v_cvt_pk_bf16_f32 v140, v188, v189
    v_cvt_pk_bf16_f32 v141, v190, v191
    v_cvt_pk_bf16_f32 v142, v192, v193
    v_cvt_pk_bf16_f32 v143, v194, v195
    buffer_store_dwordx4 v[140:143], v2, s[24:27], s53 offen offset:1024 sc1
    v_mfma_f32_16x16x32_bf16 v[56:59], v[152:155], v[144:147], 0
    v_max3_f32 v246, v246, v36, v37
    v_max3_f32 v246, v246, v38, v39
    v_mfma_f32_16x16x32_bf16 v[64:67], v[152:155], v[148:151], 0
    v_max3_f32 v244, v244, v40, v41
    v_max3_f32 v244, v244, v42, v43
    v_mfma_f32_16x16x32_bf16 v[60:63], v[156:159], v[144:147], 0
    v_max3_f32 v246, v246, v48, v49
    v_max3_f32 v246, v246, v50, v51
    v_mfma_f32_16x16x32_bf16 v[68:71], v[156:159], v[148:151], 0
    v_max3_f32 v244, v244, v44, v45
    v_max3_f32 v244, v244, v46, v47
    s_waitcnt lgkmcnt(0)
    v_mfma_f32_16x16x32_bf16 v[72:75], v[160:163], v[144:147], 0
    v_max3_f32 v246, v246, v52, v53
    v_max3_f32 v246, v246, v54, v55
    v_mfma_f32_16x16x32_bf16 v[80:83], v[160:163], v[148:151], 0
    v_max3_f32 v244, v244, v56, v57
    v_max3_f32 v244, v244, v58, v59
    v_mfma_f32_16x16x32_bf16 v[76:79], v[164:167], v[144:147], 0
    v_max3_f32 v246, v246, v64, v65
    v_max3_f32 v246, v246, v66, v67
    v_mfma_f32_16x16x32_bf16 v[84:87], v[164:167], v[148:151], 0
    v_max3_f32 v244, v244, v60, v61
    v_max3_f32 v244, v244, v62, v63
    s_nop 7
    v_max3_f32 v246, v246, v68, v69
    v_max3_f32 v246, v246, v70, v71
    v_max3_f32 v244, v244, v72, v73
    v_max3_f32 v244, v244, v74, v75
    v_max3_f32 v246, v246, v80, v81
    v_max3_f32 v246, v246, v82, v83
    v_max3_f32 v244, v244, v76, v77
    v_max3_f32 v244, v244, v78, v79
    v_max3_f32 v246, v246, v84, v85
    v_max3_f32 v246, v246, v86, v87
    ds_read_b128 v[152:155], v248 offset:30720
    ds_read_b128 v[156:159], v248 offset:31744
    ds_read_b128 v[160:163], v248 offset:32768
    ds_read_b128 v[164:167], v248 offset:33792
    s_cmp_lt_u32 s44, 2
    s_cbranch_scc1 sequential_preLN__sliding_block__dense_activation_gelu__prompt_kernel_bound65
sequential_preLN__sliding_block__dense_activation_gelu__prompt_kernel_nobound66:
    v_max_f32 v244, v244, v240
    v_max_f32 v246, v246, v242
    v_mov_b32 v245, v244
    v_mov_b32 v247, v246
    s_nop 0
    v_permlane32_swap_b32 v244, v245
    v_permlane32_swap_b32 v246, v247
    v_max_f32 v244, v244, v245
    v_max_f32 v246, v246, v247
    v_mov_b32 v245, v244
    v_mov_b32 v247, v246
    s_nop 0
    v_permlane16_swap_b32 v244, v245
    v_permlane16_swap_b32 v246, v247
    v_max_f32 v244, v244, v245
    v_max_f32 v246, v246, v247
    v_sub_f32 v240, v240, v244
    v_sub_f32 v242, v242, v246
    v_exp_f32 v240, v240
    v_exp_f32 v242, v242
    s_nop 0
    s_nop 0
    v_pk_mul_f32 v[200:201], v[200:201], v[240:241] op_sel_hi:[1,0]
    v_pk_mul_f32 v[202:203], v[202:203], v[240:241] op_sel_hi:[1,0]
    v_pk_mul_f32 v[204:205], v[204:205], v[240:241] op_sel_hi:[1,0]
    v_pk_mul_f32 v[206:207], v[206:207], v[240:241] op_sel_hi:[1,0]
    v_pk_mul_f32 v[208:209], v[208:209], v[240:241] op_sel_hi:[1,0]
    v_pk_mul_f32 v[210:211], v[210:211], v[240:241] op_sel_hi:[1,0]
    v_pk_mul_f32 v[212:213], v[212:213], v[242:243] op_sel_hi:[1,0]
    v_pk_mul_f32 v[214:215], v[214:215], v[242:243] op_sel_hi:[1,0]
    v_pk_mul_f32 v[216:217], v[216:217], v[242:243] op_sel_hi:[1,0]
    v_pk_mul_f32 v[218:219], v[218:219], v[242:243] op_sel_hi:[1,0]
    v_pk_mul_f32 v[220:221], v[220:221], v[242:243] op_sel_hi:[1,0]
    v_pk_mul_f32 v[222:223], v[222:223], v[242:243] op_sel_hi:[1,0]
    v_pk_add_f32 v[8:9], v[8:9], v[244:245] op_sel_hi:[1,0] neg_lo:[0,1] neg_hi:[0,1]
    v_pk_add_f32 v[10:11], v[10:11], v[244:245] op_sel_hi:[1,0] neg_lo:[0,1] neg_hi:[0,1]
    v_exp_f32 v8, v8
    v_exp_f32 v9, v9
    v_exp_f32 v10, v10
    v_exp_f32 v11, v11
    v_cvt_pk_bf16_f32 v8, v8, v9
    v_cvt_pk_bf16_f32 v9, v10, v11
    v_pk_add_f32 v[12:13], v[12:13], v[244:245] op_sel_hi:[1,0] neg_lo:[0,1] neg_hi:[0,1]
    v_pk_add_f32 v[14:15], v[14:15], v[244:245] op_sel_hi:[1,0] neg_lo:[0,1] neg_hi:[0,1]
    v_exp_f32 v12, v12
    v_exp_f32 v13, v13
    v_exp_f32 v14, v14
    v_exp_f32 v15, v15
    v_cvt_pk_bf16_f32 v10, v12, v13
    v_cvt_pk_bf16_f32 v11, v14, v15
    v_mov_b32 v16, 0
    v_mov_b32 v17, 0
    v_pk_add_f32 v[20:21], v[20:21], v[246:247] op_sel_hi:[1,0] neg_lo:[0,1] neg_hi:[0,1]
    v_pk_add_f32 v[22:23], v[22:23], v[246:247] op_sel_hi:[1,0] neg_lo:[0,1] neg_hi:[0,1]
    v_exp_f32 v20, v20
    v_exp_f32 v21, v21
    v_exp_f32 v22, v22
    v_exp_f32 v23, v23
    v_cvt_pk_bf16_f32 v18, v20, v21
    v_cvt_pk_bf16_f32 v19, v22, v23
    s_waitcnt lgkmcnt(2)
    v_pk_add_f32 v[24:25], v[24:25], v[244:245] op_sel_hi:[1,0] neg_lo:[0,1] neg_hi:[0,1]
    v_pk_add_f32 v[26:27], v[26:27], v[244:245] op_sel_hi:[1,0] neg_lo:[0,1] neg_hi:[0,1]
    v_mfma_f32_16x16x32_bf16 v[200:203], v[152:155], v[8:11], v[200:203]
    v_exp_f32 v24, v24
    v_exp_f32 v25, v25
    v_mfma_f32_16x16x32_bf16 v[204:207], v[156:159], v[8:11], v[204:207]
    v_exp_f32 v26, v26
    v_exp_f32_e64 v27, v27
    v_cvt_pk_bf16_f32 v24, v24, v25
    v_cvt_pk_bf16_f32 v25, v26, v27
    v_pk_add_f32 v[28:29], v[28:29], v[244:245] op_sel_hi:[1,0] neg_lo:[0,1] neg_hi:[0,1]
    v_pk_add_f32 v[30:31], v[30:31], v[244:245] op_sel_hi:[1,0] neg_lo:[0,1] neg_hi:[0,1]
    v_mfma_f32_16x16x32_bf16 v[208:211], v[232:235], v[8:11], v[208:211]
    v_exp_f32 v28, v28
    v_exp_f32 v29, v29
    v_exp_f32 v30, v30
    v_exp_f32 v31, v31
    v_cvt_pk_bf16_f32 v26, v28, v29
    v_cvt_pk_bf16_f32 v27, v30, v31
    v_pk_add_f32 v[32:33], v[32:33], v[246:247] op_sel_hi:[1,0] neg_lo:[0,1] neg_hi:[0,1]
    v_pk_add_f32 v[34:35], v[34:35], v[246:247] op_sel_hi:[1,0] neg_lo:[0,1] neg_hi:[0,1]
    v_mfma_f32_16x16x32_bf16 v[212:215], v[152:155], v[16:19], v[212:215]
    v_exp_f32 v32, v32
    v_exp_f32 v33, v33
    v_mfma_f32_16x16x32_bf16 v[216:219], v[156:159], v[16:19], v[216:219]
    v_exp_f32 v34, v34
    v_exp_f32 v35, v35
    v_cvt_pk_bf16_f32 v32, v32, v33
    v_cvt_pk_bf16_f32 v33, v34, v35
    v_pk_add_f32 v[36:37], v[36:37], v[246:247] op_sel_hi:[1,0] neg_lo:[0,1] neg_hi:[0,1]
    v_pk_add_f32 v[38:39], v[38:39], v[246:247] op_sel_hi:[1,0] neg_lo:[0,1] neg_hi:[0,1]
    v_mfma_f32_16x16x32_bf16 v[220:223], v[232:235], v[16:19], v[220:223]
    v_exp_f32 v36, v36
    v_exp_f32 v37, v37
    v_exp_f32 v38, v38
    v_exp_f32 v39, v39
    v_cvt_pk_bf16_f32 v34, v36, v37
    v_cvt_pk_bf16_f32 v35, v38, v39
    ds_read_b128 v[152:155], v248 offset:34816
    ds_read_b128 v[156:159], v248 offset:35840
    s_waitcnt lgkmcnt(2)
    v_pk_add_f32 v[40:41], v[40:41], v[244:245] op_sel_hi:[1,0] neg_lo:[0,1] neg_hi:[0,1]
    v_pk_add_f32 v[42:43], v[42:43], v[244:245] op_sel_hi:[1,0] neg_lo:[0,1] neg_hi:[0,1]
    v_mfma_f32_16x16x32_bf16 v[200:203], v[160:163], v[24:27], v[200:203]
    v_exp_f32 v40, v40
    v_exp_f32 v41, v41
    v_mfma_f32_16x16x32_bf16 v[204:207], v[164:167], v[24:27], v[204:207]
    v_exp_f32 v42, v42
    v_exp_f32_e64 v43, v43
    v_cvt_pk_bf16_f32 v40, v40, v41
    v_cvt_pk_bf16_f32 v41, v42, v43
    v_pk_add_f32 v[44:45], v[44:45], v[244:245] op_sel_hi:[1,0] neg_lo:[0,1] neg_hi:[0,1]
    v_pk_add_f32 v[46:47], v[46:47], v[244:245] op_sel_hi:[1,0] neg_lo:[0,1] neg_hi:[0,1]
    v_mfma_f32_16x16x32_bf16 v[208:211], v[232:235], v[24:27], v[208:211]
    v_exp_f32 v44, v44
    v_exp_f32 v45, v45
    v_exp_f32 v46, v46
    v_exp_f32 v47, v47
    v_cvt_pk_bf16_f32 v42, v44, v45
    v_cvt_pk_bf16_f32 v43, v46, v47
    v_pk_add_f32 v[48:49], v[48:49], v[246:247] op_sel_hi:[1,0] neg_lo:[0,1] neg_hi:[0,1]
    v_pk_add_f32 v[50:51], v[50:51], v[246:247] op_sel_hi:[1,0] neg_lo:[0,1] neg_hi:[0,1]
    v_mfma_f32_16x16x32_bf16 v[212:215], v[160:163], v[32:35], v[212:215]
    v_exp_f32 v48, v48
    v_exp_f32 v49, v49
    v_mfma_f32_16x16x32_bf16 v[216:219], v[164:167], v[32:35], v[216:219]
    v_exp_f32 v50, v50
    v_exp_f32 v51, v51
    v_cvt_pk_bf16_f32 v48, v48, v49
    v_cvt_pk_bf16_f32 v49, v50, v51
    v_pk_add_f32 v[52:53], v[52:53], v[246:247] op_sel_hi:[1,0] neg_lo:[0,1] neg_hi:[0,1]
    v_pk_add_f32 v[54:55], v[54:55], v[246:247] op_sel_hi:[1,0] neg_lo:[0,1] neg_hi:[0,1]
    v_mfma_f32_16x16x32_bf16 v[220:223], v[232:235], v[32:35], v[220:223]
    v_exp_f32 v52, v52
    v_exp_f32 v53, v53
    v_exp_f32 v54, v54
    v_exp_f32 v55, v55
    v_cvt_pk_bf16_f32 v50, v52, v53
    v_cvt_pk_bf16_f32 v51, v54, v55
    ds_read_b128 v[160:163], v248 offset:36864
    ds_read_b128 v[164:167], v248 offset:37888
    s_waitcnt lgkmcnt(2)
    v_pk_add_f32 v[56:57], v[56:57], v[244:245] op_sel_hi:[1,0] neg_lo:[0,1] neg_hi:[0,1]
    v_pk_add_f32 v[58:59], v[58:59], v[244:245] op_sel_hi:[1,0] neg_lo:[0,1] neg_hi:[0,1]
    v_mfma_f32_16x16x32_bf16 v[200:203], v[152:155], v[40:43], v[200:203]
    v_exp_f32 v56, v56
    v_exp_f32 v57, v57
    v_mfma_f32_16x16x32_bf16 v[204:207], v[156:159], v[40:43], v[204:207]
    v_exp_f32 v58, v58
    v_exp_f32_e64 v59, v59
    v_cvt_pk_bf16_f32 v56, v56, v57
    v_cvt_pk_bf16_f32 v57, v58, v59
    v_pk_add_f32 v[60:61], v[60:61], v[244:245] op_sel_hi:[1,0] neg_lo:[0,1] neg_hi:[0,1]
    v_pk_add_f32 v[62:63], v[62:63], v[244:245] op_sel_hi:[1,0] neg_lo:[0,1] neg_hi:[0,1]
    v_mfma_f32_16x16x32_bf16 v[208:211], v[232:235], v[40:43], v[208:211]
    v_exp_f32 v60, v60
    v_exp_f32 v61, v61
    v_exp_f32 v62, v62
    v_exp_f32 v63, v63
    v_cvt_pk_bf16_f32 v58, v60, v61
    v_cvt_pk_bf16_f32 v59, v62, v63
    v_pk_add_f32 v[64:65], v[64:65], v[246:247] op_sel_hi:[1,0] neg_lo:[0,1] neg_hi:[0,1]
    v_pk_add_f32 v[66:67], v[66:67], v[246:247] op_sel_hi:[1,0] neg_lo:[0,1] neg_hi:[0,1]
    v_mfma_f32_16x16x32_bf16 v[212:215], v[152:155], v[48:51], v[212:215]
    v_exp_f32 v64, v64
    v_exp_f32 v65, v65
    v_mfma_f32_16x16x32_bf16 v[216:219], v[156:159], v[48:51], v[216:219]
    v_exp_f32 v66, v66
    v_exp_f32 v67, v67
    v_cvt_pk_bf16_f32 v64, v64, v65
    v_cvt_pk_bf16_f32 v65, v66, v67
    v_pk_add_f32 v[68:69], v[68:69], v[246:247] op_sel_hi:[1,0] neg_lo:[0,1] neg_hi:[0,1]
    v_pk_add_f32 v[70:71], v[70:71], v[246:247] op_sel_hi:[1,0] neg_lo:[0,1] neg_hi:[0,1]
    v_mfma_f32_16x16x32_bf16 v[220:223], v[232:235], v[48:51], v[220:223]
    v_exp_f32 v68, v68
    v_exp_f32 v69, v69
    v_exp_f32 v70, v70
    v_exp_f32 v71, v71
    v_cvt_pk_bf16_f32 v66, v68, v69
    v_cvt_pk_bf16_f32 v67, v70, v71
    ds_read_b128 v[152:155], v248 offset:38912
    ds_read_b128 v[156:159], v248 offset:39936
    s_waitcnt lgkmcnt(2)
    v_pk_add_f32 v[72:73], v[72:73], v[244:245] op_sel_hi:[1,0] neg_lo:[0,1] neg_hi:[0,1]
    v_pk_add_f32 v[74:75], v[74:75], v[244:245] op_sel_hi:[1,0] neg_lo:[0,1] neg_hi:[0,1]
    v_mfma_f32_16x16x32_bf16 v[200:203], v[160:163], v[56:59], v[200:203]
    v_exp_f32 v72, v72
    v_exp_f32 v73, v73
    v_mfma_f32_16x16x32_bf16 v[204:207], v[164:167], v[56:59], v[204:207]
    v_exp_f32 v74, v74
    v_exp_f32_e64 v75, v75
    v_cvt_pk_bf16_f32 v72, v72, v73
    v_cvt_pk_bf16_f32 v73, v74, v75
    v_pk_add_f32 v[76:77], v[76:77], v[244:245] op_sel_hi:[1,0] neg_lo:[0,1] neg_hi:[0,1]
    v_pk_add_f32 v[78:79], v[78:79], v[244:245] op_sel_hi:[1,0] neg_lo:[0,1] neg_hi:[0,1]
    v_mfma_f32_16x16x32_bf16 v[208:211], v[232:235], v[56:59], v[208:211]
    v_exp_f32 v76, v76
    v_exp_f32 v77, v77
    v_exp_f32 v78, v78
    v_exp_f32 v79, v79
    v_cvt_pk_bf16_f32 v74, v76, v77
    v_cvt_pk_bf16_f32 v75, v78, v79
    v_pk_add_f32 v[80:81], v[80:81], v[246:247] op_sel_hi:[1,0] neg_lo:[0,1] neg_hi:[0,1]
    v_pk_add_f32 v[82:83], v[82:83], v[246:247] op_sel_hi:[1,0] neg_lo:[0,1] neg_hi:[0,1]
    v_mfma_f32_16x16x32_bf16 v[212:215], v[160:163], v[64:67], v[212:215]
    v_exp_f32 v80, v80
    v_exp_f32 v81, v81
    v_mfma_f32_16x16x32_bf16 v[216:219], v[164:167], v[64:67], v[216:219]
    v_exp_f32 v82, v82
    v_exp_f32 v83, v83
    v_cvt_pk_bf16_f32 v80, v80, v81
    v_cvt_pk_bf16_f32 v81, v82, v83
    v_pk_add_f32 v[84:85], v[84:85], v[246:247] op_sel_hi:[1,0] neg_lo:[0,1] neg_hi:[0,1]
    v_pk_add_f32 v[86:87], v[86:87], v[246:247] op_sel_hi:[1,0] neg_lo:[0,1] neg_hi:[0,1]
    v_mfma_f32_16x16x32_bf16 v[220:223], v[232:235], v[64:67], v[220:223]
    v_exp_f32 v84, v84
    v_exp_f32 v85, v85
    v_exp_f32 v86, v86
    v_exp_f32 v87, v87
    v_cvt_pk_bf16_f32 v82, v84, v85
    v_cvt_pk_bf16_f32 v83, v86, v87
    s_waitcnt lgkmcnt(0)
    s_nop 1
    v_mfma_f32_16x16x32_bf16 v[200:203], v[152:155], v[72:75], v[200:203]
    v_mfma_f32_16x16x32_bf16 v[204:207], v[156:159], v[72:75], v[204:207]
    v_mfma_f32_16x16x32_bf16 v[208:211], v[232:235], v[72:75], v[208:211]
    v_mfma_f32_16x16x32_bf16 v[212:215], v[152:155], v[80:83], v[212:215]
    v_mfma_f32_16x16x32_bf16 v[216:219], v[156:159], v[80:83], v[216:219]
    v_mfma_f32_16x16x32_bf16 v[220:223], v[232:235], v[80:83], v[220:223]
    s_nop 6
    s_add_u32 s53, s68, 6144
    v_rcp_f32 v240, v208
    v_rcp_f32 v242, v220
    s_nop 0
    v_mul_f32 v200, v200, v240
    v_mul_f32 v201, v201, v240
    v_mul_f32 v202, v202, v240
    v_mul_f32 v203, v203, v240
    v_mul_f32 v204, v204, v240
    v_mul_f32 v205, v205, v240
    v_mul_f32 v206, v206, v240
    v_mul_f32 v207, v207, v240
    v_cvt_pk_bf16_f32 v144, v200, v201
    v_cvt_pk_bf16_f32 v145, v202, v203
    v_cvt_pk_bf16_f32 v146, v204, v205
    v_cvt_pk_bf16_f32 v147, v206, v207
    buffer_store_dwordx4 v[144:147], v2, s[24:27], s53 offen offset:0 sc1
    v_mul_f32 v212, v212, v242
    v_mul_f32 v213, v213, v242
    v_mul_f32 v214, v214, v242
    v_mul_f32 v215, v215, v242
    v_mul_f32 v216, v216, v242
    v_mul_f32 v217, v217, v242
    v_mul_f32 v218, v218, v242
    v_mul_f32 v219, v219, v242
    v_cvt_pk_bf16_f32 v148, v212, v213
    v_cvt_pk_bf16_f32 v149, v214, v215
    v_cvt_pk_bf16_f32 v150, v216, v217
    v_cvt_pk_bf16_f32 v151, v218, v219
    buffer_store_dwordx4 v[148:151], v2, s[24:27], s53 offen offset:1024 sc1
    s_branch sequential_preLN__sliding_block__dense_activation_gelu__prompt_kernel_attd60
sequential_preLN__sliding_block__dense_activation_gelu__prompt_kernel_bound61:
    v_mov_b32 v8, 0xf149f2ca
    v_mov_b32 v9, 0xf149f2ca
    v_mov_b32 v10, 0xf149f2ca
    v_mov_b32 v11, 0xf149f2ca
    v_mov_b32 v12, 0xf149f2ca
    v_mov_b32 v13, 0xf149f2ca
    v_mov_b32 v14, 0xf149f2ca
    v_mov_b32 v15, 0xf149f2ca
    v_mov_b32 v20, 0xf149f2ca
    v_mov_b32 v21, 0xf149f2ca
    v_mov_b32 v22, 0xf149f2ca
    v_mov_b32 v23, 0xf149f2ca
    v_mov_b32 v24, 0xf149f2ca
    v_mov_b32 v25, 0xf149f2ca
    v_mov_b32 v26, 0xf149f2ca
    v_mov_b32 v27, 0xf149f2ca
    v_mov_b32 v32, 0xf149f2ca
    v_mov_b32 v33, 0xf149f2ca
    v_mov_b32 v34, 0xf149f2ca
    v_mov_b32 v35, 0xf149f2ca
    v_mov_b32 v28, 0xf149f2ca
    v_mov_b32 v29, 0xf149f2ca
    v_mov_b32 v30, 0xf149f2ca
    v_mov_b32 v31, 0xf149f2ca
    v_mov_b32 v36, 0xf149f2ca
    v_mov_b32 v37, 0xf149f2ca
    v_mov_b32 v38, 0xf149f2ca
    v_mov_b32 v39, 0xf149f2ca
    v_mov_b32 v40, 0xf149f2ca
    v_mov_b32 v41, 0xf149f2ca
    v_mov_b32 v42, 0xf149f2ca
    v_mov_b32 v43, 0xf149f2ca
    v_mov_b32 v48, 0xf149f2ca
    v_mov_b32 v49, 0xf149f2ca
    v_mov_b32 v50, 0xf149f2ca
    v_mov_b32 v51, 0xf149f2ca
    v_mov_b32 v44, 0xf149f2ca
    v_mov_b32 v45, 0xf149f2ca
    v_mov_b32 v46, 0xf149f2ca
    v_mov_b32 v47, 0xf149f2ca
    v_mov_b32 v52, 0xf149f2ca
    v_mov_b32 v53, 0xf149f2ca
    v_mov_b32 v54, 0xf149f2ca
    v_mov_b32 v55, 0xf149f2ca
    v_mov_b32 v56, 0xf149f2ca
    v_mov_b32 v57, 0xf149f2ca
    v_mov_b32 v58, 0xf149f2ca
    v_mov_b32 v59, 0xf149f2ca
    v_mov_b32 v64, 0xf149f2ca
    v_mov_b32 v65, 0xf149f2ca
    v_mov_b32 v66, 0xf149f2ca
    v_mov_b32 v67, 0xf149f2ca
    v_mov_b32 v60, 0xf149f2ca
    v_mov_b32 v61, 0xf149f2ca
    v_mov_b32 v62, 0xf149f2ca
    v_mov_b32 v63, 0xf149f2ca
    v_mov_b32 v68, 0xf149f2ca
    v_mov_b32 v69, 0xf149f2ca
    v_mov_b32 v70, 0xf149f2ca
    v_mov_b32 v71, 0xf149f2ca
    s_cmp_eq_u32 s44, 1
    s_cbranch_scc1 sequential_preLN__sliding_block__dense_activation_gelu__prompt_kernel_remax67
    v_mov_b32 v72, 0xf149f2ca
    v_mov_b32 v73, 0xf149f2ca
    v_mov_b32 v74, 0xf149f2ca
    v_mov_b32 v75, 0xf149f2ca
    v_mov_b32 v80, 0xf149f2ca
    v_mov_b32 v81, 0xf149f2ca
    v_mov_b32 v82, 0xf149f2ca
    v_mov_b32 v83, 0xf149f2ca
    v_mov_b32 v76, 0xf149f2ca
    v_mov_b32 v77, 0xf149f2ca
    v_mov_b32 v78, 0xf149f2ca
    v_mov_b32 v79, 0xf149f2ca
    v_mov_b32 v84, 0xf149f2ca
    v_mov_b32 v85, 0xf149f2ca
    v_mov_b32 v86, 0xf149f2ca
    v_mov_b32 v87, 0xf149f2ca
    v_mov_b32 v88, 0xf149f2ca
    v_mov_b32 v89, 0xf149f2ca
    v_mov_b32 v90, 0xf149f2ca
    v_mov_b32 v91, 0xf149f2ca
    v_mov_b32 v96, 0xf149f2ca
    v_mov_b32 v97, 0xf149f2ca
    v_mov_b32 v98, 0xf149f2ca
    v_mov_b32 v99, 0xf149f2ca
    v_mov_b32 v92, 0xf149f2ca
    v_mov_b32 v93, 0xf149f2ca
    v_mov_b32 v94, 0xf149f2ca
    v_mov_b32 v95, 0xf149f2ca
    v_mov_b32 v100, 0xf149f2ca
    v_mov_b32 v101, 0xf149f2ca
    v_mov_b32 v102, 0xf149f2ca
    v_mov_b32 v103, 0xf149f2ca
    v_mov_b32 v104, 0xf149f2ca
    v_mov_b32 v105, 0xf149f2ca
    v_mov_b32 v106, 0xf149f2ca
    v_mov_b32 v107, 0xf149f2ca
    v_mov_b32 v112, 0xf149f2ca
    v_mov_b32 v113, 0xf149f2ca
    v_mov_b32 v114, 0xf149f2ca
    v_mov_b32 v115, 0xf149f2ca
    v_mov_b32 v108, 0xf149f2ca
    v_mov_b32 v109, 0xf149f2ca
    v_mov_b32 v110, 0xf149f2ca
    v_mov_b32 v111, 0xf149f2ca
    v_mov_b32 v116, 0xf149f2ca
    v_mov_b32 v117, 0xf149f2ca
    v_mov_b32 v118, 0xf149f2ca
    v_mov_b32 v119, 0xf149f2ca
    v_mov_b32 v120, 0xf149f2ca
    v_mov_b32 v121, 0xf149f2ca
    v_mov_b32 v122, 0xf149f2ca
    v_mov_b32 v123, 0xf149f2ca
    v_mov_b32 v128, 0xf149f2ca
    v_mov_b32 v129, 0xf149f2ca
    v_mov_b32 v130, 0xf149f2ca
    v_mov_b32 v131, 0xf149f2ca
    v_mov_b32 v124, 0xf149f2ca
    v_mov_b32 v125, 0xf149f2ca
    v_mov_b32 v126, 0xf149f2ca
    v_mov_b32 v127, 0xf149f2ca
    v_mov_b32 v132, 0xf149f2ca
    v_mov_b32 v133, 0xf149f2ca
    v_mov_b32 v134, 0xf149f2ca
    v_mov_b32 v135, 0xf149f2ca
sequential_preLN__sliding_block__dense_activation_gelu__prompt_kernel_remax67:
    v_max3_f32 v244, v8, v9, v10
    v_max_f32 v244, v244, v11
    v_max3_f32 v244, v244, v12, v13
    v_max3_f32 v244, v244, v14, v15
    v_max3_f32 v244, v244, v24, v25
    v_max3_f32 v244, v244, v26, v27
    v_max3_f32 v244, v244, v28, v29
    v_max3_f32 v244, v244, v30, v31
    v_max3_f32 v244, v244, v40, v41
    v_max3_f32 v244, v244, v42, v43
    v_max3_f32 v244, v244, v44, v45
    v_max3_f32 v244, v244, v46, v47
    v_max3_f32 v244, v244, v56, v57
    v_max3_f32 v244, v244, v58, v59
    v_max3_f32 v244, v244, v60, v61
    v_max3_f32 v244, v244, v62, v63
    v_max3_f32 v244, v244, v72, v73
    v_max3_f32 v244, v244, v74, v75
    v_max3_f32 v244, v244, v76, v77
    v_max3_f32 v244, v244, v78, v79
    v_max3_f32 v244, v244, v88, v89
    v_max3_f32 v244, v244, v90, v91
    v_max3_f32 v244, v244, v92, v93
    v_max3_f32 v244, v244, v94, v95
    v_max3_f32 v244, v244, v104, v105
    v_max3_f32 v244, v244, v106, v107
    v_max3_f32 v244, v244, v108, v109
    v_max3_f32 v244, v244, v110, v111
    v_max3_f32 v244, v244, v120, v121
    v_max3_f32 v244, v244, v122, v123
    v_max3_f32 v244, v244, v124, v125
    v_max3_f32 v244, v244, v126, v127
    v_max3_f32 v246, v20, v21, v22
    v_max_f32_e64 v246, v246, v23
    v_max3_f32 v246, v246, v32, v33
    v_max3_f32 v246, v246, v34, v35
    v_max3_f32 v246, v246, v36, v37
    v_max3_f32 v246, v246, v38, v39
    v_max3_f32 v246, v246, v48, v49
    v_max3_f32 v246, v246, v50, v51
    v_max3_f32 v246, v246, v52, v53
    v_max3_f32 v246, v246, v54, v55
    v_max3_f32 v246, v246, v64, v65
    v_max3_f32 v246, v246, v66, v67
    v_max3_f32 v246, v246, v68, v69
    v_max3_f32 v246, v246, v70, v71
    v_max3_f32 v246, v246, v80, v81
    v_max3_f32 v246, v246, v82, v83
    v_max3_f32 v246, v246, v84, v85
    v_max3_f32 v246, v246, v86, v87
    v_max3_f32 v246, v246, v96, v97
    v_max3_f32 v246, v246, v98, v99
    v_max3_f32 v246, v246, v100, v101
    v_max3_f32 v246, v246, v102, v103
    v_max3_f32 v246, v246, v112, v113
    v_max3_f32 v246, v246, v114, v115
    v_max3_f32 v246, v246, v116, v117
    v_max3_f32 v246, v246, v118, v119
    v_max3_f32 v246, v246, v128, v129
    v_max3_f32 v246, v246, v130, v131
    v_max3_f32 v246, v246, v132, v133
    v_max3_f32 v246, v246, v134, v135
    s_branch sequential_preLN__sliding_block__dense_activation_gelu__prompt_kernel_nobound62
sequential_preLN__sliding_block__dense_activation_gelu__prompt_kernel_vspin63:
    s_mov_b32 s61, 0
sequential_preLN__sliding_block__dense_activation_gelu__prompt_kernel_lw68:
    ds_read_b32 v4, v250
    s_waitcnt lgkmcnt(0)
    v_cmp_gt_u32 vcc, 1, v4
    s_cmp_eq_u64 vcc, 0
    s_cbranch_scc1 sequential_preLN__sliding_block__dense_activation_gelu__prompt_kernel_lwd69
    s_add_u32 s61, s61, 1
    s_cmp_lt_u32 s61, 262144
    s_cbranch_scc1 sequential_preLN__sliding_block__dense_activation_gelu__prompt_kernel_lw68
sequential_preLN__sliding_block__dense_activation_gelu__prompt_kernel_lwd69:
    s_branch sequential_preLN__sliding_block__dense_activation_gelu__prompt_kernel_vok64
sequential_preLN__sliding_block__dense_activation_gelu__prompt_kernel_bound65:
    v_mov_b32 v8, 0xf149f2ca
    v_mov_b32 v9, 0xf149f2ca
    v_mov_b32 v10, 0xf149f2ca
    v_mov_b32 v11, 0xf149f2ca
    v_mov_b32 v12, 0xf149f2ca
    v_mov_b32 v13, 0xf149f2ca
    v_mov_b32 v14, 0xf149f2ca
    v_mov_b32 v15, 0xf149f2ca
    v_mov_b32 v20, 0xf149f2ca
    v_mov_b32 v21, 0xf149f2ca
    v_mov_b32 v22, 0xf149f2ca
    v_mov_b32 v23, 0xf149f2ca
    s_cmp_eq_u32 s44, 1
    s_cbranch_scc1 sequential_preLN__sliding_block__dense_activation_gelu__prompt_kernel_remax70
    v_mov_b32 v24, 0xf149f2ca
    v_mov_b32 v25, 0xf149f2ca
    v_mov_b32 v26, 0xf149f2ca
    v_mov_b32 v27, 0xf149f2ca
    v_mov_b32 v32, 0xf149f2ca
    v_mov_b32 v33, 0xf149f2ca
    v_mov_b32 v34, 0xf149f2ca
    v_mov_b32 v35, 0xf149f2ca
    v_mov_b32 v28, 0xf149f2ca
    v_mov_b32 v29, 0xf149f2ca
    v_mov_b32 v30, 0xf149f2ca
    v_mov_b32 v31, 0xf149f2ca
    v_mov_b32 v36, 0xf149f2ca
    v_mov_b32 v37, 0xf149f2ca
    v_mov_b32 v38, 0xf149f2ca
    v_mov_b32 v39, 0xf149f2ca
    v_mov_b32 v40, 0xf149f2ca
    v_mov_b32 v41, 0xf149f2ca
    v_mov_b32 v42, 0xf149f2ca
    v_mov_b32 v43, 0xf149f2ca
    v_mov_b32 v48, 0xf149f2ca
    v_mov_b32 v49, 0xf149f2ca
    v_mov_b32 v50, 0xf149f2ca
    v_mov_b32 v51, 0xf149f2ca
    v_mov_b32 v44, 0xf149f2ca
    v_mov_b32 v45, 0xf149f2ca
    v_mov_b32 v46, 0xf149f2ca
    v_mov_b32 v47, 0xf149f2ca
    v_mov_b32 v52, 0xf149f2ca
    v_mov_b32 v53, 0xf149f2ca
    v_mov_b32 v54, 0xf149f2ca
    v_mov_b32 v55, 0xf149f2ca
    v_mov_b32 v56, 0xf149f2ca
    v_mov_b32 v57, 0xf149f2ca
    v_mov_b32 v58, 0xf149f2ca
    v_mov_b32 v59, 0xf149f2ca
    v_mov_b32 v64, 0xf149f2ca
    v_mov_b32 v65, 0xf149f2ca
    v_mov_b32 v66, 0xf149f2ca
    v_mov_b32 v67, 0xf149f2ca
    v_mov_b32 v60, 0xf149f2ca
    v_mov_b32 v61, 0xf149f2ca
    v_mov_b32 v62, 0xf149f2ca
    v_mov_b32 v63, 0xf149f2ca
    v_mov_b32 v68, 0xf149f2ca
    v_mov_b32 v69, 0xf149f2ca
    v_mov_b32 v70, 0xf149f2ca
    v_mov_b32 v71, 0xf149f2ca
    v_mov_b32 v72, 0xf149f2ca
    v_mov_b32 v73, 0xf149f2ca
    v_mov_b32 v74, 0xf149f2ca
    v_mov_b32 v75, 0xf149f2ca
    v_mov_b32 v80, 0xf149f2ca
    v_mov_b32 v81, 0xf149f2ca
    v_mov_b32 v82, 0xf149f2ca
    v_mov_b32 v83, 0xf149f2ca
    v_mov_b32 v76, 0xf149f2ca
    v_mov_b32 v77, 0xf149f2ca
    v_mov_b32 v78, 0xf149f2ca
    v_mov_b32 v79, 0xf149f2ca
    v_mov_b32 v84, 0xf149f2ca
    v_mov_b32 v85, 0xf149f2ca
    v_mov_b32 v86, 0xf149f2ca
    v_mov_b32 v87, 0xf149f2ca
sequential_preLN__sliding_block__dense_activation_gelu__prompt_kernel_remax70:
    v_max3_f32 v244, v8, v9, v10
    v_max_f32 v244, v244, v11
    v_max3_f32 v244, v244, v12, v13
    v_max3_f32 v244, v244, v14, v15
    v_max3_f32 v244, v244, v24, v25
    v_max3_f32 v244, v244, v26, v27
    v_max3_f32 v244, v244, v28, v29
    v_max3_f32 v244, v244, v30, v31
    v_max3_f32 v244, v244, v40, v41
    v_max3_f32 v244, v244, v42, v43
    v_max3_f32 v244, v244, v44, v45
    v_max3_f32 v244, v244, v46, v47
    v_max3_f32 v244, v244, v56, v57
    v_max3_f32 v244, v244, v58, v59
    v_max3_f32 v244, v244, v60, v61
    v_max3_f32 v244, v244, v62, v63
    v_max3_f32 v244, v244, v72, v73
    v_max3_f32 v244, v244, v74, v75
    v_max3_f32 v244, v244, v76, v77
    v_max3_f32 v244, v244, v78, v79
    v_max3_f32 v246, v20, v21, v22
    v_max_f32_e64 v246, v246, v23
    v_max3_f32 v246, v246, v32, v33
    v_max3_f32 v246, v246, v34, v35
    v_max3_f32 v246, v246, v36, v37
    v_max3_f32 v246, v246, v38, v39
    v_max3_f32 v246, v246, v48, v49
    v_max3_f32 v246, v246, v50, v51
    v_max3_f32 v246, v246, v52, v53
    v_max3_f32 v246, v246, v54, v55
    v_max3_f32 v246, v246, v64, v65
    v_max3_f32 v246, v246, v66, v67
    v_max3_f32 v246, v246, v68, v69
    v_max3_f32 v246, v246, v70, v71
    v_max3_f32 v246, v246, v80, v81
    v_max3_f32 v246, v246, v82, v83
    v_max3_f32 v246, v246, v84, v85
    v_max3_f32 v246, v246, v86, v87
    s_branch sequential_preLN__sliding_block__dense_activation_gelu__prompt_kernel_nobound66
sequential_preLN__sliding_block__dense_activation_gelu__prompt_kernel_att159:
    ds_read_b128 v[136:139], v249 offset:2048
    ds_read_b128 v[140:143], v249 offset:3072
    ds_read_b128 v[144:147], v249 offset:4096
    ds_read_b128 v[148:151], v249 offset:5120
    ds_read_b128 v[152:155], v248 offset:16384
    ds_read_b128 v[156:159], v248 offset:17408
    ds_read_b128 v[160:163], v248 offset:18432
    ds_read_b128 v[164:167], v248 offset:19456
    ds_read_b128 v[168:171], v248 offset:16384
    ds_read_b128 v[172:175], v248 offset:17408
    s_waitcnt lgkmcnt(4)
    v_mfma_f32_16x16x32_bf16 v[8:11], v[152:155], v[136:139], 0
    v_mfma_f32_16x16x32_bf16 v[16:19], v[152:155], v[140:143], 0
    v_mfma_f32_16x16x32_bf16 v[12:15], v[156:159], v[136:139], 0
    v_mfma_f32_16x16x32_bf16 v[20:23], v[156:159], v[140:143], 0
    ds_read_b128 v[152:155], v248 offset:18432
    ds_read_b128 v[156:159], v248 offset:19456
    s_waitcnt lgkmcnt(4)
    v_mfma_f32_16x16x32_bf16 v[24:27], v[160:163], v[136:139], v[224:227]
    v_mfma_f32_16x16x32_bf16 v[28:31], v[160:163], v[140:143], 0
    v_max3_f32 v236, v8, v9, v10
    v_max_f32 v236, v236, v11
    v_mfma_f32_16x16x32_bf16 v[32:35], v[164:167], v[140:143], v[224:227]
    v_max3_f32 v238, v16, v17, v18
    v_max_f32 v238, v238, v19
    ds_read_b128 v[160:163], v248 offset:20480
    ds_read_b128 v[164:167], v248 offset:21504
    s_waitcnt lgkmcnt(4)
    v_mfma_f32_16x16x32_bf16 v[36:39], v[168:171], v[144:147], 0
    v_max3_f32 v236, v236, v12, v13
    v_max3_f32 v236, v236, v14, v15
    v_mfma_f32_16x16x32_bf16 v[44:47], v[168:171], v[148:151], 0
    v_max3_f32 v238, v238, v20, v21
    v_max3_f32 v238, v238, v22, v23
    v_mfma_f32_16x16x32_bf16 v[40:43], v[172:175], v[144:147], 0
    v_max3_f32 v236, v236, v24, v25
    v_max3_f32 v236, v236, v26, v27
    v_mfma_f32_16x16x32_bf16 v[48:51], v[172:175], v[148:151], 0
    v_max3_f32 v238, v238, v28, v29
    v_max3_f32 v238, v238, v30, v31
    s_waitcnt lgkmcnt(2)
    v_mfma_f32_16x16x32_bf16 v[52:55], v[152:155], v[144:147], 0
    v_max3_f32 v238, v238, v32, v33
    v_max3_f32 v238, v238, v34, v35
    v_mfma_f32_16x16x32_bf16 v[60:63], v[152:155], v[148:151], 0
    v_max3_f32 v240, v36, v37, v38
    v_max_f32 v240, v240, v39
    v_mfma_f32_16x16x32_bf16 v[56:59], v[156:159], v[144:147], 0
    v_max3_f32 v242, v44, v45, v46
    v_max_f32 v242, v242, v47
    v_mfma_f32_16x16x32_bf16 v[64:67], v[156:159], v[148:151], 0
    v_max3_f32 v240, v240, v40, v41
    v_max3_f32 v240, v240, v42, v43
    s_waitcnt lgkmcnt(0)
    v_mfma_f32_16x16x32_bf16 v[68:71], v[160:163], v[144:147], v[224:227]
    v_max3_f32 v242, v242, v48, v49
    v_max3_f32 v242, v242, v50, v51
    v_mfma_f32_16x16x32_bf16 v[72:75], v[160:163], v[148:151], 0
    v_max3_f32 v240, v240, v52, v53
    v_max3_f32 v240, v240, v54, v55
    v_mfma_f32_16x16x32_bf16 v[76:79], v[164:167], v[148:151], v[224:227]
    v_max3_f32 v242, v242, v60, v61
    v_max3_f32 v242, v242, v62, v63
    s_nop 7
    s_nop 0
    v_max3_f32 v240, v240, v56, v57
    v_max3_f32 v240, v240, v58, v59
    v_max3_f32 v242, v242, v64, v65
    v_max3_f32 v242, v242, v66, v67
    v_max3_f32 v240, v240, v68, v69
    v_max3_f32 v240, v240, v70, v71
    v_max3_f32 v242, v242, v72, v73
    v_max3_f32 v242, v242, v74, v75
    v_max3_f32 v242, v242, v76, v77
    v_max3_f32 v242, v242, v78, v79
    ds_read_b128 v[152:155], v248 offset:40960
    ds_read_b128 v[156:159], v248 offset:41984
    ds_read_b128 v[160:163], v248 offset:43008
    ds_read_b128 v[164:167], v248 offset:44032
    v_mov_b32 v237, v236
    v_mov_b32 v239, v238
    v_mov_b32 v241, v240
    v_mov_b32 v243, v242
    s_nop 0
    v_permlane32_swap_b32 v236, v237
    v_permlane32_swap_b32 v238, v239
    v_permlane32_swap_b32 v240, v241
    v_permlane32_swap_b32 v242, v243
    v_max_f32 v236, v236, v237
    v_max_f32 v238, v238, v239
    v_max_f32 v240, v240, v241
    v_max_f32 v242, v242, v243
    v_mov_b32 v237, v236
    v_mov_b32 v239, v238
    v_mov_b32 v241, v240
    v_mov_b32 v243, v242
    s_nop 0
    v_permlane16_swap_b32 v236, v237
    v_permlane16_swap_b32 v238, v239
    v_permlane16_swap_b32 v240, v241
    v_permlane16_swap_b32 v242, v243
    v_max_f32 v236, v236, v237
    v_max_f32 v238, v238, v239
    v_max_f32 v240, v240, v241
    v_max_f32 v242, v242, v243
    s_waitcnt vmcnt(0)
    s_barrier
    v_pk_add_f32 v[8:9], v[8:9], v[236:237] op_sel_hi:[1,0] neg_lo:[0,1] neg_hi:[0,1]
    v_pk_add_f32 v[10:11], v[10:11], v[236:237] op_sel_hi:[1,0] neg_lo:[0,1] neg_hi:[0,1]
    v_exp_f32 v8, v8
    v_exp_f32 v9, v9
    v_exp_f32 v10, v10
    v_exp_f32 v11, v11
    v_cvt_pk_bf16_f32 v8, v8, v9
    v_cvt_pk_bf16_f32 v9, v10, v11
    v_pk_add_f32 v[12:13], v[12:13], v[236:237] op_sel_hi:[1,0] neg_lo:[0,1] neg_hi:[0,1]
    v_pk_add_f32 v[14:15], v[14:15], v[236:237] op_sel_hi:[1,0] neg_lo:[0,1] neg_hi:[0,1]
    v_exp_f32 v12, v12
    v_exp_f32 v13, v13
    v_exp_f32 v14, v14
    v_exp_f32 v15, v15
    v_cvt_pk_bf16_f32 v10, v12, v13
    v_cvt_pk_bf16_f32 v11, v14, v15
    v_pk_add_f32 v[16:17], v[16:17], v[238:239] op_sel_hi:[1,0] neg_lo:[0,1] neg_hi:[0,1]
    v_pk_add_f32 v[18:19], v[18:19], v[238:239] op_sel_hi:[1,0] neg_lo:[0,1] neg_hi:[0,1]
    v_exp_f32 v16, v16
    v_exp_f32 v17, v17
    v_exp_f32 v18, v18
    v_exp_f32 v19, v19
    v_cvt_pk_bf16_f32 v16, v16, v17
    v_cvt_pk_bf16_f32 v17, v18, v19
    v_pk_add_f32 v[20:21], v[20:21], v[238:239] op_sel_hi:[1,0] neg_lo:[0,1] neg_hi:[0,1]
    v_pk_add_f32 v[22:23], v[22:23], v[238:239] op_sel_hi:[1,0] neg_lo:[0,1] neg_hi:[0,1]
    v_exp_f32 v20, v20
    v_exp_f32 v21, v21
    v_exp_f32 v22, v22
    v_exp_f32 v23, v23
    v_cvt_pk_bf16_f32 v18, v20, v21
    v_cvt_pk_bf16_f32 v19, v22, v23
    s_waitcnt lgkmcnt(2)
    v_pk_add_f32 v[24:25], v[24:25], v[236:237] op_sel_hi:[1,0] neg_lo:[0,1] neg_hi:[0,1]
    v_pk_add_f32 v[26:27], v[26:27], v[236:237] op_sel_hi:[1,0] neg_lo:[0,1] neg_hi:[0,1]
    v_mfma_f32_16x16x32_bf16 v[176:179], v[152:155], v[8:11], 0
    v_exp_f32 v24, v24
    v_exp_f32 v25, v25
    v_mfma_f32_16x16x32_bf16 v[180:183], v[156:159], v[8:11], 0
    v_exp_f32 v26, v26
    v_exp_f32 v27, v27
    v_cvt_pk_bf16_f32 v24, v24, v25
    v_cvt_pk_bf16_f32 v25, v26, v27
    v_mov_b32 v26, 0
    v_mov_b32 v27, 0
    v_pk_add_f32 v[28:29], v[28:29], v[238:239] op_sel_hi:[1,0] neg_lo:[0,1] neg_hi:[0,1]
    v_pk_add_f32 v[30:31], v[30:31], v[238:239] op_sel_hi:[1,0] neg_lo:[0,1] neg_hi:[0,1]
    v_mfma_f32_16x16x32_bf16 v[184:187], v[232:235], v[8:11], 0
    v_exp_f32 v28, v28
    v_exp_f32 v29, v29
    v_exp_f32 v30, v30
    v_exp_f32_e64 v31, v31
    v_cvt_pk_bf16_f32 v28, v28, v29
    v_cvt_pk_bf16_f32 v29, v30, v31
    v_pk_add_f32 v[32:33], v[32:33], v[238:239] op_sel_hi:[1,0] neg_lo:[0,1] neg_hi:[0,1]
    v_pk_add_f32 v[34:35], v[34:35], v[238:239] op_sel_hi:[1,0] neg_lo:[0,1] neg_hi:[0,1]
    v_mfma_f32_16x16x32_bf16 v[188:191], v[152:155], v[16:19], 0
    v_exp_f32 v32, v32
    v_exp_f32 v33, v33
    v_mfma_f32_16x16x32_bf16 v[192:195], v[156:159], v[16:19], 0
    v_exp_f32 v34, v34
    v_exp_f32 v35, v35
    v_cvt_pk_bf16_f32 v30, v32, v33
    v_cvt_pk_bf16_f32 v31, v34, v35
    v_mfma_f32_16x16x32_bf16 v[196:199], v[232:235], v[16:19], 0
    ds_read_b128 v[152:155], v248 offset:40960
    ds_read_b128 v[156:159], v248 offset:41984
    s_waitcnt lgkmcnt(2)
    v_pk_add_f32 v[36:37], v[36:37], v[240:241] op_sel_hi:[1,0] neg_lo:[0,1] neg_hi:[0,1]
    v_pk_add_f32 v[38:39], v[38:39], v[240:241] op_sel_hi:[1,0] neg_lo:[0,1] neg_hi:[0,1]
    v_mfma_f32_16x16x32_bf16 v[176:179], v[160:163], v[24:27], v[176:179]
    v_exp_f32 v36, v36
    v_exp_f32 v37, v37
    v_mfma_f32_16x16x32_bf16 v[180:183], v[164:167], v[24:27], v[180:183]
    v_exp_f32 v38, v38
    v_exp_f32_e64 v39, v39
    v_cvt_pk_bf16_f32 v36, v36, v37
    v_cvt_pk_bf16_f32 v37, v38, v39
    v_pk_add_f32 v[40:41], v[40:41], v[240:241] op_sel_hi:[1,0] neg_lo:[0,1] neg_hi:[0,1]
    v_pk_add_f32 v[42:43], v[42:43], v[240:241] op_sel_hi:[1,0] neg_lo:[0,1] neg_hi:[0,1]
    v_mfma_f32_16x16x32_bf16 v[184:187], v[232:235], v[24:27], v[184:187]
    v_exp_f32 v40, v40
    v_exp_f32 v41, v41
    v_exp_f32 v42, v42
    v_exp_f32 v43, v43
    v_cvt_pk_bf16_f32 v38, v40, v41
    v_cvt_pk_bf16_f32 v39, v42, v43
    v_pk_add_f32 v[44:45], v[44:45], v[242:243] op_sel_hi:[1,0] neg_lo:[0,1] neg_hi:[0,1]
    v_pk_add_f32 v[46:47], v[46:47], v[242:243] op_sel_hi:[1,0] neg_lo:[0,1] neg_hi:[0,1]
    v_mfma_f32_16x16x32_bf16 v[188:191], v[160:163], v[28:31], v[188:191]
    v_exp_f32 v44, v44
    v_exp_f32 v45, v45
    v_mfma_f32_16x16x32_bf16 v[192:195], v[164:167], v[28:31], v[192:195]
    v_exp_f32 v46, v46
    v_exp_f32 v47, v47
    v_cvt_pk_bf16_f32 v44, v44, v45
    v_cvt_pk_bf16_f32 v45, v46, v47
    v_pk_add_f32 v[48:49], v[48:49], v[242:243] op_sel_hi:[1,0] neg_lo:[0,1] neg_hi:[0,1]
    v_pk_add_f32 v[50:51], v[50:51], v[242:243] op_sel_hi:[1,0] neg_lo:[0,1] neg_hi:[0,1]
    v_mfma_f32_16x16x32_bf16 v[196:199], v[232:235], v[28:31], v[196:199]
    v_exp_f32 v48, v48
    v_exp_f32 v49, v49
    v_exp_f32 v50, v50
    v_exp_f32 v51, v51
    v_cvt_pk_bf16_f32 v46, v48, v49
    v_cvt_pk_bf16_f32 v47, v50, v51
    ds_read_b128 v[160:163], v248 offset:43008
    ds_read_b128 v[164:167], v248 offset:44032
    s_waitcnt lgkmcnt(2)
    v_pk_add_f32 v[52:53], v[52:53], v[240:241] op_sel_hi:[1,0] neg_lo:[0,1] neg_hi:[0,1]
    v_pk_add_f32 v[54:55], v[54:55], v[240:241] op_sel_hi:[1,0] neg_lo:[0,1] neg_hi:[0,1]
    v_mfma_f32_16x16x32_bf16 v[200:203], v[152:155], v[36:39], 0
    v_exp_f32 v52, v52
    v_exp_f32 v53, v53
    v_mfma_f32_16x16x32_bf16 v[204:207], v[156:159], v[36:39], 0
    v_exp_f32 v54, v54
    v_exp_f32_e64 v55, v55
    v_cvt_pk_bf16_f32 v52, v52, v53
    v_cvt_pk_bf16_f32 v53, v54, v55
    v_pk_add_f32 v[56:57], v[56:57], v[240:241] op_sel_hi:[1,0] neg_lo:[0,1] neg_hi:[0,1]
    v_pk_add_f32 v[58:59], v[58:59], v[240:241] op_sel_hi:[1,0] neg_lo:[0,1] neg_hi:[0,1]
    v_mfma_f32_16x16x32_bf16 v[208:211], v[232:235], v[36:39], 0
    v_exp_f32 v56, v56
    v_exp_f32 v57, v57
    v_exp_f32 v58, v58
    v_exp_f32 v59, v59
    v_cvt_pk_bf16_f32 v54, v56, v57
    v_cvt_pk_bf16_f32 v55, v58, v59
    v_pk_add_f32 v[60:61], v[60:61], v[242:243] op_sel_hi:[1,0] neg_lo:[0,1] neg_hi:[0,1]
    v_pk_add_f32 v[62:63], v[62:63], v[242:243] op_sel_hi:[1,0] neg_lo:[0,1] neg_hi:[0,1]
    v_mfma_f32_16x16x32_bf16 v[212:215], v[152:155], v[44:47], 0
    v_exp_f32 v60, v60
    v_exp_f32 v61, v61
    v_mfma_f32_16x16x32_bf16 v[216:219], v[156:159], v[44:47], 0
    v_exp_f32 v62, v62
    v_exp_f32 v63, v63
    v_cvt_pk_bf16_f32 v60, v60, v61
    v_cvt_pk_bf16_f32 v61, v62, v63
    v_pk_add_f32 v[64:65], v[64:65], v[242:243] op_sel_hi:[1,0] neg_lo:[0,1] neg_hi:[0,1]
    v_pk_add_f32 v[66:67], v[66:67], v[242:243] op_sel_hi:[1,0] neg_lo:[0,1] neg_hi:[0,1]
    v_mfma_f32_16x16x32_bf16 v[220:223], v[232:235], v[44:47], 0
    v_exp_f32 v64, v64
    v_exp_f32 v65, v65
    v_exp_f32 v66, v66
    v_exp_f32 v67, v67
    v_cvt_pk_bf16_f32 v62, v64, v65
    v_cvt_pk_bf16_f32 v63, v66, v67
    ds_read_b128 v[152:155], v248 offset:45056
    ds_read_b128 v[156:159], v248 offset:46080
    s_waitcnt lgkmcnt(2)
    v_pk_add_f32 v[68:69], v[68:69], v[240:241] op_sel_hi:[1,0] neg_lo:[0,1] neg_hi:[0,1]
    v_pk_add_f32 v[70:71], v[70:71], v[240:241] op_sel_hi:[1,0] neg_lo:[0,1] neg_hi:[0,1]
    v_mfma_f32_16x16x32_bf16 v[200:203], v[160:163], v[52:55], v[200:203]
    v_exp_f32 v68, v68
    v_exp_f32 v69, v69
    v_mfma_f32_16x16x32_bf16 v[204:207], v[164:167], v[52:55], v[204:207]
    v_exp_f32 v70, v70
    v_exp_f32 v71, v71
    v_cvt_pk_bf16_f32 v68, v68, v69
    v_cvt_pk_bf16_f32 v69, v70, v71
    v_mov_b32 v70, 0
    v_mov_b32 v71, 0
    v_pk_add_f32 v[72:73], v[72:73], v[242:243] op_sel_hi:[1,0] neg_lo:[0,1] neg_hi:[0,1]
    v_pk_add_f32 v[74:75], v[74:75], v[242:243] op_sel_hi:[1,0] neg_lo:[0,1] neg_hi:[0,1]
    v_mfma_f32_16x16x32_bf16 v[208:211], v[232:235], v[52:55], v[208:211]
    v_exp_f32 v72, v72
    v_exp_f32 v73, v73
    v_exp_f32 v74, v74
    v_exp_f32_e64 v75, v75
    v_cvt_pk_bf16_f32 v72, v72, v73
    v_cvt_pk_bf16_f32 v73, v74, v75
    v_pk_add_f32 v[76:77], v[76:77], v[242:243] op_sel_hi:[1,0] neg_lo:[0,1] neg_hi:[0,1]
    v_pk_add_f32 v[78:79], v[78:79], v[242:243] op_sel_hi:[1,0] neg_lo:[0,1] neg_hi:[0,1]
    v_mfma_f32_16x16x32_bf16 v[212:215], v[160:163], v[60:63], v[212:215]
    v_exp_f32 v76, v76
    v_exp_f32 v77, v77
    v_mfma_f32_16x16x32_bf16 v[216:219], v[164:167], v[60:63], v[216:219]
    v_exp_f32 v78, v78
    v_exp_f32 v79, v79
    v_cvt_pk_bf16_f32 v74, v76, v77
    v_cvt_pk_bf16_f32 v75, v78, v79
    v_mfma_f32_16x16x32_bf16 v[220:223], v[232:235], v[60:63], v[220:223]
    s_waitcnt lgkmcnt(0)
    s_nop 1
    v_mfma_f32_16x16x32_bf16 v[200:203], v[152:155], v[68:71], v[200:203]
    v_mfma_f32_16x16x32_bf16 v[204:207], v[156:159], v[68:71], v[204:207]
    v_mfma_f32_16x16x32_bf16 v[208:211], v[232:235], v[68:71], v[208:211]
    v_mfma_f32_16x16x32_bf16 v[212:215], v[152:155], v[72:75], v[212:215]
    v_mfma_f32_16x16x32_bf16 v[216:219], v[156:159], v[72:75], v[216:219]
    v_mfma_f32_16x16x32_bf16 v[220:223], v[232:235], v[72:75], v[220:223]
    s_barrier
    s_barrier
    ds_read_b128 v[152:155], v248 offset:2048
    ds_read_b128 v[156:159], v248 offset:3072
    ds_read_b128 v[160:163], v248 offset:4096
    ds_read_b128 v[164:167], v248 offset:5120
    ds_read_b128 v[168:171], v248 offset:6144
    ds_read_b128 v[172:175], v248 offset:7168
    s_waitcnt lgkmcnt(4)
    v_mfma_f32_16x16x32_bf16 v[8:11], v[152:155], v[136:139], v[228:231]
    v_mfma_f32_16x16x32_bf16 v[12:15], v[156:159], v[136:139], 0
    v_mfma_f32_16x16x32_bf16 v[20:23], v[156:159], v[140:143], v[228:231]
    ds_read_b128 v[152:155], v248 offset:8192
    ds_read_b128 v[156:159], v248 offset:9216
    s_waitcnt lgkmcnt(4)
    v_mfma_f32_16x16x32_bf16 v[24:27], v[160:163], v[136:139], 0
    v_mfma_f32_16x16x32_bf16 v[32:35], v[160:163], v[140:143], 0
    v_mfma_f32_16x16x32_bf16 v[28:31], v[164:167], v[136:139], 0
    v_max3_f32 v244, v8, v9, v10
    v_max_f32 v244, v244, v11
    v_mfma_f32_16x16x32_bf16 v[36:39], v[164:167], v[140:143], 0
    s_nop 0
    v_max3_f32 v244, v244, v12, v13
    v_max3_f32 v244, v244, v14, v15
    ds_read_b128 v[160:163], v248 offset:10240
    ds_read_b128 v[164:167], v248 offset:11264
    s_waitcnt lgkmcnt(4)
    v_mfma_f32_16x16x32_bf16 v[40:43], v[168:171], v[136:139], 0
    v_max3_f32 v246, v20, v21, v22
    v_max_f32 v246, v246, v23
    v_mfma_f32_16x16x32_bf16 v[48:51], v[168:171], v[140:143], 0
    v_max3_f32 v244, v244, v24, v25
    v_max3_f32 v244, v244, v26, v27
    v_mfma_f32_16x16x32_bf16 v[44:47], v[172:175], v[136:139], 0
    v_max3_f32 v246, v246, v32, v33
    v_max3_f32 v246, v246, v34, v35
    v_mfma_f32_16x16x32_bf16 v[52:55], v[172:175], v[140:143], 0
    v_max3_f32 v244, v244, v28, v29
    v_max3_f32 v244, v244, v30, v31
    ds_read_b128 v[168:171], v248 offset:12288
    ds_read_b128 v[172:175], v248 offset:13312
    s_waitcnt lgkmcnt(4)
    v_mfma_f32_16x16x32_bf16 v[56:59], v[152:155], v[136:139], 0
    v_max3_f32 v246, v246, v36, v37
    v_max3_f32 v246, v246, v38, v39
    v_mfma_f32_16x16x32_bf16 v[64:67], v[152:155], v[140:143], 0
    v_max3_f32 v244, v244, v40, v41
    v_max3_f32 v244, v244, v42, v43
    v_mfma_f32_16x16x32_bf16 v[60:63], v[156:159], v[136:139], 0
    v_max3_f32 v246, v246, v48, v49
    v_max3_f32 v246, v246, v50, v51
    v_mfma_f32_16x16x32_bf16 v[68:71], v[156:159], v[140:143], 0
    s_nop 0
    v_max3_f32 v244, v244, v44, v45
    v_max3_f32 v244, v244, v46, v47
    ds_read_b128 v[152:155], v248 offset:14336
    ds_read_b128 v[156:159], v248 offset:15360
    s_waitcnt lgkmcnt(4)
    v_mfma_f32_16x16x32_bf16 v[72:75], v[160:163], v[136:139], 0
    v_max3_f32 v246, v246, v52, v53
    v_max3_f32 v246, v246, v54, v55
    v_mfma_f32_16x16x32_bf16 v[80:83], v[160:163], v[140:143], 0
    v_max3_f32 v244, v244, v56, v57
    v_max3_f32 v244, v244, v58, v59
    v_mfma_f32_16x16x32_bf16 v[76:79], v[164:167], v[136:139], 0
    v_max3_f32 v246, v246, v64, v65
    v_max3_f32 v246, v246, v66, v67
    v_mfma_f32_16x16x32_bf16 v[84:87], v[164:167], v[140:143], 0
    v_max3_f32 v244, v244, v60, v61
    v_max3_f32 v244, v244, v62, v63
    s_waitcnt lgkmcnt(2)
    v_mfma_f32_16x16x32_bf16 v[88:91], v[168:171], v[136:139], 0
    v_max3_f32 v246, v246, v68, v69
    v_max3_f32 v246, v246, v70, v71
    v_mfma_f32_16x16x32_bf16 v[96:99], v[168:171], v[140:143], 0
    v_max3_f32 v244, v244, v72, v73
    v_max3_f32 v244, v244, v74, v75
    v_mfma_f32_16x16x32_bf16 v[92:95], v[172:175], v[136:139], 0
    v_max3_f32 v246, v246, v80, v81
    v_max3_f32 v246, v246, v82, v83
    v_mfma_f32_16x16x32_bf16 v[100:103], v[172:175], v[140:143], 0
    v_max3_f32 v244, v244, v76, v77
    v_max3_f32 v244, v244, v78, v79
    s_waitcnt lgkmcnt(0)
    v_mfma_f32_16x16x32_bf16 v[104:107], v[152:155], v[136:139], 0
    v_max3_f32 v246, v246, v84, v85
    v_max3_f32 v246, v246, v86, v87
    v_mfma_f32_16x16x32_bf16 v[112:115], v[152:155], v[140:143], 0
    v_max3_f32 v244, v244, v88, v89
    v_max3_f32 v244, v244, v90, v91
    v_mfma_f32_16x16x32_bf16 v[108:111], v[156:159], v[136:139], 0
    v_max3_f32 v246, v246, v96, v97
    v_max3_f32 v246, v246, v98, v99
    v_mfma_f32_16x16x32_bf16 v[116:119], v[156:159], v[140:143], 0
    v_max3_f32 v244, v244, v92, v93
    v_max3_f32 v244, v244, v94, v95
    s_nop 7
    v_max3_f32 v246, v246, v100, v101
    v_max3_f32 v246, v246, v102, v103
    v_max3_f32 v244, v244, v104, v105
    v_max3_f32 v244, v244, v106, v107
    v_max3_f32 v246, v246, v112, v113
    v_max3_f32 v246, v246, v114, v115
    v_max3_f32 v244, v244, v108, v109
    v_max3_f32 v244, v244, v110, v111
    v_max3_f32 v246, v246, v116, v117
    v_max3_f32 v246, v246, v118, v119
    s_cmp_lt_u32 s44, 2
    s_cbranch_scc1 sequential_preLN__sliding_block__dense_activation_gelu__prompt_kernel_bound71
sequential_preLN__sliding_block__dense_activation_gelu__prompt_kernel_nobound72:
    v_max_f32 v244, v244, v236
    v_max_f32 v246, v246, v238
    v_mov_b32 v245, v244
    v_mov_b32 v247, v246
    s_nop 0
    v_permlane32_swap_b32 v244, v245
    v_permlane32_swap_b32 v246, v247
    v_max_f32 v244, v244, v245
    v_max_f32 v246, v246, v247
    v_mov_b32 v245, v244
    v_mov_b32 v247, v246
    s_nop 0
    v_permlane16_swap_b32 v244, v245
    v_permlane16_swap_b32 v246, v247
    v_max_f32 v244, v244, v245
    v_max_f32 v246, v246, v247
    v_sub_f32 v236, v236, v244
    v_sub_f32 v238, v238, v246
    v_exp_f32 v236, v236
    v_exp_f32 v238, v238
    s_nop 0
    s_nop 0
    v_pk_mul_f32 v[176:177], v[176:177], v[236:237] op_sel_hi:[1,0]
    v_pk_mul_f32 v[178:179], v[178:179], v[236:237] op_sel_hi:[1,0]
    v_pk_mul_f32 v[180:181], v[180:181], v[236:237] op_sel_hi:[1,0]
    v_pk_mul_f32 v[182:183], v[182:183], v[236:237] op_sel_hi:[1,0]
    v_pk_mul_f32 v[184:185], v[184:185], v[236:237] op_sel_hi:[1,0]
    v_pk_mul_f32 v[186:187], v[186:187], v[236:237] op_sel_hi:[1,0]
    v_pk_mul_f32 v[188:189], v[188:189], v[238:239] op_sel_hi:[1,0]
    v_pk_mul_f32 v[190:191], v[190:191], v[238:239] op_sel_hi:[1,0]
    v_pk_mul_f32 v[192:193], v[192:193], v[238:239] op_sel_hi:[1,0]
    v_pk_mul_f32 v[194:195], v[194:195], v[238:239] op_sel_hi:[1,0]
    v_pk_mul_f32 v[196:197], v[196:197], v[238:239] op_sel_hi:[1,0]
    v_pk_mul_f32 v[198:199], v[198:199], v[238:239] op_sel_hi:[1,0]
    v_pk_add_f32 v[8:9], v[8:9], v[244:245] op_sel_hi:[1,0] neg_lo:[0,1] neg_hi:[0,1]
    v_pk_add_f32 v[10:11], v[10:11], v[244:245] op_sel_hi:[1,0] neg_lo:[0,1] neg_hi:[0,1]
    v_exp_f32 v8, v8
    v_exp_f32 v9, v9
    v_exp_f32 v10, v10
    v_exp_f32 v11, v11
    v_cvt_pk_bf16_f32 v8, v8, v9
    v_cvt_pk_bf16_f32 v9, v10, v11
    v_pk_add_f32 v[12:13], v[12:13], v[244:245] op_sel_hi:[1,0] neg_lo:[0,1] neg_hi:[0,1]
    v_pk_add_f32 v[14:15], v[14:15], v[244:245] op_sel_hi:[1,0] neg_lo:[0,1] neg_hi:[0,1]
    v_exp_f32 v12, v12
    v_exp_f32 v13, v13
    v_exp_f32 v14, v14
    v_exp_f32 v15, v15
    v_cvt_pk_bf16_f32 v10, v12, v13
    v_cvt_pk_bf16_f32 v11, v14, v15
    v_mov_b32 v16, 0
    v_mov_b32 v17, 0
    v_pk_add_f32 v[20:21], v[20:21], v[246:247] op_sel_hi:[1,0] neg_lo:[0,1] neg_hi:[0,1]
    v_pk_add_f32 v[22:23], v[22:23], v[246:247] op_sel_hi:[1,0] neg_lo:[0,1] neg_hi:[0,1]
    v_exp_f32 v20, v20
    v_exp_f32 v21, v21
    v_exp_f32 v22, v22
    v_exp_f32 v23, v23
    v_cvt_pk_bf16_f32 v18, v20, v21
    v_cvt_pk_bf16_f32 v19, v22, v23
    ds_read_b32 v4, v250
    s_waitcnt lgkmcnt(0)
    v_cmp_gt_u32 vcc, 1, v4
    s_cmp_eq_u64 vcc, 0
    s_cbranch_scc0 sequential_preLN__sliding_block__dense_activation_gelu__prompt_kernel_vspin73
sequential_preLN__sliding_block__dense_activation_gelu__prompt_kernel_vok74:
    ds_read_b128 v[152:155], v248 offset:26624
    ds_read_b128 v[156:159], v248 offset:27648
    ds_read_b128 v[160:163], v248 offset:28672
    ds_read_b128 v[164:167], v248 offset:29696
    s_waitcnt lgkmcnt(2)
    v_pk_add_f32 v[24:25], v[24:25], v[244:245] op_sel_hi:[1,0] neg_lo:[0,1] neg_hi:[0,1]
    v_pk_add_f32 v[26:27], v[26:27], v[244:245] op_sel_hi:[1,0] neg_lo:[0,1] neg_hi:[0,1]
    v_mfma_f32_16x16x32_bf16 v[176:179], v[152:155], v[8:11], v[176:179]
    v_exp_f32 v24, v24
    v_exp_f32 v25, v25
    v_mfma_f32_16x16x32_bf16 v[180:183], v[156:159], v[8:11], v[180:183]
    v_exp_f32 v26, v26
    v_exp_f32_e64 v27, v27
    v_cvt_pk_bf16_f32 v24, v24, v25
    v_cvt_pk_bf16_f32 v25, v26, v27
    v_pk_add_f32 v[28:29], v[28:29], v[244:245] op_sel_hi:[1,0] neg_lo:[0,1] neg_hi:[0,1]
    v_pk_add_f32 v[30:31], v[30:31], v[244:245] op_sel_hi:[1,0] neg_lo:[0,1] neg_hi:[0,1]
    v_mfma_f32_16x16x32_bf16 v[184:187], v[232:235], v[8:11], v[184:187]
    v_exp_f32 v28, v28
    v_exp_f32 v29, v29
    v_exp_f32 v30, v30
    v_exp_f32 v31, v31
    v_cvt_pk_bf16_f32 v26, v28, v29
    v_cvt_pk_bf16_f32 v27, v30, v31
    v_pk_add_f32 v[32:33], v[32:33], v[246:247] op_sel_hi:[1,0] neg_lo:[0,1] neg_hi:[0,1]
    v_pk_add_f32 v[34:35], v[34:35], v[246:247] op_sel_hi:[1,0] neg_lo:[0,1] neg_hi:[0,1]
    v_mfma_f32_16x16x32_bf16 v[188:191], v[152:155], v[16:19], v[188:191]
    v_exp_f32 v32, v32
    v_exp_f32 v33, v33
    v_mfma_f32_16x16x32_bf16 v[192:195], v[156:159], v[16:19], v[192:195]
    v_exp_f32 v34, v34
    v_exp_f32 v35, v35
    v_cvt_pk_bf16_f32 v32, v32, v33
    v_cvt_pk_bf16_f32 v33, v34, v35
    v_pk_add_f32 v[36:37], v[36:37], v[246:247] op_sel_hi:[1,0] neg_lo:[0,1] neg_hi:[0,1]
    v_pk_add_f32 v[38:39], v[38:39], v[246:247] op_sel_hi:[1,0] neg_lo:[0,1] neg_hi:[0,1]
    v_mfma_f32_16x16x32_bf16 v[196:199], v[232:235], v[16:19], v[196:199]
    v_exp_f32 v36, v36
    v_exp_f32 v37, v37
    v_exp_f32 v38, v38
    v_exp_f32 v39, v39
    v_cvt_pk_bf16_f32 v34, v36, v37
    v_cvt_pk_bf16_f32 v35, v38, v39
    ds_read_b128 v[152:155], v248 offset:30720
    ds_read_b128 v[156:159], v248 offset:31744
    s_waitcnt lgkmcnt(2)
    v_pk_add_f32 v[40:41], v[40:41], v[244:245] op_sel_hi:[1,0] neg_lo:[0,1] neg_hi:[0,1]
    v_pk_add_f32 v[42:43], v[42:43], v[244:245] op_sel_hi:[1,0] neg_lo:[0,1] neg_hi:[0,1]
    v_mfma_f32_16x16x32_bf16 v[176:179], v[160:163], v[24:27], v[176:179]
    v_exp_f32 v40, v40
    v_exp_f32 v41, v41
    v_mfma_f32_16x16x32_bf16 v[180:183], v[164:167], v[24:27], v[180:183]
    v_exp_f32 v42, v42
    v_exp_f32_e64 v43, v43
    v_cvt_pk_bf16_f32 v40, v40, v41
    v_cvt_pk_bf16_f32 v41, v42, v43
    v_pk_add_f32 v[44:45], v[44:45], v[244:245] op_sel_hi:[1,0] neg_lo:[0,1] neg_hi:[0,1]
    v_pk_add_f32 v[46:47], v[46:47], v[244:245] op_sel_hi:[1,0] neg_lo:[0,1] neg_hi:[0,1]
    v_mfma_f32_16x16x32_bf16 v[184:187], v[232:235], v[24:27], v[184:187]
    v_exp_f32 v44, v44
    v_exp_f32 v45, v45
    v_exp_f32 v46, v46
    v_exp_f32 v47, v47
    v_cvt_pk_bf16_f32 v42, v44, v45
    v_cvt_pk_bf16_f32 v43, v46, v47
    v_pk_add_f32 v[48:49], v[48:49], v[246:247] op_sel_hi:[1,0] neg_lo:[0,1] neg_hi:[0,1]
    v_pk_add_f32 v[50:51], v[50:51], v[246:247] op_sel_hi:[1,0] neg_lo:[0,1] neg_hi:[0,1]
    v_mfma_f32_16x16x32_bf16 v[188:191], v[160:163], v[32:35], v[188:191]
    v_exp_f32 v48, v48
    v_exp_f32 v49, v49
    v_mfma_f32_16x16x32_bf16 v[192:195], v[164:167], v[32:35], v[192:195]
    v_exp_f32 v50, v50
    v_exp_f32 v51, v51
    v_cvt_pk_bf16_f32 v48, v48, v49
    v_cvt_pk_bf16_f32 v49, v50, v51
    v_pk_add_f32 v[52:53], v[52:53], v[246:247] op_sel_hi:[1,0] neg_lo:[0,1] neg_hi:[0,1]
    v_pk_add_f32 v[54:55], v[54:55], v[246:247] op_sel_hi:[1,0] neg_lo:[0,1] neg_hi:[0,1]
    v_mfma_f32_16x16x32_bf16 v[196:199], v[232:235], v[32:35], v[196:199]
    v_exp_f32 v52, v52
    v_exp_f32 v53, v53
    v_exp_f32 v54, v54
    v_exp_f32 v55, v55
    v_cvt_pk_bf16_f32 v50, v52, v53
    v_cvt_pk_bf16_f32 v51, v54, v55
    ds_read_b128 v[160:163], v248 offset:32768
    ds_read_b128 v[164:167], v248 offset:33792
    s_waitcnt lgkmcnt(2)
    v_pk_add_f32 v[56:57], v[56:57], v[244:245] op_sel_hi:[1,0] neg_lo:[0,1] neg_hi:[0,1]
    v_pk_add_f32 v[58:59], v[58:59], v[244:245] op_sel_hi:[1,0] neg_lo:[0,1] neg_hi:[0,1]
    v_mfma_f32_16x16x32_bf16 v[176:179], v[152:155], v[40:43], v[176:179]
    v_exp_f32 v56, v56
    v_exp_f32 v57, v57
    v_mfma_f32_16x16x32_bf16 v[180:183], v[156:159], v[40:43], v[180:183]
    v_exp_f32 v58, v58
    v_exp_f32_e64 v59, v59
    v_cvt_pk_bf16_f32 v56, v56, v57
    v_cvt_pk_bf16_f32 v57, v58, v59
    v_pk_add_f32 v[60:61], v[60:61], v[244:245] op_sel_hi:[1,0] neg_lo:[0,1] neg_hi:[0,1]
    v_pk_add_f32 v[62:63], v[62:63], v[244:245] op_sel_hi:[1,0] neg_lo:[0,1] neg_hi:[0,1]
    v_mfma_f32_16x16x32_bf16 v[184:187], v[232:235], v[40:43], v[184:187]
    v_exp_f32 v60, v60
    v_exp_f32 v61, v61
    v_exp_f32 v62, v62
    v_exp_f32 v63, v63
    v_cvt_pk_bf16_f32 v58, v60, v61
    v_cvt_pk_bf16_f32 v59, v62, v63
    v_pk_add_f32 v[64:65], v[64:65], v[246:247] op_sel_hi:[1,0] neg_lo:[0,1] neg_hi:[0,1]
    v_pk_add_f32 v[66:67], v[66:67], v[246:247] op_sel_hi:[1,0] neg_lo:[0,1] neg_hi:[0,1]
    v_mfma_f32_16x16x32_bf16 v[188:191], v[152:155], v[48:51], v[188:191]
    v_exp_f32 v64, v64
    v_exp_f32 v65, v65
    v_mfma_f32_16x16x32_bf16 v[192:195], v[156:159], v[48:51], v[192:195]
    v_exp_f32 v66, v66
    v_exp_f32 v67, v67
    v_cvt_pk_bf16_f32 v64, v64, v65
    v_cvt_pk_bf16_f32 v65, v66, v67
    v_pk_add_f32 v[68:69], v[68:69], v[246:247] op_sel_hi:[1,0] neg_lo:[0,1] neg_hi:[0,1]
    v_pk_add_f32 v[70:71], v[70:71], v[246:247] op_sel_hi:[1,0] neg_lo:[0,1] neg_hi:[0,1]
    v_mfma_f32_16x16x32_bf16 v[196:199], v[232:235], v[48:51], v[196:199]
    v_exp_f32 v68, v68
    v_exp_f32 v69, v69
    v_exp_f32 v70, v70
    v_exp_f32 v71, v71
    v_cvt_pk_bf16_f32 v66, v68, v69
    v_cvt_pk_bf16_f32 v67, v70, v71
    ds_read_b128 v[152:155], v248 offset:34816
    ds_read_b128 v[156:159], v248 offset:35840
    s_waitcnt lgkmcnt(2)
    v_pk_add_f32 v[72:73], v[72:73], v[244:245] op_sel_hi:[1,0] neg_lo:[0,1] neg_hi:[0,1]
    v_pk_add_f32 v[74:75], v[74:75], v[244:245] op_sel_hi:[1,0] neg_lo:[0,1] neg_hi:[0,1]
    v_mfma_f32_16x16x32_bf16 v[176:179], v[160:163], v[56:59], v[176:179]
    v_exp_f32 v72, v72
    v_exp_f32 v73, v73
    v_mfma_f32_16x16x32_bf16 v[180:183], v[164:167], v[56:59], v[180:183]
    v_exp_f32 v74, v74
    v_exp_f32_e64 v75, v75
    v_cvt_pk_bf16_f32 v72, v72, v73
    v_cvt_pk_bf16_f32 v73, v74, v75
    v_pk_add_f32 v[76:77], v[76:77], v[244:245] op_sel_hi:[1,0] neg_lo:[0,1] neg_hi:[0,1]
    v_pk_add_f32 v[78:79], v[78:79], v[244:245] op_sel_hi:[1,0] neg_lo:[0,1] neg_hi:[0,1]
    v_mfma_f32_16x16x32_bf16 v[184:187], v[232:235], v[56:59], v[184:187]
    v_exp_f32 v76, v76
    v_exp_f32 v77, v77
    v_exp_f32 v78, v78
    v_exp_f32 v79, v79
    v_cvt_pk_bf16_f32 v74, v76, v77
    v_cvt_pk_bf16_f32 v75, v78, v79
    v_pk_add_f32 v[80:81], v[80:81], v[246:247] op_sel_hi:[1,0] neg_lo:[0,1] neg_hi:[0,1]
    v_pk_add_f32 v[82:83], v[82:83], v[246:247] op_sel_hi:[1,0] neg_lo:[0,1] neg_hi:[0,1]
    v_mfma_f32_16x16x32_bf16 v[188:191], v[160:163], v[64:67], v[188:191]
    v_exp_f32 v80, v80
    v_exp_f32 v81, v81
    v_mfma_f32_16x16x32_bf16 v[192:195], v[164:167], v[64:67], v[192:195]
    v_exp_f32 v82, v82
    v_exp_f32 v83, v83
    v_cvt_pk_bf16_f32 v80, v80, v81
    v_cvt_pk_bf16_f32 v81, v82, v83
    v_pk_add_f32 v[84:85], v[84:85], v[246:247] op_sel_hi:[1,0] neg_lo:[0,1] neg_hi:[0,1]
    v_pk_add_f32 v[86:87], v[86:87], v[246:247] op_sel_hi:[1,0] neg_lo:[0,1] neg_hi:[0,1]
    v_mfma_f32_16x16x32_bf16 v[196:199], v[232:235], v[64:67], v[196:199]
    v_exp_f32 v84, v84
    v_exp_f32 v85, v85
    v_exp_f32 v86, v86
    v_exp_f32 v87, v87
    v_cvt_pk_bf16_f32 v82, v84, v85
    v_cvt_pk_bf16_f32 v83, v86, v87
    ds_read_b128 v[160:163], v248 offset:36864
    ds_read_b128 v[164:167], v248 offset:37888
    s_waitcnt lgkmcnt(2)
    v_pk_add_f32 v[88:89], v[88:89], v[244:245] op_sel_hi:[1,0] neg_lo:[0,1] neg_hi:[0,1]
    v_pk_add_f32 v[90:91], v[90:91], v[244:245] op_sel_hi:[1,0] neg_lo:[0,1] neg_hi:[0,1]
    v_mfma_f32_16x16x32_bf16 v[176:179], v[152:155], v[72:75], v[176:179]
    v_exp_f32 v88, v88
    v_exp_f32 v89, v89
    v_mfma_f32_16x16x32_bf16 v[180:183], v[156:159], v[72:75], v[180:183]
    v_exp_f32 v90, v90
    v_exp_f32_e64 v91, v91
    v_cvt_pk_bf16_f32 v88, v88, v89
    v_cvt_pk_bf16_f32 v89, v90, v91
    v_pk_add_f32 v[92:93], v[92:93], v[244:245] op_sel_hi:[1,0] neg_lo:[0,1] neg_hi:[0,1]
    v_pk_add_f32 v[94:95], v[94:95], v[244:245] op_sel_hi:[1,0] neg_lo:[0,1] neg_hi:[0,1]
    v_mfma_f32_16x16x32_bf16 v[184:187], v[232:235], v[72:75], v[184:187]
    v_exp_f32 v92, v92
    v_exp_f32 v93, v93
    v_exp_f32 v94, v94
    v_exp_f32 v95, v95
    v_cvt_pk_bf16_f32 v90, v92, v93
    v_cvt_pk_bf16_f32 v91, v94, v95
    v_pk_add_f32 v[96:97], v[96:97], v[246:247] op_sel_hi:[1,0] neg_lo:[0,1] neg_hi:[0,1]
    v_pk_add_f32 v[98:99], v[98:99], v[246:247] op_sel_hi:[1,0] neg_lo:[0,1] neg_hi:[0,1]
    v_mfma_f32_16x16x32_bf16 v[188:191], v[152:155], v[80:83], v[188:191]
    v_exp_f32 v96, v96
    v_exp_f32 v97, v97
    v_mfma_f32_16x16x32_bf16 v[192:195], v[156:159], v[80:83], v[192:195]
    v_exp_f32 v98, v98
    v_exp_f32 v99, v99
    v_cvt_pk_bf16_f32 v96, v96, v97
    v_cvt_pk_bf16_f32 v97, v98, v99
    v_pk_add_f32 v[100:101], v[100:101], v[246:247] op_sel_hi:[1,0] neg_lo:[0,1] neg_hi:[0,1]
    v_pk_add_f32 v[102:103], v[102:103], v[246:247] op_sel_hi:[1,0] neg_lo:[0,1] neg_hi:[0,1]
    v_mfma_f32_16x16x32_bf16 v[196:199], v[232:235], v[80:83], v[196:199]
    v_exp_f32 v100, v100
    v_exp_f32 v101, v101
    v_exp_f32 v102, v102
    v_exp_f32 v103, v103
    v_cvt_pk_bf16_f32 v98, v100, v101
    v_cvt_pk_bf16_f32 v99, v102, v103
    ds_read_b128 v[152:155], v248 offset:38912
    ds_read_b128 v[156:159], v248 offset:39936
    s_waitcnt lgkmcnt(2)
    v_pk_add_f32 v[104:105], v[104:105], v[244:245] op_sel_hi:[1,0] neg_lo:[0,1] neg_hi:[0,1]
    v_pk_add_f32 v[106:107], v[106:107], v[244:245] op_sel_hi:[1,0] neg_lo:[0,1] neg_hi:[0,1]
    v_mfma_f32_16x16x32_bf16 v[176:179], v[160:163], v[88:91], v[176:179]
    v_exp_f32 v104, v104
    v_exp_f32 v105, v105
    v_mfma_f32_16x16x32_bf16 v[180:183], v[164:167], v[88:91], v[180:183]
    v_exp_f32 v106, v106
    v_exp_f32_e64 v107, v107
    v_cvt_pk_bf16_f32 v104, v104, v105
    v_cvt_pk_bf16_f32 v105, v106, v107
    v_pk_add_f32 v[108:109], v[108:109], v[244:245] op_sel_hi:[1,0] neg_lo:[0,1] neg_hi:[0,1]
    v_pk_add_f32 v[110:111], v[110:111], v[244:245] op_sel_hi:[1,0] neg_lo:[0,1] neg_hi:[0,1]
    v_mfma_f32_16x16x32_bf16 v[184:187], v[232:235], v[88:91], v[184:187]
    v_exp_f32 v108, v108
    v_exp_f32 v109, v109
    v_exp_f32 v110, v110
    v_exp_f32 v111, v111
    v_cvt_pk_bf16_f32 v106, v108, v109
    v_cvt_pk_bf16_f32 v107, v110, v111
    v_pk_add_f32 v[112:113], v[112:113], v[246:247] op_sel_hi:[1,0] neg_lo:[0,1] neg_hi:[0,1]
    v_pk_add_f32 v[114:115], v[114:115], v[246:247] op_sel_hi:[1,0] neg_lo:[0,1] neg_hi:[0,1]
    v_mfma_f32_16x16x32_bf16 v[188:191], v[160:163], v[96:99], v[188:191]
    v_exp_f32 v112, v112
    v_exp_f32 v113, v113
    v_mfma_f32_16x16x32_bf16 v[192:195], v[164:167], v[96:99], v[192:195]
    v_exp_f32 v114, v114
    v_exp_f32 v115, v115
    v_cvt_pk_bf16_f32 v112, v112, v113
    v_cvt_pk_bf16_f32 v113, v114, v115
    v_pk_add_f32 v[116:117], v[116:117], v[246:247] op_sel_hi:[1,0] neg_lo:[0,1] neg_hi:[0,1]
    v_pk_add_f32 v[118:119], v[118:119], v[246:247] op_sel_hi:[1,0] neg_lo:[0,1] neg_hi:[0,1]
    v_mfma_f32_16x16x32_bf16 v[196:199], v[232:235], v[96:99], v[196:199]
    v_exp_f32 v116, v116
    v_exp_f32 v117, v117
    v_exp_f32 v118, v118
    v_exp_f32 v119, v119
    v_cvt_pk_bf16_f32 v114, v116, v117
    v_cvt_pk_bf16_f32 v115, v118, v119
    s_waitcnt lgkmcnt(0)
    s_nop 1
    v_mfma_f32_16x16x32_bf16 v[176:179], v[152:155], v[104:107], v[176:179]
    v_mfma_f32_16x16x32_bf16 v[180:183], v[156:159], v[104:107], v[180:183]
    v_mfma_f32_16x16x32_bf16 v[184:187], v[232:235], v[104:107], v[184:187]
    v_mfma_f32_16x16x32_bf16 v[188:191], v[152:155], v[112:115], v[188:191]
    v_mfma_f32_16x16x32_bf16 v[192:195], v[156:159], v[112:115], v[192:195]
    v_mfma_f32_16x16x32_bf16 v[196:199], v[232:235], v[112:115], v[196:199]
    ds_read_b128 v[152:155], v248 offset:4096
    ds_read_b128 v[156:159], v248 offset:5120
    ds_read_b128 v[160:163], v248 offset:6144
    ds_read_b128 v[164:167], v248 offset:7168
    ds_read_b128 v[168:171], v248 offset:8192
    ds_read_b128 v[172:175], v248 offset:9216
    s_waitcnt lgkmcnt(4)
    s_nop 3
    s_add_u32 s53, s68, 2048
    v_rcp_f32 v236, v184
    v_rcp_f32 v238, v196
    s_nop 0
    v_mul_f32 v176, v176, v236
    v_mul_f32 v177, v177, v236
    v_mul_f32 v178, v178, v236
    v_mfma_f32_16x16x32_bf16 v[8:11], v[152:155], v[144:147], v[228:231]
    v_mfma_f32_16x16x32_bf16 v[12:15], v[156:159], v[144:147], 0
    v_mfma_f32_16x16x32_bf16 v[20:23], v[156:159], v[148:151], v[228:231]
    ds_read_b128 v[152:155], v248 offset:10240
    ds_read_b128 v[156:159], v248 offset:11264
    s_waitcnt lgkmcnt(4)
    v_mul_f32 v179, v179, v236
    v_mul_f32 v180, v180, v236
    v_mul_f32 v181, v181, v236
    v_mul_f32 v182, v182, v236
    v_mul_f32 v183, v183, v236
    v_cvt_pk_bf16_f32 v136, v176, v177
    v_cvt_pk_bf16_f32 v137, v178, v179
    v_cvt_pk_bf16_f32 v138, v180, v181
    v_mfma_f32_16x16x32_bf16 v[24:27], v[160:163], v[144:147], 0
    v_mfma_f32_16x16x32_bf16 v[32:35], v[160:163], v[148:151], 0
    v_mfma_f32_16x16x32_bf16 v[28:31], v[164:167], v[144:147], 0
    v_max3_f32 v244, v8, v9, v10
    v_max_f32 v244, v244, v11
    v_mfma_f32_16x16x32_bf16 v[36:39], v[164:167], v[148:151], 0
    s_nop 0
    v_max3_f32 v244, v244, v12, v13
    v_max3_f32 v244, v244, v14, v15
    ds_read_b128 v[160:163], v248 offset:12288
    ds_read_b128 v[164:167], v248 offset:13312
    s_waitcnt lgkmcnt(4)
    v_cvt_pk_bf16_f32 v139, v182, v183
    buffer_store_dwordx4 v[136:139], v2, s[24:27], s53 offen offset:0 sc1
    v_mul_f32 v188, v188, v238
    v_mul_f32 v189, v189, v238
    v_mul_f32 v190, v190, v238
    v_mul_f32 v191, v191, v238
    v_mul_f32 v192, v192, v238
    v_mul_f32 v193, v193, v238
    v_mfma_f32_16x16x32_bf16 v[40:43], v[168:171], v[144:147], 0
    v_max3_f32 v246, v20, v21, v22
    v_max_f32 v246, v246, v23
    v_mfma_f32_16x16x32_bf16 v[48:51], v[168:171], v[148:151], 0
    v_max3_f32 v244, v244, v24, v25
    v_max3_f32 v244, v244, v26, v27
    v_mfma_f32_16x16x32_bf16 v[44:47], v[172:175], v[144:147], 0
    v_max3_f32 v246, v246, v32, v33
    v_max3_f32 v246, v246, v34, v35
    v_mfma_f32_16x16x32_bf16 v[52:55], v[172:175], v[148:151], 0
    v_max3_f32 v244, v244, v28, v29
    v_max3_f32 v244, v244, v30, v31
    ds_read_b128 v[168:171], v248 offset:14336
    ds_read_b128 v[172:175], v248 offset:15360
    s_waitcnt lgkmcnt(4)
    v_mul_f32 v194, v194, v238
    v_mul_f32_e64 v195, v195, v238
    v_cvt_pk_bf16_f32 v140, v188, v189
    v_cvt_pk_bf16_f32 v141, v190, v191
    v_cvt_pk_bf16_f32 v142, v192, v193
    v_cvt_pk_bf16_f32 v143, v194, v195
    buffer_store_dwordx4 v[140:143], v2, s[24:27], s53 offen offset:1024 sc1
    v_mfma_f32_16x16x32_bf16 v[56:59], v[152:155], v[144:147], 0
    v_max3_f32 v246, v246, v36, v37
    v_max3_f32 v246, v246, v38, v39
    v_mfma_f32_16x16x32_bf16 v[64:67], v[152:155], v[148:151], 0
    v_max3_f32 v244, v244, v40, v41
    v_max3_f32 v244, v244, v42, v43
    v_mfma_f32_16x16x32_bf16 v[60:63], v[156:159], v[144:147], 0
    v_max3_f32 v246, v246, v48, v49
    v_max3_f32 v246, v246, v50, v51
    v_mfma_f32_16x16x32_bf16 v[68:71], v[156:159], v[148:151], 0
    v_max3_f32 v244, v244, v44, v45
    v_max3_f32 v244, v244, v46, v47
    s_waitcnt lgkmcnt(2)
    v_mfma_f32_16x16x32_bf16 v[72:75], v[160:163], v[144:147], 0
    v_max3_f32 v246, v246, v52, v53
    v_max3_f32 v246, v246, v54, v55
    v_mfma_f32_16x16x32_bf16 v[80:83], v[160:163], v[148:151], 0
    v_max3_f32 v244, v244, v56, v57
    v_max3_f32 v244, v244, v58, v59
    v_mfma_f32_16x16x32_bf16 v[76:79], v[164:167], v[144:147], 0
    v_max3_f32 v246, v246, v64, v65
    v_max3_f32 v246, v246, v66, v67
    v_mfma_f32_16x16x32_bf16 v[84:87], v[164:167], v[148:151], 0
    v_max3_f32 v244, v244, v60, v61
    v_max3_f32 v244, v244, v62, v63
    s_waitcnt lgkmcnt(0)
    v_mfma_f32_16x16x32_bf16 v[88:91], v[168:171], v[144:147], 0
    v_max3_f32 v246, v246, v68, v69
    v_max3_f32 v246, v246, v70, v71
    v_mfma_f32_16x16x32_bf16 v[96:99], v[168:171], v[148:151], 0
    v_max3_f32 v244, v244, v72, v73
    v_max3_f32 v244, v244, v74, v75
    v_mfma_f32_16x16x32_bf16 v[92:95], v[172:175], v[144:147], 0
    v_max3_f32 v246, v246, v80, v81
    v_max3_f32 v246, v246, v82, v83
    v_mfma_f32_16x16x32_bf16 v[100:103], v[172:175], v[148:151], 0
    v_max3_f32 v244, v244, v76, v77
    v_max3_f32 v244, v244, v78, v79
    s_nop 7
    s_nop 0
    v_max3_f32 v246, v246, v84, v85
    v_max3_f32 v246, v246, v86, v87
    v_max3_f32 v244, v244, v88, v89
    v_max3_f32 v244, v244, v90, v91
    v_max3_f32 v246, v246, v96, v97
    v_max3_f32 v246, v246, v98, v99
    v_max3_f32 v244, v244, v92, v93
    v_max3_f32 v244, v244, v94, v95
    v_max3_f32 v246, v246, v100, v101
    v_max3_f32 v246, v246, v102, v103
    ds_read_b128 v[152:155], v248 offset:28672
    ds_read_b128 v[156:159], v248 offset:29696
    ds_read_b128 v[160:163], v248 offset:30720
    ds_read_b128 v[164:167], v248 offset:31744
    s_cmp_lt_u32 s44, 2
    s_cbranch_scc1 sequential_preLN__sliding_block__dense_activation_gelu__prompt_kernel_bound75
sequential_preLN__sliding_block__dense_activation_gelu__prompt_kernel_nobound76:
    v_max_f32 v244, v244, v240
    v_max_f32 v246, v246, v242
    v_mov_b32 v245, v244
    v_mov_b32 v247, v246
    s_nop 0
    v_permlane32_swap_b32 v244, v245
    v_permlane32_swap_b32 v246, v247
    v_max_f32 v244, v244, v245
    v_max_f32 v246, v246, v247
    v_mov_b32 v245, v244
    v_mov_b32 v247, v246
    s_nop 0
    v_permlane16_swap_b32 v244, v245
    v_permlane16_swap_b32 v246, v247
    v_max_f32 v244, v244, v245
    v_max_f32 v246, v246, v247
    v_sub_f32 v240, v240, v244
    v_sub_f32 v242, v242, v246
    v_exp_f32 v240, v240
    v_exp_f32 v242, v242
    s_nop 0
    s_nop 0
    v_pk_mul_f32 v[200:201], v[200:201], v[240:241] op_sel_hi:[1,0]
    v_pk_mul_f32 v[202:203], v[202:203], v[240:241] op_sel_hi:[1,0]
    v_pk_mul_f32 v[204:205], v[204:205], v[240:241] op_sel_hi:[1,0]
    v_pk_mul_f32 v[206:207], v[206:207], v[240:241] op_sel_hi:[1,0]
    v_pk_mul_f32 v[208:209], v[208:209], v[240:241] op_sel_hi:[1,0]
    v_pk_mul_f32 v[210:211], v[210:211], v[240:241] op_sel_hi:[1,0]
    v_pk_mul_f32 v[212:213], v[212:213], v[242:243] op_sel_hi:[1,0]
    v_pk_mul_f32 v[214:215], v[214:215], v[242:243] op_sel_hi:[1,0]
    v_pk_mul_f32 v[216:217], v[216:217], v[242:243] op_sel_hi:[1,0]
    v_pk_mul_f32 v[218:219], v[218:219], v[242:243] op_sel_hi:[1,0]
    v_pk_mul_f32 v[220:221], v[220:221], v[242:243] op_sel_hi:[1,0]
    v_pk_mul_f32 v[222:223], v[222:223], v[242:243] op_sel_hi:[1,0]
    v_pk_add_f32 v[8:9], v[8:9], v[244:245] op_sel_hi:[1,0] neg_lo:[0,1] neg_hi:[0,1]
    v_pk_add_f32 v[10:11], v[10:11], v[244:245] op_sel_hi:[1,0] neg_lo:[0,1] neg_hi:[0,1]
    v_exp_f32 v8, v8
    v_exp_f32 v9, v9
    v_exp_f32 v10, v10
    v_exp_f32 v11, v11
    v_cvt_pk_bf16_f32 v8, v8, v9
    v_cvt_pk_bf16_f32 v9, v10, v11
    v_pk_add_f32 v[12:13], v[12:13], v[244:245] op_sel_hi:[1,0] neg_lo:[0,1] neg_hi:[0,1]
    v_pk_add_f32 v[14:15], v[14:15], v[244:245] op_sel_hi:[1,0] neg_lo:[0,1] neg_hi:[0,1]
    v_exp_f32 v12, v12
    v_exp_f32 v13, v13
    v_exp_f32 v14, v14
    v_exp_f32 v15, v15
    v_cvt_pk_bf16_f32 v10, v12, v13
    v_cvt_pk_bf16_f32 v11, v14, v15
    v_mov_b32 v16, 0
    v_mov_b32 v17, 0
    v_pk_add_f32 v[20:21], v[20:21], v[246:247] op_sel_hi:[1,0] neg_lo:[0,1] neg_hi:[0,1]
    v_pk_add_f32 v[22:23], v[22:23], v[246:247] op_sel_hi:[1,0] neg_lo:[0,1] neg_hi:[0,1]
    v_exp_f32 v20, v20
    v_exp_f32 v21, v21
    v_exp_f32 v22, v22
    v_exp_f32 v23, v23
    v_cvt_pk_bf16_f32 v18, v20, v21
    v_cvt_pk_bf16_f32 v19, v22, v23
    s_waitcnt lgkmcnt(2)
    v_pk_add_f32 v[24:25], v[24:25], v[244:245] op_sel_hi:[1,0] neg_lo:[0,1] neg_hi:[0,1]
    v_pk_add_f32 v[26:27], v[26:27], v[244:245] op_sel_hi:[1,0] neg_lo:[0,1] neg_hi:[0,1]
    v_mfma_f32_16x16x32_bf16 v[200:203], v[152:155], v[8:11], v[200:203]
    v_exp_f32 v24, v24
    v_exp_f32 v25, v25
    v_mfma_f32_16x16x32_bf16 v[204:207], v[156:159], v[8:11], v[204:207]
    v_exp_f32 v26, v26
    v_exp_f32_e64 v27, v27
    v_cvt_pk_bf16_f32 v24, v24, v25
    v_cvt_pk_bf16_f32 v25, v26, v27
    v_pk_add_f32 v[28:29], v[28:29], v[244:245] op_sel_hi:[1,0] neg_lo:[0,1] neg_hi:[0,1]
    v_pk_add_f32 v[30:31], v[30:31], v[244:245] op_sel_hi:[1,0] neg_lo:[0,1] neg_hi:[0,1]
    v_mfma_f32_16x16x32_bf16 v[208:211], v[232:235], v[8:11], v[208:211]
    v_exp_f32 v28, v28
    v_exp_f32 v29, v29
    v_exp_f32 v30, v30
    v_exp_f32 v31, v31
    v_cvt_pk_bf16_f32 v26, v28, v29
    v_cvt_pk_bf16_f32 v27, v30, v31
    v_pk_add_f32 v[32:33], v[32:33], v[246:247] op_sel_hi:[1,0] neg_lo:[0,1] neg_hi:[0,1]
    v_pk_add_f32 v[34:35], v[34:35], v[246:247] op_sel_hi:[1,0] neg_lo:[0,1] neg_hi:[0,1]
    v_mfma_f32_16x16x32_bf16 v[212:215], v[152:155], v[16:19], v[212:215]
    v_exp_f32 v32, v32
    v_exp_f32 v33, v33
    v_mfma_f32_16x16x32_bf16 v[216:219], v[156:159], v[16:19], v[216:219]
    v_exp_f32 v34, v34
    v_exp_f32 v35, v35
    v_cvt_pk_bf16_f32 v32, v32, v33
    v_cvt_pk_bf16_f32 v33, v34, v35
    v_pk_add_f32 v[36:37], v[36:37], v[246:247] op_sel_hi:[1,0] neg_lo:[0,1] neg_hi:[0,1]
    v_pk_add_f32 v[38:39], v[38:39], v[246:247] op_sel_hi:[1,0] neg_lo:[0,1] neg_hi:[0,1]
    v_mfma_f32_16x16x32_bf16 v[220:223], v[232:235], v[16:19], v[220:223]
    v_exp_f32 v36, v36
    v_exp_f32 v37, v37
    v_exp_f32 v38, v38
    v_exp_f32 v39, v39
    v_cvt_pk_bf16_f32 v34, v36, v37
    v_cvt_pk_bf16_f32 v35, v38, v39
    ds_read_b128 v[152:155], v248 offset:32768
    ds_read_b128 v[156:159], v248 offset:33792
    s_waitcnt lgkmcnt(2)
    v_pk_add_f32 v[40:41], v[40:41], v[244:245] op_sel_hi:[1,0] neg_lo:[0,1] neg_hi:[0,1]
    v_pk_add_f32 v[42:43], v[42:43], v[244:245] op_sel_hi:[1,0] neg_lo:[0,1] neg_hi:[0,1]
    v_mfma_f32_16x16x32_bf16 v[200:203], v[160:163], v[24:27], v[200:203]
    v_exp_f32 v40, v40
    v_exp_f32 v41, v41
    v_mfma_f32_16x16x32_bf16 v[204:207], v[164:167], v[24:27], v[204:207]
    v_exp_f32 v42, v42
    v_exp_f32_e64 v43, v43
    v_cvt_pk_bf16_f32 v40, v40, v41
    v_cvt_pk_bf16_f32 v41, v42, v43
    v_pk_add_f32 v[44:45], v[44:45], v[244:245] op_sel_hi:[1,0] neg_lo:[0,1] neg_hi:[0,1]
    v_pk_add_f32 v[46:47], v[46:47], v[244:245] op_sel_hi:[1,0] neg_lo:[0,1] neg_hi:[0,1]
    v_mfma_f32_16x16x32_bf16 v[208:211], v[232:235], v[24:27], v[208:211]
    v_exp_f32 v44, v44
    v_exp_f32 v45, v45
    v_exp_f32 v46, v46
    v_exp_f32 v47, v47
    v_cvt_pk_bf16_f32 v42, v44, v45
    v_cvt_pk_bf16_f32 v43, v46, v47
    v_pk_add_f32 v[48:49], v[48:49], v[246:247] op_sel_hi:[1,0] neg_lo:[0,1] neg_hi:[0,1]
    v_pk_add_f32 v[50:51], v[50:51], v[246:247] op_sel_hi:[1,0] neg_lo:[0,1] neg_hi:[0,1]
    v_mfma_f32_16x16x32_bf16 v[212:215], v[160:163], v[32:35], v[212:215]
    v_exp_f32 v48, v48
    v_exp_f32 v49, v49
    v_mfma_f32_16x16x32_bf16 v[216:219], v[164:167], v[32:35], v[216:219]
    v_exp_f32 v50, v50
    v_exp_f32 v51, v51
    v_cvt_pk_bf16_f32 v48, v48, v49
    v_cvt_pk_bf16_f32 v49, v50, v51
    v_pk_add_f32 v[52:53], v[52:53], v[246:247] op_sel_hi:[1,0] neg_lo:[0,1] neg_hi:[0,1]
    v_pk_add_f32 v[54:55], v[54:55], v[246:247] op_sel_hi:[1,0] neg_lo:[0,1] neg_hi:[0,1]
    v_mfma_f32_16x16x32_bf16 v[220:223], v[232:235], v[32:35], v[220:223]
    v_exp_f32 v52, v52
    v_exp_f32 v53, v53
    v_exp_f32 v54, v54
    v_exp_f32 v55, v55
    v_cvt_pk_bf16_f32 v50, v52, v53
    v_cvt_pk_bf16_f32 v51, v54, v55
    ds_read_b128 v[160:163], v248 offset:34816
    ds_read_b128 v[164:167], v248 offset:35840
    s_waitcnt lgkmcnt(2)
    v_pk_add_f32 v[56:57], v[56:57], v[244:245] op_sel_hi:[1,0] neg_lo:[0,1] neg_hi:[0,1]
    v_pk_add_f32 v[58:59], v[58:59], v[244:245] op_sel_hi:[1,0] neg_lo:[0,1] neg_hi:[0,1]
    v_mfma_f32_16x16x32_bf16 v[200:203], v[152:155], v[40:43], v[200:203]
    v_exp_f32 v56, v56
    v_exp_f32 v57, v57
    v_mfma_f32_16x16x32_bf16 v[204:207], v[156:159], v[40:43], v[204:207]
    v_exp_f32 v58, v58
    v_exp_f32_e64 v59, v59
    v_cvt_pk_bf16_f32 v56, v56, v57
    v_cvt_pk_bf16_f32 v57, v58, v59
    v_pk_add_f32 v[60:61], v[60:61], v[244:245] op_sel_hi:[1,0] neg_lo:[0,1] neg_hi:[0,1]
    v_pk_add_f32 v[62:63], v[62:63], v[244:245] op_sel_hi:[1,0] neg_lo:[0,1] neg_hi:[0,1]
    v_mfma_f32_16x16x32_bf16 v[208:211], v[232:235], v[40:43], v[208:211]
    v_exp_f32 v60, v60
    v_exp_f32 v61, v61
    v_exp_f32 v62, v62
    v_exp_f32 v63, v63
    v_cvt_pk_bf16_f32 v58, v60, v61
    v_cvt_pk_bf16_f32 v59, v62, v63
    v_pk_add_f32 v[64:65], v[64:65], v[246:247] op_sel_hi:[1,0] neg_lo:[0,1] neg_hi:[0,1]
    v_pk_add_f32 v[66:67], v[66:67], v[246:247] op_sel_hi:[1,0] neg_lo:[0,1] neg_hi:[0,1]
    v_mfma_f32_16x16x32_bf16 v[212:215], v[152:155], v[48:51], v[212:215]
    v_exp_f32 v64, v64
    v_exp_f32 v65, v65
    v_mfma_f32_16x16x32_bf16 v[216:219], v[156:159], v[48:51], v[216:219]
    v_exp_f32 v66, v66
    v_exp_f32 v67, v67
    v_cvt_pk_bf16_f32 v64, v64, v65
    v_cvt_pk_bf16_f32 v65, v66, v67
    v_pk_add_f32 v[68:69], v[68:69], v[246:247] op_sel_hi:[1,0] neg_lo:[0,1] neg_hi:[0,1]
    v_pk_add_f32 v[70:71], v[70:71], v[246:247] op_sel_hi:[1,0] neg_lo:[0,1] neg_hi:[0,1]
    v_mfma_f32_16x16x32_bf16 v[220:223], v[232:235], v[48:51], v[220:223]
    v_exp_f32 v68, v68
    v_exp_f32 v69, v69
    v_exp_f32 v70, v70
    v_exp_f32 v71, v71
    v_cvt_pk_bf16_f32 v66, v68, v69
    v_cvt_pk_bf16_f32 v67, v70, v71
    ds_read_b128 v[152:155], v248 offset:36864
    ds_read_b128 v[156:159], v248 offset:37888
    s_waitcnt lgkmcnt(2)
    v_pk_add_f32 v[72:73], v[72:73], v[244:245] op_sel_hi:[1,0] neg_lo:[0,1] neg_hi:[0,1]
    v_pk_add_f32 v[74:75], v[74:75], v[244:245] op_sel_hi:[1,0] neg_lo:[0,1] neg_hi:[0,1]
    v_mfma_f32_16x16x32_bf16 v[200:203], v[160:163], v[56:59], v[200:203]
    v_exp_f32 v72, v72
    v_exp_f32 v73, v73
    v_mfma_f32_16x16x32_bf16 v[204:207], v[164:167], v[56:59], v[204:207]
    v_exp_f32 v74, v74
    v_exp_f32_e64 v75, v75
    v_cvt_pk_bf16_f32 v72, v72, v73
    v_cvt_pk_bf16_f32 v73, v74, v75
    v_pk_add_f32 v[76:77], v[76:77], v[244:245] op_sel_hi:[1,0] neg_lo:[0,1] neg_hi:[0,1]
    v_pk_add_f32 v[78:79], v[78:79], v[244:245] op_sel_hi:[1,0] neg_lo:[0,1] neg_hi:[0,1]
    v_mfma_f32_16x16x32_bf16 v[208:211], v[232:235], v[56:59], v[208:211]
    v_exp_f32 v76, v76
    v_exp_f32 v77, v77
    v_exp_f32 v78, v78
    v_exp_f32 v79, v79
    v_cvt_pk_bf16_f32 v74, v76, v77
    v_cvt_pk_bf16_f32 v75, v78, v79
    v_pk_add_f32 v[80:81], v[80:81], v[246:247] op_sel_hi:[1,0] neg_lo:[0,1] neg_hi:[0,1]
    v_pk_add_f32 v[82:83], v[82:83], v[246:247] op_sel_hi:[1,0] neg_lo:[0,1] neg_hi:[0,1]
    v_mfma_f32_16x16x32_bf16 v[212:215], v[160:163], v[64:67], v[212:215]
    v_exp_f32 v80, v80
    v_exp_f32 v81, v81
    v_mfma_f32_16x16x32_bf16 v[216:219], v[164:167], v[64:67], v[216:219]
    v_exp_f32 v82, v82
    v_exp_f32 v83, v83
    v_cvt_pk_bf16_f32 v80, v80, v81
    v_cvt_pk_bf16_f32 v81, v82, v83
    v_pk_add_f32 v[84:85], v[84:85], v[246:247] op_sel_hi:[1,0] neg_lo:[0,1] neg_hi:[0,1]
    v_pk_add_f32 v[86:87], v[86:87], v[246:247] op_sel_hi:[1,0] neg_lo:[0,1] neg_hi:[0,1]
    v_mfma_f32_16x16x32_bf16 v[220:223], v[232:235], v[64:67], v[220:223]
    v_exp_f32 v84, v84
    v_exp_f32 v85, v85
    v_exp_f32 v86, v86
    v_exp_f32 v87, v87
    v_cvt_pk_bf16_f32 v82, v84, v85
    v_cvt_pk_bf16_f32 v83, v86, v87
    ds_read_b128 v[160:163], v248 offset:38912
    ds_read_b128 v[164:167], v248 offset:39936
    s_waitcnt lgkmcnt(2)
    v_pk_add_f32 v[88:89], v[88:89], v[244:245] op_sel_hi:[1,0] neg_lo:[0,1] neg_hi:[0,1]
    v_pk_add_f32 v[90:91], v[90:91], v[244:245] op_sel_hi:[1,0] neg_lo:[0,1] neg_hi:[0,1]
    v_mfma_f32_16x16x32_bf16 v[200:203], v[152:155], v[72:75], v[200:203]
    v_exp_f32 v88, v88
    v_exp_f32 v89, v89
    v_mfma_f32_16x16x32_bf16 v[204:207], v[156:159], v[72:75], v[204:207]
    v_exp_f32 v90, v90
    v_exp_f32_e64 v91, v91
    v_cvt_pk_bf16_f32 v88, v88, v89
    v_cvt_pk_bf16_f32 v89, v90, v91
    v_pk_add_f32 v[92:93], v[92:93], v[244:245] op_sel_hi:[1,0] neg_lo:[0,1] neg_hi:[0,1]
    v_pk_add_f32 v[94:95], v[94:95], v[244:245] op_sel_hi:[1,0] neg_lo:[0,1] neg_hi:[0,1]
    v_mfma_f32_16x16x32_bf16 v[208:211], v[232:235], v[72:75], v[208:211]
    v_exp_f32 v92, v92
    v_exp_f32 v93, v93
    v_exp_f32 v94, v94
    v_exp_f32 v95, v95
    v_cvt_pk_bf16_f32 v90, v92, v93
    v_cvt_pk_bf16_f32 v91, v94, v95
    v_pk_add_f32 v[96:97], v[96:97], v[246:247] op_sel_hi:[1,0] neg_lo:[0,1] neg_hi:[0,1]
    v_pk_add_f32 v[98:99], v[98:99], v[246:247] op_sel_hi:[1,0] neg_lo:[0,1] neg_hi:[0,1]
    v_mfma_f32_16x16x32_bf16 v[212:215], v[152:155], v[80:83], v[212:215]
    v_exp_f32 v96, v96
    v_exp_f32 v97, v97
    v_mfma_f32_16x16x32_bf16 v[216:219], v[156:159], v[80:83], v[216:219]
    v_exp_f32 v98, v98
    v_exp_f32 v99, v99
    v_cvt_pk_bf16_f32 v96, v96, v97
    v_cvt_pk_bf16_f32 v97, v98, v99
    v_pk_add_f32 v[100:101], v[100:101], v[246:247] op_sel_hi:[1,0] neg_lo:[0,1] neg_hi:[0,1]
    v_pk_add_f32 v[102:103], v[102:103], v[246:247] op_sel_hi:[1,0] neg_lo:[0,1] neg_hi:[0,1]
    v_mfma_f32_16x16x32_bf16 v[220:223], v[232:235], v[80:83], v[220:223]
    v_exp_f32 v100, v100
    v_exp_f32 v101, v101
    v_exp_f32 v102, v102
    v_exp_f32 v103, v103
    v_cvt_pk_bf16_f32 v98, v100, v101
    v_cvt_pk_bf16_f32 v99, v102, v103
    s_waitcnt lgkmcnt(0)
    s_nop 1
    v_mfma_f32_16x16x32_bf16 v[200:203], v[160:163], v[88:91], v[200:203]
    v_mfma_f32_16x16x32_bf16 v[204:207], v[164:167], v[88:91], v[204:207]
    v_mfma_f32_16x16x32_bf16 v[208:211], v[232:235], v[88:91], v[208:211]
    v_mfma_f32_16x16x32_bf16 v[212:215], v[160:163], v[96:99], v[212:215]
    v_mfma_f32_16x16x32_bf16 v[216:219], v[164:167], v[96:99], v[216:219]
    v_mfma_f32_16x16x32_bf16 v[220:223], v[232:235], v[96:99], v[220:223]
    s_nop 6
    s_add_u32 s53, s68, 4096
    v_rcp_f32 v240, v208
    v_rcp_f32 v242, v220
    s_nop 0
    v_mul_f32 v200, v200, v240
    v_mul_f32 v201, v201, v240
    v_mul_f32 v202, v202, v240
    v_mul_f32 v203, v203, v240
    v_mul_f32 v204, v204, v240
    v_mul_f32 v205, v205, v240
    v_mul_f32 v206, v206, v240
    v_mul_f32 v207, v207, v240
    v_cvt_pk_bf16_f32 v144, v200, v201
    v_cvt_pk_bf16_f32 v145, v202, v203
    v_cvt_pk_bf16_f32 v146, v204, v205
    v_cvt_pk_bf16_f32 v147, v206, v207
    buffer_store_dwordx4 v[144:147], v2, s[24:27], s53 offen offset:0 sc1
    v_mul_f32 v212, v212, v242
    v_mul_f32 v213, v213, v242
    v_mul_f32 v214, v214, v242
    v_mul_f32 v215, v215, v242
    v_mul_f32 v216, v216, v242
    v_mul_f32 v217, v217, v242
    v_mul_f32 v218, v218, v242
    v_mul_f32 v219, v219, v242
    v_cvt_pk_bf16_f32 v148, v212, v213
    v_cvt_pk_bf16_f32 v149, v214, v215
    v_cvt_pk_bf16_f32 v150, v216, v217
    v_cvt_pk_bf16_f32 v151, v218, v219
    buffer_store_dwordx4 v[148:151], v2, s[24:27], s53 offen offset:1024 sc1
    s_branch sequential_preLN__sliding_block__dense_activation_gelu__prompt_kernel_attd60
sequential_preLN__sliding_block__dense_activation_gelu__prompt_kernel_bound71:
    v_mov_b32 v8, 0xf149f2ca
    v_mov_b32 v9, 0xf149f2ca
    v_mov_b32 v10, 0xf149f2ca
    v_mov_b32 v11, 0xf149f2ca
    v_mov_b32 v12, 0xf149f2ca
    v_mov_b32 v13, 0xf149f2ca
    v_mov_b32 v14, 0xf149f2ca
    v_mov_b32 v15, 0xf149f2ca
    v_mov_b32 v20, 0xf149f2ca
    v_mov_b32 v21, 0xf149f2ca
    v_mov_b32 v22, 0xf149f2ca
    v_mov_b32 v23, 0xf149f2ca
    v_mov_b32 v24, 0xf149f2ca
    v_mov_b32 v25, 0xf149f2ca
    v_mov_b32 v26, 0xf149f2ca
    v_mov_b32 v27, 0xf149f2ca
    v_mov_b32 v32, 0xf149f2ca
    v_mov_b32 v33, 0xf149f2ca
    v_mov_b32 v34, 0xf149f2ca
    v_mov_b32 v35, 0xf149f2ca
    v_mov_b32 v28, 0xf149f2ca
    v_mov_b32 v29, 0xf149f2ca
    v_mov_b32 v30, 0xf149f2ca
    v_mov_b32 v31, 0xf149f2ca
    v_mov_b32 v36, 0xf149f2ca
    v_mov_b32 v37, 0xf149f2ca
    v_mov_b32 v38, 0xf149f2ca
    v_mov_b32 v39, 0xf149f2ca
    v_mov_b32 v40, 0xf149f2ca
    v_mov_b32 v41, 0xf149f2ca
    v_mov_b32 v42, 0xf149f2ca
    v_mov_b32 v43, 0xf149f2ca
    v_mov_b32 v48, 0xf149f2ca
    v_mov_b32 v49, 0xf149f2ca
    v_mov_b32 v50, 0xf149f2ca
    v_mov_b32 v51, 0xf149f2ca
    v_mov_b32 v44, 0xf149f2ca
    v_mov_b32 v45, 0xf149f2ca
    v_mov_b32 v46, 0xf149f2ca
    v_mov_b32 v47, 0xf149f2ca
    v_mov_b32 v52, 0xf149f2ca
    v_mov_b32 v53, 0xf149f2ca
    v_mov_b32 v54, 0xf149f2ca
    v_mov_b32 v55, 0xf149f2ca
    s_cmp_eq_u32 s44, 1
    s_cbranch_scc1 sequential_preLN__sliding_block__dense_activation_gelu__prompt_kernel_remax77
    v_mov_b32 v56, 0xf149f2ca
    v_mov_b32 v57, 0xf149f2ca
    v_mov_b32 v58, 0xf149f2ca
    v_mov_b32 v59, 0xf149f2ca
    v_mov_b32 v64, 0xf149f2ca
    v_mov_b32 v65, 0xf149f2ca
    v_mov_b32 v66, 0xf149f2ca
    v_mov_b32 v67, 0xf149f2ca
    v_mov_b32 v60, 0xf149f2ca
    v_mov_b32 v61, 0xf149f2ca
    v_mov_b32 v62, 0xf149f2ca
    v_mov_b32 v63, 0xf149f2ca
    v_mov_b32 v68, 0xf149f2ca
    v_mov_b32 v69, 0xf149f2ca
    v_mov_b32 v70, 0xf149f2ca
    v_mov_b32 v71, 0xf149f2ca
    v_mov_b32 v72, 0xf149f2ca
    v_mov_b32 v73, 0xf149f2ca
    v_mov_b32 v74, 0xf149f2ca
    v_mov_b32 v75, 0xf149f2ca
    v_mov_b32 v80, 0xf149f2ca
    v_mov_b32 v81, 0xf149f2ca
    v_mov_b32 v82, 0xf149f2ca
    v_mov_b32 v83, 0xf149f2ca
    v_mov_b32 v76, 0xf149f2ca
    v_mov_b32 v77, 0xf149f2ca
    v_mov_b32 v78, 0xf149f2ca
    v_mov_b32 v79, 0xf149f2ca
    v_mov_b32 v84, 0xf149f2ca
    v_mov_b32 v85, 0xf149f2ca
    v_mov_b32 v86, 0xf149f2ca
    v_mov_b32 v87, 0xf149f2ca
    v_mov_b32 v88, 0xf149f2ca
    v_mov_b32 v89, 0xf149f2ca
    v_mov_b32 v90, 0xf149f2ca
    v_mov_b32 v91, 0xf149f2ca
    v_mov_b32 v96, 0xf149f2ca
    v_mov_b32 v97, 0xf149f2ca
    v_mov_b32 v98, 0xf149f2ca
    v_mov_b32 v99, 0xf149f2ca
    v_mov_b32 v92, 0xf149f2ca
    v_mov_b32 v93, 0xf149f2ca
    v_mov_b32 v94, 0xf149f2ca
    v_mov_b32 v95, 0xf149f2ca
    v_mov_b32 v100, 0xf149f2ca
    v_mov_b32 v101, 0xf149f2ca
    v_mov_b32 v102, 0xf149f2ca
    v_mov_b32 v103, 0xf149f2ca
    v_mov_b32 v104, 0xf149f2ca
    v_mov_b32 v105, 0xf149f2ca
    v_mov_b32 v106, 0xf149f2ca
    v_mov_b32 v107, 0xf149f2ca
    v_mov_b32 v112, 0xf149f2ca
    v_mov_b32 v113, 0xf149f2ca
    v_mov_b32 v114, 0xf149f2ca
    v_mov_b32 v115, 0xf149f2ca
    v_mov_b32 v108, 0xf149f2ca
    v_mov_b32 v109, 0xf149f2ca
    v_mov_b32 v110, 0xf149f2ca
    v_mov_b32 v111, 0xf149f2ca
    v_mov_b32 v116, 0xf149f2ca
    v_mov_b32 v117, 0xf149f2ca
    v_mov_b32 v118, 0xf149f2ca
    v_mov_b32 v119, 0xf149f2ca
sequential_preLN__sliding_block__dense_activation_gelu__prompt_kernel_remax77:
    v_max3_f32 v244, v8, v9, v10
    v_max_f32 v244, v244, v11
    v_max3_f32 v244, v244, v12, v13
    v_max3_f32 v244, v244, v14, v15
    v_max3_f32 v244, v244, v24, v25
    v_max3_f32 v244, v244, v26, v27
    v_max3_f32 v244, v244, v28, v29
    v_max3_f32 v244, v244, v30, v31
    v_max3_f32 v244, v244, v40, v41
    v_max3_f32 v244, v244, v42, v43
    v_max3_f32 v244, v244, v44, v45
    v_max3_f32 v244, v244, v46, v47
    v_max3_f32 v244, v244, v56, v57
    v_max3_f32 v244, v244, v58, v59
    v_max3_f32 v244, v244, v60, v61
    v_max3_f32 v244, v244, v62, v63
    v_max3_f32 v244, v244, v72, v73
    v_max3_f32 v244, v244, v74, v75
    v_max3_f32 v244, v244, v76, v77
    v_max3_f32 v244, v244, v78, v79
    v_max3_f32 v244, v244, v88, v89
    v_max3_f32 v244, v244, v90, v91
    v_max3_f32 v244, v244, v92, v93
    v_max3_f32 v244, v244, v94, v95
    v_max3_f32 v244, v244, v104, v105
    v_max3_f32 v244, v244, v106, v107
    v_max3_f32 v244, v244, v108, v109
    v_max3_f32 v244, v244, v110, v111
    v_max3_f32 v246, v20, v21, v22
    v_max_f32_e64 v246, v246, v23
    v_max3_f32 v246, v246, v32, v33
    v_max3_f32 v246, v246, v34, v35
    v_max3_f32 v246, v246, v36, v37
    v_max3_f32 v246, v246, v38, v39
    v_max3_f32 v246, v246, v48, v49
    v_max3_f32 v246, v246, v50, v51
    v_max3_f32 v246, v246, v52, v53
    v_max3_f32 v246, v246, v54, v55
    v_max3_f32 v246, v246, v64, v65
    v_max3_f32 v246, v246, v66, v67
    v_max3_f32 v246, v246, v68, v69
    v_max3_f32 v246, v246, v70, v71
    v_max3_f32 v246, v246, v80, v81
    v_max3_f32 v246, v246, v82, v83
    v_max3_f32 v246, v246, v84, v85
    v_max3_f32 v246, v246, v86, v87
    v_max3_f32 v246, v246, v96, v97
    v_max3_f32 v246, v246, v98, v99
    v_max3_f32 v246, v246, v100, v101
    v_max3_f32 v246, v246, v102, v103
    v_max3_f32 v246, v246, v112, v113
    v_max3_f32 v246, v246, v114, v115
    v_max3_f32 v246, v246, v116, v117
    v_max3_f32 v246, v246, v118, v119
    s_branch sequential_preLN__sliding_block__dense_activation_gelu__prompt_kernel_nobound72
sequential_preLN__sliding_block__dense_activation_gelu__prompt_kernel_vspin73:
    s_mov_b32 s61, 0
sequential_preLN__sliding_block__dense_activation_gelu__prompt_kernel_lw78:
    ds_read_b32 v4, v250
    s_waitcnt lgkmcnt(0)
    v_cmp_gt_u32 vcc, 1, v4
    s_cmp_eq_u64 vcc, 0
    s_cbranch_scc1 sequential_preLN__sliding_block__dense_activation_gelu__prompt_kernel_lwd79
    s_add_u32 s61, s61, 1
    s_cmp_lt_u32 s61, 262144
    s_cbranch_scc1 sequential_preLN__sliding_block__dense_activation_gelu__prompt_kernel_lw78
sequential_preLN__sliding_block__dense_activation_gelu__prompt_kernel_lwd79:
    s_branch sequential_preLN__sliding_block__dense_activation_gelu__prompt_kernel_vok74
sequential_preLN__sliding_block__dense_activation_gelu__prompt_kernel_bound75:
    v_mov_b32 v8, 0xf149f2ca
    v_mov_b32 v9, 0xf149f2ca
    v_mov_b32 v10, 0xf149f2ca
    v_mov_b32 v11, 0xf149f2ca
    v_mov_b32 v12, 0xf149f2ca
    v_mov_b32 v13, 0xf149f2ca
    v_mov_b32 v14, 0xf149f2ca
    v_mov_b32 v15, 0xf149f2ca
    v_mov_b32 v20, 0xf149f2ca
    v_mov_b32 v21, 0xf149f2ca
    v_mov_b32 v22, 0xf149f2ca
    v_mov_b32 v23, 0xf149f2ca
    v_mov_b32 v24, 0xf149f2ca
    v_mov_b32 v25, 0xf149f2ca
    v_mov_b32 v26, 0xf149f2ca
    v_mov_b32 v27, 0xf149f2ca
    v_mov_b32 v32, 0xf149f2ca
    v_mov_b32 v33, 0xf149f2ca
    v_mov_b32 v34, 0xf149f2ca
    v_mov_b32 v35, 0xf149f2ca
    v_mov_b32 v28, 0xf149f2ca
    v_mov_b32 v29, 0xf149f2ca
    v_mov_b32 v30, 0xf149f2ca
    v_mov_b32 v31, 0xf149f2ca
    v_mov_b32 v36, 0xf149f2ca
    v_mov_b32 v37, 0xf149f2ca
    v_mov_b32 v38, 0xf149f2ca
    v_mov_b32 v39, 0xf149f2ca
    s_cmp_eq_u32 s44, 1
    s_cbranch_scc1 sequential_preLN__sliding_block__dense_activation_gelu__prompt_kernel_remax80
    v_mov_b32 v40, 0xf149f2ca
    v_mov_b32 v41, 0xf149f2ca
    v_mov_b32 v42, 0xf149f2ca
    v_mov_b32 v43, 0xf149f2ca
    v_mov_b32 v48, 0xf149f2ca
    v_mov_b32 v49, 0xf149f2ca
    v_mov_b32 v50, 0xf149f2ca
    v_mov_b32 v51, 0xf149f2ca
    v_mov_b32 v44, 0xf149f2ca
    v_mov_b32 v45, 0xf149f2ca
    v_mov_b32 v46, 0xf149f2ca
    v_mov_b32 v47, 0xf149f2ca
    v_mov_b32 v52, 0xf149f2ca
    v_mov_b32 v53, 0xf149f2ca
    v_mov_b32 v54, 0xf149f2ca
    v_mov_b32 v55, 0xf149f2ca
    v_mov_b32 v56, 0xf149f2ca
    v_mov_b32 v57, 0xf149f2ca
    v_mov_b32 v58, 0xf149f2ca
    v_mov_b32 v59, 0xf149f2ca
    v_mov_b32 v64, 0xf149f2ca
    v_mov_b32 v65, 0xf149f2ca
    v_mov_b32 v66, 0xf149f2ca
    v_mov_b32 v67, 0xf149f2ca
    v_mov_b32 v60, 0xf149f2ca
    v_mov_b32 v61, 0xf149f2ca
    v_mov_b32 v62, 0xf149f2ca
    v_mov_b32 v63, 0xf149f2ca
    v_mov_b32 v68, 0xf149f2ca
    v_mov_b32 v69, 0xf149f2ca
    v_mov_b32 v70, 0xf149f2ca
    v_mov_b32 v71, 0xf149f2ca
    v_mov_b32 v72, 0xf149f2ca
    v_mov_b32 v73, 0xf149f2ca
    v_mov_b32 v74, 0xf149f2ca
    v_mov_b32 v75, 0xf149f2ca
    v_mov_b32 v80, 0xf149f2ca
    v_mov_b32 v81, 0xf149f2ca
    v_mov_b32 v82, 0xf149f2ca
    v_mov_b32 v83, 0xf149f2ca
    v_mov_b32 v76, 0xf149f2ca
    v_mov_b32 v77, 0xf149f2ca
    v_mov_b32 v78, 0xf149f2ca
    v_mov_b32 v79, 0xf149f2ca
    v_mov_b32 v84, 0xf149f2ca
    v_mov_b32 v85, 0xf149f2ca
    v_mov_b32 v86, 0xf149f2ca
    v_mov_b32 v87, 0xf149f2ca
    v_mov_b32 v88, 0xf149f2ca
    v_mov_b32 v89, 0xf149f2ca
    v_mov_b32 v90, 0xf149f2ca
    v_mov_b32 v91, 0xf149f2ca
    v_mov_b32 v96, 0xf149f2ca
    v_mov_b32 v97, 0xf149f2ca
    v_mov_b32 v98, 0xf149f2ca
    v_mov_b32 v99, 0xf149f2ca
    v_mov_b32 v92, 0xf149f2ca
    v_mov_b32 v93, 0xf149f2ca
    v_mov_b32 v94, 0xf149f2ca
    v_mov_b32 v95, 0xf149f2ca
    v_mov_b32 v100, 0xf149f2ca
    v_mov_b32 v101, 0xf149f2ca
    v_mov_b32 v102, 0xf149f2ca
    v_mov_b32 v103, 0xf149f2ca
sequential_preLN__sliding_block__dense_activation_gelu__prompt_kernel_remax80:
    v_max3_f32 v244, v8, v9, v10
    v_max_f32 v244, v244, v11
    v_max3_f32 v244, v244, v12, v13
    v_max3_f32 v244, v244, v14, v15
    v_max3_f32 v244, v244, v24, v25
    v_max3_f32 v244, v244, v26, v27
    v_max3_f32 v244, v244, v28, v29
    v_max3_f32 v244, v244, v30, v31
    v_max3_f32 v244, v244, v40, v41
    v_max3_f32 v244, v244, v42, v43
    v_max3_f32 v244, v244, v44, v45
    v_max3_f32 v244, v244, v46, v47
    v_max3_f32 v244, v244, v56, v57
    v_max3_f32 v244, v244, v58, v59
    v_max3_f32 v244, v244, v60, v61
    v_max3_f32 v244, v244, v62, v63
    v_max3_f32 v244, v244, v72, v73
    v_max3_f32 v244, v244, v74, v75
    v_max3_f32 v244, v244, v76, v77
    v_max3_f32 v244, v244, v78, v79
    v_max3_f32 v244, v244, v88, v89
    v_max3_f32 v244, v244, v90, v91
    v_max3_f32 v244, v244, v92, v93
    v_max3_f32 v244, v244, v94, v95
    v_max3_f32 v246, v20, v21, v22
    v_max_f32_e64 v246, v246, v23
    v_max3_f32 v246, v246, v32, v33
    v_max3_f32 v246, v246, v34, v35
    v_max3_f32 v246, v246, v36, v37
    v_max3_f32 v246, v246, v38, v39
    v_max3_f32 v246, v246, v48, v49
    v_max3_f32 v246, v246, v50, v51
    v_max3_f32 v246, v246, v52, v53
    v_max3_f32 v246, v246, v54, v55
    v_max3_f32 v246, v246, v64, v65
    v_max3_f32 v246, v246, v66, v67
    v_max3_f32 v246, v246, v68, v69
    v_max3_f32 v246, v246, v70, v71
    v_max3_f32 v246, v246, v80, v81
    v_max3_f32 v246, v246, v82, v83
    v_max3_f32 v246, v246, v84, v85
    v_max3_f32 v246, v246, v86, v87
    v_max3_f32 v246, v246, v96, v97
    v_max3_f32 v246, v246, v98, v99
    v_max3_f32 v246, v246, v100, v101
    v_max3_f32 v246, v246, v102, v103
    s_branch sequential_preLN__sliding_block__dense_activation_gelu__prompt_kernel_nobound76
sequential_preLN__sliding_block__dense_activation_gelu__prompt_kernel_attd60:
    s_waitcnt vmcnt(0)
    s_barrier
    v_and_b32 v3, 15, v1
    v_lshlrev_b32 v3, 11, v3
    v_lshrrev_b32 v4, 4, v1
    v_lshl_add_u32 v3, v4, 3, v3
    s_lshl_b32 s53, s44, 2
    s_add_u32 s53, s53, s47
    s_lshl_b32 s53, s53, 16
    s_lshl_b32 s55, s45, 7
    s_add_u32 s53, s53, s55
    buffer_load_dwordx2 v[40:41], v3, s[4:7], s53 offen offset:0
    buffer_load_dwordx2 v[44:45], v3, s[4:7], s53 offen offset:32
    buffer_load_dwordx2 v[48:49], v3, s[4:7], s53 offen offset:64
    buffer_load_dwordx2 v[52:53], v3, s[4:7], s53 offen offset:96
    s_add_u32 s53, s53, 0x8000
    buffer_load_dwordx2 v[42:43], v3, s[4:7], s53 offen offset:0
    buffer_load_dwordx2 v[46:47], v3, s[4:7], s53 offen offset:32
    buffer_load_dwordx2 v[50:51], v3, s[4:7], s53 offen offset:64
    buffer_load_dwordx2 v[54:55], v3, s[4:7], s53 offen offset:96
    s_lshl_b32 s53, s47, 11
    v_add_u32 v56, s53, v2
    v_add_u32 v57, 0x10000, v56
    v_bfe_u32 v3, v1, 3, 2
    v_xor_b32 v3, 0, v3
    v_lshlrev_b32 v3, 5, v3
    v_and_b32 v4, 3, v1
    v_lshl_add_u32 v3, v4, 3, v3
    v_lshrrev_b32 v4, 2, v1
    v_mul_u32_u24 v4, 128, v4
    v_add_u32 v58, v3, v4
    v_add_u32 v59, 0x10000, v58
    v_bfe_u32 v3, v1, 3, 2
    v_xor_b32 v3, 1, v3
    v_lshlrev_b32 v3, 5, v3
    v_and_b32 v4, 3, v1
    v_lshl_add_u32 v3, v4, 3, v3
    v_lshrrev_b32 v4, 2, v1
    v_mul_u32_u24 v4, 128, v4
    v_add_u32 v60, v3, v4
    v_add_u32 v61, 0x10000, v60
    v_bfe_u32 v3, v1, 3, 2
    v_xor_b32 v3, 2, v3
    v_lshlrev_b32 v3, 5, v3
    v_and_b32 v4, 3, v1
    v_lshl_add_u32 v3, v4, 3, v3
    v_lshrrev_b32 v4, 2, v1
    v_mul_u32_u24 v4, 128, v4
    v_add_u32 v62, v3, v4
    v_add_u32 v63, 0x10000, v62
    v_bfe_u32 v3, v1, 3, 2
    v_xor_b32 v3, 3, v3
    v_lshlrev_b32 v3, 5, v3
    v_and_b32 v4, 3, v1
    v_lshl_add_u32 v3, v4, 3, v3
    v_lshrrev_b32 v4, 2, v1
    v_mul_u32_u24 v4, 128, v4
    v_add_u32 v64, v3, v4
    v_add_u32 v65, 0x10000, v64
    s_lshl_b32 s68, s49, 14
    s_lshl_b32 s53, s47, 11
    s_add_u32 s68, s68, s53
    s_add_u32 s68, s68, 0xc00000
    s_add_u32 s69, s68, 8192
    v_and_b32 v66, 15, v1
    v_lshlrev_b32 v66, 3, v66
    v_lshrrev_b32 v4, 5, v1
    v_lshl_add_u32 v66, v4, 7, v66
    v_bfe_u32 v4, v1, 4, 1
    v_lshl_add_u32 v66, v4, 2, v66
    s_lshl_b32 s70, s49, 10
    s_lshl_b32 s54, s47, 8
    s_add_u32 s70, s70, s54
    s_add_u32 s70, s70, 0x2880000
    v_mov_b32 v67, 0x3f803f80
    s_waitcnt vmcnt(0)
    v_lshlrev_b32 v8, 16, v40
    v_and_b32 v9, 0xffff0000, v40
    v_lshlrev_b32 v10, 16, v41
    v_and_b32 v11, 0xffff0000, v41
    v_lshlrev_b32 v12, 16, v42
    v_and_b32 v13, 0xffff0000, v42
    v_lshlrev_b32 v14, 16, v43
    v_and_b32 v15, 0xffff0000, v43
    v_lshlrev_b32 v16, 16, v44
    v_and_b32 v17, 0xffff0000, v44
    v_lshlrev_b32 v18, 16, v45
    v_and_b32 v19, 0xffff0000, v45
    v_lshlrev_b32 v20, 16, v46
    v_and_b32 v21, 0xffff0000, v46
    v_lshlrev_b32 v22, 16, v47
    v_and_b32 v23, 0xffff0000, v47
    v_lshlrev_b32 v24, 16, v48
    v_and_b32 v25, 0xffff0000, v48
    v_lshlrev_b32 v26, 16, v49
    v_and_b32 v27, 0xffff0000, v49
    v_lshlrev_b32 v28, 16, v50
    v_and_b32 v29, 0xffff0000, v50
    v_lshlrev_b32 v30, 16, v51
    v_and_b32 v31, 0xffff0000, v51
    v_lshlrev_b32 v32, 16, v52
    v_and_b32 v33, 0xffff0000, v52
    v_lshlrev_b32 v34, 16, v53
    v_and_b32 v35, 0xffff0000, v53
    v_lshlrev_b32 v36, 16, v54
    v_and_b32 v37, 0xffff0000, v54
    v_lshlrev_b32 v38, 16, v55
    v_and_b32 v39, 0xffff0000, v55
    s_barrier
    s_barrier
    ds_read_b128 v[68:71], v56 offset:0
    ds_read_b64_tr_b16 v[100:101], v59 offset:49152
    ds_read_b64_tr_b16 v[102:103], v59 offset:51200
    ds_read_b128 v[72:75], v56 offset:1024
    ds_read_b64_tr_b16 v[104:105], v61 offset:49152
    ds_read_b64_tr_b16 v[106:107], v61 offset:51200
    ds_read_b64_tr_b16 v[108:109], v63 offset:49152
    ds_read_b64_tr_b16 v[110:111], v63 offset:51200
    ds_read_b64_tr_b16 v[112:113], v65 offset:49152
    ds_read_b64_tr_b16 v[114:115], v65 offset:51200
    ds_read_b128 v[76:79], v56 offset:8192
    ds_read_b64_tr_b16 v[116:117], v59 offset:53248
    ds_read_b64_tr_b16 v[118:119], v59 offset:55296
    ds_read_b128 v[80:83], v56 offset:9216
    ds_read_b64_tr_b16 v[120:121], v61 offset:53248
    ds_read_b64_tr_b16 v[122:123], v61 offset:55296
    ds_read_b64_tr_b16 v[124:125], v63 offset:53248
    ds_read_b64_tr_b16 v[126:127], v63 offset:55296
    ds_read_b64_tr_b16 v[128:129], v65 offset:53248
    ds_read_b64_tr_b16 v[130:131], v65 offset:55296
    s_waitcnt lgkmcnt(14)
    v_mfma_f32_16x16x32_bf16 v[8:11], v[100:103], v[68:71], v[8:11]
    v_mfma_f32_16x16x32_bf16 v[12:15], v[100:103], v[72:75], v[12:15]
    v_mfma_f32_16x16x32_bf16 v[20:23], v[104:107], v[72:75], v[20:23]
    v_mfma_f32_16x16x32_bf16 v[16:19], v[104:107], v[68:71], v[16:19]
    s_waitcnt lgkmcnt(0)
    s_barrier
    v_mfma_f32_16x16x32_bf16 v[24:27], v[108:111], v[68:71], v[24:27]
    ds_read_b128 v[84:87], v56 offset:16384
    ds_read_b64_tr_b16 v[132:133], v59 offset:57344
    v_mfma_f32_16x16x32_bf16 v[28:31], v[108:111], v[72:75], v[28:31]
    ds_read_b64_tr_b16 v[134:135], v59 offset:59392
    ds_read_b128 v[88:91], v56 offset:17408
    v_mfma_f32_16x16x32_bf16 v[36:39], v[112:115], v[72:75], v[36:39]
    ds_read_b64_tr_b16 v[136:137], v61 offset:57344
    ds_read_b64_tr_b16 v[138:139], v61 offset:59392
    v_mfma_f32_16x16x32_bf16 v[32:35], v[112:115], v[68:71], v[32:35]
    ds_read_b64_tr_b16 v[140:141], v63 offset:57344
    ds_read_b64_tr_b16 v[142:143], v63 offset:59392
    v_mfma_f32_16x16x32_bf16 v[8:11], v[116:119], v[76:79], v[8:11]
    ds_read_b64_tr_b16 v[144:145], v65 offset:57344
    ds_read_b64_tr_b16 v[146:147], v65 offset:59392
    v_mfma_f32_16x16x32_bf16 v[12:15], v[116:119], v[80:83], v[12:15]
    ds_read_b128 v[92:95], v56 offset:24576
    ds_read_b64_tr_b16 v[148:149], v59 offset:61440
    v_mfma_f32_16x16x32_bf16 v[20:23], v[120:123], v[80:83], v[20:23]
    ds_read_b64_tr_b16 v[150:151], v59 offset:63488
    ds_read_b128 v[96:99], v56 offset:25600
    v_mfma_f32_16x16x32_bf16 v[16:19], v[120:123], v[76:79], v[16:19]
    ds_read_b64_tr_b16 v[152:153], v61 offset:61440
    ds_read_b64_tr_b16 v[154:155], v61 offset:63488
    v_mfma_f32_16x16x32_bf16 v[24:27], v[124:127], v[76:79], v[24:27]
    ds_read_b64_tr_b16 v[156:157], v63 offset:61440
    ds_read_b64_tr_b16 v[158:159], v63 offset:63488
    v_mfma_f32_16x16x32_bf16 v[28:31], v[124:127], v[80:83], v[28:31]
    ds_read_b64_tr_b16 v[160:161], v65 offset:61440
    ds_read_b64_tr_b16 v[162:163], v65 offset:63488
    v_mfma_f32_16x16x32_bf16 v[36:39], v[128:131], v[80:83], v[36:39]
    v_mfma_f32_16x16x32_bf16 v[32:35], v[128:131], v[76:79], v[32:35]
    s_waitcnt lgkmcnt(14)
    v_mfma_f32_16x16x32_bf16 v[8:11], v[132:135], v[84:87], v[8:11]
    v_mfma_f32_16x16x32_bf16 v[12:15], v[132:135], v[88:91], v[12:15]
    v_mfma_f32_16x16x32_bf16 v[20:23], v[136:139], v[88:91], v[20:23]
    v_mfma_f32_16x16x32_bf16 v[16:19], v[136:139], v[84:87], v[16:19]
    s_waitcnt lgkmcnt(0)
    s_barrier
    v_mfma_f32_16x16x32_bf16 v[24:27], v[140:143], v[84:87], v[24:27]
    ds_read_b128 v[68:71], v56 offset:32768
    ds_read_b64_tr_b16 v[100:101], v59 offset:32768
    v_mfma_f32_16x16x32_bf16 v[28:31], v[140:143], v[88:91], v[28:31]
    ds_read_b64_tr_b16 v[102:103], v59 offset:34816
    ds_read_b128 v[72:75], v56 offset:33792
    v_mfma_f32_16x16x32_bf16 v[36:39], v[144:147], v[88:91], v[36:39]
    ds_read_b64_tr_b16 v[104:105], v61 offset:32768
    ds_read_b64_tr_b16 v[106:107], v61 offset:34816
    v_mfma_f32_16x16x32_bf16 v[32:35], v[144:147], v[84:87], v[32:35]
    ds_read_b64_tr_b16 v[108:109], v63 offset:32768
    ds_read_b64_tr_b16 v[110:111], v63 offset:34816
    v_mfma_f32_16x16x32_bf16 v[8:11], v[148:151], v[92:95], v[8:11]
    ds_read_b64_tr_b16 v[112:113], v65 offset:32768
    ds_read_b64_tr_b16 v[114:115], v65 offset:34816
    v_mfma_f32_16x16x32_bf16 v[12:15], v[148:151], v[96:99], v[12:15]
    ds_read_b128 v[76:79], v56 offset:40960
    ds_read_b64_tr_b16 v[116:117], v59 offset:36864
    v_mfma_f32_16x16x32_bf16 v[20:23], v[152:155], v[96:99], v[20:23]
    ds_read_b64_tr_b16 v[118:119], v59 offset:38912
    ds_read_b128 v[80:83], v56 offset:41984
    v_mfma_f32_16x16x32_bf16 v[16:19], v[152:155], v[92:95], v[16:19]
    ds_read_b64_tr_b16 v[120:121], v61 offset:36864
    ds_read_b64_tr_b16 v[122:123], v61 offset:38912
    v_mfma_f32_16x16x32_bf16 v[24:27], v[156:159], v[92:95], v[24:27]
    ds_read_b64_tr_b16 v[124:125], v63 offset:36864
    ds_read_b64_tr_b16 v[126:127], v63 offset:38912
    v_mfma_f32_16x16x32_bf16 v[28:31], v[156:159], v[96:99], v[28:31]
    ds_read_b64_tr_b16 v[128:129], v65 offset:36864
    ds_read_b64_tr_b16 v[130:131], v65 offset:38912
    v_mfma_f32_16x16x32_bf16 v[36:39], v[160:163], v[96:99], v[36:39]
    v_mfma_f32_16x16x32_bf16 v[32:35], v[160:163], v[92:95], v[32:35]
    s_waitcnt lgkmcnt(14)
    v_mfma_f32_16x16x32_bf16 v[8:11], v[100:103], v[68:71], v[8:11]
    v_mfma_f32_16x16x32_bf16 v[12:15], v[100:103], v[72:75], v[12:15]
    v_mfma_f32_16x16x32_bf16 v[20:23], v[104:107], v[72:75], v[20:23]
    v_mfma_f32_16x16x32_bf16 v[16:19], v[104:107], v[68:71], v[16:19]
    s_waitcnt lgkmcnt(0)
    s_barrier
    v_mfma_f32_16x16x32_bf16 v[24:27], v[108:111], v[68:71], v[24:27]
    ds_read_b128 v[84:87], v56 offset:49152
    ds_read_b64_tr_b16 v[132:133], v59 offset:40960
    v_mfma_f32_16x16x32_bf16 v[28:31], v[108:111], v[72:75], v[28:31]
    ds_read_b64_tr_b16 v[134:135], v59 offset:43008
    ds_read_b128 v[88:91], v56 offset:50176
    v_mfma_f32_16x16x32_bf16 v[36:39], v[112:115], v[72:75], v[36:39]
    ds_read_b64_tr_b16 v[136:137], v61 offset:40960
    ds_read_b64_tr_b16 v[138:139], v61 offset:43008
    v_mfma_f32_16x16x32_bf16 v[32:35], v[112:115], v[68:71], v[32:35]
    ds_read_b64_tr_b16 v[140:141], v63 offset:40960
    ds_read_b64_tr_b16 v[142:143], v63 offset:43008
    v_mfma_f32_16x16x32_bf16 v[8:11], v[116:119], v[76:79], v[8:11]
    ds_read_b64_tr_b16 v[144:145], v65 offset:40960
    ds_read_b64_tr_b16 v[146:147], v65 offset:43008
    v_mfma_f32_16x16x32_bf16 v[12:15], v[116:119], v[80:83], v[12:15]
    ds_read_b128 v[92:95], v56 offset:57344
    ds_read_b64_tr_b16 v[148:149], v59 offset:45056
    v_mfma_f32_16x16x32_bf16 v[20:23], v[120:123], v[80:83], v[20:23]
    ds_read_b64_tr_b16 v[150:151], v59 offset:47104
    ds_read_b128 v[96:99], v56 offset:58368
    v_mfma_f32_16x16x32_bf16 v[16:19], v[120:123], v[76:79], v[16:19]
    ds_read_b64_tr_b16 v[152:153], v61 offset:45056
    ds_read_b64_tr_b16 v[154:155], v61 offset:47104
    v_mfma_f32_16x16x32_bf16 v[24:27], v[124:127], v[76:79], v[24:27]
    ds_read_b64_tr_b16 v[156:157], v63 offset:45056
    ds_read_b64_tr_b16 v[158:159], v63 offset:47104
    v_mfma_f32_16x16x32_bf16 v[28:31], v[124:127], v[80:83], v[28:31]
    ds_read_b64_tr_b16 v[160:161], v65 offset:45056
    ds_read_b64_tr_b16 v[162:163], v65 offset:47104
    v_mfma_f32_16x16x32_bf16 v[36:39], v[128:131], v[80:83], v[36:39]
    v_mfma_f32_16x16x32_bf16 v[32:35], v[128:131], v[76:79], v[32:35]
    s_waitcnt lgkmcnt(14)
    v_mfma_f32_16x16x32_bf16 v[8:11], v[132:135], v[84:87], v[8:11]
    v_mfma_f32_16x16x32_bf16 v[12:15], v[132:135], v[88:91], v[12:15]
    v_mfma_f32_16x16x32_bf16 v[20:23], v[136:139], v[88:91], v[20:23]
    v_mfma_f32_16x16x32_bf16 v[16:19], v[136:139], v[84:87], v[16:19]
    s_waitcnt lgkmcnt(0)
    s_barrier
    v_mfma_f32_16x16x32_bf16 v[24:27], v[140:143], v[84:87], v[24:27]
    ds_read_b128 v[68:71], v57 offset:0
    ds_read_b64_tr_b16 v[100:101], v59 offset:16384
    v_mfma_f32_16x16x32_bf16 v[28:31], v[140:143], v[88:91], v[28:31]
    ds_read_b64_tr_b16 v[102:103], v59 offset:18432
    ds_read_b128 v[72:75], v57 offset:1024
    v_mfma_f32_16x16x32_bf16 v[36:39], v[144:147], v[88:91], v[36:39]
    ds_read_b64_tr_b16 v[104:105], v61 offset:16384
    ds_read_b64_tr_b16 v[106:107], v61 offset:18432
    v_mfma_f32_16x16x32_bf16 v[32:35], v[144:147], v[84:87], v[32:35]
    ds_read_b64_tr_b16 v[108:109], v63 offset:16384
    ds_read_b64_tr_b16 v[110:111], v63 offset:18432
    v_mfma_f32_16x16x32_bf16 v[8:11], v[148:151], v[92:95], v[8:11]
    ds_read_b64_tr_b16 v[112:113], v65 offset:16384
    ds_read_b64_tr_b16 v[114:115], v65 offset:18432
    v_mfma_f32_16x16x32_bf16 v[12:15], v[148:151], v[96:99], v[12:15]
    ds_read_b128 v[76:79], v57 offset:8192
    ds_read_b64_tr_b16 v[116:117], v59 offset:20480
    v_mfma_f32_16x16x32_bf16 v[20:23], v[152:155], v[96:99], v[20:23]
    ds_read_b64_tr_b16 v[118:119], v59 offset:22528
    ds_read_b128 v[80:83], v57 offset:9216
    v_mfma_f32_16x16x32_bf16 v[16:19], v[152:155], v[92:95], v[16:19]
    ds_read_b64_tr_b16 v[120:121], v61 offset:20480
    ds_read_b64_tr_b16 v[122:123], v61 offset:22528
    v_mfma_f32_16x16x32_bf16 v[24:27], v[156:159], v[92:95], v[24:27]
    ds_read_b64_tr_b16 v[124:125], v63 offset:20480
    ds_read_b64_tr_b16 v[126:127], v63 offset:22528
    v_mfma_f32_16x16x32_bf16 v[28:31], v[156:159], v[96:99], v[28:31]
    ds_read_b64_tr_b16 v[128:129], v65 offset:20480
    ds_read_b64_tr_b16 v[130:131], v65 offset:22528
    v_mfma_f32_16x16x32_bf16 v[36:39], v[160:163], v[96:99], v[36:39]
    v_mfma_f32_16x16x32_bf16 v[32:35], v[160:163], v[92:95], v[32:35]
    s_waitcnt lgkmcnt(14)
    v_mfma_f32_16x16x32_bf16 v[8:11], v[100:103], v[68:71], v[8:11]
    v_mfma_f32_16x16x32_bf16 v[12:15], v[100:103], v[72:75], v[12:15]
    v_mfma_f32_16x16x32_bf16 v[20:23], v[104:107], v[72:75], v[20:23]
    v_mfma_f32_16x16x32_bf16 v[16:19], v[104:107], v[68:71], v[16:19]
    s_waitcnt lgkmcnt(0)
    s_barrier
    v_mfma_f32_16x16x32_bf16 v[24:27], v[108:111], v[68:71], v[24:27]
    ds_read_b128 v[84:87], v56 offset:0
    ds_read_b64_tr_b16 v[132:133], v59 offset:24576
    v_mfma_f32_16x16x32_bf16 v[28:31], v[108:111], v[72:75], v[28:31]
    ds_read_b64_tr_b16 v[134:135], v59 offset:26624
    ds_read_b128 v[88:91], v56 offset:1024
    v_mfma_f32_16x16x32_bf16 v[36:39], v[112:115], v[72:75], v[36:39]
    ds_read_b64_tr_b16 v[136:137], v61 offset:24576
    ds_read_b64_tr_b16 v[138:139], v61 offset:26624
    v_mfma_f32_16x16x32_bf16 v[32:35], v[112:115], v[68:71], v[32:35]
    ds_read_b64_tr_b16 v[140:141], v63 offset:24576
    ds_read_b64_tr_b16 v[142:143], v63 offset:26624
    v_mfma_f32_16x16x32_bf16 v[8:11], v[116:119], v[76:79], v[8:11]
    ds_read_b64_tr_b16 v[144:145], v65 offset:24576
    ds_read_b64_tr_b16 v[146:147], v65 offset:26624
    v_mfma_f32_16x16x32_bf16 v[12:15], v[116:119], v[80:83], v[12:15]
    ds_read_b128 v[92:95], v56 offset:8192
    ds_read_b64_tr_b16 v[148:149], v59 offset:28672
    v_mfma_f32_16x16x32_bf16 v[20:23], v[120:123], v[80:83], v[20:23]
    ds_read_b64_tr_b16 v[150:151], v59 offset:30720
    ds_read_b128 v[96:99], v56 offset:9216
    v_mfma_f32_16x16x32_bf16 v[16:19], v[120:123], v[76:79], v[16:19]
    ds_read_b64_tr_b16 v[152:153], v61 offset:28672
    ds_read_b64_tr_b16 v[154:155], v61 offset:30720
    v_mfma_f32_16x16x32_bf16 v[24:27], v[124:127], v[76:79], v[24:27]
    ds_read_b64_tr_b16 v[156:157], v63 offset:28672
    ds_read_b64_tr_b16 v[158:159], v63 offset:30720
    v_mfma_f32_16x16x32_bf16 v[28:31], v[124:127], v[80:83], v[28:31]
    ds_read_b64_tr_b16 v[160:161], v65 offset:28672
    ds_read_b64_tr_b16 v[162:163], v65 offset:30720
    v_mfma_f32_16x16x32_bf16 v[36:39], v[128:131], v[80:83], v[36:39]
    v_mfma_f32_16x16x32_bf16 v[32:35], v[128:131], v[76:79], v[32:35]
    s_waitcnt lgkmcnt(14)
    v_mfma_f32_16x16x32_bf16 v[8:11], v[132:135], v[84:87], v[8:11]
    v_mfma_f32_16x16x32_bf16 v[12:15], v[132:135], v[88:91], v[12:15]
    v_mfma_f32_16x16x32_bf16 v[20:23], v[136:139], v[88:91], v[20:23]
    v_mfma_f32_16x16x32_bf16 v[16:19], v[136:139], v[84:87], v[16:19]
    s_waitcnt lgkmcnt(0)
    s_barrier
    v_mfma_f32_16x16x32_bf16 v[24:27], v[140:143], v[84:87], v[24:27]
    ds_read_b128 v[68:71], v56 offset:16384
    ds_read_b64_tr_b16 v[100:101], v59 offset:49152
    v_mfma_f32_16x16x32_bf16 v[28:31], v[140:143], v[88:91], v[28:31]
    ds_read_b64_tr_b16 v[102:103], v59 offset:51200
    ds_read_b128 v[72:75], v56 offset:17408
    v_mfma_f32_16x16x32_bf16 v[36:39], v[144:147], v[88:91], v[36:39]
    ds_read_b64_tr_b16 v[104:105], v61 offset:49152
    ds_read_b64_tr_b16 v[106:107], v61 offset:51200
    v_mfma_f32_16x16x32_bf16 v[32:35], v[144:147], v[84:87], v[32:35]
    ds_read_b64_tr_b16 v[108:109], v63 offset:49152
    ds_read_b64_tr_b16 v[110:111], v63 offset:51200
    v_mfma_f32_16x16x32_bf16 v[8:11], v[148:151], v[92:95], v[8:11]
    ds_read_b64_tr_b16 v[112:113], v65 offset:49152
    ds_read_b64_tr_b16 v[114:115], v65 offset:51200
    v_mfma_f32_16x16x32_bf16 v[12:15], v[148:151], v[96:99], v[12:15]
    ds_read_b128 v[76:79], v56 offset:24576
    ds_read_b64_tr_b16 v[116:117], v59 offset:53248
    v_mfma_f32_16x16x32_bf16 v[20:23], v[152:155], v[96:99], v[20:23]
    ds_read_b64_tr_b16 v[118:119], v59 offset:55296
    ds_read_b128 v[80:83], v56 offset:25600
    v_mfma_f32_16x16x32_bf16 v[16:19], v[152:155], v[92:95], v[16:19]
    ds_read_b64_tr_b16 v[120:121], v61 offset:53248
    ds_read_b64_tr_b16 v[122:123], v61 offset:55296
    v_mfma_f32_16x16x32_bf16 v[24:27], v[156:159], v[92:95], v[24:27]
    ds_read_b64_tr_b16 v[124:125], v63 offset:53248
    ds_read_b64_tr_b16 v[126:127], v63 offset:55296
    v_mfma_f32_16x16x32_bf16 v[28:31], v[156:159], v[96:99], v[28:31]
    ds_read_b64_tr_b16 v[128:129], v65 offset:53248
    ds_read_b64_tr_b16 v[130:131], v65 offset:55296
    v_mfma_f32_16x16x32_bf16 v[36:39], v[160:163], v[96:99], v[36:39]
    v_mfma_f32_16x16x32_bf16 v[32:35], v[160:163], v[92:95], v[32:35]
    s_waitcnt lgkmcnt(14)
    v_mfma_f32_16x16x32_bf16 v[8:11], v[100:103], v[68:71], v[8:11]
    v_mfma_f32_16x16x32_bf16 v[12:15], v[100:103], v[72:75], v[12:15]
    v_mfma_f32_16x16x32_bf16 v[20:23], v[104:107], v[72:75], v[20:23]
    v_mfma_f32_16x16x32_bf16 v[16:19], v[104:107], v[68:71], v[16:19]
    s_waitcnt lgkmcnt(0)
    s_barrier
    v_mfma_f32_16x16x32_bf16 v[24:27], v[108:111], v[68:71], v[24:27]
    ds_read_b128 v[84:87], v56 offset:32768
    ds_read_b64_tr_b16 v[132:133], v59 offset:57344
    v_mfma_f32_16x16x32_bf16 v[28:31], v[108:111], v[72:75], v[28:31]
    ds_read_b64_tr_b16 v[134:135], v59 offset:59392
    ds_read_b128 v[88:91], v56 offset:33792
    v_mfma_f32_16x16x32_bf16 v[36:39], v[112:115], v[72:75], v[36:39]
    ds_read_b64_tr_b16 v[136:137], v61 offset:57344
    ds_read_b64_tr_b16 v[138:139], v61 offset:59392
    v_mfma_f32_16x16x32_bf16 v[32:35], v[112:115], v[68:71], v[32:35]
    ds_read_b64_tr_b16 v[140:141], v63 offset:57344
    ds_read_b64_tr_b16 v[142:143], v63 offset:59392
    v_mfma_f32_16x16x32_bf16 v[8:11], v[116:119], v[76:79], v[8:11]
    ds_read_b64_tr_b16 v[144:145], v65 offset:57344
    ds_read_b64_tr_b16 v[146:147], v65 offset:59392
    v_mfma_f32_16x16x32_bf16 v[12:15], v[116:119], v[80:83], v[12:15]
    ds_read_b128 v[92:95], v56 offset:40960
    ds_read_b64_tr_b16 v[148:149], v59 offset:61440
    v_mfma_f32_16x16x32_bf16 v[20:23], v[120:123], v[80:83], v[20:23]
    ds_read_b64_tr_b16 v[150:151], v59 offset:63488
    ds_read_b128 v[96:99], v56 offset:41984
    v_mfma_f32_16x16x32_bf16 v[16:19], v[120:123], v[76:79], v[16:19]
    ds_read_b64_tr_b16 v[152:153], v61 offset:61440
    ds_read_b64_tr_b16 v[154:155], v61 offset:63488
    v_mfma_f32_16x16x32_bf16 v[24:27], v[124:127], v[76:79], v[24:27]
    ds_read_b64_tr_b16 v[156:157], v63 offset:61440
    ds_read_b64_tr_b16 v[158:159], v63 offset:63488
    v_mfma_f32_16x16x32_bf16 v[28:31], v[124:127], v[80:83], v[28:31]
    ds_read_b64_tr_b16 v[160:161], v65 offset:61440
    ds_read_b64_tr_b16 v[162:163], v65 offset:63488
    v_mfma_f32_16x16x32_bf16 v[36:39], v[128:131], v[80:83], v[36:39]
    v_mfma_f32_16x16x32_bf16 v[32:35], v[128:131], v[76:79], v[32:35]
    s_waitcnt lgkmcnt(14)
    v_mfma_f32_16x16x32_bf16 v[8:11], v[132:135], v[84:87], v[8:11]
    v_mfma_f32_16x16x32_bf16 v[12:15], v[132:135], v[88:91], v[12:15]
    v_mfma_f32_16x16x32_bf16 v[20:23], v[136:139], v[88:91], v[20:23]
    v_mfma_f32_16x16x32_bf16 v[16:19], v[136:139], v[84:87], v[16:19]
    s_waitcnt lgkmcnt(0)
    s_barrier
    v_mfma_f32_16x16x32_bf16 v[24:27], v[140:143], v[84:87], v[24:27]
    ds_read_b128 v[68:71], v56 offset:49152
    ds_read_b64_tr_b16 v[100:101], v59 offset:32768
    v_mfma_f32_16x16x32_bf16 v[28:31], v[140:143], v[88:91], v[28:31]
    ds_read_b64_tr_b16 v[102:103], v59 offset:34816
    ds_read_b128 v[72:75], v56 offset:50176
    v_mfma_f32_16x16x32_bf16 v[36:39], v[144:147], v[88:91], v[36:39]
    ds_read_b64_tr_b16 v[104:105], v61 offset:32768
    ds_read_b64_tr_b16 v[106:107], v61 offset:34816
    v_mfma_f32_16x16x32_bf16 v[32:35], v[144:147], v[84:87], v[32:35]
    ds_read_b64_tr_b16 v[108:109], v63 offset:32768
    ds_read_b64_tr_b16 v[110:111], v63 offset:34816
    v_mfma_f32_16x16x32_bf16 v[8:11], v[148:151], v[92:95], v[8:11]
    ds_read_b64_tr_b16 v[112:113], v65 offset:32768
    ds_read_b64_tr_b16 v[114:115], v65 offset:34816
    v_mfma_f32_16x16x32_bf16 v[12:15], v[148:151], v[96:99], v[12:15]
    ds_read_b128 v[76:79], v56 offset:57344
    ds_read_b64_tr_b16 v[116:117], v59 offset:36864
    v_mfma_f32_16x16x32_bf16 v[20:23], v[152:155], v[96:99], v[20:23]
    ds_read_b64_tr_b16 v[118:119], v59 offset:38912
    ds_read_b128 v[80:83], v56 offset:58368
    v_mfma_f32_16x16x32_bf16 v[16:19], v[152:155], v[92:95], v[16:19]
    ds_read_b64_tr_b16 v[120:121], v61 offset:36864
    ds_read_b64_tr_b16 v[122:123], v61 offset:38912
    v_mfma_f32_16x16x32_bf16 v[24:27], v[156:159], v[92:95], v[24:27]
    ds_read_b64_tr_b16 v[124:125], v63 offset:36864
    ds_read_b64_tr_b16 v[126:127], v63 offset:38912
    v_mfma_f32_16x16x32_bf16 v[28:31], v[156:159], v[96:99], v[28:31]
    ds_read_b64_tr_b16 v[128:129], v65 offset:36864
    ds_read_b64_tr_b16 v[130:131], v65 offset:38912
    v_mfma_f32_16x16x32_bf16 v[36:39], v[160:163], v[96:99], v[36:39]
    v_mfma_f32_16x16x32_bf16 v[32:35], v[160:163], v[92:95], v[32:35]
    s_waitcnt lgkmcnt(14)
    v_mfma_f32_16x16x32_bf16 v[8:11], v[100:103], v[68:71], v[8:11]
    v_mfma_f32_16x16x32_bf16 v[12:15], v[100:103], v[72:75], v[12:15]
    v_mfma_f32_16x16x32_bf16 v[20:23], v[104:107], v[72:75], v[20:23]
    v_mfma_f32_16x16x32_bf16 v[16:19], v[104:107], v[68:71], v[16:19]
    s_waitcnt lgkmcnt(0)
    s_barrier
    v_mfma_f32_16x16x32_bf16 v[24:27], v[108:111], v[68:71], v[24:27]
    ds_read_b128 v[84:87], v57 offset:0
    ds_read_b64_tr_b16 v[132:133], v59 offset:40960
    v_mfma_f32_16x16x32_bf16 v[28:31], v[108:111], v[72:75], v[28:31]
    ds_read_b64_tr_b16 v[134:135], v59 offset:43008
    ds_read_b128 v[88:91], v57 offset:1024
    v_mfma_f32_16x16x32_bf16 v[36:39], v[112:115], v[72:75], v[36:39]
    ds_read_b64_tr_b16 v[136:137], v61 offset:40960
    ds_read_b64_tr_b16 v[138:139], v61 offset:43008
    v_mfma_f32_16x16x32_bf16 v[32:35], v[112:115], v[68:71], v[32:35]
    ds_read_b64_tr_b16 v[140:141], v63 offset:40960
    ds_read_b64_tr_b16 v[142:143], v63 offset:43008
    v_mfma_f32_16x16x32_bf16 v[8:11], v[116:119], v[76:79], v[8:11]
    ds_read_b64_tr_b16 v[144:145], v65 offset:40960
    ds_read_b64_tr_b16 v[146:147], v65 offset:43008
    v_mfma_f32_16x16x32_bf16 v[12:15], v[116:119], v[80:83], v[12:15]
    ds_read_b128 v[92:95], v57 offset:8192
    ds_read_b64_tr_b16 v[148:149], v59 offset:45056
    v_mfma_f32_16x16x32_bf16 v[20:23], v[120:123], v[80:83], v[20:23]
    ds_read_b64_tr_b16 v[150:151], v59 offset:47104
    ds_read_b128 v[96:99], v57 offset:9216
    v_mfma_f32_16x16x32_bf16 v[16:19], v[120:123], v[76:79], v[16:19]
    ds_read_b64_tr_b16 v[152:153], v61 offset:45056
    ds_read_b64_tr_b16 v[154:155], v61 offset:47104
    v_mfma_f32_16x16x32_bf16 v[24:27], v[124:127], v[76:79], v[24:27]
    ds_read_b64_tr_b16 v[156:157], v63 offset:45056
    ds_read_b64_tr_b16 v[158:159], v63 offset:47104
    v_mfma_f32_16x16x32_bf16 v[28:31], v[124:127], v[80:83], v[28:31]
    ds_read_b64_tr_b16 v[160:161], v65 offset:45056
    ds_read_b64_tr_b16 v[162:163], v65 offset:47104
    v_mfma_f32_16x16x32_bf16 v[36:39], v[128:131], v[80:83], v[36:39]
    v_mfma_f32_16x16x32_bf16 v[32:35], v[128:131], v[76:79], v[32:35]
    s_waitcnt lgkmcnt(14)
    v_mfma_f32_16x16x32_bf16 v[8:11], v[132:135], v[84:87], v[8:11]
    v_mfma_f32_16x16x32_bf16 v[12:15], v[132:135], v[88:91], v[12:15]
    v_mfma_f32_16x16x32_bf16 v[20:23], v[136:139], v[88:91], v[20:23]
    v_mfma_f32_16x16x32_bf16 v[16:19], v[136:139], v[84:87], v[16:19]
    s_waitcnt lgkmcnt(0)
    s_barrier
    v_mfma_f32_16x16x32_bf16 v[24:27], v[140:143], v[84:87], v[24:27]
    ds_read_b128 v[68:71], v56 offset:0
    ds_read_b64_tr_b16 v[100:101], v59 offset:16384
    v_mfma_f32_16x16x32_bf16 v[28:31], v[140:143], v[88:91], v[28:31]
    ds_read_b64_tr_b16 v[102:103], v59 offset:18432
    ds_read_b128 v[72:75], v56 offset:1024
    v_mfma_f32_16x16x32_bf16 v[36:39], v[144:147], v[88:91], v[36:39]
    ds_read_b64_tr_b16 v[104:105], v61 offset:16384
    ds_read_b64_tr_b16 v[106:107], v61 offset:18432
    v_mfma_f32_16x16x32_bf16 v[32:35], v[144:147], v[84:87], v[32:35]
    ds_read_b64_tr_b16 v[108:109], v63 offset:16384
    ds_read_b64_tr_b16 v[110:111], v63 offset:18432
    v_mfma_f32_16x16x32_bf16 v[8:11], v[148:151], v[92:95], v[8:11]
    ds_read_b64_tr_b16 v[112:113], v65 offset:16384
    ds_read_b64_tr_b16 v[114:115], v65 offset:18432
    v_mfma_f32_16x16x32_bf16 v[12:15], v[148:151], v[96:99], v[12:15]
    ds_read_b128 v[76:79], v56 offset:8192
    ds_read_b64_tr_b16 v[116:117], v59 offset:20480
    v_mfma_f32_16x16x32_bf16 v[20:23], v[152:155], v[96:99], v[20:23]
    ds_read_b64_tr_b16 v[118:119], v59 offset:22528
    ds_read_b128 v[80:83], v56 offset:9216
    v_mfma_f32_16x16x32_bf16 v[16:19], v[152:155], v[92:95], v[16:19]
    ds_read_b64_tr_b16 v[120:121], v61 offset:20480
    ds_read_b64_tr_b16 v[122:123], v61 offset:22528
    v_mfma_f32_16x16x32_bf16 v[24:27], v[156:159], v[92:95], v[24:27]
    ds_read_b64_tr_b16 v[124:125], v63 offset:20480
    ds_read_b64_tr_b16 v[126:127], v63 offset:22528
    v_mfma_f32_16x16x32_bf16 v[28:31], v[156:159], v[96:99], v[28:31]
    ds_read_b64_tr_b16 v[128:129], v65 offset:20480
    ds_read_b64_tr_b16 v[130:131], v65 offset:22528
    v_mfma_f32_16x16x32_bf16 v[36:39], v[160:163], v[96:99], v[36:39]
    v_mfma_f32_16x16x32_bf16 v[32:35], v[160:163], v[92:95], v[32:35]
    s_waitcnt lgkmcnt(14)
    v_mfma_f32_16x16x32_bf16 v[8:11], v[100:103], v[68:71], v[8:11]
    v_mfma_f32_16x16x32_bf16 v[12:15], v[100:103], v[72:75], v[12:15]
    v_mfma_f32_16x16x32_bf16 v[20:23], v[104:107], v[72:75], v[20:23]
    v_mfma_f32_16x16x32_bf16 v[16:19], v[104:107], v[68:71], v[16:19]
    s_waitcnt lgkmcnt(0)
    s_barrier
    v_mfma_f32_16x16x32_bf16 v[24:27], v[108:111], v[68:71], v[24:27]
    ds_read_b128 v[84:87], v56 offset:16384
    ds_read_b64_tr_b16 v[132:133], v59 offset:24576
    v_mfma_f32_16x16x32_bf16 v[28:31], v[108:111], v[72:75], v[28:31]
    ds_read_b64_tr_b16 v[134:135], v59 offset:26624
    ds_read_b128 v[88:91], v56 offset:17408
    v_mfma_f32_16x16x32_bf16 v[36:39], v[112:115], v[72:75], v[36:39]
    ds_read_b64_tr_b16 v[136:137], v61 offset:24576
    ds_read_b64_tr_b16 v[138:139], v61 offset:26624
    v_mfma_f32_16x16x32_bf16 v[32:35], v[112:115], v[68:71], v[32:35]
    ds_read_b64_tr_b16 v[140:141], v63 offset:24576
    ds_read_b64_tr_b16 v[142:143], v63 offset:26624
    v_mfma_f32_16x16x32_bf16 v[8:11], v[116:119], v[76:79], v[8:11]
    ds_read_b64_tr_b16 v[144:145], v65 offset:24576
    ds_read_b64_tr_b16 v[146:147], v65 offset:26624
    v_mfma_f32_16x16x32_bf16 v[12:15], v[116:119], v[80:83], v[12:15]
    ds_read_b128 v[92:95], v56 offset:24576
    ds_read_b64_tr_b16 v[148:149], v59 offset:28672
    v_mfma_f32_16x16x32_bf16 v[20:23], v[120:123], v[80:83], v[20:23]
    ds_read_b64_tr_b16 v[150:151], v59 offset:30720
    ds_read_b128 v[96:99], v56 offset:25600
    v_mfma_f32_16x16x32_bf16 v[16:19], v[120:123], v[76:79], v[16:19]
    ds_read_b64_tr_b16 v[152:153], v61 offset:28672
    ds_read_b64_tr_b16 v[154:155], v61 offset:30720
    v_mfma_f32_16x16x32_bf16 v[24:27], v[124:127], v[76:79], v[24:27]
    ds_read_b64_tr_b16 v[156:157], v63 offset:28672
    ds_read_b64_tr_b16 v[158:159], v63 offset:30720
    v_mfma_f32_16x16x32_bf16 v[28:31], v[124:127], v[80:83], v[28:31]
    ds_read_b64_tr_b16 v[160:161], v65 offset:28672
    ds_read_b64_tr_b16 v[162:163], v65 offset:30720
    v_mfma_f32_16x16x32_bf16 v[36:39], v[128:131], v[80:83], v[36:39]
    v_mfma_f32_16x16x32_bf16 v[32:35], v[128:131], v[76:79], v[32:35]
    s_waitcnt lgkmcnt(14)
    v_mfma_f32_16x16x32_bf16 v[8:11], v[132:135], v[84:87], v[8:11]
    v_mfma_f32_16x16x32_bf16 v[12:15], v[132:135], v[88:91], v[12:15]
    v_mfma_f32_16x16x32_bf16 v[20:23], v[136:139], v[88:91], v[20:23]
    v_mfma_f32_16x16x32_bf16 v[16:19], v[136:139], v[84:87], v[16:19]
    s_waitcnt lgkmcnt(0)
    s_barrier
    v_mfma_f32_16x16x32_bf16 v[24:27], v[140:143], v[84:87], v[24:27]
    ds_read_b128 v[68:71], v56 offset:32768
    ds_read_b64_tr_b16 v[100:101], v59 offset:49152
    v_mfma_f32_16x16x32_bf16 v[28:31], v[140:143], v[88:91], v[28:31]
    ds_read_b64_tr_b16 v[102:103], v59 offset:51200
    ds_read_b128 v[72:75], v56 offset:33792
    v_mfma_f32_16x16x32_bf16 v[36:39], v[144:147], v[88:91], v[36:39]
    ds_read_b64_tr_b16 v[104:105], v61 offset:49152
    ds_read_b64_tr_b16 v[106:107], v61 offset:51200
    v_mfma_f32_16x16x32_bf16 v[32:35], v[144:147], v[84:87], v[32:35]
    ds_read_b64_tr_b16 v[108:109], v63 offset:49152
    ds_read_b64_tr_b16 v[110:111], v63 offset:51200
    v_mfma_f32_16x16x32_bf16 v[8:11], v[148:151], v[92:95], v[8:11]
    ds_read_b64_tr_b16 v[112:113], v65 offset:49152
    ds_read_b64_tr_b16 v[114:115], v65 offset:51200
    v_mfma_f32_16x16x32_bf16 v[12:15], v[148:151], v[96:99], v[12:15]
    ds_read_b128 v[76:79], v56 offset:40960
    ds_read_b64_tr_b16 v[116:117], v59 offset:53248
    v_mfma_f32_16x16x32_bf16 v[20:23], v[152:155], v[96:99], v[20:23]
    ds_read_b64_tr_b16 v[118:119], v59 offset:55296
    ds_read_b128 v[80:83], v56 offset:41984
    v_mfma_f32_16x16x32_bf16 v[16:19], v[152:155], v[92:95], v[16:19]
    ds_read_b64_tr_b16 v[120:121], v61 offset:53248
    ds_read_b64_tr_b16 v[122:123], v61 offset:55296
    v_mfma_f32_16x16x32_bf16 v[24:27], v[156:159], v[92:95], v[24:27]
    ds_read_b64_tr_b16 v[124:125], v63 offset:53248
    ds_read_b64_tr_b16 v[126:127], v63 offset:55296
    v_mfma_f32_16x16x32_bf16 v[28:31], v[156:159], v[96:99], v[28:31]
    ds_read_b64_tr_b16 v[128:129], v65 offset:53248
    ds_read_b64_tr_b16 v[130:131], v65 offset:55296
    v_mfma_f32_16x16x32_bf16 v[36:39], v[160:163], v[96:99], v[36:39]
    v_mfma_f32_16x16x32_bf16 v[32:35], v[160:163], v[92:95], v[32:35]
    s_waitcnt lgkmcnt(14)
    v_mfma_f32_16x16x32_bf16 v[8:11], v[100:103], v[68:71], v[8:11]
    v_mfma_f32_16x16x32_bf16 v[12:15], v[100:103], v[72:75], v[12:15]
    v_mfma_f32_16x16x32_bf16 v[20:23], v[104:107], v[72:75], v[20:23]
    v_mfma_f32_16x16x32_bf16 v[16:19], v[104:107], v[68:71], v[16:19]
    s_waitcnt lgkmcnt(0)
    s_barrier
    v_mfma_f32_16x16x32_bf16 v[24:27], v[108:111], v[68:71], v[24:27]
    ds_read_b128 v[84:87], v56 offset:49152
    ds_read_b64_tr_b16 v[132:133], v59 offset:57344
    v_mfma_f32_16x16x32_bf16 v[28:31], v[108:111], v[72:75], v[28:31]
    ds_read_b64_tr_b16 v[134:135], v59 offset:59392
    ds_read_b128 v[88:91], v56 offset:50176
    v_mfma_f32_16x16x32_bf16 v[36:39], v[112:115], v[72:75], v[36:39]
    ds_read_b64_tr_b16 v[136:137], v61 offset:57344
    ds_read_b64_tr_b16 v[138:139], v61 offset:59392
    v_mfma_f32_16x16x32_bf16 v[32:35], v[112:115], v[68:71], v[32:35]
    ds_read_b64_tr_b16 v[140:141], v63 offset:57344
    ds_read_b64_tr_b16 v[142:143], v63 offset:59392
    v_mfma_f32_16x16x32_bf16 v[8:11], v[116:119], v[76:79], v[8:11]
    ds_read_b64_tr_b16 v[144:145], v65 offset:57344
    ds_read_b64_tr_b16 v[146:147], v65 offset:59392
    v_mfma_f32_16x16x32_bf16 v[12:15], v[116:119], v[80:83], v[12:15]
    ds_read_b128 v[92:95], v56 offset:57344
    ds_read_b64_tr_b16 v[148:149], v59 offset:61440
    v_mfma_f32_16x16x32_bf16 v[20:23], v[120:123], v[80:83], v[20:23]
    ds_read_b64_tr_b16 v[150:151], v59 offset:63488
    ds_read_b128 v[96:99], v56 offset:58368
    v_mfma_f32_16x16x32_bf16 v[16:19], v[120:123], v[76:79], v[16:19]
    ds_read_b64_tr_b16 v[152:153], v61 offset:61440
    ds_read_b64_tr_b16 v[154:155], v61 offset:63488
    v_mfma_f32_16x16x32_bf16 v[24:27], v[124:127], v[76:79], v[24:27]
    ds_read_b64_tr_b16 v[156:157], v63 offset:61440
    ds_read_b64_tr_b16 v[158:159], v63 offset:63488
    v_mfma_f32_16x16x32_bf16 v[28:31], v[124:127], v[80:83], v[28:31]
    ds_read_b64_tr_b16 v[160:161], v65 offset:61440
    ds_read_b64_tr_b16 v[162:163], v65 offset:63488
    v_mfma_f32_16x16x32_bf16 v[36:39], v[128:131], v[80:83], v[36:39]
    v_mfma_f32_16x16x32_bf16 v[32:35], v[128:131], v[76:79], v[32:35]
    s_waitcnt lgkmcnt(14)
    v_mfma_f32_16x16x32_bf16 v[8:11], v[132:135], v[84:87], v[8:11]
    v_mfma_f32_16x16x32_bf16 v[12:15], v[132:135], v[88:91], v[12:15]
    v_mfma_f32_16x16x32_bf16 v[20:23], v[136:139], v[88:91], v[20:23]
    v_mfma_f32_16x16x32_bf16 v[16:19], v[136:139], v[84:87], v[16:19]
    s_waitcnt lgkmcnt(0)
    s_barrier
    v_mfma_f32_16x16x32_bf16 v[24:27], v[140:143], v[84:87], v[24:27]
    ds_read_b128 v[68:71], v57 offset:0
    ds_read_b64_tr_b16 v[100:101], v59 offset:32768
    v_mfma_f32_16x16x32_bf16 v[28:31], v[140:143], v[88:91], v[28:31]
    ds_read_b64_tr_b16 v[102:103], v59 offset:34816
    ds_read_b128 v[72:75], v57 offset:1024
    v_mfma_f32_16x16x32_bf16 v[36:39], v[144:147], v[88:91], v[36:39]
    ds_read_b64_tr_b16 v[104:105], v61 offset:32768
    ds_read_b64_tr_b16 v[106:107], v61 offset:34816
    v_mfma_f32_16x16x32_bf16 v[32:35], v[144:147], v[84:87], v[32:35]
    ds_read_b64_tr_b16 v[108:109], v63 offset:32768
    ds_read_b64_tr_b16 v[110:111], v63 offset:34816
    v_mfma_f32_16x16x32_bf16 v[8:11], v[148:151], v[92:95], v[8:11]
    ds_read_b64_tr_b16 v[112:113], v65 offset:32768
    ds_read_b64_tr_b16 v[114:115], v65 offset:34816
    v_mfma_f32_16x16x32_bf16 v[12:15], v[148:151], v[96:99], v[12:15]
    ds_read_b128 v[76:79], v57 offset:8192
    ds_read_b64_tr_b16 v[116:117], v59 offset:36864
    v_mfma_f32_16x16x32_bf16 v[20:23], v[152:155], v[96:99], v[20:23]
    ds_read_b64_tr_b16 v[118:119], v59 offset:38912
    ds_read_b128 v[80:83], v57 offset:9216
    v_mfma_f32_16x16x32_bf16 v[16:19], v[152:155], v[92:95], v[16:19]
    ds_read_b64_tr_b16 v[120:121], v61 offset:36864
    ds_read_b64_tr_b16 v[122:123], v61 offset:38912
    v_mfma_f32_16x16x32_bf16 v[24:27], v[156:159], v[92:95], v[24:27]
    ds_read_b64_tr_b16 v[124:125], v63 offset:36864
    ds_read_b64_tr_b16 v[126:127], v63 offset:38912
    v_mfma_f32_16x16x32_bf16 v[28:31], v[156:159], v[96:99], v[28:31]
    ds_read_b64_tr_b16 v[128:129], v65 offset:36864
    ds_read_b64_tr_b16 v[130:131], v65 offset:38912
    v_mfma_f32_16x16x32_bf16 v[36:39], v[160:163], v[96:99], v[36:39]
    v_mfma_f32_16x16x32_bf16 v[32:35], v[160:163], v[92:95], v[32:35]
    s_waitcnt lgkmcnt(14)
    v_mfma_f32_16x16x32_bf16 v[8:11], v[100:103], v[68:71], v[8:11]
    v_mfma_f32_16x16x32_bf16 v[12:15], v[100:103], v[72:75], v[12:15]
    v_mfma_f32_16x16x32_bf16 v[20:23], v[104:107], v[72:75], v[20:23]
    v_mfma_f32_16x16x32_bf16 v[16:19], v[104:107], v[68:71], v[16:19]
    s_waitcnt lgkmcnt(0)
    s_barrier
    v_mfma_f32_16x16x32_bf16 v[24:27], v[108:111], v[68:71], v[24:27]
    ds_read_b128 v[84:87], v56 offset:0
    ds_read_b64_tr_b16 v[132:133], v59 offset:40960
    v_mfma_f32_16x16x32_bf16 v[28:31], v[108:111], v[72:75], v[28:31]
    ds_read_b64_tr_b16 v[134:135], v59 offset:43008
    ds_read_b128 v[88:91], v56 offset:1024
    v_mfma_f32_16x16x32_bf16 v[36:39], v[112:115], v[72:75], v[36:39]
    ds_read_b64_tr_b16 v[136:137], v61 offset:40960
    ds_read_b64_tr_b16 v[138:139], v61 offset:43008
    v_mfma_f32_16x16x32_bf16 v[32:35], v[112:115], v[68:71], v[32:35]
    ds_read_b64_tr_b16 v[140:141], v63 offset:40960
    ds_read_b64_tr_b16 v[142:143], v63 offset:43008
    v_mfma_f32_16x16x32_bf16 v[8:11], v[116:119], v[76:79], v[8:11]
    ds_read_b64_tr_b16 v[144:145], v65 offset:40960
    ds_read_b64_tr_b16 v[146:147], v65 offset:43008
    v_mfma_f32_16x16x32_bf16 v[12:15], v[116:119], v[80:83], v[12:15]
    ds_read_b128 v[92:95], v56 offset:8192
    ds_read_b64_tr_b16 v[148:149], v59 offset:45056
    v_mfma_f32_16x16x32_bf16 v[20:23], v[120:123], v[80:83], v[20:23]
    ds_read_b64_tr_b16 v[150:151], v59 offset:47104
    ds_read_b128 v[96:99], v56 offset:9216
    v_mfma_f32_16x16x32_bf16 v[16:19], v[120:123], v[76:79], v[16:19]
    ds_read_b64_tr_b16 v[152:153], v61 offset:45056
    ds_read_b64_tr_b16 v[154:155], v61 offset:47104
    v_mfma_f32_16x16x32_bf16 v[24:27], v[124:127], v[76:79], v[24:27]
    ds_read_b64_tr_b16 v[156:157], v63 offset:45056
    ds_read_b64_tr_b16 v[158:159], v63 offset:47104
    v_mfma_f32_16x16x32_bf16 v[28:31], v[124:127], v[80:83], v[28:31]
    ds_read_b64_tr_b16 v[160:161], v65 offset:45056
    ds_read_b64_tr_b16 v[162:163], v65 offset:47104
    v_mfma_f32_16x16x32_bf16 v[36:39], v[128:131], v[80:83], v[36:39]
    v_mfma_f32_16x16x32_bf16 v[32:35], v[128:131], v[76:79], v[32:35]
    s_waitcnt lgkmcnt(14)
    v_mfma_f32_16x16x32_bf16 v[8:11], v[132:135], v[84:87], v[8:11]
    v_mfma_f32_16x16x32_bf16 v[12:15], v[132:135], v[88:91], v[12:15]
    v_mfma_f32_16x16x32_bf16 v[20:23], v[136:139], v[88:91], v[20:23]
    v_mfma_f32_16x16x32_bf16 v[16:19], v[136:139], v[84:87], v[16:19]
    s_waitcnt lgkmcnt(0)
    s_barrier
    v_mfma_f32_16x16x32_bf16 v[24:27], v[140:143], v[84:87], v[24:27]
    v_mfma_f32_16x16x32_bf16 v[28:31], v[140:143], v[88:91], v[28:31]
    v_mfma_f32_16x16x32_bf16 v[36:39], v[144:147], v[88:91], v[36:39]
    v_mfma_f32_16x16x32_bf16 v[32:35], v[144:147], v[84:87], v[32:35]
    v_mfma_f32_16x16x32_bf16 v[8:11], v[148:151], v[92:95], v[8:11]
    v_mfma_f32_16x16x32_bf16 v[12:15], v[148:151], v[96:99], v[12:15]
    v_mfma_f32_16x16x32_bf16 v[20:23], v[152:155], v[96:99], v[20:23]
    v_mfma_f32_16x16x32_bf16 v[16:19], v[152:155], v[92:95], v[16:19]
    v_mfma_f32_16x16x32_bf16 v[24:27], v[156:159], v[92:95], v[24:27]
    v_mfma_f32_16x16x32_bf16 v[28:31], v[156:159], v[96:99], v[28:31]
    v_mfma_f32_16x16x32_bf16 v[36:39], v[160:163], v[96:99], v[36:39]
    v_mfma_f32_16x16x32_bf16 v[32:35], v[160:163], v[92:95], v[32:35]
    s_nop 3
    v_cvt_pk_bf16_f32 v168, v8, v9
    v_cvt_pk_bf16_f32 v169, v10, v11
    v_cvt_pk_bf16_f32 v170, v16, v17
    v_cvt_pk_bf16_f32 v171, v18, v19
    buffer_store_dwordx4 v[168:171], v2, s[24:27], s68 offen offset:0 sc1
    ds_write_b128 v56, v[168:171] offset:0
    v_cvt_pk_bf16_f32 v172, v12, v13
    v_cvt_pk_bf16_f32 v173, v14, v15
    v_cvt_pk_bf16_f32 v174, v20, v21
    v_cvt_pk_bf16_f32 v175, v22, v23
    buffer_store_dwordx4 v[172:175], v2, s[24:27], s68 offen offset:1024 sc1
    ds_write_b128 v56, v[172:175] offset:1024
    v_cvt_pk_bf16_f32 v176, v24, v25
    v_cvt_pk_bf16_f32 v177, v26, v27
    v_cvt_pk_bf16_f32 v178, v32, v33
    v_cvt_pk_bf16_f32 v179, v34, v35
    buffer_store_dwordx4 v[176:179], v2, s[24:27], s69 offen offset:0 sc1
    ds_write_b128 v56, v[176:179] offset:8192
    v_cvt_pk_bf16_f32 v180, v28, v29
    v_cvt_pk_bf16_f32 v181, v30, v31
    v_cvt_pk_bf16_f32 v182, v36, v37
    v_cvt_pk_bf16_f32 v183, v38, v39
    buffer_store_dwordx4 v[180:183], v2, s[24:27], s69 offen offset:1024 sc1
    ds_write_b128 v56, v[180:183] offset:9216
    v_dot2_f32_bf16 v184, v168, v67, 0
    v_dot2_f32_bf16 v185, v168, v168, 0
    v_dot2_f32_bf16 v186, v172, v67, 0
    v_dot2_f32_bf16 v187, v172, v172, 0
    v_dot2_f32_bf16 v184, v169, v67, v184
    v_dot2_f32_bf16 v185, v169, v169, v185
    v_dot2_f32_bf16 v186, v173, v67, v186
    v_dot2_f32_bf16 v187, v173, v173, v187
    v_dot2_f32_bf16 v184, v170, v67, v184
    v_dot2_f32_bf16 v185, v170, v170, v185
    v_dot2_f32_bf16 v186, v174, v67, v186
    v_dot2_f32_bf16 v187, v174, v174, v187
    v_dot2_f32_bf16 v184, v171, v67, v184
    v_dot2_f32_bf16 v185, v171, v171, v185
    v_dot2_f32_bf16 v186, v175, v67, v186
    v_dot2_f32_bf16 v187, v175, v175, v187
    v_dot2_f32_bf16 v184, v176, v67, v184
    v_dot2_f32_bf16 v185, v176, v176, v185
    v_dot2_f32_bf16 v186, v180, v67, v186
    v_dot2_f32_bf16 v187, v180, v180, v187
    v_dot2_f32_bf16 v184, v177, v67, v184
    v_dot2_f32_bf16 v185, v177, v177, v185
    v_dot2_f32_bf16 v186, v181, v67, v186
    v_dot2_f32_bf16 v187, v181, v181, v187
    v_dot2_f32_bf16 v184, v178, v67, v184
    v_dot2_f32_bf16 v185, v178, v178, v185
    v_dot2_f32_bf16 v186, v182, v67, v186
    v_dot2_f32_bf16 v187, v182, v182, v187
    v_dot2_f32_bf16 v184, v179, v67, v184
    v_dot2_f32_bf16 v185, v179, v179, v185
    v_dot2_f32_bf16 v186, v183, v67, v186
    v_dot2_f32_bf16 v187, v183, v183, v187
    s_nop 2
    v_permlane32_swap_b32 v184, v186
    v_permlane32_swap_b32 v185, v187
    v_add_f32 v184, v184, v186
    v_add_f32 v185, v185, v187
    s_nop 1
    v_permlane16_swap_b32 v184, v185
    v_add_f32 v184, v184, v185
    buffer_store_dword v184, v66, s[24:27], s70 offen sc1
    s_waitcnt lgkmcnt(0)
    s_barrier
    s_lshl_b32 s53, s66, 12
    v_add_u32 v120, s53, v2
    s_lshl_b32 s53, s67, 3
    s_add_u32 s53, s53, 0
    v_bfe_u32 v3, v1, 4, 1
    v_xor_b32 v3, s53, v3
    v_lshlrev_b32 v3, 5, v3
    v_and_b32 v4, 3, v1
    v_lshl_add_u32 v3, v4, 3, v3
    v_lshrrev_b32 v4, 2, v1
    v_mul_u32_u24 v4, 448, v4
    v_add_u32 v121, v3, v4
    v_add_u32 v122, 0x10000, v121
    v_add_u32 v123, 0x20000, v121
    s_lshl_b32 s53, s67, 3
    s_add_u32 s53, s53, 1
    v_bfe_u32 v3, v1, 4, 1
    v_xor_b32 v3, s53, v3
    v_lshlrev_b32 v3, 5, v3
    v_and_b32 v4, 3, v1
    v_lshl_add_u32 v3, v4, 3, v3
    v_lshrrev_b32 v4, 2, v1
    v_mul_u32_u24 v4, 448, v4
    v_add_u32 v124, v3, v4
    v_add_u32 v125, 0x10000, v124
    v_add_u32 v126, 0x20000, v124
    s_add_u32 s53, s67, 6
    v_bfe_u32 v3, v1, 4, 1
    v_xor_b32 v3, s53, v3
    v_lshlrev_b32 v3, 5, v3
    v_and_b32 v4, 3, v1
    v_lshl_add_u32 v3, v4, 3, v3
    v_lshrrev_b32 v4, 2, v1
    v_mul_u32_u24 v4, 448, v4
    v_add_u32 v127, v3, v4
    v_add_u32 v128, 0x10000, v127
    v_add_u32 v129, 0x20000, v127
    ds_read_b128 v[132:135], v120 offset:0
    ds_read_b64_tr_b16 v[164:165], v123 offset:0
    ds_read_b64_tr_b16 v[166:167], v123 offset:7168
    ds_read_b128 v[136:139], v120 offset:1024
    ds_read_b128 v[140:143], v120 offset:2048
    ds_read_b128 v[144:147], v120 offset:3072
    ds_read_b64_tr_b16 v[168:169], v126 offset:0
    ds_read_b64_tr_b16 v[170:171], v126 offset:7168
    ds_read_b64_tr_b16 v[172:173], v123 offset:64
    ds_read_b64_tr_b16 v[174:175], v123 offset:7232
    ds_read_b64_tr_b16 v[176:177], v126 offset:64
    ds_read_b64_tr_b16 v[178:179], v126 offset:7232
    ds_read_b64_tr_b16 v[180:181], v123 offset:128
    ds_read_b64_tr_b16 v[182:183], v123 offset:7296
    ds_read_b64_tr_b16 v[184:185], v126 offset:128
    ds_read_b64_tr_b16 v[186:187], v126 offset:7296
    ds_read_b64_tr_b16 v[188:189], v129 offset:0
    ds_read_b64_tr_b16 v[190:191], v129 offset:7168
    s_waitcnt lgkmcnt(10)
    v_mfma_f32_16x16x32_bf16 v[8:11], v[164:167], v[132:135], 0
    ds_read_b128 v[148:151], v120 offset:8192
    v_mfma_f32_16x16x32_bf16 v[12:15], v[164:167], v[136:139], 0
    ds_read_b64_tr_b16 v[192:193], v123 offset:14336
    v_mfma_f32_16x16x32_bf16 v[16:19], v[164:167], v[140:143], 0
    ds_read_b64_tr_b16 v[194:195], v123 offset:21504
    v_mfma_f32_16x16x32_bf16 v[20:23], v[164:167], v[144:147], 0
    ds_read_b128 v[152:155], v120 offset:9216
    v_mfma_f32_16x16x32_bf16 v[36:39], v[168:171], v[144:147], 0
    ds_read_b128 v[156:159], v120 offset:10240
    v_mfma_f32_16x16x32_bf16 v[32:35], v[168:171], v[140:143], 0
    ds_read_b128 v[160:163], v120 offset:11264
    v_mfma_f32_16x16x32_bf16 v[28:31], v[168:171], v[136:139], 0
    ds_read_b64_tr_b16 v[196:197], v126 offset:14336
    v_mfma_f32_16x16x32_bf16 v[24:27], v[168:171], v[132:135], 0
    ds_read_b64_tr_b16 v[198:199], v126 offset:21504
    s_waitcnt lgkmcnt(14)
    v_mfma_f32_16x16x32_bf16 v[40:43], v[172:175], v[132:135], 0
    ds_read_b64_tr_b16 v[200:201], v123 offset:14400
    v_mfma_f32_16x16x32_bf16 v[44:47], v[172:175], v[136:139], 0
    ds_read_b64_tr_b16 v[202:203], v123 offset:21568
    v_mfma_f32_16x16x32_bf16 v[48:51], v[172:175], v[140:143], 0
    ds_read_b64_tr_b16 v[204:205], v126 offset:14400
    v_mfma_f32_16x16x32_bf16 v[52:55], v[172:175], v[144:147], 0
    ds_read_b64_tr_b16 v[206:207], v126 offset:21568
    v_mfma_f32_16x16x32_bf16 v[68:71], v[176:179], v[144:147], 0
    ds_read_b64_tr_b16 v[208:209], v123 offset:14464
    v_mfma_f32_16x16x32_bf16 v[64:67], v[176:179], v[140:143], 0
    ds_read_b64_tr_b16 v[210:211], v123 offset:21632
    v_mfma_f32_16x16x32_bf16 v[60:63], v[176:179], v[136:139], 0
    ds_read_b64_tr_b16 v[212:213], v126 offset:14464
    v_mfma_f32_16x16x32_bf16 v[56:59], v[176:179], v[132:135], 0
    ds_read_b64_tr_b16 v[214:215], v126 offset:21632
    s_waitcnt lgkmcnt(15)
    v_mfma_f32_16x16x32_bf16 v[72:75], v[180:183], v[132:135], 0
    ds_read_b64_tr_b16 v[216:217], v129 offset:14336
    v_mfma_f32_16x16x32_bf16 v[76:79], v[180:183], v[136:139], 0
    ds_read_b64_tr_b16 v[218:219], v129 offset:21504
    v_mfma_f32_16x16x32_bf16 v[80:83], v[180:183], v[140:143], 0
    v_mfma_f32_16x16x32_bf16 v[84:87], v[180:183], v[144:147], 0
    v_mfma_f32_16x16x32_bf16 v[100:103], v[184:187], v[144:147], 0
    v_mfma_f32_16x16x32_bf16 v[96:99], v[184:187], v[140:143], 0
    v_mfma_f32_16x16x32_bf16 v[92:95], v[184:187], v[136:139], 0
    v_mfma_f32_16x16x32_bf16 v[88:91], v[184:187], v[132:135], 0
    v_mfma_f32_16x16x32_bf16 v[104:107], v[188:191], v[132:135], 0
    v_mfma_f32_16x16x32_bf16 v[108:111], v[188:191], v[136:139], 0
    v_mfma_f32_16x16x32_bf16 v[112:115], v[188:191], v[140:143], 0
    v_mfma_f32_16x16x32_bf16 v[116:119], v[188:191], v[144:147], 0
    s_waitcnt lgkmcnt(0)
    s_waitcnt vmcnt(0)
    s_barrier
    v_mfma_f32_16x16x32_bf16 v[8:11], v[192:195], v[148:151], v[8:11]
    v_mfma_f32_16x16x32_bf16 v[12:15], v[192:195], v[152:155], v[12:15]
    v_mfma_f32_16x16x32_bf16 v[16:19], v[192:195], v[156:159], v[16:19]
    v_mfma_f32_16x16x32_bf16 v[20:23], v[192:195], v[160:163], v[20:23]
    v_mfma_f32_16x16x32_bf16 v[36:39], v[196:199], v[160:163], v[36:39]
    v_mfma_f32_16x16x32_bf16 v[32:35], v[196:199], v[156:159], v[32:35]
    v_mfma_f32_16x16x32_bf16 v[28:31], v[196:199], v[152:155], v[28:31]
    v_mfma_f32_16x16x32_bf16 v[24:27], v[196:199], v[148:151], v[24:27]
    v_mfma_f32_16x16x32_bf16 v[40:43], v[200:203], v[148:151], v[40:43]
    v_mfma_f32_16x16x32_bf16 v[44:47], v[200:203], v[152:155], v[44:47]
    v_mfma_f32_16x16x32_bf16 v[48:51], v[200:203], v[156:159], v[48:51]
    v_mfma_f32_16x16x32_bf16 v[52:55], v[200:203], v[160:163], v[52:55]
    v_mfma_f32_16x16x32_bf16 v[68:71], v[204:207], v[160:163], v[68:71]
    v_mfma_f32_16x16x32_bf16 v[64:67], v[204:207], v[156:159], v[64:67]
    v_mfma_f32_16x16x32_bf16 v[60:63], v[204:207], v[152:155], v[60:63]
    v_mfma_f32_16x16x32_bf16 v[56:59], v[204:207], v[148:151], v[56:59]
    v_mfma_f32_16x16x32_bf16 v[72:75], v[208:211], v[148:151], v[72:75]
    v_mfma_f32_16x16x32_bf16 v[76:79], v[208:211], v[152:155], v[76:79]
    v_mfma_f32_16x16x32_bf16 v[80:83], v[208:211], v[156:159], v[80:83]
    v_mfma_f32_16x16x32_bf16 v[84:87], v[208:211], v[160:163], v[84:87]
    v_mfma_f32_16x16x32_bf16 v[100:103], v[212:215], v[160:163], v[100:103]
    v_mfma_f32_16x16x32_bf16 v[96:99], v[212:215], v[156:159], v[96:99]
    v_mfma_f32_16x16x32_bf16 v[92:95], v[212:215], v[152:155], v[92:95]
    v_mfma_f32_16x16x32_bf16 v[88:91], v[212:215], v[148:151], v[88:91]
    v_mfma_f32_16x16x32_bf16 v[104:107], v[216:219], v[148:151], v[104:107]
    v_mfma_f32_16x16x32_bf16 v[108:111], v[216:219], v[152:155], v[108:111]
    v_mfma_f32_16x16x32_bf16 v[112:115], v[216:219], v[156:159], v[112:115]
    v_mfma_f32_16x16x32_bf16 v[116:119], v[216:219], v[160:163], v[116:119]
    s_barrier
    s_barrier
    s_waitcnt lgkmcnt(0)
    ds_read_b128 v[132:135], v120 offset:16384
    ds_read_b64_tr_b16 v[164:165], v122 offset:0
    ds_read_b64_tr_b16 v[166:167], v122 offset:7168
    ds_read_b128 v[136:139], v120 offset:17408
    ds_read_b128 v[140:143], v120 offset:18432
    ds_read_b128 v[144:147], v120 offset:19456
    ds_read_b64_tr_b16 v[168:169], v125 offset:0
    ds_read_b64_tr_b16 v[170:171], v125 offset:7168
    ds_read_b64_tr_b16 v[172:173], v122 offset:64
    ds_read_b64_tr_b16 v[174:175], v122 offset:7232
    ds_read_b64_tr_b16 v[176:177], v125 offset:64
    ds_read_b64_tr_b16 v[178:179], v125 offset:7232
    ds_read_b64_tr_b16 v[180:181], v122 offset:128
    ds_read_b64_tr_b16 v[182:183], v122 offset:7296
    ds_read_b64_tr_b16 v[184:185], v125 offset:128
    ds_read_b64_tr_b16 v[186:187], v125 offset:7296
    ds_read_b64_tr_b16 v[188:189], v128 offset:0
    ds_read_b64_tr_b16 v[190:191], v128 offset:7168
    s_waitcnt lgkmcnt(10)
    v_mfma_f32_16x16x32_bf16 v[8:11], v[164:167], v[132:135], v[8:11]
    ds_read_b128 v[148:151], v120 offset:24576
    v_mfma_f32_16x16x32_bf16 v[12:15], v[164:167], v[136:139], v[12:15]
    ds_read_b64_tr_b16 v[192:193], v122 offset:14336
    v_mfma_f32_16x16x32_bf16 v[16:19], v[164:167], v[140:143], v[16:19]
    ds_read_b64_tr_b16 v[194:195], v122 offset:21504
    v_mfma_f32_16x16x32_bf16 v[20:23], v[164:167], v[144:147], v[20:23]
    ds_read_b128 v[152:155], v120 offset:25600
    v_mfma_f32_16x16x32_bf16 v[36:39], v[168:171], v[144:147], v[36:39]
    ds_read_b128 v[156:159], v120 offset:26624
    v_mfma_f32_16x16x32_bf16 v[32:35], v[168:171], v[140:143], v[32:35]
    ds_read_b128 v[160:163], v120 offset:27648
    v_mfma_f32_16x16x32_bf16 v[28:31], v[168:171], v[136:139], v[28:31]
    ds_read_b64_tr_b16 v[196:197], v125 offset:14336
    v_mfma_f32_16x16x32_bf16 v[24:27], v[168:171], v[132:135], v[24:27]
    ds_read_b64_tr_b16 v[198:199], v125 offset:21504
    s_waitcnt lgkmcnt(14)
    v_mfma_f32_16x16x32_bf16 v[40:43], v[172:175], v[132:135], v[40:43]
    ds_read_b64_tr_b16 v[200:201], v122 offset:14400
    v_mfma_f32_16x16x32_bf16 v[44:47], v[172:175], v[136:139], v[44:47]
    ds_read_b64_tr_b16 v[202:203], v122 offset:21568
    v_mfma_f32_16x16x32_bf16 v[48:51], v[172:175], v[140:143], v[48:51]
    ds_read_b64_tr_b16 v[204:205], v125 offset:14400
    v_mfma_f32_16x16x32_bf16 v[52:55], v[172:175], v[144:147], v[52:55]
    ds_read_b64_tr_b16 v[206:207], v125 offset:21568
    v_mfma_f32_16x16x32_bf16 v[68:71], v[176:179], v[144:147], v[68:71]
    ds_read_b64_tr_b16 v[208:209], v122 offset:14464
    v_mfma_f32_16x16x32_bf16 v[64:67], v[176:179], v[140:143], v[64:67]
    ds_read_b64_tr_b16 v[210:211], v122 offset:21632
    v_mfma_f32_16x16x32_bf16 v[60:63], v[176:179], v[136:139], v[60:63]
    ds_read_b64_tr_b16 v[212:213], v125 offset:14464
    v_mfma_f32_16x16x32_bf16 v[56:59], v[176:179], v[132:135], v[56:59]
    ds_read_b64_tr_b16 v[214:215], v125 offset:21632
    s_waitcnt lgkmcnt(15)
    v_mfma_f32_16x16x32_bf16 v[72:75], v[180:183], v[132:135], v[72:75]
    ds_read_b64_tr_b16 v[216:217], v128 offset:14336
    v_mfma_f32_16x16x32_bf16 v[76:79], v[180:183], v[136:139], v[76:79]
    ds_read_b64_tr_b16 v[218:219], v128 offset:21504
    v_mfma_f32_16x16x32_bf16 v[80:83], v[180:183], v[140:143], v[80:83]
    v_mfma_f32_16x16x32_bf16 v[84:87], v[180:183], v[144:147], v[84:87]
    v_mfma_f32_16x16x32_bf16 v[100:103], v[184:187], v[144:147], v[100:103]
    v_mfma_f32_16x16x32_bf16 v[96:99], v[184:187], v[140:143], v[96:99]
    v_mfma_f32_16x16x32_bf16 v[92:95], v[184:187], v[136:139], v[92:95]
    v_mfma_f32_16x16x32_bf16 v[88:91], v[184:187], v[132:135], v[88:91]
    v_mfma_f32_16x16x32_bf16 v[104:107], v[188:191], v[132:135], v[104:107]
    v_mfma_f32_16x16x32_bf16 v[108:111], v[188:191], v[136:139], v[108:111]
    v_mfma_f32_16x16x32_bf16 v[112:115], v[188:191], v[140:143], v[112:115]
    v_mfma_f32_16x16x32_bf16 v[116:119], v[188:191], v[144:147], v[116:119]
    s_waitcnt lgkmcnt(10)
    v_mfma_f32_16x16x32_bf16 v[8:11], v[192:195], v[148:151], v[8:11]
    v_mfma_f32_16x16x32_bf16 v[12:15], v[192:195], v[152:155], v[12:15]
    v_mfma_f32_16x16x32_bf16 v[16:19], v[192:195], v[156:159], v[16:19]
    v_mfma_f32_16x16x32_bf16 v[20:23], v[192:195], v[160:163], v[20:23]
    s_waitcnt lgkmcnt(0)
    s_barrier
    v_mfma_f32_16x16x32_bf16 v[36:39], v[196:199], v[160:163], v[36:39]
    ds_read_b128 v[132:135], v120 offset:32768
    v_mfma_f32_16x16x32_bf16 v[32:35], v[196:199], v[156:159], v[32:35]
    ds_read_b64_tr_b16 v[164:165], v122 offset:28672
    v_mfma_f32_16x16x32_bf16 v[28:31], v[196:199], v[152:155], v[28:31]
    ds_read_b64_tr_b16 v[166:167], v122 offset:35840
    v_mfma_f32_16x16x32_bf16 v[24:27], v[196:199], v[148:151], v[24:27]
    ds_read_b128 v[136:139], v120 offset:33792
    v_mfma_f32_16x16x32_bf16 v[40:43], v[200:203], v[148:151], v[40:43]
    ds_read_b128 v[140:143], v120 offset:34816
    v_mfma_f32_16x16x32_bf16 v[44:47], v[200:203], v[152:155], v[44:47]
    ds_read_b128 v[144:147], v120 offset:35840
    v_mfma_f32_16x16x32_bf16 v[48:51], v[200:203], v[156:159], v[48:51]
    ds_read_b64_tr_b16 v[168:169], v125 offset:28672
    v_mfma_f32_16x16x32_bf16 v[52:55], v[200:203], v[160:163], v[52:55]
    ds_read_b64_tr_b16 v[170:171], v125 offset:35840
    v_mfma_f32_16x16x32_bf16 v[68:71], v[204:207], v[160:163], v[68:71]
    ds_read_b64_tr_b16 v[172:173], v122 offset:28736
    v_mfma_f32_16x16x32_bf16 v[64:67], v[204:207], v[156:159], v[64:67]
    ds_read_b64_tr_b16 v[174:175], v122 offset:35904
    v_mfma_f32_16x16x32_bf16 v[60:63], v[204:207], v[152:155], v[60:63]
    ds_read_b64_tr_b16 v[176:177], v125 offset:28736
    v_mfma_f32_16x16x32_bf16 v[56:59], v[204:207], v[148:151], v[56:59]
    ds_read_b64_tr_b16 v[178:179], v125 offset:35904
    v_mfma_f32_16x16x32_bf16 v[72:75], v[208:211], v[148:151], v[72:75]
    ds_read_b64_tr_b16 v[180:181], v122 offset:28800
    v_mfma_f32_16x16x32_bf16 v[76:79], v[208:211], v[152:155], v[76:79]
    ds_read_b64_tr_b16 v[182:183], v122 offset:35968
    v_mfma_f32_16x16x32_bf16 v[80:83], v[208:211], v[156:159], v[80:83]
    ds_read_b64_tr_b16 v[184:185], v125 offset:28800
    v_mfma_f32_16x16x32_bf16 v[84:87], v[208:211], v[160:163], v[84:87]
    ds_read_b64_tr_b16 v[186:187], v125 offset:35968
    v_mfma_f32_16x16x32_bf16 v[100:103], v[212:215], v[160:163], v[100:103]
    ds_read_b64_tr_b16 v[188:189], v128 offset:28672
    v_mfma_f32_16x16x32_bf16 v[96:99], v[212:215], v[156:159], v[96:99]
    ds_read_b64_tr_b16 v[190:191], v128 offset:35840
    v_mfma_f32_16x16x32_bf16 v[92:95], v[212:215], v[152:155], v[92:95]
    v_mfma_f32_16x16x32_bf16 v[88:91], v[212:215], v[148:151], v[88:91]
    v_mfma_f32_16x16x32_bf16 v[104:107], v[216:219], v[148:151], v[104:107]
    v_mfma_f32_16x16x32_bf16 v[108:111], v[216:219], v[152:155], v[108:111]
    v_mfma_f32_16x16x32_bf16 v[112:115], v[216:219], v[156:159], v[112:115]
    v_mfma_f32_16x16x32_bf16 v[116:119], v[216:219], v[160:163], v[116:119]
    s_waitcnt lgkmcnt(10)
    v_mfma_f32_16x16x32_bf16 v[8:11], v[164:167], v[132:135], v[8:11]
    ds_read_b128 v[148:151], v120 offset:40960
    v_mfma_f32_16x16x32_bf16 v[12:15], v[164:167], v[136:139], v[12:15]
    ds_read_b64_tr_b16 v[192:193], v122 offset:43008
    v_mfma_f32_16x16x32_bf16 v[16:19], v[164:167], v[140:143], v[16:19]
    ds_read_b64_tr_b16 v[194:195], v122 offset:50176
    v_mfma_f32_16x16x32_bf16 v[20:23], v[164:167], v[144:147], v[20:23]
    ds_read_b128 v[152:155], v120 offset:41984
    v_mfma_f32_16x16x32_bf16 v[36:39], v[168:171], v[144:147], v[36:39]
    ds_read_b128 v[156:159], v120 offset:43008
    v_mfma_f32_16x16x32_bf16 v[32:35], v[168:171], v[140:143], v[32:35]
    ds_read_b128 v[160:163], v120 offset:44032
    v_mfma_f32_16x16x32_bf16 v[28:31], v[168:171], v[136:139], v[28:31]
    ds_read_b64_tr_b16 v[196:197], v125 offset:43008
    v_mfma_f32_16x16x32_bf16 v[24:27], v[168:171], v[132:135], v[24:27]
    ds_read_b64_tr_b16 v[198:199], v125 offset:50176
    s_waitcnt lgkmcnt(14)
    v_mfma_f32_16x16x32_bf16 v[40:43], v[172:175], v[132:135], v[40:43]
    ds_read_b64_tr_b16 v[200:201], v122 offset:43072
    v_mfma_f32_16x16x32_bf16 v[44:47], v[172:175], v[136:139], v[44:47]
    ds_read_b64_tr_b16 v[202:203], v122 offset:50240
    v_mfma_f32_16x16x32_bf16 v[48:51], v[172:175], v[140:143], v[48:51]
    ds_read_b64_tr_b16 v[204:205], v125 offset:43072
    v_mfma_f32_16x16x32_bf16 v[52:55], v[172:175], v[144:147], v[52:55]
    ds_read_b64_tr_b16 v[206:207], v125 offset:50240
    v_mfma_f32_16x16x32_bf16 v[68:71], v[176:179], v[144:147], v[68:71]
    ds_read_b64_tr_b16 v[208:209], v122 offset:43136
    v_mfma_f32_16x16x32_bf16 v[64:67], v[176:179], v[140:143], v[64:67]
    ds_read_b64_tr_b16 v[210:211], v122 offset:50304
    v_mfma_f32_16x16x32_bf16 v[60:63], v[176:179], v[136:139], v[60:63]
    ds_read_b64_tr_b16 v[212:213], v125 offset:43136
    v_mfma_f32_16x16x32_bf16 v[56:59], v[176:179], v[132:135], v[56:59]
    ds_read_b64_tr_b16 v[214:215], v125 offset:50304
    s_waitcnt lgkmcnt(15)
    v_mfma_f32_16x16x32_bf16 v[72:75], v[180:183], v[132:135], v[72:75]
    ds_read_b64_tr_b16 v[216:217], v128 offset:43008
    v_mfma_f32_16x16x32_bf16 v[76:79], v[180:183], v[136:139], v[76:79]
    ds_read_b64_tr_b16 v[218:219], v128 offset:50176
    v_mfma_f32_16x16x32_bf16 v[80:83], v[180:183], v[140:143], v[80:83]
    v_mfma_f32_16x16x32_bf16 v[84:87], v[180:183], v[144:147], v[84:87]
    v_mfma_f32_16x16x32_bf16 v[100:103], v[184:187], v[144:147], v[100:103]
    v_mfma_f32_16x16x32_bf16 v[96:99], v[184:187], v[140:143], v[96:99]
    v_mfma_f32_16x16x32_bf16 v[92:95], v[184:187], v[136:139], v[92:95]
    v_mfma_f32_16x16x32_bf16 v[88:91], v[184:187], v[132:135], v[88:91]
    v_mfma_f32_16x16x32_bf16 v[104:107], v[188:191], v[132:135], v[104:107]
    v_mfma_f32_16x16x32_bf16 v[108:111], v[188:191], v[136:139], v[108:111]
    v_mfma_f32_16x16x32_bf16 v[112:115], v[188:191], v[140:143], v[112:115]
    v_mfma_f32_16x16x32_bf16 v[116:119], v[188:191], v[144:147], v[116:119]
    s_waitcnt lgkmcnt(10)
    v_mfma_f32_16x16x32_bf16 v[8:11], v[192:195], v[148:151], v[8:11]
    v_mfma_f32_16x16x32_bf16 v[12:15], v[192:195], v[152:155], v[12:15]
    v_mfma_f32_16x16x32_bf16 v[16:19], v[192:195], v[156:159], v[16:19]
    v_mfma_f32_16x16x32_bf16 v[20:23], v[192:195], v[160:163], v[20:23]
    s_waitcnt lgkmcnt(0)
    s_barrier
    v_mfma_f32_16x16x32_bf16 v[36:39], v[196:199], v[160:163], v[36:39]
    ds_read_b128 v[132:135], v120 offset:49152
    v_mfma_f32_16x16x32_bf16 v[32:35], v[196:199], v[156:159], v[32:35]
    ds_read_b64_tr_b16 v[164:165], v123 offset:0
    v_mfma_f32_16x16x32_bf16 v[28:31], v[196:199], v[152:155], v[28:31]
    ds_read_b64_tr_b16 v[166:167], v123 offset:7168
    v_mfma_f32_16x16x32_bf16 v[24:27], v[196:199], v[148:151], v[24:27]
    ds_read_b128 v[136:139], v120 offset:50176
    v_mfma_f32_16x16x32_bf16 v[40:43], v[200:203], v[148:151], v[40:43]
    ds_read_b128 v[140:143], v120 offset:51200
    v_mfma_f32_16x16x32_bf16 v[44:47], v[200:203], v[152:155], v[44:47]
    ds_read_b128 v[144:147], v120 offset:52224
    v_mfma_f32_16x16x32_bf16 v[48:51], v[200:203], v[156:159], v[48:51]
    ds_read_b64_tr_b16 v[168:169], v126 offset:0
    v_mfma_f32_16x16x32_bf16 v[52:55], v[200:203], v[160:163], v[52:55]
    ds_read_b64_tr_b16 v[170:171], v126 offset:7168
    v_mfma_f32_16x16x32_bf16 v[68:71], v[204:207], v[160:163], v[68:71]
    ds_read_b64_tr_b16 v[172:173], v123 offset:64
    v_mfma_f32_16x16x32_bf16 v[64:67], v[204:207], v[156:159], v[64:67]
    ds_read_b64_tr_b16 v[174:175], v123 offset:7232
    v_mfma_f32_16x16x32_bf16 v[60:63], v[204:207], v[152:155], v[60:63]
    ds_read_b64_tr_b16 v[176:177], v126 offset:64
    v_mfma_f32_16x16x32_bf16 v[56:59], v[204:207], v[148:151], v[56:59]
    ds_read_b64_tr_b16 v[178:179], v126 offset:7232
    v_mfma_f32_16x16x32_bf16 v[72:75], v[208:211], v[148:151], v[72:75]
    ds_read_b64_tr_b16 v[180:181], v123 offset:128
    v_mfma_f32_16x16x32_bf16 v[76:79], v[208:211], v[152:155], v[76:79]
    ds_read_b64_tr_b16 v[182:183], v123 offset:7296
    v_mfma_f32_16x16x32_bf16 v[80:83], v[208:211], v[156:159], v[80:83]
    ds_read_b64_tr_b16 v[184:185], v126 offset:128
    v_mfma_f32_16x16x32_bf16 v[84:87], v[208:211], v[160:163], v[84:87]
    ds_read_b64_tr_b16 v[186:187], v126 offset:7296
    v_mfma_f32_16x16x32_bf16 v[100:103], v[212:215], v[160:163], v[100:103]
    ds_read_b64_tr_b16 v[188:189], v129 offset:0
    v_mfma_f32_16x16x32_bf16 v[96:99], v[212:215], v[156:159], v[96:99]
    ds_read_b64_tr_b16 v[190:191], v129 offset:7168
    v_mfma_f32_16x16x32_bf16 v[92:95], v[212:215], v[152:155], v[92:95]
    v_mfma_f32_16x16x32_bf16 v[88:91], v[212:215], v[148:151], v[88:91]
    v_mfma_f32_16x16x32_bf16 v[104:107], v[216:219], v[148:151], v[104:107]
    v_mfma_f32_16x16x32_bf16 v[108:111], v[216:219], v[152:155], v[108:111]
    v_mfma_f32_16x16x32_bf16 v[112:115], v[216:219], v[156:159], v[112:115]
    v_mfma_f32_16x16x32_bf16 v[116:119], v[216:219], v[160:163], v[116:119]
    s_waitcnt lgkmcnt(10)
    v_mfma_f32_16x16x32_bf16 v[8:11], v[164:167], v[132:135], v[8:11]
    ds_read_b128 v[148:151], v120 offset:57344
    v_mfma_f32_16x16x32_bf16 v[12:15], v[164:167], v[136:139], v[12:15]
    ds_read_b64_tr_b16 v[192:193], v123 offset:14336
    v_mfma_f32_16x16x32_bf16 v[16:19], v[164:167], v[140:143], v[16:19]
    ds_read_b64_tr_b16 v[194:195], v123 offset:21504
    v_mfma_f32_16x16x32_bf16 v[20:23], v[164:167], v[144:147], v[20:23]
    ds_read_b128 v[152:155], v120 offset:58368
    v_mfma_f32_16x16x32_bf16 v[36:39], v[168:171], v[144:147], v[36:39]
    ds_read_b128 v[156:159], v120 offset:59392
    v_mfma_f32_16x16x32_bf16 v[32:35], v[168:171], v[140:143], v[32:35]
    ds_read_b128 v[160:163], v120 offset:60416
    v_mfma_f32_16x16x32_bf16 v[28:31], v[168:171], v[136:139], v[28:31]
    ds_read_b64_tr_b16 v[196:197], v126 offset:14336
    v_mfma_f32_16x16x32_bf16 v[24:27], v[168:171], v[132:135], v[24:27]
    ds_read_b64_tr_b16 v[198:199], v126 offset:21504
    s_waitcnt lgkmcnt(14)
    v_mfma_f32_16x16x32_bf16 v[40:43], v[172:175], v[132:135], v[40:43]
    ds_read_b64_tr_b16 v[200:201], v123 offset:14400
    v_mfma_f32_16x16x32_bf16 v[44:47], v[172:175], v[136:139], v[44:47]
    ds_read_b64_tr_b16 v[202:203], v123 offset:21568
    v_mfma_f32_16x16x32_bf16 v[48:51], v[172:175], v[140:143], v[48:51]
    ds_read_b64_tr_b16 v[204:205], v126 offset:14400
    v_mfma_f32_16x16x32_bf16 v[52:55], v[172:175], v[144:147], v[52:55]
    ds_read_b64_tr_b16 v[206:207], v126 offset:21568
    v_mfma_f32_16x16x32_bf16 v[68:71], v[176:179], v[144:147], v[68:71]
    ds_read_b64_tr_b16 v[208:209], v123 offset:14464
    v_mfma_f32_16x16x32_bf16 v[64:67], v[176:179], v[140:143], v[64:67]
    ds_read_b64_tr_b16 v[210:211], v123 offset:21632
    v_mfma_f32_16x16x32_bf16 v[60:63], v[176:179], v[136:139], v[60:63]
    ds_read_b64_tr_b16 v[212:213], v126 offset:14464
    v_mfma_f32_16x16x32_bf16 v[56:59], v[176:179], v[132:135], v[56:59]
    ds_read_b64_tr_b16 v[214:215], v126 offset:21632
    s_waitcnt lgkmcnt(15)
    v_mfma_f32_16x16x32_bf16 v[72:75], v[180:183], v[132:135], v[72:75]
    ds_read_b64_tr_b16 v[216:217], v129 offset:14336
    v_mfma_f32_16x16x32_bf16 v[76:79], v[180:183], v[136:139], v[76:79]
    ds_read_b64_tr_b16 v[218:219], v129 offset:21504
    v_mfma_f32_16x16x32_bf16 v[80:83], v[180:183], v[140:143], v[80:83]
    v_mfma_f32_16x16x32_bf16 v[84:87], v[180:183], v[144:147], v[84:87]
    v_mfma_f32_16x16x32_bf16 v[100:103], v[184:187], v[144:147], v[100:103]
    v_mfma_f32_16x16x32_bf16 v[96:99], v[184:187], v[140:143], v[96:99]
    v_mfma_f32_16x16x32_bf16 v[92:95], v[184:187], v[136:139], v[92:95]
    v_mfma_f32_16x16x32_bf16 v[88:91], v[184:187], v[132:135], v[88:91]
    v_mfma_f32_16x16x32_bf16 v[104:107], v[188:191], v[132:135], v[104:107]
    v_mfma_f32_16x16x32_bf16 v[108:111], v[188:191], v[136:139], v[108:111]
    v_mfma_f32_16x16x32_bf16 v[112:115], v[188:191], v[140:143], v[112:115]
    v_mfma_f32_16x16x32_bf16 v[116:119], v[188:191], v[144:147], v[116:119]
    s_waitcnt lgkmcnt(10)
    v_mfma_f32_16x16x32_bf16 v[8:11], v[192:195], v[148:151], v[8:11]
    v_mfma_f32_16x16x32_bf16 v[12:15], v[192:195], v[152:155], v[12:15]
    v_mfma_f32_16x16x32_bf16 v[16:19], v[192:195], v[156:159], v[16:19]
    v_mfma_f32_16x16x32_bf16 v[20:23], v[192:195], v[160:163], v[20:23]
    s_waitcnt lgkmcnt(0)
    s_barrier
    v_mfma_f32_16x16x32_bf16 v[36:39], v[196:199], v[160:163], v[36:39]
    ds_read_b128 v[132:135], v120 offset:0
    v_mfma_f32_16x16x32_bf16 v[32:35], v[196:199], v[156:159], v[32:35]
    ds_read_b64_tr_b16 v[164:165], v122 offset:0
    v_mfma_f32_16x16x32_bf16 v[28:31], v[196:199], v[152:155], v[28:31]
    ds_read_b64_tr_b16 v[166:167], v122 offset:7168
    v_mfma_f32_16x16x32_bf16 v[24:27], v[196:199], v[148:151], v[24:27]
    ds_read_b128 v[136:139], v120 offset:1024
    v_mfma_f32_16x16x32_bf16 v[40:43], v[200:203], v[148:151], v[40:43]
    ds_read_b128 v[140:143], v120 offset:2048
    v_mfma_f32_16x16x32_bf16 v[44:47], v[200:203], v[152:155], v[44:47]
    ds_read_b128 v[144:147], v120 offset:3072
    v_mfma_f32_16x16x32_bf16 v[48:51], v[200:203], v[156:159], v[48:51]
    ds_read_b64_tr_b16 v[168:169], v125 offset:0
    v_mfma_f32_16x16x32_bf16 v[52:55], v[200:203], v[160:163], v[52:55]
    ds_read_b64_tr_b16 v[170:171], v125 offset:7168
    v_mfma_f32_16x16x32_bf16 v[68:71], v[204:207], v[160:163], v[68:71]
    ds_read_b64_tr_b16 v[172:173], v122 offset:64
    v_mfma_f32_16x16x32_bf16 v[64:67], v[204:207], v[156:159], v[64:67]
    ds_read_b64_tr_b16 v[174:175], v122 offset:7232
    v_mfma_f32_16x16x32_bf16 v[60:63], v[204:207], v[152:155], v[60:63]
    ds_read_b64_tr_b16 v[176:177], v125 offset:64
    v_mfma_f32_16x16x32_bf16 v[56:59], v[204:207], v[148:151], v[56:59]
    ds_read_b64_tr_b16 v[178:179], v125 offset:7232
    v_mfma_f32_16x16x32_bf16 v[72:75], v[208:211], v[148:151], v[72:75]
    ds_read_b64_tr_b16 v[180:181], v122 offset:128
    v_mfma_f32_16x16x32_bf16 v[76:79], v[208:211], v[152:155], v[76:79]
    ds_read_b64_tr_b16 v[182:183], v122 offset:7296
    v_mfma_f32_16x16x32_bf16 v[80:83], v[208:211], v[156:159], v[80:83]
    ds_read_b64_tr_b16 v[184:185], v125 offset:128
    v_mfma_f32_16x16x32_bf16 v[84:87], v[208:211], v[160:163], v[84:87]
    ds_read_b64_tr_b16 v[186:187], v125 offset:7296
    v_mfma_f32_16x16x32_bf16 v[100:103], v[212:215], v[160:163], v[100:103]
    ds_read_b64_tr_b16 v[188:189], v128 offset:0
    v_mfma_f32_16x16x32_bf16 v[96:99], v[212:215], v[156:159], v[96:99]
    ds_read_b64_tr_b16 v[190:191], v128 offset:7168
    v_mfma_f32_16x16x32_bf16 v[92:95], v[212:215], v[152:155], v[92:95]
    v_mfma_f32_16x16x32_bf16 v[88:91], v[212:215], v[148:151], v[88:91]
    v_mfma_f32_16x16x32_bf16 v[104:107], v[216:219], v[148:151], v[104:107]
    v_mfma_f32_16x16x32_bf16 v[108:111], v[216:219], v[152:155], v[108:111]
    v_mfma_f32_16x16x32_bf16 v[112:115], v[216:219], v[156:159], v[112:115]
    v_mfma_f32_16x16x32_bf16 v[116:119], v[216:219], v[160:163], v[116:119]
    s_waitcnt lgkmcnt(10)
    v_mfma_f32_16x16x32_bf16 v[8:11], v[164:167], v[132:135], v[8:11]
    ds_read_b128 v[148:151], v120 offset:8192
    v_mfma_f32_16x16x32_bf16 v[12:15], v[164:167], v[136:139], v[12:15]
    ds_read_b64_tr_b16 v[192:193], v122 offset:14336
    v_mfma_f32_16x16x32_bf16 v[16:19], v[164:167], v[140:143], v[16:19]
    ds_read_b64_tr_b16 v[194:195], v122 offset:21504
    v_mfma_f32_16x16x32_bf16 v[20:23], v[164:167], v[144:147], v[20:23]
    ds_read_b128 v[152:155], v120 offset:9216
    v_mfma_f32_16x16x32_bf16 v[36:39], v[168:171], v[144:147], v[36:39]
    ds_read_b128 v[156:159], v120 offset:10240
    v_mfma_f32_16x16x32_bf16 v[32:35], v[168:171], v[140:143], v[32:35]
    ds_read_b128 v[160:163], v120 offset:11264
    v_mfma_f32_16x16x32_bf16 v[28:31], v[168:171], v[136:139], v[28:31]
    ds_read_b64_tr_b16 v[196:197], v125 offset:14336
    v_mfma_f32_16x16x32_bf16 v[24:27], v[168:171], v[132:135], v[24:27]
    ds_read_b64_tr_b16 v[198:199], v125 offset:21504
    s_waitcnt lgkmcnt(14)
    v_mfma_f32_16x16x32_bf16 v[40:43], v[172:175], v[132:135], v[40:43]
    ds_read_b64_tr_b16 v[200:201], v122 offset:14400
    v_mfma_f32_16x16x32_bf16 v[44:47], v[172:175], v[136:139], v[44:47]
    ds_read_b64_tr_b16 v[202:203], v122 offset:21568
    v_mfma_f32_16x16x32_bf16 v[48:51], v[172:175], v[140:143], v[48:51]
    ds_read_b64_tr_b16 v[204:205], v125 offset:14400
    v_mfma_f32_16x16x32_bf16 v[52:55], v[172:175], v[144:147], v[52:55]
    ds_read_b64_tr_b16 v[206:207], v125 offset:21568
    v_mfma_f32_16x16x32_bf16 v[68:71], v[176:179], v[144:147], v[68:71]
    ds_read_b64_tr_b16 v[208:209], v122 offset:14464
    v_mfma_f32_16x16x32_bf16 v[64:67], v[176:179], v[140:143], v[64:67]
    ds_read_b64_tr_b16 v[210:211], v122 offset:21632
    v_mfma_f32_16x16x32_bf16 v[60:63], v[176:179], v[136:139], v[60:63]
    ds_read_b64_tr_b16 v[212:213], v125 offset:14464
    v_mfma_f32_16x16x32_bf16 v[56:59], v[176:179], v[132:135], v[56:59]
    ds_read_b64_tr_b16 v[214:215], v125 offset:21632
    s_waitcnt lgkmcnt(15)
    v_mfma_f32_16x16x32_bf16 v[72:75], v[180:183], v[132:135], v[72:75]
    ds_read_b64_tr_b16 v[216:217], v128 offset:14336
    v_mfma_f32_16x16x32_bf16 v[76:79], v[180:183], v[136:139], v[76:79]
    ds_read_b64_tr_b16 v[218:219], v128 offset:21504
    v_mfma_f32_16x16x32_bf16 v[80:83], v[180:183], v[140:143], v[80:83]
    v_mfma_f32_16x16x32_bf16 v[84:87], v[180:183], v[144:147], v[84:87]
    v_mfma_f32_16x16x32_bf16 v[100:103], v[184:187], v[144:147], v[100:103]
    v_mfma_f32_16x16x32_bf16 v[96:99], v[184:187], v[140:143], v[96:99]
    v_mfma_f32_16x16x32_bf16 v[92:95], v[184:187], v[136:139], v[92:95]
    v_mfma_f32_16x16x32_bf16 v[88:91], v[184:187], v[132:135], v[88:91]
    v_mfma_f32_16x16x32_bf16 v[104:107], v[188:191], v[132:135], v[104:107]
    v_mfma_f32_16x16x32_bf16 v[108:111], v[188:191], v[136:139], v[108:111]
    v_mfma_f32_16x16x32_bf16 v[112:115], v[188:191], v[140:143], v[112:115]
    v_mfma_f32_16x16x32_bf16 v[116:119], v[188:191], v[144:147], v[116:119]
    s_waitcnt lgkmcnt(10)
    v_mfma_f32_16x16x32_bf16 v[8:11], v[192:195], v[148:151], v[8:11]
    v_mfma_f32_16x16x32_bf16 v[12:15], v[192:195], v[152:155], v[12:15]
    v_mfma_f32_16x16x32_bf16 v[16:19], v[192:195], v[156:159], v[16:19]
    v_mfma_f32_16x16x32_bf16 v[20:23], v[192:195], v[160:163], v[20:23]
    s_waitcnt lgkmcnt(0)
    s_barrier
    v_mfma_f32_16x16x32_bf16 v[36:39], v[196:199], v[160:163], v[36:39]
    ds_read_b128 v[132:135], v120 offset:16384
    v_mfma_f32_16x16x32_bf16 v[32:35], v[196:199], v[156:159], v[32:35]
    ds_read_b64_tr_b16 v[164:165], v122 offset:28672
    v_mfma_f32_16x16x32_bf16 v[28:31], v[196:199], v[152:155], v[28:31]
    ds_read_b64_tr_b16 v[166:167], v122 offset:35840
    v_mfma_f32_16x16x32_bf16 v[24:27], v[196:199], v[148:151], v[24:27]
    ds_read_b128 v[136:139], v120 offset:17408
    v_mfma_f32_16x16x32_bf16 v[40:43], v[200:203], v[148:151], v[40:43]
    ds_read_b128 v[140:143], v120 offset:18432
    v_mfma_f32_16x16x32_bf16 v[44:47], v[200:203], v[152:155], v[44:47]
    ds_read_b128 v[144:147], v120 offset:19456
    v_mfma_f32_16x16x32_bf16 v[48:51], v[200:203], v[156:159], v[48:51]
    ds_read_b64_tr_b16 v[168:169], v125 offset:28672
    v_mfma_f32_16x16x32_bf16 v[52:55], v[200:203], v[160:163], v[52:55]
    ds_read_b64_tr_b16 v[170:171], v125 offset:35840
    v_mfma_f32_16x16x32_bf16 v[68:71], v[204:207], v[160:163], v[68:71]
    ds_read_b64_tr_b16 v[172:173], v122 offset:28736
    v_mfma_f32_16x16x32_bf16 v[64:67], v[204:207], v[156:159], v[64:67]
    ds_read_b64_tr_b16 v[174:175], v122 offset:35904
    v_mfma_f32_16x16x32_bf16 v[60:63], v[204:207], v[152:155], v[60:63]
    ds_read_b64_tr_b16 v[176:177], v125 offset:28736
    v_mfma_f32_16x16x32_bf16 v[56:59], v[204:207], v[148:151], v[56:59]
    ds_read_b64_tr_b16 v[178:179], v125 offset:35904
    v_mfma_f32_16x16x32_bf16 v[72:75], v[208:211], v[148:151], v[72:75]
    ds_read_b64_tr_b16 v[180:181], v122 offset:28800
    v_mfma_f32_16x16x32_bf16 v[76:79], v[208:211], v[152:155], v[76:79]
    ds_read_b64_tr_b16 v[182:183], v122 offset:35968
    v_mfma_f32_16x16x32_bf16 v[80:83], v[208:211], v[156:159], v[80:83]
    ds_read_b64_tr_b16 v[184:185], v125 offset:28800
    v_mfma_f32_16x16x32_bf16 v[84:87], v[208:211], v[160:163], v[84:87]
    ds_read_b64_tr_b16 v[186:187], v125 offset:35968
    v_mfma_f32_16x16x32_bf16 v[100:103], v[212:215], v[160:163], v[100:103]
    ds_read_b64_tr_b16 v[188:189], v128 offset:28672
    v_mfma_f32_16x16x32_bf16 v[96:99], v[212:215], v[156:159], v[96:99]
    ds_read_b64_tr_b16 v[190:191], v128 offset:35840
    v_mfma_f32_16x16x32_bf16 v[92:95], v[212:215], v[152:155], v[92:95]
    v_mfma_f32_16x16x32_bf16 v[88:91], v[212:215], v[148:151], v[88:91]
    v_mfma_f32_16x16x32_bf16 v[104:107], v[216:219], v[148:151], v[104:107]
    v_mfma_f32_16x16x32_bf16 v[108:111], v[216:219], v[152:155], v[108:111]
    v_mfma_f32_16x16x32_bf16 v[112:115], v[216:219], v[156:159], v[112:115]
    v_mfma_f32_16x16x32_bf16 v[116:119], v[216:219], v[160:163], v[116:119]
    s_waitcnt lgkmcnt(10)
    v_mfma_f32_16x16x32_bf16 v[8:11], v[164:167], v[132:135], v[8:11]
    ds_read_b128 v[148:151], v120 offset:24576
    v_mfma_f32_16x16x32_bf16 v[12:15], v[164:167], v[136:139], v[12:15]
    ds_read_b64_tr_b16 v[192:193], v122 offset:43008
    v_mfma_f32_16x16x32_bf16 v[16:19], v[164:167], v[140:143], v[16:19]
    ds_read_b64_tr_b16 v[194:195], v122 offset:50176
    v_mfma_f32_16x16x32_bf16 v[20:23], v[164:167], v[144:147], v[20:23]
    ds_read_b128 v[152:155], v120 offset:25600
    v_mfma_f32_16x16x32_bf16 v[36:39], v[168:171], v[144:147], v[36:39]
    ds_read_b128 v[156:159], v120 offset:26624
    v_mfma_f32_16x16x32_bf16 v[32:35], v[168:171], v[140:143], v[32:35]
    ds_read_b128 v[160:163], v120 offset:27648
    v_mfma_f32_16x16x32_bf16 v[28:31], v[168:171], v[136:139], v[28:31]
    ds_read_b64_tr_b16 v[196:197], v125 offset:43008
    v_mfma_f32_16x16x32_bf16 v[24:27], v[168:171], v[132:135], v[24:27]
    ds_read_b64_tr_b16 v[198:199], v125 offset:50176
    s_waitcnt lgkmcnt(14)
    v_mfma_f32_16x16x32_bf16 v[40:43], v[172:175], v[132:135], v[40:43]
    ds_read_b64_tr_b16 v[200:201], v122 offset:43072
    v_mfma_f32_16x16x32_bf16 v[44:47], v[172:175], v[136:139], v[44:47]
    ds_read_b64_tr_b16 v[202:203], v122 offset:50240
    v_mfma_f32_16x16x32_bf16 v[48:51], v[172:175], v[140:143], v[48:51]
    ds_read_b64_tr_b16 v[204:205], v125 offset:43072
    v_mfma_f32_16x16x32_bf16 v[52:55], v[172:175], v[144:147], v[52:55]
    ds_read_b64_tr_b16 v[206:207], v125 offset:50240
    v_mfma_f32_16x16x32_bf16 v[68:71], v[176:179], v[144:147], v[68:71]
    ds_read_b64_tr_b16 v[208:209], v122 offset:43136
    v_mfma_f32_16x16x32_bf16 v[64:67], v[176:179], v[140:143], v[64:67]
    ds_read_b64_tr_b16 v[210:211], v122 offset:50304
    v_mfma_f32_16x16x32_bf16 v[60:63], v[176:179], v[136:139], v[60:63]
    ds_read_b64_tr_b16 v[212:213], v125 offset:43136
    v_mfma_f32_16x16x32_bf16 v[56:59], v[176:179], v[132:135], v[56:59]
    ds_read_b64_tr_b16 v[214:215], v125 offset:50304
    s_waitcnt lgkmcnt(15)
    v_mfma_f32_16x16x32_bf16 v[72:75], v[180:183], v[132:135], v[72:75]
    ds_read_b64_tr_b16 v[216:217], v128 offset:43008
    v_mfma_f32_16x16x32_bf16 v[76:79], v[180:183], v[136:139], v[76:79]
    ds_read_b64_tr_b16 v[218:219], v128 offset:50176
    v_mfma_f32_16x16x32_bf16 v[80:83], v[180:183], v[140:143], v[80:83]
    v_mfma_f32_16x16x32_bf16 v[84:87], v[180:183], v[144:147], v[84:87]
    v_mfma_f32_16x16x32_bf16 v[100:103], v[184:187], v[144:147], v[100:103]
    v_mfma_f32_16x16x32_bf16 v[96:99], v[184:187], v[140:143], v[96:99]
    v_mfma_f32_16x16x32_bf16 v[92:95], v[184:187], v[136:139], v[92:95]
    v_mfma_f32_16x16x32_bf16 v[88:91], v[184:187], v[132:135], v[88:91]
    v_mfma_f32_16x16x32_bf16 v[104:107], v[188:191], v[132:135], v[104:107]
    v_mfma_f32_16x16x32_bf16 v[108:111], v[188:191], v[136:139], v[108:111]
    v_mfma_f32_16x16x32_bf16 v[112:115], v[188:191], v[140:143], v[112:115]
    v_mfma_f32_16x16x32_bf16 v[116:119], v[188:191], v[144:147], v[116:119]
    s_waitcnt lgkmcnt(10)
    v_mfma_f32_16x16x32_bf16 v[8:11], v[192:195], v[148:151], v[8:11]
    v_mfma_f32_16x16x32_bf16 v[12:15], v[192:195], v[152:155], v[12:15]
    v_mfma_f32_16x16x32_bf16 v[16:19], v[192:195], v[156:159], v[16:19]
    v_mfma_f32_16x16x32_bf16 v[20:23], v[192:195], v[160:163], v[20:23]
    s_waitcnt lgkmcnt(0)
    s_barrier
    v_mfma_f32_16x16x32_bf16 v[36:39], v[196:199], v[160:163], v[36:39]
    ds_read_b128 v[132:135], v120 offset:32768
    v_mfma_f32_16x16x32_bf16 v[32:35], v[196:199], v[156:159], v[32:35]
    ds_read_b64_tr_b16 v[164:165], v123 offset:0
    v_mfma_f32_16x16x32_bf16 v[28:31], v[196:199], v[152:155], v[28:31]
    ds_read_b64_tr_b16 v[166:167], v123 offset:7168
    v_mfma_f32_16x16x32_bf16 v[24:27], v[196:199], v[148:151], v[24:27]
    ds_read_b128 v[136:139], v120 offset:33792
    v_mfma_f32_16x16x32_bf16 v[40:43], v[200:203], v[148:151], v[40:43]
    ds_read_b128 v[140:143], v120 offset:34816
    v_mfma_f32_16x16x32_bf16 v[44:47], v[200:203], v[152:155], v[44:47]
    ds_read_b128 v[144:147], v120 offset:35840
    v_mfma_f32_16x16x32_bf16 v[48:51], v[200:203], v[156:159], v[48:51]
    ds_read_b64_tr_b16 v[168:169], v126 offset:0
    v_mfma_f32_16x16x32_bf16 v[52:55], v[200:203], v[160:163], v[52:55]
    ds_read_b64_tr_b16 v[170:171], v126 offset:7168
    v_mfma_f32_16x16x32_bf16 v[68:71], v[204:207], v[160:163], v[68:71]
    ds_read_b64_tr_b16 v[172:173], v123 offset:64
    v_mfma_f32_16x16x32_bf16 v[64:67], v[204:207], v[156:159], v[64:67]
    ds_read_b64_tr_b16 v[174:175], v123 offset:7232
    v_mfma_f32_16x16x32_bf16 v[60:63], v[204:207], v[152:155], v[60:63]
    ds_read_b64_tr_b16 v[176:177], v126 offset:64
    v_mfma_f32_16x16x32_bf16 v[56:59], v[204:207], v[148:151], v[56:59]
    ds_read_b64_tr_b16 v[178:179], v126 offset:7232
    v_mfma_f32_16x16x32_bf16 v[72:75], v[208:211], v[148:151], v[72:75]
    ds_read_b64_tr_b16 v[180:181], v123 offset:128
    v_mfma_f32_16x16x32_bf16 v[76:79], v[208:211], v[152:155], v[76:79]
    ds_read_b64_tr_b16 v[182:183], v123 offset:7296
    v_mfma_f32_16x16x32_bf16 v[80:83], v[208:211], v[156:159], v[80:83]
    ds_read_b64_tr_b16 v[184:185], v126 offset:128
    v_mfma_f32_16x16x32_bf16 v[84:87], v[208:211], v[160:163], v[84:87]
    ds_read_b64_tr_b16 v[186:187], v126 offset:7296
    v_mfma_f32_16x16x32_bf16 v[100:103], v[212:215], v[160:163], v[100:103]
    ds_read_b64_tr_b16 v[188:189], v129 offset:0
    v_mfma_f32_16x16x32_bf16 v[96:99], v[212:215], v[156:159], v[96:99]
    ds_read_b64_tr_b16 v[190:191], v129 offset:7168
    v_mfma_f32_16x16x32_bf16 v[92:95], v[212:215], v[152:155], v[92:95]
    v_mfma_f32_16x16x32_bf16 v[88:91], v[212:215], v[148:151], v[88:91]
    v_mfma_f32_16x16x32_bf16 v[104:107], v[216:219], v[148:151], v[104:107]
    v_mfma_f32_16x16x32_bf16 v[108:111], v[216:219], v[152:155], v[108:111]
    v_mfma_f32_16x16x32_bf16 v[112:115], v[216:219], v[156:159], v[112:115]
    v_mfma_f32_16x16x32_bf16 v[116:119], v[216:219], v[160:163], v[116:119]
    s_waitcnt lgkmcnt(10)
    v_mfma_f32_16x16x32_bf16 v[8:11], v[164:167], v[132:135], v[8:11]
    ds_read_b128 v[148:151], v120 offset:40960
    v_mfma_f32_16x16x32_bf16 v[12:15], v[164:167], v[136:139], v[12:15]
    ds_read_b64_tr_b16 v[192:193], v123 offset:14336
    v_mfma_f32_16x16x32_bf16 v[16:19], v[164:167], v[140:143], v[16:19]
    ds_read_b64_tr_b16 v[194:195], v123 offset:21504
    v_mfma_f32_16x16x32_bf16 v[20:23], v[164:167], v[144:147], v[20:23]
    ds_read_b128 v[152:155], v120 offset:41984
    v_mfma_f32_16x16x32_bf16 v[36:39], v[168:171], v[144:147], v[36:39]
    ds_read_b128 v[156:159], v120 offset:43008
    v_mfma_f32_16x16x32_bf16 v[32:35], v[168:171], v[140:143], v[32:35]
    ds_read_b128 v[160:163], v120 offset:44032
    v_mfma_f32_16x16x32_bf16 v[28:31], v[168:171], v[136:139], v[28:31]
    ds_read_b64_tr_b16 v[196:197], v126 offset:14336
    v_mfma_f32_16x16x32_bf16 v[24:27], v[168:171], v[132:135], v[24:27]
    ds_read_b64_tr_b16 v[198:199], v126 offset:21504
    s_waitcnt lgkmcnt(14)
    v_mfma_f32_16x16x32_bf16 v[40:43], v[172:175], v[132:135], v[40:43]
    ds_read_b64_tr_b16 v[200:201], v123 offset:14400
    v_mfma_f32_16x16x32_bf16 v[44:47], v[172:175], v[136:139], v[44:47]
    ds_read_b64_tr_b16 v[202:203], v123 offset:21568
    v_mfma_f32_16x16x32_bf16 v[48:51], v[172:175], v[140:143], v[48:51]
    ds_read_b64_tr_b16 v[204:205], v126 offset:14400
    v_mfma_f32_16x16x32_bf16 v[52:55], v[172:175], v[144:147], v[52:55]
    ds_read_b64_tr_b16 v[206:207], v126 offset:21568
    v_mfma_f32_16x16x32_bf16 v[68:71], v[176:179], v[144:147], v[68:71]
    ds_read_b64_tr_b16 v[208:209], v123 offset:14464
    v_mfma_f32_16x16x32_bf16 v[64:67], v[176:179], v[140:143], v[64:67]
    ds_read_b64_tr_b16 v[210:211], v123 offset:21632
    v_mfma_f32_16x16x32_bf16 v[60:63], v[176:179], v[136:139], v[60:63]
    ds_read_b64_tr_b16 v[212:213], v126 offset:14464
    v_mfma_f32_16x16x32_bf16 v[56:59], v[176:179], v[132:135], v[56:59]
    ds_read_b64_tr_b16 v[214:215], v126 offset:21632
    s_waitcnt lgkmcnt(15)
    v_mfma_f32_16x16x32_bf16 v[72:75], v[180:183], v[132:135], v[72:75]
    ds_read_b64_tr_b16 v[216:217], v129 offset:14336
    v_mfma_f32_16x16x32_bf16 v[76:79], v[180:183], v[136:139], v[76:79]
    ds_read_b64_tr_b16 v[218:219], v129 offset:21504
    v_mfma_f32_16x16x32_bf16 v[80:83], v[180:183], v[140:143], v[80:83]
    v_mfma_f32_16x16x32_bf16 v[84:87], v[180:183], v[144:147], v[84:87]
    v_mfma_f32_16x16x32_bf16 v[100:103], v[184:187], v[144:147], v[100:103]
    v_mfma_f32_16x16x32_bf16 v[96:99], v[184:187], v[140:143], v[96:99]
    v_mfma_f32_16x16x32_bf16 v[92:95], v[184:187], v[136:139], v[92:95]
    v_mfma_f32_16x16x32_bf16 v[88:91], v[184:187], v[132:135], v[88:91]
    v_mfma_f32_16x16x32_bf16 v[104:107], v[188:191], v[132:135], v[104:107]
    v_mfma_f32_16x16x32_bf16 v[108:111], v[188:191], v[136:139], v[108:111]
    v_mfma_f32_16x16x32_bf16 v[112:115], v[188:191], v[140:143], v[112:115]
    v_mfma_f32_16x16x32_bf16 v[116:119], v[188:191], v[144:147], v[116:119]
    s_waitcnt lgkmcnt(10)
    v_mfma_f32_16x16x32_bf16 v[8:11], v[192:195], v[148:151], v[8:11]
    v_mfma_f32_16x16x32_bf16 v[12:15], v[192:195], v[152:155], v[12:15]
    v_mfma_f32_16x16x32_bf16 v[16:19], v[192:195], v[156:159], v[16:19]
    v_mfma_f32_16x16x32_bf16 v[20:23], v[192:195], v[160:163], v[20:23]
    s_waitcnt lgkmcnt(0)
    s_barrier
    v_mfma_f32_16x16x32_bf16 v[36:39], v[196:199], v[160:163], v[36:39]
    ds_read_b128 v[132:135], v120 offset:49152
    v_mfma_f32_16x16x32_bf16 v[32:35], v[196:199], v[156:159], v[32:35]
    ds_read_b64_tr_b16 v[164:165], v122 offset:0
    v_mfma_f32_16x16x32_bf16 v[28:31], v[196:199], v[152:155], v[28:31]
    ds_read_b64_tr_b16 v[166:167], v122 offset:7168
    v_mfma_f32_16x16x32_bf16 v[24:27], v[196:199], v[148:151], v[24:27]
    ds_read_b128 v[136:139], v120 offset:50176
    v_mfma_f32_16x16x32_bf16 v[40:43], v[200:203], v[148:151], v[40:43]
    ds_read_b128 v[140:143], v120 offset:51200
    v_mfma_f32_16x16x32_bf16 v[44:47], v[200:203], v[152:155], v[44:47]
    ds_read_b128 v[144:147], v120 offset:52224
    v_mfma_f32_16x16x32_bf16 v[48:51], v[200:203], v[156:159], v[48:51]
    ds_read_b64_tr_b16 v[168:169], v125 offset:0
    v_mfma_f32_16x16x32_bf16 v[52:55], v[200:203], v[160:163], v[52:55]
    ds_read_b64_tr_b16 v[170:171], v125 offset:7168
    v_mfma_f32_16x16x32_bf16 v[68:71], v[204:207], v[160:163], v[68:71]
    ds_read_b64_tr_b16 v[172:173], v122 offset:64
    v_mfma_f32_16x16x32_bf16 v[64:67], v[204:207], v[156:159], v[64:67]
    ds_read_b64_tr_b16 v[174:175], v122 offset:7232
    v_mfma_f32_16x16x32_bf16 v[60:63], v[204:207], v[152:155], v[60:63]
    ds_read_b64_tr_b16 v[176:177], v125 offset:64
    v_mfma_f32_16x16x32_bf16 v[56:59], v[204:207], v[148:151], v[56:59]
    ds_read_b64_tr_b16 v[178:179], v125 offset:7232
    v_mfma_f32_16x16x32_bf16 v[72:75], v[208:211], v[148:151], v[72:75]
    ds_read_b64_tr_b16 v[180:181], v122 offset:128
    v_mfma_f32_16x16x32_bf16 v[76:79], v[208:211], v[152:155], v[76:79]
    ds_read_b64_tr_b16 v[182:183], v122 offset:7296
    v_mfma_f32_16x16x32_bf16 v[80:83], v[208:211], v[156:159], v[80:83]
    ds_read_b64_tr_b16 v[184:185], v125 offset:128
    v_mfma_f32_16x16x32_bf16 v[84:87], v[208:211], v[160:163], v[84:87]
    ds_read_b64_tr_b16 v[186:187], v125 offset:7296
    v_mfma_f32_16x16x32_bf16 v[100:103], v[212:215], v[160:163], v[100:103]
    ds_read_b64_tr_b16 v[188:189], v128 offset:0
    v_mfma_f32_16x16x32_bf16 v[96:99], v[212:215], v[156:159], v[96:99]
    ds_read_b64_tr_b16 v[190:191], v128 offset:7168
    v_mfma_f32_16x16x32_bf16 v[92:95], v[212:215], v[152:155], v[92:95]
    v_mfma_f32_16x16x32_bf16 v[88:91], v[212:215], v[148:151], v[88:91]
    v_mfma_f32_16x16x32_bf16 v[104:107], v[216:219], v[148:151], v[104:107]
    v_mfma_f32_16x16x32_bf16 v[108:111], v[216:219], v[152:155], v[108:111]
    v_mfma_f32_16x16x32_bf16 v[112:115], v[216:219], v[156:159], v[112:115]
    v_mfma_f32_16x16x32_bf16 v[116:119], v[216:219], v[160:163], v[116:119]
    s_waitcnt lgkmcnt(10)
    v_mfma_f32_16x16x32_bf16 v[8:11], v[164:167], v[132:135], v[8:11]
    ds_read_b128 v[148:151], v120 offset:57344
    v_mfma_f32_16x16x32_bf16 v[12:15], v[164:167], v[136:139], v[12:15]
    ds_read_b64_tr_b16 v[192:193], v122 offset:14336
    v_mfma_f32_16x16x32_bf16 v[16:19], v[164:167], v[140:143], v[16:19]
    ds_read_b64_tr_b16 v[194:195], v122 offset:21504
    v_mfma_f32_16x16x32_bf16 v[20:23], v[164:167], v[144:147], v[20:23]
    ds_read_b128 v[152:155], v120 offset:58368
    v_mfma_f32_16x16x32_bf16 v[36:39], v[168:171], v[144:147], v[36:39]
    ds_read_b128 v[156:159], v120 offset:59392
    v_mfma_f32_16x16x32_bf16 v[32:35], v[168:171], v[140:143], v[32:35]
    ds_read_b128 v[160:163], v120 offset:60416
    v_mfma_f32_16x16x32_bf16 v[28:31], v[168:171], v[136:139], v[28:31]
    ds_read_b64_tr_b16 v[196:197], v125 offset:14336
    v_mfma_f32_16x16x32_bf16 v[24:27], v[168:171], v[132:135], v[24:27]
    ds_read_b64_tr_b16 v[198:199], v125 offset:21504
    s_waitcnt lgkmcnt(14)
    v_mfma_f32_16x16x32_bf16 v[40:43], v[172:175], v[132:135], v[40:43]
    ds_read_b64_tr_b16 v[200:201], v122 offset:14400
    v_mfma_f32_16x16x32_bf16 v[44:47], v[172:175], v[136:139], v[44:47]
    ds_read_b64_tr_b16 v[202:203], v122 offset:21568
    v_mfma_f32_16x16x32_bf16 v[48:51], v[172:175], v[140:143], v[48:51]
    ds_read_b64_tr_b16 v[204:205], v125 offset:14400
    v_mfma_f32_16x16x32_bf16 v[52:55], v[172:175], v[144:147], v[52:55]
    ds_read_b64_tr_b16 v[206:207], v125 offset:21568
    v_mfma_f32_16x16x32_bf16 v[68:71], v[176:179], v[144:147], v[68:71]
    ds_read_b64_tr_b16 v[208:209], v122 offset:14464
    v_mfma_f32_16x16x32_bf16 v[64:67], v[176:179], v[140:143], v[64:67]
    ds_read_b64_tr_b16 v[210:211], v122 offset:21632
    v_mfma_f32_16x16x32_bf16 v[60:63], v[176:179], v[136:139], v[60:63]
    ds_read_b64_tr_b16 v[212:213], v125 offset:14464
    v_mfma_f32_16x16x32_bf16 v[56:59], v[176:179], v[132:135], v[56:59]
    ds_read_b64_tr_b16 v[214:215], v125 offset:21632
    s_waitcnt lgkmcnt(15)
    v_mfma_f32_16x16x32_bf16 v[72:75], v[180:183], v[132:135], v[72:75]
    ds_read_b64_tr_b16 v[216:217], v128 offset:14336
    v_mfma_f32_16x16x32_bf16 v[76:79], v[180:183], v[136:139], v[76:79]
    ds_read_b64_tr_b16 v[218:219], v128 offset:21504
    v_mfma_f32_16x16x32_bf16 v[80:83], v[180:183], v[140:143], v[80:83]
    v_mfma_f32_16x16x32_bf16 v[84:87], v[180:183], v[144:147], v[84:87]
    v_mfma_f32_16x16x32_bf16 v[100:103], v[184:187], v[144:147], v[100:103]
    v_mfma_f32_16x16x32_bf16 v[96:99], v[184:187], v[140:143], v[96:99]
    v_mfma_f32_16x16x32_bf16 v[92:95], v[184:187], v[136:139], v[92:95]
    v_mfma_f32_16x16x32_bf16 v[88:91], v[184:187], v[132:135], v[88:91]
    v_mfma_f32_16x16x32_bf16 v[104:107], v[188:191], v[132:135], v[104:107]
    v_mfma_f32_16x16x32_bf16 v[108:111], v[188:191], v[136:139], v[108:111]
    v_mfma_f32_16x16x32_bf16 v[112:115], v[188:191], v[140:143], v[112:115]
    v_mfma_f32_16x16x32_bf16 v[116:119], v[188:191], v[144:147], v[116:119]
    s_waitcnt lgkmcnt(10)
    v_mfma_f32_16x16x32_bf16 v[8:11], v[192:195], v[148:151], v[8:11]
    v_mfma_f32_16x16x32_bf16 v[12:15], v[192:195], v[152:155], v[12:15]
    v_mfma_f32_16x16x32_bf16 v[16:19], v[192:195], v[156:159], v[16:19]
    v_mfma_f32_16x16x32_bf16 v[20:23], v[192:195], v[160:163], v[20:23]
    s_waitcnt lgkmcnt(0)
    s_barrier
    v_mfma_f32_16x16x32_bf16 v[36:39], v[196:199], v[160:163], v[36:39]
    ds_read_b128 v[132:135], v120 offset:0
    v_mfma_f32_16x16x32_bf16 v[32:35], v[196:199], v[156:159], v[32:35]
    ds_read_b64_tr_b16 v[164:165], v122 offset:28672
    v_mfma_f32_16x16x32_bf16 v[28:31], v[196:199], v[152:155], v[28:31]
    ds_read_b64_tr_b16 v[166:167], v122 offset:35840
    v_mfma_f32_16x16x32_bf16 v[24:27], v[196:199], v[148:151], v[24:27]
    ds_read_b128 v[136:139], v120 offset:1024
    v_mfma_f32_16x16x32_bf16 v[40:43], v[200:203], v[148:151], v[40:43]
    ds_read_b128 v[140:143], v120 offset:2048
    v_mfma_f32_16x16x32_bf16 v[44:47], v[200:203], v[152:155], v[44:47]
    ds_read_b128 v[144:147], v120 offset:3072
    v_mfma_f32_16x16x32_bf16 v[48:51], v[200:203], v[156:159], v[48:51]
    ds_read_b64_tr_b16 v[168:169], v125 offset:28672
    v_mfma_f32_16x16x32_bf16 v[52:55], v[200:203], v[160:163], v[52:55]
    ds_read_b64_tr_b16 v[170:171], v125 offset:35840
    v_mfma_f32_16x16x32_bf16 v[68:71], v[204:207], v[160:163], v[68:71]
    ds_read_b64_tr_b16 v[172:173], v122 offset:28736
    v_mfma_f32_16x16x32_bf16 v[64:67], v[204:207], v[156:159], v[64:67]
    ds_read_b64_tr_b16 v[174:175], v122 offset:35904
    v_mfma_f32_16x16x32_bf16 v[60:63], v[204:207], v[152:155], v[60:63]
    ds_read_b64_tr_b16 v[176:177], v125 offset:28736
    v_mfma_f32_16x16x32_bf16 v[56:59], v[204:207], v[148:151], v[56:59]
    ds_read_b64_tr_b16 v[178:179], v125 offset:35904
    v_mfma_f32_16x16x32_bf16 v[72:75], v[208:211], v[148:151], v[72:75]
    ds_read_b64_tr_b16 v[180:181], v122 offset:28800
    v_mfma_f32_16x16x32_bf16 v[76:79], v[208:211], v[152:155], v[76:79]
    ds_read_b64_tr_b16 v[182:183], v122 offset:35968
    v_mfma_f32_16x16x32_bf16 v[80:83], v[208:211], v[156:159], v[80:83]
    ds_read_b64_tr_b16 v[184:185], v125 offset:28800
    v_mfma_f32_16x16x32_bf16 v[84:87], v[208:211], v[160:163], v[84:87]
    ds_read_b64_tr_b16 v[186:187], v125 offset:35968
    v_mfma_f32_16x16x32_bf16 v[100:103], v[212:215], v[160:163], v[100:103]
    ds_read_b64_tr_b16 v[188:189], v128 offset:28672
    v_mfma_f32_16x16x32_bf16 v[96:99], v[212:215], v[156:159], v[96:99]
    ds_read_b64_tr_b16 v[190:191], v128 offset:35840
    v_mfma_f32_16x16x32_bf16 v[92:95], v[212:215], v[152:155], v[92:95]
    v_mfma_f32_16x16x32_bf16 v[88:91], v[212:215], v[148:151], v[88:91]
    v_mfma_f32_16x16x32_bf16 v[104:107], v[216:219], v[148:151], v[104:107]
    v_mfma_f32_16x16x32_bf16 v[108:111], v[216:219], v[152:155], v[108:111]
    v_mfma_f32_16x16x32_bf16 v[112:115], v[216:219], v[156:159], v[112:115]
    v_mfma_f32_16x16x32_bf16 v[116:119], v[216:219], v[160:163], v[116:119]
    s_waitcnt lgkmcnt(10)
    v_mfma_f32_16x16x32_bf16 v[8:11], v[164:167], v[132:135], v[8:11]
    ds_read_b128 v[148:151], v120 offset:8192
    v_mfma_f32_16x16x32_bf16 v[12:15], v[164:167], v[136:139], v[12:15]
    ds_read_b64_tr_b16 v[192:193], v122 offset:43008
    v_mfma_f32_16x16x32_bf16 v[16:19], v[164:167], v[140:143], v[16:19]
    ds_read_b64_tr_b16 v[194:195], v122 offset:50176
    v_mfma_f32_16x16x32_bf16 v[20:23], v[164:167], v[144:147], v[20:23]
    ds_read_b128 v[152:155], v120 offset:9216
    v_mfma_f32_16x16x32_bf16 v[36:39], v[168:171], v[144:147], v[36:39]
    ds_read_b128 v[156:159], v120 offset:10240
    v_mfma_f32_16x16x32_bf16 v[32:35], v[168:171], v[140:143], v[32:35]
    ds_read_b128 v[160:163], v120 offset:11264
    v_mfma_f32_16x16x32_bf16 v[28:31], v[168:171], v[136:139], v[28:31]
    ds_read_b64_tr_b16 v[196:197], v125 offset:43008
    v_mfma_f32_16x16x32_bf16 v[24:27], v[168:171], v[132:135], v[24:27]
    ds_read_b64_tr_b16 v[198:199], v125 offset:50176
    s_waitcnt lgkmcnt(14)
    v_mfma_f32_16x16x32_bf16 v[40:43], v[172:175], v[132:135], v[40:43]
    ds_read_b64_tr_b16 v[200:201], v122 offset:43072
    v_mfma_f32_16x16x32_bf16 v[44:47], v[172:175], v[136:139], v[44:47]
    ds_read_b64_tr_b16 v[202:203], v122 offset:50240
    v_mfma_f32_16x16x32_bf16 v[48:51], v[172:175], v[140:143], v[48:51]
    ds_read_b64_tr_b16 v[204:205], v125 offset:43072
    v_mfma_f32_16x16x32_bf16 v[52:55], v[172:175], v[144:147], v[52:55]
    ds_read_b64_tr_b16 v[206:207], v125 offset:50240
    v_mfma_f32_16x16x32_bf16 v[68:71], v[176:179], v[144:147], v[68:71]
    ds_read_b64_tr_b16 v[208:209], v122 offset:43136
    v_mfma_f32_16x16x32_bf16 v[64:67], v[176:179], v[140:143], v[64:67]
    ds_read_b64_tr_b16 v[210:211], v122 offset:50304
    v_mfma_f32_16x16x32_bf16 v[60:63], v[176:179], v[136:139], v[60:63]
    ds_read_b64_tr_b16 v[212:213], v125 offset:43136
    v_mfma_f32_16x16x32_bf16 v[56:59], v[176:179], v[132:135], v[56:59]
    ds_read_b64_tr_b16 v[214:215], v125 offset:50304
    s_waitcnt lgkmcnt(15)
    v_mfma_f32_16x16x32_bf16 v[72:75], v[180:183], v[132:135], v[72:75]
    ds_read_b64_tr_b16 v[216:217], v128 offset:43008
    v_mfma_f32_16x16x32_bf16 v[76:79], v[180:183], v[136:139], v[76:79]
    ds_read_b64_tr_b16 v[218:219], v128 offset:50176
    v_mfma_f32_16x16x32_bf16 v[80:83], v[180:183], v[140:143], v[80:83]
    v_mfma_f32_16x16x32_bf16 v[84:87], v[180:183], v[144:147], v[84:87]
    v_mfma_f32_16x16x32_bf16 v[100:103], v[184:187], v[144:147], v[100:103]
    v_mfma_f32_16x16x32_bf16 v[96:99], v[184:187], v[140:143], v[96:99]
    v_mfma_f32_16x16x32_bf16 v[92:95], v[184:187], v[136:139], v[92:95]
    v_mfma_f32_16x16x32_bf16 v[88:91], v[184:187], v[132:135], v[88:91]
    v_mfma_f32_16x16x32_bf16 v[104:107], v[188:191], v[132:135], v[104:107]
    v_mfma_f32_16x16x32_bf16 v[108:111], v[188:191], v[136:139], v[108:111]
    v_mfma_f32_16x16x32_bf16 v[112:115], v[188:191], v[140:143], v[112:115]
    v_mfma_f32_16x16x32_bf16 v[116:119], v[188:191], v[144:147], v[116:119]
    s_waitcnt lgkmcnt(10)
    v_mfma_f32_16x16x32_bf16 v[8:11], v[192:195], v[148:151], v[8:11]
    v_mfma_f32_16x16x32_bf16 v[12:15], v[192:195], v[152:155], v[12:15]
    v_mfma_f32_16x16x32_bf16 v[16:19], v[192:195], v[156:159], v[16:19]
    v_mfma_f32_16x16x32_bf16 v[20:23], v[192:195], v[160:163], v[20:23]
    s_waitcnt lgkmcnt(0)
    s_barrier
    v_mfma_f32_16x16x32_bf16 v[36:39], v[196:199], v[160:163], v[36:39]
    ds_read_b128 v[132:135], v120 offset:16384
    v_mfma_f32_16x16x32_bf16 v[32:35], v[196:199], v[156:159], v[32:35]
    ds_read_b64_tr_b16 v[164:165], v123 offset:0
    v_mfma_f32_16x16x32_bf16 v[28:31], v[196:199], v[152:155], v[28:31]
    ds_read_b64_tr_b16 v[166:167], v123 offset:7168
    v_mfma_f32_16x16x32_bf16 v[24:27], v[196:199], v[148:151], v[24:27]
    ds_read_b128 v[136:139], v120 offset:17408
    v_mfma_f32_16x16x32_bf16 v[40:43], v[200:203], v[148:151], v[40:43]
    ds_read_b128 v[140:143], v120 offset:18432
    v_mfma_f32_16x16x32_bf16 v[44:47], v[200:203], v[152:155], v[44:47]
    ds_read_b128 v[144:147], v120 offset:19456
    v_mfma_f32_16x16x32_bf16 v[48:51], v[200:203], v[156:159], v[48:51]
    ds_read_b64_tr_b16 v[168:169], v126 offset:0
    v_mfma_f32_16x16x32_bf16 v[52:55], v[200:203], v[160:163], v[52:55]
    ds_read_b64_tr_b16 v[170:171], v126 offset:7168
    v_mfma_f32_16x16x32_bf16 v[68:71], v[204:207], v[160:163], v[68:71]
    ds_read_b64_tr_b16 v[172:173], v123 offset:64
    v_mfma_f32_16x16x32_bf16 v[64:67], v[204:207], v[156:159], v[64:67]
    ds_read_b64_tr_b16 v[174:175], v123 offset:7232
    v_mfma_f32_16x16x32_bf16 v[60:63], v[204:207], v[152:155], v[60:63]
    ds_read_b64_tr_b16 v[176:177], v126 offset:64
    v_mfma_f32_16x16x32_bf16 v[56:59], v[204:207], v[148:151], v[56:59]
    ds_read_b64_tr_b16 v[178:179], v126 offset:7232
    v_mfma_f32_16x16x32_bf16 v[72:75], v[208:211], v[148:151], v[72:75]
    ds_read_b64_tr_b16 v[180:181], v123 offset:128
    v_mfma_f32_16x16x32_bf16 v[76:79], v[208:211], v[152:155], v[76:79]
    ds_read_b64_tr_b16 v[182:183], v123 offset:7296
    v_mfma_f32_16x16x32_bf16 v[80:83], v[208:211], v[156:159], v[80:83]
    ds_read_b64_tr_b16 v[184:185], v126 offset:128
    v_mfma_f32_16x16x32_bf16 v[84:87], v[208:211], v[160:163], v[84:87]
    ds_read_b64_tr_b16 v[186:187], v126 offset:7296
    v_mfma_f32_16x16x32_bf16 v[100:103], v[212:215], v[160:163], v[100:103]
    ds_read_b64_tr_b16 v[188:189], v129 offset:0
    v_mfma_f32_16x16x32_bf16 v[96:99], v[212:215], v[156:159], v[96:99]
    ds_read_b64_tr_b16 v[190:191], v129 offset:7168
    v_mfma_f32_16x16x32_bf16 v[92:95], v[212:215], v[152:155], v[92:95]
    v_mfma_f32_16x16x32_bf16 v[88:91], v[212:215], v[148:151], v[88:91]
    v_mfma_f32_16x16x32_bf16 v[104:107], v[216:219], v[148:151], v[104:107]
    v_mfma_f32_16x16x32_bf16 v[108:111], v[216:219], v[152:155], v[108:111]
    v_mfma_f32_16x16x32_bf16 v[112:115], v[216:219], v[156:159], v[112:115]
    v_mfma_f32_16x16x32_bf16 v[116:119], v[216:219], v[160:163], v[116:119]
    s_waitcnt lgkmcnt(10)
    v_mfma_f32_16x16x32_bf16 v[8:11], v[164:167], v[132:135], v[8:11]
    ds_read_b128 v[148:151], v120 offset:24576
    v_mfma_f32_16x16x32_bf16 v[12:15], v[164:167], v[136:139], v[12:15]
    ds_read_b64_tr_b16 v[192:193], v123 offset:14336
    v_mfma_f32_16x16x32_bf16 v[16:19], v[164:167], v[140:143], v[16:19]
    ds_read_b64_tr_b16 v[194:195], v123 offset:21504
    v_mfma_f32_16x16x32_bf16 v[20:23], v[164:167], v[144:147], v[20:23]
    ds_read_b128 v[152:155], v120 offset:25600
    v_mfma_f32_16x16x32_bf16 v[36:39], v[168:171], v[144:147], v[36:39]
    ds_read_b128 v[156:159], v120 offset:26624
    v_mfma_f32_16x16x32_bf16 v[32:35], v[168:171], v[140:143], v[32:35]
    ds_read_b128 v[160:163], v120 offset:27648
    v_mfma_f32_16x16x32_bf16 v[28:31], v[168:171], v[136:139], v[28:31]
    ds_read_b64_tr_b16 v[196:197], v126 offset:14336
    v_mfma_f32_16x16x32_bf16 v[24:27], v[168:171], v[132:135], v[24:27]
    ds_read_b64_tr_b16 v[198:199], v126 offset:21504
    s_waitcnt lgkmcnt(14)
    v_mfma_f32_16x16x32_bf16 v[40:43], v[172:175], v[132:135], v[40:43]
    ds_read_b64_tr_b16 v[200:201], v123 offset:14400
    v_mfma_f32_16x16x32_bf16 v[44:47], v[172:175], v[136:139], v[44:47]
    ds_read_b64_tr_b16 v[202:203], v123 offset:21568
    v_mfma_f32_16x16x32_bf16 v[48:51], v[172:175], v[140:143], v[48:51]
    ds_read_b64_tr_b16 v[204:205], v126 offset:14400
    v_mfma_f32_16x16x32_bf16 v[52:55], v[172:175], v[144:147], v[52:55]
    ds_read_b64_tr_b16 v[206:207], v126 offset:21568
    v_mfma_f32_16x16x32_bf16 v[68:71], v[176:179], v[144:147], v[68:71]
    ds_read_b64_tr_b16 v[208:209], v123 offset:14464
    v_mfma_f32_16x16x32_bf16 v[64:67], v[176:179], v[140:143], v[64:67]
    ds_read_b64_tr_b16 v[210:211], v123 offset:21632
    v_mfma_f32_16x16x32_bf16 v[60:63], v[176:179], v[136:139], v[60:63]
    ds_read_b64_tr_b16 v[212:213], v126 offset:14464
    v_mfma_f32_16x16x32_bf16 v[56:59], v[176:179], v[132:135], v[56:59]
    ds_read_b64_tr_b16 v[214:215], v126 offset:21632
    s_waitcnt lgkmcnt(15)
    v_mfma_f32_16x16x32_bf16 v[72:75], v[180:183], v[132:135], v[72:75]
    ds_read_b64_tr_b16 v[216:217], v129 offset:14336
    v_mfma_f32_16x16x32_bf16 v[76:79], v[180:183], v[136:139], v[76:79]
    ds_read_b64_tr_b16 v[218:219], v129 offset:21504
    v_mfma_f32_16x16x32_bf16 v[80:83], v[180:183], v[140:143], v[80:83]
    v_mfma_f32_16x16x32_bf16 v[84:87], v[180:183], v[144:147], v[84:87]
    v_mfma_f32_16x16x32_bf16 v[100:103], v[184:187], v[144:147], v[100:103]
    v_mfma_f32_16x16x32_bf16 v[96:99], v[184:187], v[140:143], v[96:99]
    v_mfma_f32_16x16x32_bf16 v[92:95], v[184:187], v[136:139], v[92:95]
    v_mfma_f32_16x16x32_bf16 v[88:91], v[184:187], v[132:135], v[88:91]
    v_mfma_f32_16x16x32_bf16 v[104:107], v[188:191], v[132:135], v[104:107]
    v_mfma_f32_16x16x32_bf16 v[108:111], v[188:191], v[136:139], v[108:111]
    v_mfma_f32_16x16x32_bf16 v[112:115], v[188:191], v[140:143], v[112:115]
    v_mfma_f32_16x16x32_bf16 v[116:119], v[188:191], v[144:147], v[116:119]
    s_waitcnt lgkmcnt(10)
    v_mfma_f32_16x16x32_bf16 v[8:11], v[192:195], v[148:151], v[8:11]
    v_mfma_f32_16x16x32_bf16 v[12:15], v[192:195], v[152:155], v[12:15]
    v_mfma_f32_16x16x32_bf16 v[16:19], v[192:195], v[156:159], v[16:19]
    v_mfma_f32_16x16x32_bf16 v[20:23], v[192:195], v[160:163], v[20:23]
    s_waitcnt lgkmcnt(0)
    s_barrier
    v_mfma_f32_16x16x32_bf16 v[36:39], v[196:199], v[160:163], v[36:39]
    ds_read_b128 v[132:135], v120 offset:32768
    v_mfma_f32_16x16x32_bf16 v[32:35], v[196:199], v[156:159], v[32:35]
    ds_read_b64_tr_b16 v[164:165], v122 offset:0
    v_mfma_f32_16x16x32_bf16 v[28:31], v[196:199], v[152:155], v[28:31]
    ds_read_b64_tr_b16 v[166:167], v122 offset:7168
    v_mfma_f32_16x16x32_bf16 v[24:27], v[196:199], v[148:151], v[24:27]
    ds_read_b128 v[136:139], v120 offset:33792
    v_mfma_f32_16x16x32_bf16 v[40:43], v[200:203], v[148:151], v[40:43]
    ds_read_b128 v[140:143], v120 offset:34816
    v_mfma_f32_16x16x32_bf16 v[44:47], v[200:203], v[152:155], v[44:47]
    ds_read_b128 v[144:147], v120 offset:35840
    v_mfma_f32_16x16x32_bf16 v[48:51], v[200:203], v[156:159], v[48:51]
    ds_read_b64_tr_b16 v[168:169], v125 offset:0
    v_mfma_f32_16x16x32_bf16 v[52:55], v[200:203], v[160:163], v[52:55]
    ds_read_b64_tr_b16 v[170:171], v125 offset:7168
    v_mfma_f32_16x16x32_bf16 v[68:71], v[204:207], v[160:163], v[68:71]
    ds_read_b64_tr_b16 v[172:173], v122 offset:64
    v_mfma_f32_16x16x32_bf16 v[64:67], v[204:207], v[156:159], v[64:67]
    ds_read_b64_tr_b16 v[174:175], v122 offset:7232
    v_mfma_f32_16x16x32_bf16 v[60:63], v[204:207], v[152:155], v[60:63]
    ds_read_b64_tr_b16 v[176:177], v125 offset:64
    v_mfma_f32_16x16x32_bf16 v[56:59], v[204:207], v[148:151], v[56:59]
    ds_read_b64_tr_b16 v[178:179], v125 offset:7232
    v_mfma_f32_16x16x32_bf16 v[72:75], v[208:211], v[148:151], v[72:75]
    ds_read_b64_tr_b16 v[180:181], v122 offset:128
    v_mfma_f32_16x16x32_bf16 v[76:79], v[208:211], v[152:155], v[76:79]
    ds_read_b64_tr_b16 v[182:183], v122 offset:7296
    v_mfma_f32_16x16x32_bf16 v[80:83], v[208:211], v[156:159], v[80:83]
    ds_read_b64_tr_b16 v[184:185], v125 offset:128
    v_mfma_f32_16x16x32_bf16 v[84:87], v[208:211], v[160:163], v[84:87]
    ds_read_b64_tr_b16 v[186:187], v125 offset:7296
    v_mfma_f32_16x16x32_bf16 v[100:103], v[212:215], v[160:163], v[100:103]
    ds_read_b64_tr_b16 v[188:189], v128 offset:0
    v_mfma_f32_16x16x32_bf16 v[96:99], v[212:215], v[156:159], v[96:99]
    ds_read_b64_tr_b16 v[190:191], v128 offset:7168
    v_mfma_f32_16x16x32_bf16 v[92:95], v[212:215], v[152:155], v[92:95]
    v_mfma_f32_16x16x32_bf16 v[88:91], v[212:215], v[148:151], v[88:91]
    v_mfma_f32_16x16x32_bf16 v[104:107], v[216:219], v[148:151], v[104:107]
    v_mfma_f32_16x16x32_bf16 v[108:111], v[216:219], v[152:155], v[108:111]
    v_mfma_f32_16x16x32_bf16 v[112:115], v[216:219], v[156:159], v[112:115]
    v_mfma_f32_16x16x32_bf16 v[116:119], v[216:219], v[160:163], v[116:119]
    s_waitcnt lgkmcnt(10)
    v_mfma_f32_16x16x32_bf16 v[8:11], v[164:167], v[132:135], v[8:11]
    ds_read_b128 v[148:151], v120 offset:40960
    v_mfma_f32_16x16x32_bf16 v[12:15], v[164:167], v[136:139], v[12:15]
    ds_read_b64_tr_b16 v[192:193], v122 offset:14336
    v_mfma_f32_16x16x32_bf16 v[16:19], v[164:167], v[140:143], v[16:19]
    ds_read_b64_tr_b16 v[194:195], v122 offset:21504
    v_mfma_f32_16x16x32_bf16 v[20:23], v[164:167], v[144:147], v[20:23]
    ds_read_b128 v[152:155], v120 offset:41984
    v_mfma_f32_16x16x32_bf16 v[36:39], v[168:171], v[144:147], v[36:39]
    ds_read_b128 v[156:159], v120 offset:43008
    v_mfma_f32_16x16x32_bf16 v[32:35], v[168:171], v[140:143], v[32:35]
    ds_read_b128 v[160:163], v120 offset:44032
    v_mfma_f32_16x16x32_bf16 v[28:31], v[168:171], v[136:139], v[28:31]
    ds_read_b64_tr_b16 v[196:197], v125 offset:14336
    v_mfma_f32_16x16x32_bf16 v[24:27], v[168:171], v[132:135], v[24:27]
    ds_read_b64_tr_b16 v[198:199], v125 offset:21504
    s_waitcnt lgkmcnt(14)
    v_mfma_f32_16x16x32_bf16 v[40:43], v[172:175], v[132:135], v[40:43]
    ds_read_b64_tr_b16 v[200:201], v122 offset:14400
    v_mfma_f32_16x16x32_bf16 v[44:47], v[172:175], v[136:139], v[44:47]
    ds_read_b64_tr_b16 v[202:203], v122 offset:21568
    v_mfma_f32_16x16x32_bf16 v[48:51], v[172:175], v[140:143], v[48:51]
    ds_read_b64_tr_b16 v[204:205], v125 offset:14400
    v_mfma_f32_16x16x32_bf16 v[52:55], v[172:175], v[144:147], v[52:55]
    ds_read_b64_tr_b16 v[206:207], v125 offset:21568
    v_mfma_f32_16x16x32_bf16 v[68:71], v[176:179], v[144:147], v[68:71]
    ds_read_b64_tr_b16 v[208:209], v122 offset:14464
    v_mfma_f32_16x16x32_bf16 v[64:67], v[176:179], v[140:143], v[64:67]
    ds_read_b64_tr_b16 v[210:211], v122 offset:21632
    v_mfma_f32_16x16x32_bf16 v[60:63], v[176:179], v[136:139], v[60:63]
    ds_read_b64_tr_b16 v[212:213], v125 offset:14464
    v_mfma_f32_16x16x32_bf16 v[56:59], v[176:179], v[132:135], v[56:59]
    ds_read_b64_tr_b16 v[214:215], v125 offset:21632
    s_waitcnt lgkmcnt(15)
    v_mfma_f32_16x16x32_bf16 v[72:75], v[180:183], v[132:135], v[72:75]
    ds_read_b64_tr_b16 v[216:217], v128 offset:14336
    v_mfma_f32_16x16x32_bf16 v[76:79], v[180:183], v[136:139], v[76:79]
    ds_read_b64_tr_b16 v[218:219], v128 offset:21504
    v_mfma_f32_16x16x32_bf16 v[80:83], v[180:183], v[140:143], v[80:83]
    v_mfma_f32_16x16x32_bf16 v[84:87], v[180:183], v[144:147], v[84:87]
    v_mfma_f32_16x16x32_bf16 v[100:103], v[184:187], v[144:147], v[100:103]
    v_mfma_f32_16x16x32_bf16 v[96:99], v[184:187], v[140:143], v[96:99]
    v_mfma_f32_16x16x32_bf16 v[92:95], v[184:187], v[136:139], v[92:95]
    v_mfma_f32_16x16x32_bf16 v[88:91], v[184:187], v[132:135], v[88:91]
    v_mfma_f32_16x16x32_bf16 v[104:107], v[188:191], v[132:135], v[104:107]
    v_mfma_f32_16x16x32_bf16 v[108:111], v[188:191], v[136:139], v[108:111]
    v_mfma_f32_16x16x32_bf16 v[112:115], v[188:191], v[140:143], v[112:115]
    v_mfma_f32_16x16x32_bf16 v[116:119], v[188:191], v[144:147], v[116:119]
    s_waitcnt lgkmcnt(10)
    v_mfma_f32_16x16x32_bf16 v[8:11], v[192:195], v[148:151], v[8:11]
    v_mfma_f32_16x16x32_bf16 v[12:15], v[192:195], v[152:155], v[12:15]
    v_mfma_f32_16x16x32_bf16 v[16:19], v[192:195], v[156:159], v[16:19]
    v_mfma_f32_16x16x32_bf16 v[20:23], v[192:195], v[160:163], v[20:23]
    s_waitcnt lgkmcnt(0)
    s_barrier
    v_mfma_f32_16x16x32_bf16 v[36:39], v[196:199], v[160:163], v[36:39]
    ds_read_b128 v[132:135], v120 offset:49152
    v_mfma_f32_16x16x32_bf16 v[32:35], v[196:199], v[156:159], v[32:35]
    ds_read_b64_tr_b16 v[164:165], v122 offset:28672
    v_mfma_f32_16x16x32_bf16 v[28:31], v[196:199], v[152:155], v[28:31]
    ds_read_b64_tr_b16 v[166:167], v122 offset:35840
    v_mfma_f32_16x16x32_bf16 v[24:27], v[196:199], v[148:151], v[24:27]
    ds_read_b128 v[136:139], v120 offset:50176
    v_mfma_f32_16x16x32_bf16 v[40:43], v[200:203], v[148:151], v[40:43]
    ds_read_b128 v[140:143], v120 offset:51200
    v_mfma_f32_16x16x32_bf16 v[44:47], v[200:203], v[152:155], v[44:47]
    ds_read_b128 v[144:147], v120 offset:52224
    v_mfma_f32_16x16x32_bf16 v[48:51], v[200:203], v[156:159], v[48:51]
    ds_read_b64_tr_b16 v[168:169], v125 offset:28672
    v_mfma_f32_16x16x32_bf16 v[52:55], v[200:203], v[160:163], v[52:55]
    ds_read_b64_tr_b16 v[170:171], v125 offset:35840
    v_mfma_f32_16x16x32_bf16 v[68:71], v[204:207], v[160:163], v[68:71]
    ds_read_b64_tr_b16 v[172:173], v122 offset:28736
    v_mfma_f32_16x16x32_bf16 v[64:67], v[204:207], v[156:159], v[64:67]
    ds_read_b64_tr_b16 v[174:175], v122 offset:35904
    v_mfma_f32_16x16x32_bf16 v[60:63], v[204:207], v[152:155], v[60:63]
    ds_read_b64_tr_b16 v[176:177], v125 offset:28736
    v_mfma_f32_16x16x32_bf16 v[56:59], v[204:207], v[148:151], v[56:59]
    ds_read_b64_tr_b16 v[178:179], v125 offset:35904
    v_mfma_f32_16x16x32_bf16 v[72:75], v[208:211], v[148:151], v[72:75]
    ds_read_b64_tr_b16 v[180:181], v122 offset:28800
    v_mfma_f32_16x16x32_bf16 v[76:79], v[208:211], v[152:155], v[76:79]
    ds_read_b64_tr_b16 v[182:183], v122 offset:35968
    v_mfma_f32_16x16x32_bf16 v[80:83], v[208:211], v[156:159], v[80:83]
    ds_read_b64_tr_b16 v[184:185], v125 offset:28800
    v_mfma_f32_16x16x32_bf16 v[84:87], v[208:211], v[160:163], v[84:87]
    ds_read_b64_tr_b16 v[186:187], v125 offset:35968
    v_mfma_f32_16x16x32_bf16 v[100:103], v[212:215], v[160:163], v[100:103]
    ds_read_b64_tr_b16 v[188:189], v128 offset:28672
    v_mfma_f32_16x16x32_bf16 v[96:99], v[212:215], v[156:159], v[96:99]
    ds_read_b64_tr_b16 v[190:191], v128 offset:35840
    v_mfma_f32_16x16x32_bf16 v[92:95], v[212:215], v[152:155], v[92:95]
    v_mfma_f32_16x16x32_bf16 v[88:91], v[212:215], v[148:151], v[88:91]
    v_mfma_f32_16x16x32_bf16 v[104:107], v[216:219], v[148:151], v[104:107]
    v_mfma_f32_16x16x32_bf16 v[108:111], v[216:219], v[152:155], v[108:111]
    v_mfma_f32_16x16x32_bf16 v[112:115], v[216:219], v[156:159], v[112:115]
    v_mfma_f32_16x16x32_bf16 v[116:119], v[216:219], v[160:163], v[116:119]
    s_waitcnt lgkmcnt(10)
    v_mfma_f32_16x16x32_bf16 v[8:11], v[164:167], v[132:135], v[8:11]
    ds_read_b128 v[148:151], v120 offset:57344
    v_mfma_f32_16x16x32_bf16 v[12:15], v[164:167], v[136:139], v[12:15]
    ds_read_b64_tr_b16 v[192:193], v122 offset:43008
    v_mfma_f32_16x16x32_bf16 v[16:19], v[164:167], v[140:143], v[16:19]
    ds_read_b64_tr_b16 v[194:195], v122 offset:50176
    v_mfma_f32_16x16x32_bf16 v[20:23], v[164:167], v[144:147], v[20:23]
    ds_read_b128 v[152:155], v120 offset:58368
    v_mfma_f32_16x16x32_bf16 v[36:39], v[168:171], v[144:147], v[36:39]
    ds_read_b128 v[156:159], v120 offset:59392
    v_mfma_f32_16x16x32_bf16 v[32:35], v[168:171], v[140:143], v[32:35]
    ds_read_b128 v[160:163], v120 offset:60416
    v_mfma_f32_16x16x32_bf16 v[28:31], v[168:171], v[136:139], v[28:31]
    ds_read_b64_tr_b16 v[196:197], v125 offset:43008
    v_mfma_f32_16x16x32_bf16 v[24:27], v[168:171], v[132:135], v[24:27]
    ds_read_b64_tr_b16 v[198:199], v125 offset:50176
    s_waitcnt lgkmcnt(14)
    v_mfma_f32_16x16x32_bf16 v[40:43], v[172:175], v[132:135], v[40:43]
    ds_read_b64_tr_b16 v[200:201], v122 offset:43072
    v_mfma_f32_16x16x32_bf16 v[44:47], v[172:175], v[136:139], v[44:47]
    ds_read_b64_tr_b16 v[202:203], v122 offset:50240
    v_mfma_f32_16x16x32_bf16 v[48:51], v[172:175], v[140:143], v[48:51]
    ds_read_b64_tr_b16 v[204:205], v125 offset:43072
    v_mfma_f32_16x16x32_bf16 v[52:55], v[172:175], v[144:147], v[52:55]
    ds_read_b64_tr_b16 v[206:207], v125 offset:50240
    v_mfma_f32_16x16x32_bf16 v[68:71], v[176:179], v[144:147], v[68:71]
    ds_read_b64_tr_b16 v[208:209], v122 offset:43136
    v_mfma_f32_16x16x32_bf16 v[64:67], v[176:179], v[140:143], v[64:67]
    ds_read_b64_tr_b16 v[210:211], v122 offset:50304
    v_mfma_f32_16x16x32_bf16 v[60:63], v[176:179], v[136:139], v[60:63]
    ds_read_b64_tr_b16 v[212:213], v125 offset:43136
    v_mfma_f32_16x16x32_bf16 v[56:59], v[176:179], v[132:135], v[56:59]
    ds_read_b64_tr_b16 v[214:215], v125 offset:50304
    s_waitcnt lgkmcnt(15)
    v_mfma_f32_16x16x32_bf16 v[72:75], v[180:183], v[132:135], v[72:75]
    ds_read_b64_tr_b16 v[216:217], v128 offset:43008
    v_mfma_f32_16x16x32_bf16 v[76:79], v[180:183], v[136:139], v[76:79]
    ds_read_b64_tr_b16 v[218:219], v128 offset:50176
    v_mfma_f32_16x16x32_bf16 v[80:83], v[180:183], v[140:143], v[80:83]
    v_mfma_f32_16x16x32_bf16 v[84:87], v[180:183], v[144:147], v[84:87]
    v_mfma_f32_16x16x32_bf16 v[100:103], v[184:187], v[144:147], v[100:103]
    v_mfma_f32_16x16x32_bf16 v[96:99], v[184:187], v[140:143], v[96:99]
    v_mfma_f32_16x16x32_bf16 v[92:95], v[184:187], v[136:139], v[92:95]
    v_mfma_f32_16x16x32_bf16 v[88:91], v[184:187], v[132:135], v[88:91]
    v_mfma_f32_16x16x32_bf16 v[104:107], v[188:191], v[132:135], v[104:107]
    v_mfma_f32_16x16x32_bf16 v[108:111], v[188:191], v[136:139], v[108:111]
    v_mfma_f32_16x16x32_bf16 v[112:115], v[188:191], v[140:143], v[112:115]
    v_mfma_f32_16x16x32_bf16 v[116:119], v[188:191], v[144:147], v[116:119]
    s_waitcnt lgkmcnt(10)
    v_mfma_f32_16x16x32_bf16 v[8:11], v[192:195], v[148:151], v[8:11]
    v_mfma_f32_16x16x32_bf16 v[12:15], v[192:195], v[152:155], v[12:15]
    v_mfma_f32_16x16x32_bf16 v[16:19], v[192:195], v[156:159], v[16:19]
    v_mfma_f32_16x16x32_bf16 v[20:23], v[192:195], v[160:163], v[20:23]
    s_waitcnt lgkmcnt(0)
    s_barrier
    v_mfma_f32_16x16x32_bf16 v[36:39], v[196:199], v[160:163], v[36:39]
    ds_read_b128 v[132:135], v120 offset:0
    v_mfma_f32_16x16x32_bf16 v[32:35], v[196:199], v[156:159], v[32:35]
    ds_read_b64_tr_b16 v[164:165], v123 offset:0
    v_mfma_f32_16x16x32_bf16 v[28:31], v[196:199], v[152:155], v[28:31]
    ds_read_b64_tr_b16 v[166:167], v123 offset:7168
    v_mfma_f32_16x16x32_bf16 v[24:27], v[196:199], v[148:151], v[24:27]
    ds_read_b128 v[136:139], v120 offset:1024
    v_mfma_f32_16x16x32_bf16 v[40:43], v[200:203], v[148:151], v[40:43]
    ds_read_b128 v[140:143], v120 offset:2048
    v_mfma_f32_16x16x32_bf16 v[44:47], v[200:203], v[152:155], v[44:47]
    ds_read_b128 v[144:147], v120 offset:3072
    v_mfma_f32_16x16x32_bf16 v[48:51], v[200:203], v[156:159], v[48:51]
    ds_read_b64_tr_b16 v[168:169], v126 offset:0
    v_mfma_f32_16x16x32_bf16 v[52:55], v[200:203], v[160:163], v[52:55]
    ds_read_b64_tr_b16 v[170:171], v126 offset:7168
    v_mfma_f32_16x16x32_bf16 v[68:71], v[204:207], v[160:163], v[68:71]
    ds_read_b64_tr_b16 v[172:173], v123 offset:64
    v_mfma_f32_16x16x32_bf16 v[64:67], v[204:207], v[156:159], v[64:67]
    ds_read_b64_tr_b16 v[174:175], v123 offset:7232
    v_mfma_f32_16x16x32_bf16 v[60:63], v[204:207], v[152:155], v[60:63]
    ds_read_b64_tr_b16 v[176:177], v126 offset:64
    v_mfma_f32_16x16x32_bf16 v[56:59], v[204:207], v[148:151], v[56:59]
    ds_read_b64_tr_b16 v[178:179], v126 offset:7232
    v_mfma_f32_16x16x32_bf16 v[72:75], v[208:211], v[148:151], v[72:75]
    ds_read_b64_tr_b16 v[180:181], v123 offset:128
    v_mfma_f32_16x16x32_bf16 v[76:79], v[208:211], v[152:155], v[76:79]
    ds_read_b64_tr_b16 v[182:183], v123 offset:7296
    v_mfma_f32_16x16x32_bf16 v[80:83], v[208:211], v[156:159], v[80:83]
    ds_read_b64_tr_b16 v[184:185], v126 offset:128
    v_mfma_f32_16x16x32_bf16 v[84:87], v[208:211], v[160:163], v[84:87]
    ds_read_b64_tr_b16 v[186:187], v126 offset:7296
    v_mfma_f32_16x16x32_bf16 v[100:103], v[212:215], v[160:163], v[100:103]
    ds_read_b64_tr_b16 v[188:189], v129 offset:0
    v_mfma_f32_16x16x32_bf16 v[96:99], v[212:215], v[156:159], v[96:99]
    ds_read_b64_tr_b16 v[190:191], v129 offset:7168
    v_mfma_f32_16x16x32_bf16 v[92:95], v[212:215], v[152:155], v[92:95]
    v_mfma_f32_16x16x32_bf16 v[88:91], v[212:215], v[148:151], v[88:91]
    v_mfma_f32_16x16x32_bf16 v[104:107], v[216:219], v[148:151], v[104:107]
    v_mfma_f32_16x16x32_bf16 v[108:111], v[216:219], v[152:155], v[108:111]
    v_mfma_f32_16x16x32_bf16 v[112:115], v[216:219], v[156:159], v[112:115]
    v_mfma_f32_16x16x32_bf16 v[116:119], v[216:219], v[160:163], v[116:119]
    s_waitcnt lgkmcnt(10)
    v_mfma_f32_16x16x32_bf16 v[8:11], v[164:167], v[132:135], v[8:11]
    ds_read_b128 v[148:151], v120 offset:8192
    v_mfma_f32_16x16x32_bf16 v[12:15], v[164:167], v[136:139], v[12:15]
    ds_read_b64_tr_b16 v[192:193], v123 offset:14336
    v_mfma_f32_16x16x32_bf16 v[16:19], v[164:167], v[140:143], v[16:19]
    ds_read_b64_tr_b16 v[194:195], v123 offset:21504
    v_mfma_f32_16x16x32_bf16 v[20:23], v[164:167], v[144:147], v[20:23]
    ds_read_b128 v[152:155], v120 offset:9216
    v_mfma_f32_16x16x32_bf16 v[36:39], v[168:171], v[144:147], v[36:39]
    ds_read_b128 v[156:159], v120 offset:10240
    v_mfma_f32_16x16x32_bf16 v[32:35], v[168:171], v[140:143], v[32:35]
    ds_read_b128 v[160:163], v120 offset:11264
    v_mfma_f32_16x16x32_bf16 v[28:31], v[168:171], v[136:139], v[28:31]
    ds_read_b64_tr_b16 v[196:197], v126 offset:14336
    v_mfma_f32_16x16x32_bf16 v[24:27], v[168:171], v[132:135], v[24:27]
    ds_read_b64_tr_b16 v[198:199], v126 offset:21504
    s_waitcnt lgkmcnt(14)
    v_mfma_f32_16x16x32_bf16 v[40:43], v[172:175], v[132:135], v[40:43]
    ds_read_b64_tr_b16 v[200:201], v123 offset:14400
    v_mfma_f32_16x16x32_bf16 v[44:47], v[172:175], v[136:139], v[44:47]
    ds_read_b64_tr_b16 v[202:203], v123 offset:21568
    v_mfma_f32_16x16x32_bf16 v[48:51], v[172:175], v[140:143], v[48:51]
    ds_read_b64_tr_b16 v[204:205], v126 offset:14400
    v_mfma_f32_16x16x32_bf16 v[52:55], v[172:175], v[144:147], v[52:55]
    ds_read_b64_tr_b16 v[206:207], v126 offset:21568
    v_mfma_f32_16x16x32_bf16 v[68:71], v[176:179], v[144:147], v[68:71]
    ds_read_b64_tr_b16 v[208:209], v123 offset:14464
    v_mfma_f32_16x16x32_bf16 v[64:67], v[176:179], v[140:143], v[64:67]
    ds_read_b64_tr_b16 v[210:211], v123 offset:21632
    v_mfma_f32_16x16x32_bf16 v[60:63], v[176:179], v[136:139], v[60:63]
    ds_read_b64_tr_b16 v[212:213], v126 offset:14464
    v_mfma_f32_16x16x32_bf16 v[56:59], v[176:179], v[132:135], v[56:59]
    ds_read_b64_tr_b16 v[214:215], v126 offset:21632
    s_waitcnt lgkmcnt(15)
    v_mfma_f32_16x16x32_bf16 v[72:75], v[180:183], v[132:135], v[72:75]
    ds_read_b64_tr_b16 v[216:217], v129 offset:14336
    v_mfma_f32_16x16x32_bf16 v[76:79], v[180:183], v[136:139], v[76:79]
    ds_read_b64_tr_b16 v[218:219], v129 offset:21504
    v_mfma_f32_16x16x32_bf16 v[80:83], v[180:183], v[140:143], v[80:83]
    v_mfma_f32_16x16x32_bf16 v[84:87], v[180:183], v[144:147], v[84:87]
    v_mfma_f32_16x16x32_bf16 v[100:103], v[184:187], v[144:147], v[100:103]
    v_mfma_f32_16x16x32_bf16 v[96:99], v[184:187], v[140:143], v[96:99]
    v_mfma_f32_16x16x32_bf16 v[92:95], v[184:187], v[136:139], v[92:95]
    v_mfma_f32_16x16x32_bf16 v[88:91], v[184:187], v[132:135], v[88:91]
    v_mfma_f32_16x16x32_bf16 v[104:107], v[188:191], v[132:135], v[104:107]
    v_mfma_f32_16x16x32_bf16 v[108:111], v[188:191], v[136:139], v[108:111]
    v_mfma_f32_16x16x32_bf16 v[112:115], v[188:191], v[140:143], v[112:115]
    v_mfma_f32_16x16x32_bf16 v[116:119], v[188:191], v[144:147], v[116:119]
    s_waitcnt lgkmcnt(10)
    v_mfma_f32_16x16x32_bf16 v[8:11], v[192:195], v[148:151], v[8:11]
    v_mfma_f32_16x16x32_bf16 v[12:15], v[192:195], v[152:155], v[12:15]
    v_mfma_f32_16x16x32_bf16 v[16:19], v[192:195], v[156:159], v[16:19]
    v_mfma_f32_16x16x32_bf16 v[20:23], v[192:195], v[160:163], v[20:23]
    s_waitcnt lgkmcnt(0)
    s_barrier
    v_mfma_f32_16x16x32_bf16 v[36:39], v[196:199], v[160:163], v[36:39]
    ds_read_b128 v[132:135], v120 offset:16384
    v_mfma_f32_16x16x32_bf16 v[32:35], v[196:199], v[156:159], v[32:35]
    ds_read_b64_tr_b16 v[164:165], v122 offset:0
    v_mfma_f32_16x16x32_bf16 v[28:31], v[196:199], v[152:155], v[28:31]
    ds_read_b64_tr_b16 v[166:167], v122 offset:7168
    v_mfma_f32_16x16x32_bf16 v[24:27], v[196:199], v[148:151], v[24:27]
    ds_read_b128 v[136:139], v120 offset:17408
    v_mfma_f32_16x16x32_bf16 v[40:43], v[200:203], v[148:151], v[40:43]
    ds_read_b128 v[140:143], v120 offset:18432
    v_mfma_f32_16x16x32_bf16 v[44:47], v[200:203], v[152:155], v[44:47]
    ds_read_b128 v[144:147], v120 offset:19456
    v_mfma_f32_16x16x32_bf16 v[48:51], v[200:203], v[156:159], v[48:51]
    ds_read_b64_tr_b16 v[168:169], v125 offset:0
    v_mfma_f32_16x16x32_bf16 v[52:55], v[200:203], v[160:163], v[52:55]
    ds_read_b64_tr_b16 v[170:171], v125 offset:7168
    v_mfma_f32_16x16x32_bf16 v[68:71], v[204:207], v[160:163], v[68:71]
    ds_read_b64_tr_b16 v[172:173], v122 offset:64
    v_mfma_f32_16x16x32_bf16 v[64:67], v[204:207], v[156:159], v[64:67]
    ds_read_b64_tr_b16 v[174:175], v122 offset:7232
    v_mfma_f32_16x16x32_bf16 v[60:63], v[204:207], v[152:155], v[60:63]
    ds_read_b64_tr_b16 v[176:177], v125 offset:64
    v_mfma_f32_16x16x32_bf16 v[56:59], v[204:207], v[148:151], v[56:59]
    ds_read_b64_tr_b16 v[178:179], v125 offset:7232
    v_mfma_f32_16x16x32_bf16 v[72:75], v[208:211], v[148:151], v[72:75]
    ds_read_b64_tr_b16 v[180:181], v122 offset:128
    v_mfma_f32_16x16x32_bf16 v[76:79], v[208:211], v[152:155], v[76:79]
    ds_read_b64_tr_b16 v[182:183], v122 offset:7296
    v_mfma_f32_16x16x32_bf16 v[80:83], v[208:211], v[156:159], v[80:83]
    ds_read_b64_tr_b16 v[184:185], v125 offset:128
    v_mfma_f32_16x16x32_bf16 v[84:87], v[208:211], v[160:163], v[84:87]
    ds_read_b64_tr_b16 v[186:187], v125 offset:7296
    v_mfma_f32_16x16x32_bf16 v[100:103], v[212:215], v[160:163], v[100:103]
    ds_read_b64_tr_b16 v[188:189], v128 offset:0
    v_mfma_f32_16x16x32_bf16 v[96:99], v[212:215], v[156:159], v[96:99]
    ds_read_b64_tr_b16 v[190:191], v128 offset:7168
    v_mfma_f32_16x16x32_bf16 v[92:95], v[212:215], v[152:155], v[92:95]
    v_mfma_f32_16x16x32_bf16 v[88:91], v[212:215], v[148:151], v[88:91]
    v_mfma_f32_16x16x32_bf16 v[104:107], v[216:219], v[148:151], v[104:107]
    v_mfma_f32_16x16x32_bf16 v[108:111], v[216:219], v[152:155], v[108:111]
    v_mfma_f32_16x16x32_bf16 v[112:115], v[216:219], v[156:159], v[112:115]
    v_mfma_f32_16x16x32_bf16 v[116:119], v[216:219], v[160:163], v[116:119]
    s_waitcnt lgkmcnt(10)
    v_mfma_f32_16x16x32_bf16 v[8:11], v[164:167], v[132:135], v[8:11]
    ds_read_b128 v[148:151], v120 offset:24576
    v_mfma_f32_16x16x32_bf16 v[12:15], v[164:167], v[136:139], v[12:15]
    ds_read_b64_tr_b16 v[192:193], v122 offset:14336
    v_mfma_f32_16x16x32_bf16 v[16:19], v[164:167], v[140:143], v[16:19]
    ds_read_b64_tr_b16 v[194:195], v122 offset:21504
    v_mfma_f32_16x16x32_bf16 v[20:23], v[164:167], v[144:147], v[20:23]
    ds_read_b128 v[152:155], v120 offset:25600
    v_mfma_f32_16x16x32_bf16 v[36:39], v[168:171], v[144:147], v[36:39]
    ds_read_b128 v[156:159], v120 offset:26624
    v_mfma_f32_16x16x32_bf16 v[32:35], v[168:171], v[140:143], v[32:35]
    ds_read_b128 v[160:163], v120 offset:27648
    v_mfma_f32_16x16x32_bf16 v[28:31], v[168:171], v[136:139], v[28:31]
    ds_read_b64_tr_b16 v[196:197], v125 offset:14336
    v_mfma_f32_16x16x32_bf16 v[24:27], v[168:171], v[132:135], v[24:27]
    ds_read_b64_tr_b16 v[198:199], v125 offset:21504
    s_waitcnt lgkmcnt(14)
    v_mfma_f32_16x16x32_bf16 v[40:43], v[172:175], v[132:135], v[40:43]
    ds_read_b64_tr_b16 v[200:201], v122 offset:14400
    v_mfma_f32_16x16x32_bf16 v[44:47], v[172:175], v[136:139], v[44:47]
    ds_read_b64_tr_b16 v[202:203], v122 offset:21568
    v_mfma_f32_16x16x32_bf16 v[48:51], v[172:175], v[140:143], v[48:51]
    ds_read_b64_tr_b16 v[204:205], v125 offset:14400
    v_mfma_f32_16x16x32_bf16 v[52:55], v[172:175], v[144:147], v[52:55]
    ds_read_b64_tr_b16 v[206:207], v125 offset:21568
    v_mfma_f32_16x16x32_bf16 v[68:71], v[176:179], v[144:147], v[68:71]
    ds_read_b64_tr_b16 v[208:209], v122 offset:14464
    v_mfma_f32_16x16x32_bf16 v[64:67], v[176:179], v[140:143], v[64:67]
    ds_read_b64_tr_b16 v[210:211], v122 offset:21632
    v_mfma_f32_16x16x32_bf16 v[60:63], v[176:179], v[136:139], v[60:63]
    ds_read_b64_tr_b16 v[212:213], v125 offset:14464
    v_mfma_f32_16x16x32_bf16 v[56:59], v[176:179], v[132:135], v[56:59]
    ds_read_b64_tr_b16 v[214:215], v125 offset:21632
    s_waitcnt lgkmcnt(15)
    v_mfma_f32_16x16x32_bf16 v[72:75], v[180:183], v[132:135], v[72:75]
    ds_read_b64_tr_b16 v[216:217], v128 offset:14336
    v_mfma_f32_16x16x32_bf16 v[76:79], v[180:183], v[136:139], v[76:79]
    ds_read_b64_tr_b16 v[218:219], v128 offset:21504
    v_mfma_f32_16x16x32_bf16 v[80:83], v[180:183], v[140:143], v[80:83]
    v_mfma_f32_16x16x32_bf16 v[84:87], v[180:183], v[144:147], v[84:87]
    v_mfma_f32_16x16x32_bf16 v[100:103], v[184:187], v[144:147], v[100:103]
    v_mfma_f32_16x16x32_bf16 v[96:99], v[184:187], v[140:143], v[96:99]
    v_mfma_f32_16x16x32_bf16 v[92:95], v[184:187], v[136:139], v[92:95]
    v_mfma_f32_16x16x32_bf16 v[88:91], v[184:187], v[132:135], v[88:91]
    v_mfma_f32_16x16x32_bf16 v[104:107], v[188:191], v[132:135], v[104:107]
    v_mfma_f32_16x16x32_bf16 v[108:111], v[188:191], v[136:139], v[108:111]
    v_mfma_f32_16x16x32_bf16 v[112:115], v[188:191], v[140:143], v[112:115]
    v_mfma_f32_16x16x32_bf16 v[116:119], v[188:191], v[144:147], v[116:119]
    s_waitcnt lgkmcnt(10)
    v_mfma_f32_16x16x32_bf16 v[8:11], v[192:195], v[148:151], v[8:11]
    v_mfma_f32_16x16x32_bf16 v[12:15], v[192:195], v[152:155], v[12:15]
    v_mfma_f32_16x16x32_bf16 v[16:19], v[192:195], v[156:159], v[16:19]
    v_mfma_f32_16x16x32_bf16 v[20:23], v[192:195], v[160:163], v[20:23]
    s_waitcnt lgkmcnt(0)
    s_barrier
    v_mfma_f32_16x16x32_bf16 v[36:39], v[196:199], v[160:163], v[36:39]
    ds_read_b128 v[132:135], v120 offset:32768
    v_mfma_f32_16x16x32_bf16 v[32:35], v[196:199], v[156:159], v[32:35]
    ds_read_b64_tr_b16 v[164:165], v122 offset:28672
    v_mfma_f32_16x16x32_bf16 v[28:31], v[196:199], v[152:155], v[28:31]
    ds_read_b64_tr_b16 v[166:167], v122 offset:35840
    v_mfma_f32_16x16x32_bf16 v[24:27], v[196:199], v[148:151], v[24:27]
    ds_read_b128 v[136:139], v120 offset:33792
    v_mfma_f32_16x16x32_bf16 v[40:43], v[200:203], v[148:151], v[40:43]
    ds_read_b128 v[140:143], v120 offset:34816
    v_mfma_f32_16x16x32_bf16 v[44:47], v[200:203], v[152:155], v[44:47]
    ds_read_b128 v[144:147], v120 offset:35840
    v_mfma_f32_16x16x32_bf16 v[48:51], v[200:203], v[156:159], v[48:51]
    ds_read_b64_tr_b16 v[168:169], v125 offset:28672
    v_mfma_f32_16x16x32_bf16 v[52:55], v[200:203], v[160:163], v[52:55]
    ds_read_b64_tr_b16 v[170:171], v125 offset:35840
    v_mfma_f32_16x16x32_bf16 v[68:71], v[204:207], v[160:163], v[68:71]
    ds_read_b64_tr_b16 v[172:173], v122 offset:28736
    v_mfma_f32_16x16x32_bf16 v[64:67], v[204:207], v[156:159], v[64:67]
    ds_read_b64_tr_b16 v[174:175], v122 offset:35904
    v_mfma_f32_16x16x32_bf16 v[60:63], v[204:207], v[152:155], v[60:63]
    ds_read_b64_tr_b16 v[176:177], v125 offset:28736
    v_mfma_f32_16x16x32_bf16 v[56:59], v[204:207], v[148:151], v[56:59]
    ds_read_b64_tr_b16 v[178:179], v125 offset:35904
    v_mfma_f32_16x16x32_bf16 v[72:75], v[208:211], v[148:151], v[72:75]
    ds_read_b64_tr_b16 v[180:181], v122 offset:28800
    v_mfma_f32_16x16x32_bf16 v[76:79], v[208:211], v[152:155], v[76:79]
    ds_read_b64_tr_b16 v[182:183], v122 offset:35968
    v_mfma_f32_16x16x32_bf16 v[80:83], v[208:211], v[156:159], v[80:83]
    ds_read_b64_tr_b16 v[184:185], v125 offset:28800
    v_mfma_f32_16x16x32_bf16 v[84:87], v[208:211], v[160:163], v[84:87]
    ds_read_b64_tr_b16 v[186:187], v125 offset:35968
    v_mfma_f32_16x16x32_bf16 v[100:103], v[212:215], v[160:163], v[100:103]
    ds_read_b64_tr_b16 v[188:189], v128 offset:28672
    v_mfma_f32_16x16x32_bf16 v[96:99], v[212:215], v[156:159], v[96:99]
    ds_read_b64_tr_b16 v[190:191], v128 offset:35840
    v_mfma_f32_16x16x32_bf16 v[92:95], v[212:215], v[152:155], v[92:95]
    v_mfma_f32_16x16x32_bf16 v[88:91], v[212:215], v[148:151], v[88:91]
    v_mfma_f32_16x16x32_bf16 v[104:107], v[216:219], v[148:151], v[104:107]
    v_mfma_f32_16x16x32_bf16 v[108:111], v[216:219], v[152:155], v[108:111]
    v_mfma_f32_16x16x32_bf16 v[112:115], v[216:219], v[156:159], v[112:115]
    v_mfma_f32_16x16x32_bf16 v[116:119], v[216:219], v[160:163], v[116:119]
    s_waitcnt lgkmcnt(10)
    v_mfma_f32_16x16x32_bf16 v[8:11], v[164:167], v[132:135], v[8:11]
    ds_read_b128 v[148:151], v120 offset:40960
    v_mfma_f32_16x16x32_bf16 v[12:15], v[164:167], v[136:139], v[12:15]
    ds_read_b64_tr_b16 v[192:193], v122 offset:43008
    v_mfma_f32_16x16x32_bf16 v[16:19], v[164:167], v[140:143], v[16:19]
    ds_read_b64_tr_b16 v[194:195], v122 offset:50176
    v_mfma_f32_16x16x32_bf16 v[20:23], v[164:167], v[144:147], v[20:23]
    ds_read_b128 v[152:155], v120 offset:41984
    v_mfma_f32_16x16x32_bf16 v[36:39], v[168:171], v[144:147], v[36:39]
    ds_read_b128 v[156:159], v120 offset:43008
    v_mfma_f32_16x16x32_bf16 v[32:35], v[168:171], v[140:143], v[32:35]
    ds_read_b128 v[160:163], v120 offset:44032
    v_mfma_f32_16x16x32_bf16 v[28:31], v[168:171], v[136:139], v[28:31]
    ds_read_b64_tr_b16 v[196:197], v125 offset:43008
    v_mfma_f32_16x16x32_bf16 v[24:27], v[168:171], v[132:135], v[24:27]
    ds_read_b64_tr_b16 v[198:199], v125 offset:50176
    s_waitcnt lgkmcnt(14)
    v_mfma_f32_16x16x32_bf16 v[40:43], v[172:175], v[132:135], v[40:43]
    ds_read_b64_tr_b16 v[200:201], v122 offset:43072
    v_mfma_f32_16x16x32_bf16 v[44:47], v[172:175], v[136:139], v[44:47]
    ds_read_b64_tr_b16 v[202:203], v122 offset:50240
    v_mfma_f32_16x16x32_bf16 v[48:51], v[172:175], v[140:143], v[48:51]
    ds_read_b64_tr_b16 v[204:205], v125 offset:43072
    v_mfma_f32_16x16x32_bf16 v[52:55], v[172:175], v[144:147], v[52:55]
    ds_read_b64_tr_b16 v[206:207], v125 offset:50240
    v_mfma_f32_16x16x32_bf16 v[68:71], v[176:179], v[144:147], v[68:71]
    ds_read_b64_tr_b16 v[208:209], v122 offset:43136
    v_mfma_f32_16x16x32_bf16 v[64:67], v[176:179], v[140:143], v[64:67]
    ds_read_b64_tr_b16 v[210:211], v122 offset:50304
    v_mfma_f32_16x16x32_bf16 v[60:63], v[176:179], v[136:139], v[60:63]
    ds_read_b64_tr_b16 v[212:213], v125 offset:43136
    v_mfma_f32_16x16x32_bf16 v[56:59], v[176:179], v[132:135], v[56:59]
    ds_read_b64_tr_b16 v[214:215], v125 offset:50304
    s_waitcnt lgkmcnt(15)
    v_mfma_f32_16x16x32_bf16 v[72:75], v[180:183], v[132:135], v[72:75]
    ds_read_b64_tr_b16 v[216:217], v128 offset:43008
    v_mfma_f32_16x16x32_bf16 v[76:79], v[180:183], v[136:139], v[76:79]
    ds_read_b64_tr_b16 v[218:219], v128 offset:50176
    v_mfma_f32_16x16x32_bf16 v[80:83], v[180:183], v[140:143], v[80:83]
    v_mfma_f32_16x16x32_bf16 v[84:87], v[180:183], v[144:147], v[84:87]
    v_mfma_f32_16x16x32_bf16 v[100:103], v[184:187], v[144:147], v[100:103]
    v_mfma_f32_16x16x32_bf16 v[96:99], v[184:187], v[140:143], v[96:99]
    v_mfma_f32_16x16x32_bf16 v[92:95], v[184:187], v[136:139], v[92:95]
    v_mfma_f32_16x16x32_bf16 v[88:91], v[184:187], v[132:135], v[88:91]
    v_mfma_f32_16x16x32_bf16 v[104:107], v[188:191], v[132:135], v[104:107]
    v_mfma_f32_16x16x32_bf16 v[108:111], v[188:191], v[136:139], v[108:111]
    v_mfma_f32_16x16x32_bf16 v[112:115], v[188:191], v[140:143], v[112:115]
    v_mfma_f32_16x16x32_bf16 v[116:119], v[188:191], v[144:147], v[116:119]
    s_waitcnt lgkmcnt(10)
    v_mfma_f32_16x16x32_bf16 v[8:11], v[192:195], v[148:151], v[8:11]
    v_mfma_f32_16x16x32_bf16 v[12:15], v[192:195], v[152:155], v[12:15]
    v_mfma_f32_16x16x32_bf16 v[16:19], v[192:195], v[156:159], v[16:19]
    v_mfma_f32_16x16x32_bf16 v[20:23], v[192:195], v[160:163], v[20:23]
    s_waitcnt lgkmcnt(0)
    s_barrier
    v_mfma_f32_16x16x32_bf16 v[36:39], v[196:199], v[160:163], v[36:39]
    ds_read_b128 v[132:135], v120 offset:49152
    v_mfma_f32_16x16x32_bf16 v[32:35], v[196:199], v[156:159], v[32:35]
    ds_read_b64_tr_b16 v[164:165], v123 offset:0
    v_mfma_f32_16x16x32_bf16 v[28:31], v[196:199], v[152:155], v[28:31]
    ds_read_b64_tr_b16 v[166:167], v123 offset:7168
    v_mfma_f32_16x16x32_bf16 v[24:27], v[196:199], v[148:151], v[24:27]
    ds_read_b128 v[136:139], v120 offset:50176
    v_mfma_f32_16x16x32_bf16 v[40:43], v[200:203], v[148:151], v[40:43]
    ds_read_b128 v[140:143], v120 offset:51200
    v_mfma_f32_16x16x32_bf16 v[44:47], v[200:203], v[152:155], v[44:47]
    ds_read_b128 v[144:147], v120 offset:52224
    v_mfma_f32_16x16x32_bf16 v[48:51], v[200:203], v[156:159], v[48:51]
    ds_read_b64_tr_b16 v[168:169], v126 offset:0
    v_mfma_f32_16x16x32_bf16 v[52:55], v[200:203], v[160:163], v[52:55]
    ds_read_b64_tr_b16 v[170:171], v126 offset:7168
    v_mfma_f32_16x16x32_bf16 v[68:71], v[204:207], v[160:163], v[68:71]
    ds_read_b64_tr_b16 v[172:173], v123 offset:64
    v_mfma_f32_16x16x32_bf16 v[64:67], v[204:207], v[156:159], v[64:67]
    ds_read_b64_tr_b16 v[174:175], v123 offset:7232
    v_mfma_f32_16x16x32_bf16 v[60:63], v[204:207], v[152:155], v[60:63]
    ds_read_b64_tr_b16 v[176:177], v126 offset:64
    v_mfma_f32_16x16x32_bf16 v[56:59], v[204:207], v[148:151], v[56:59]
    ds_read_b64_tr_b16 v[178:179], v126 offset:7232
    v_mfma_f32_16x16x32_bf16 v[72:75], v[208:211], v[148:151], v[72:75]
    ds_read_b64_tr_b16 v[180:181], v123 offset:128
    v_mfma_f32_16x16x32_bf16 v[76:79], v[208:211], v[152:155], v[76:79]
    ds_read_b64_tr_b16 v[182:183], v123 offset:7296
    v_mfma_f32_16x16x32_bf16 v[80:83], v[208:211], v[156:159], v[80:83]
    ds_read_b64_tr_b16 v[184:185], v126 offset:128
    v_mfma_f32_16x16x32_bf16 v[84:87], v[208:211], v[160:163], v[84:87]
    ds_read_b64_tr_b16 v[186:187], v126 offset:7296
    v_mfma_f32_16x16x32_bf16 v[100:103], v[212:215], v[160:163], v[100:103]
    ds_read_b64_tr_b16 v[188:189], v129 offset:0
    v_mfma_f32_16x16x32_bf16 v[96:99], v[212:215], v[156:159], v[96:99]
    ds_read_b64_tr_b16 v[190:191], v129 offset:7168
    v_mfma_f32_16x16x32_bf16 v[92:95], v[212:215], v[152:155], v[92:95]
    v_mfma_f32_16x16x32_bf16 v[88:91], v[212:215], v[148:151], v[88:91]
    v_mfma_f32_16x16x32_bf16 v[104:107], v[216:219], v[148:151], v[104:107]
    v_mfma_f32_16x16x32_bf16 v[108:111], v[216:219], v[152:155], v[108:111]
    v_mfma_f32_16x16x32_bf16 v[112:115], v[216:219], v[156:159], v[112:115]
    v_mfma_f32_16x16x32_bf16 v[116:119], v[216:219], v[160:163], v[116:119]
    s_waitcnt lgkmcnt(10)
    v_mfma_f32_16x16x32_bf16 v[8:11], v[164:167], v[132:135], v[8:11]
    ds_read_b128 v[148:151], v120 offset:57344
    v_mfma_f32_16x16x32_bf16 v[12:15], v[164:167], v[136:139], v[12:15]
    ds_read_b64_tr_b16 v[192:193], v123 offset:14336
    v_mfma_f32_16x16x32_bf16 v[16:19], v[164:167], v[140:143], v[16:19]
    ds_read_b64_tr_b16 v[194:195], v123 offset:21504
    v_mfma_f32_16x16x32_bf16 v[20:23], v[164:167], v[144:147], v[20:23]
    ds_read_b128 v[152:155], v120 offset:58368
    v_mfma_f32_16x16x32_bf16 v[36:39], v[168:171], v[144:147], v[36:39]
    ds_read_b128 v[156:159], v120 offset:59392
    v_mfma_f32_16x16x32_bf16 v[32:35], v[168:171], v[140:143], v[32:35]
    ds_read_b128 v[160:163], v120 offset:60416
    v_mfma_f32_16x16x32_bf16 v[28:31], v[168:171], v[136:139], v[28:31]
    ds_read_b64_tr_b16 v[196:197], v126 offset:14336
    v_mfma_f32_16x16x32_bf16 v[24:27], v[168:171], v[132:135], v[24:27]
    ds_read_b64_tr_b16 v[198:199], v126 offset:21504
    s_waitcnt lgkmcnt(14)
    v_mfma_f32_16x16x32_bf16 v[40:43], v[172:175], v[132:135], v[40:43]
    ds_read_b64_tr_b16 v[200:201], v123 offset:14400
    v_mfma_f32_16x16x32_bf16 v[44:47], v[172:175], v[136:139], v[44:47]
    ds_read_b64_tr_b16 v[202:203], v123 offset:21568
    v_mfma_f32_16x16x32_bf16 v[48:51], v[172:175], v[140:143], v[48:51]
    ds_read_b64_tr_b16 v[204:205], v126 offset:14400
    v_mfma_f32_16x16x32_bf16 v[52:55], v[172:175], v[144:147], v[52:55]
    ds_read_b64_tr_b16 v[206:207], v126 offset:21568
    v_mfma_f32_16x16x32_bf16 v[68:71], v[176:179], v[144:147], v[68:71]
    ds_read_b64_tr_b16 v[208:209], v123 offset:14464
    v_mfma_f32_16x16x32_bf16 v[64:67], v[176:179], v[140:143], v[64:67]
    ds_read_b64_tr_b16 v[210:211], v123 offset:21632
    v_mfma_f32_16x16x32_bf16 v[60:63], v[176:179], v[136:139], v[60:63]
    ds_read_b64_tr_b16 v[212:213], v126 offset:14464
    v_mfma_f32_16x16x32_bf16 v[56:59], v[176:179], v[132:135], v[56:59]
    ds_read_b64_tr_b16 v[214:215], v126 offset:21632
    s_waitcnt lgkmcnt(15)
    v_mfma_f32_16x16x32_bf16 v[72:75], v[180:183], v[132:135], v[72:75]
    ds_read_b64_tr_b16 v[216:217], v129 offset:14336
    v_mfma_f32_16x16x32_bf16 v[76:79], v[180:183], v[136:139], v[76:79]
    ds_read_b64_tr_b16 v[218:219], v129 offset:21504
    v_mfma_f32_16x16x32_bf16 v[80:83], v[180:183], v[140:143], v[80:83]
    v_mfma_f32_16x16x32_bf16 v[84:87], v[180:183], v[144:147], v[84:87]
    v_mfma_f32_16x16x32_bf16 v[100:103], v[184:187], v[144:147], v[100:103]
    v_mfma_f32_16x16x32_bf16 v[96:99], v[184:187], v[140:143], v[96:99]
    v_mfma_f32_16x16x32_bf16 v[92:95], v[184:187], v[136:139], v[92:95]
    v_mfma_f32_16x16x32_bf16 v[88:91], v[184:187], v[132:135], v[88:91]
    v_mfma_f32_16x16x32_bf16 v[104:107], v[188:191], v[132:135], v[104:107]
    v_mfma_f32_16x16x32_bf16 v[108:111], v[188:191], v[136:139], v[108:111]
    v_mfma_f32_16x16x32_bf16 v[112:115], v[188:191], v[140:143], v[112:115]
    v_mfma_f32_16x16x32_bf16 v[116:119], v[188:191], v[144:147], v[116:119]
    s_waitcnt lgkmcnt(10)
    v_mfma_f32_16x16x32_bf16 v[8:11], v[192:195], v[148:151], v[8:11]
    v_mfma_f32_16x16x32_bf16 v[12:15], v[192:195], v[152:155], v[12:15]
    v_mfma_f32_16x16x32_bf16 v[16:19], v[192:195], v[156:159], v[16:19]
    v_mfma_f32_16x16x32_bf16 v[20:23], v[192:195], v[160:163], v[20:23]
    s_waitcnt lgkmcnt(0)
    s_barrier
    v_mfma_f32_16x16x32_bf16 v[36:39], v[196:199], v[160:163], v[36:39]
    v_mfma_f32_16x16x32_bf16 v[32:35], v[196:199], v[156:159], v[32:35]
    v_mfma_f32_16x16x32_bf16 v[28:31], v[196:199], v[152:155], v[28:31]
    v_mfma_f32_16x16x32_bf16 v[24:27], v[196:199], v[148:151], v[24:27]
    v_mfma_f32_16x16x32_bf16 v[40:43], v[200:203], v[148:151], v[40:43]
    v_mfma_f32_16x16x32_bf16 v[44:47], v[200:203], v[152:155], v[44:47]
    v_mfma_f32_16x16x32_bf16 v[48:51], v[200:203], v[156:159], v[48:51]
    v_mfma_f32_16x16x32_bf16 v[52:55], v[200:203], v[160:163], v[52:55]
    v_mfma_f32_16x16x32_bf16 v[68:71], v[204:207], v[160:163], v[68:71]
    v_mfma_f32_16x16x32_bf16 v[64:67], v[204:207], v[156:159], v[64:67]
    v_mfma_f32_16x16x32_bf16 v[60:63], v[204:207], v[152:155], v[60:63]
    v_mfma_f32_16x16x32_bf16 v[56:59], v[204:207], v[148:151], v[56:59]
    v_mfma_f32_16x16x32_bf16 v[72:75], v[208:211], v[148:151], v[72:75]
    v_mfma_f32_16x16x32_bf16 v[76:79], v[208:211], v[152:155], v[76:79]
    v_mfma_f32_16x16x32_bf16 v[80:83], v[208:211], v[156:159], v[80:83]
    v_mfma_f32_16x16x32_bf16 v[84:87], v[208:211], v[160:163], v[84:87]
    v_mfma_f32_16x16x32_bf16 v[100:103], v[212:215], v[160:163], v[100:103]
    v_mfma_f32_16x16x32_bf16 v[96:99], v[212:215], v[156:159], v[96:99]
    v_mfma_f32_16x16x32_bf16 v[92:95], v[212:215], v[152:155], v[92:95]
    v_mfma_f32_16x16x32_bf16 v[88:91], v[212:215], v[148:151], v[88:91]
    v_mfma_f32_16x16x32_bf16 v[104:107], v[216:219], v[148:151], v[104:107]
    v_mfma_f32_16x16x32_bf16 v[108:111], v[216:219], v[152:155], v[108:111]
    v_mfma_f32_16x16x32_bf16 v[112:115], v[216:219], v[156:159], v[112:115]
    v_mfma_f32_16x16x32_bf16 v[116:119], v[216:219], v[160:163], v[116:119]
    s_barrier
    v_and_b32 v3, 15, v1
    s_lshl_b32 s53, s66, 8
    s_add_u32 s53, s53, 159744
    v_lshl_add_u32 v186, v3, 2, s53
    v_and_b32 v3, 48, v1
    s_lshl_b32 s53, s67, 9
    s_add_u32 s53, s53, 160768
    v_add_u32 v187, s53, v3
    s_lshl_b32 s53, s67, 6
    s_add_u32 s53, s53, 161152
    v_add_u32 v188, s53, v3
    ds_read2_b32 v[120:121], v186 offset0:0 offset1:128
    ds_read2_b32 v[122:123], v186 offset0:16 offset1:144
    ds_read2_b32 v[124:125], v186 offset0:32 offset1:160
    ds_read2_b32 v[126:127], v186 offset0:48 offset1:176
    ds_read_b128 v[128:131], v187 offset:0
    ds_read_b128 v[156:159], v187 offset:1024
    ds_read_b128 v[132:135], v187 offset:64
    ds_read_b128 v[160:163], v187 offset:1088
    ds_read_b128 v[136:139], v187 offset:128
    ds_read_b128 v[164:167], v187 offset:1152
    ds_read_b128 v[140:143], v187 offset:192
    ds_read_b128 v[168:171], v187 offset:1216
    ds_read_b128 v[144:147], v187 offset:256
    ds_read_b128 v[172:175], v187 offset:1280
    ds_read_b128 v[148:151], v187 offset:320
    ds_read_b128 v[176:179], v187 offset:1344
    ds_read_b128 v[152:155], v188 offset:0
    ds_read_b128 v[180:183], v188 offset:1024
    v_mov_b32 v184, 0xc0135761
    v_mov_b32 v185, 0xbdd2d3e8
    s_lshl_b32 s53, s66, 12
    s_add_u32 s53, s53, 65536
    s_lshl_b32 s54, s67, 15
    s_add_u32 s54, s54, s53
    v_add_u32 v224, s54, v2
    s_lshl_b32 s54, s67, 3
    s_add_u32 s54, s54, s53
    v_add_u32 v225, s54, v2
    s_waitcnt lgkmcnt(0)
    s_lshl_b32 s53, s47, 2
    s_add_u32 s53, s53, 162816
    v_mov_b32_e64 v3, s53
    v_pk_fma_f32 v[192:193], v[152:153], v[120:121], v[180:181] op_sel:[0,1,0] op_sel_hi:[1,1,1] neg_lo:[0,1,0] neg_hi:[0,1,0]
    v_pk_fma_f32 v[194:195], v[154:155], v[120:121], v[182:183] op_sel:[0,1,0] op_sel_hi:[1,1,1] neg_lo:[0,1,0] neg_hi:[0,1,0]
    v_pk_fma_f32 v[196:197], v[152:153], v[122:123], v[180:181] op_sel:[0,1,0] op_sel_hi:[1,1,1] neg_lo:[0,1,0] neg_hi:[0,1,0]
    v_pk_fma_f32 v[198:199], v[154:155], v[122:123], v[182:183] op_sel:[0,1,0] op_sel_hi:[1,1,1] neg_lo:[0,1,0] neg_hi:[0,1,0]
    v_pk_fma_f32 v[192:193], v[104:105], v[120:121], v[192:193] op_sel_hi:[1,0,1]
    v_pk_fma_f32 v[194:195], v[106:107], v[120:121], v[194:195] op_sel_hi:[1,0,1]
    v_pk_fma_f32 v[196:197], v[108:109], v[122:123], v[196:197] op_sel_hi:[1,0,1]
    v_pk_fma_f32 v[198:199], v[110:111], v[122:123], v[198:199] op_sel_hi:[1,0,1]
    v_pk_mul_f32 v[200:201], v[192:193], v[192:193]
    v_pk_mul_f32 v[202:203], v[194:195], v[194:195]
    v_pk_mul_f32 v[204:205], v[196:197], v[196:197]
    v_pk_mul_f32 v[206:207], v[198:199], v[198:199]
    v_pk_fma_f32 v[200:201], v[200:201], v[184:185], v[184:185] op_sel:[0,1,0] op_sel_hi:[1,1,0]
    v_pk_fma_f32 v[202:203], v[202:203], v[184:185], v[184:185] op_sel:[0,1,0] op_sel_hi:[1,1,0]
    v_pk_fma_f32 v[204:205], v[204:205], v[184:185], v[184:185] op_sel:[0,1,0] op_sel_hi:[1,1,0]
    v_pk_fma_f32 v[206:207], v[206:207], v[184:185], v[184:185] op_sel:[0,1,0] op_sel_hi:[1,1,0]
    v_pk_mul_f32 v[200:201], v[200:201], v[192:193]
    v_pk_mul_f32 v[202:203], v[202:203], v[194:195]
    v_pk_mul_f32 v[204:205], v[204:205], v[196:197]
    v_pk_mul_f32 v[206:207], v[206:207], v[198:199]
    v_exp_f32 v200, v200
    v_exp_f32 v201, v201
    v_exp_f32 v202, v202
    v_exp_f32 v203, v203
    v_exp_f32 v204, v204
    v_exp_f32 v205, v205
    v_exp_f32 v206, v206
    v_exp_f32 v207, v207
    v_pk_add_f32 v[200:201], v[200:201], 1.0 op_sel_hi:[1,0]
    v_pk_add_f32 v[202:203], v[202:203], 1.0 op_sel_hi:[1,0]
    v_pk_add_f32 v[204:205], v[204:205], 1.0 op_sel_hi:[1,0]
    v_pk_add_f32 v[206:207], v[206:207], 1.0 op_sel_hi:[1,0]
    v_rcp_f32 v200, v200
    v_rcp_f32 v201, v201
    v_rcp_f32 v202, v202
    v_rcp_f32 v203, v203
    v_rcp_f32 v204, v204
    v_rcp_f32 v205, v205
    v_rcp_f32 v206, v206
    v_rcp_f32 v207, v207
    v_pk_mul_f32 v[192:193], v[192:193], v[200:201]
    v_pk_mul_f32 v[194:195], v[194:195], v[202:203]
    v_pk_mul_f32 v[196:197], v[196:197], v[204:205]
    v_pk_mul_f32 v[198:199], v[198:199], v[206:207]
    v_cvt_pk_bf16_f32 v208, v192, v193
    v_cvt_pk_bf16_f32 v209, v194, v195
    v_cvt_pk_bf16_f32 v212, v196, v197
    v_cvt_pk_bf16_f32 v213, v198, v199
    ds_write_b64 v225, v[208:209] offset:24576
    ds_write_b64 v225, v[212:213] offset:25600
    v_pk_fma_f32 v[192:193], v[152:153], v[124:125], v[180:181] op_sel:[0,1,0] op_sel_hi:[1,1,1] neg_lo:[0,1,0] neg_hi:[0,1,0]
    v_pk_fma_f32 v[194:195], v[154:155], v[124:125], v[182:183] op_sel:[0,1,0] op_sel_hi:[1,1,1] neg_lo:[0,1,0] neg_hi:[0,1,0]
    v_pk_fma_f32 v[196:197], v[152:153], v[126:127], v[180:181] op_sel:[0,1,0] op_sel_hi:[1,1,1] neg_lo:[0,1,0] neg_hi:[0,1,0]
    v_pk_fma_f32 v[198:199], v[154:155], v[126:127], v[182:183] op_sel:[0,1,0] op_sel_hi:[1,1,1] neg_lo:[0,1,0] neg_hi:[0,1,0]
    v_pk_fma_f32 v[192:193], v[112:113], v[124:125], v[192:193] op_sel_hi:[1,0,1]
    v_pk_fma_f32 v[194:195], v[114:115], v[124:125], v[194:195] op_sel_hi:[1,0,1]
    v_pk_fma_f32 v[196:197], v[116:117], v[126:127], v[196:197] op_sel_hi:[1,0,1]
    v_pk_fma_f32 v[198:199], v[118:119], v[126:127], v[198:199] op_sel_hi:[1,0,1]
    v_pk_mul_f32 v[200:201], v[192:193], v[192:193]
    v_pk_mul_f32 v[202:203], v[194:195], v[194:195]
    v_pk_mul_f32 v[204:205], v[196:197], v[196:197]
    v_pk_mul_f32 v[206:207], v[198:199], v[198:199]
    v_pk_fma_f32 v[200:201], v[200:201], v[184:185], v[184:185] op_sel:[0,1,0] op_sel_hi:[1,1,0]
    v_pk_fma_f32 v[202:203], v[202:203], v[184:185], v[184:185] op_sel:[0,1,0] op_sel_hi:[1,1,0]
    v_pk_fma_f32 v[204:205], v[204:205], v[184:185], v[184:185] op_sel:[0,1,0] op_sel_hi:[1,1,0]
    v_pk_fma_f32 v[206:207], v[206:207], v[184:185], v[184:185] op_sel:[0,1,0] op_sel_hi:[1,1,0]
    v_pk_mul_f32 v[200:201], v[200:201], v[192:193]
    v_pk_mul_f32 v[202:203], v[202:203], v[194:195]
    v_pk_mul_f32 v[204:205], v[204:205], v[196:197]
    v_pk_mul_f32 v[206:207], v[206:207], v[198:199]
    v_exp_f32 v200, v200
    v_exp_f32 v201, v201
    v_exp_f32 v202, v202
    v_exp_f32 v203, v203
    v_exp_f32 v204, v204
    v_exp_f32 v205, v205
    v_exp_f32 v206, v206
    v_exp_f32 v207, v207
    v_pk_add_f32 v[200:201], v[200:201], 1.0 op_sel_hi:[1,0]
    v_pk_add_f32 v[202:203], v[202:203], 1.0 op_sel_hi:[1,0]
    v_pk_add_f32 v[204:205], v[204:205], 1.0 op_sel_hi:[1,0]
    v_pk_add_f32 v[206:207], v[206:207], 1.0 op_sel_hi:[1,0]
    v_rcp_f32 v200, v200
    v_rcp_f32 v201, v201
    v_rcp_f32 v202, v202
    v_rcp_f32 v203, v203
    v_rcp_f32 v204, v204
    v_rcp_f32 v205, v205
    v_rcp_f32 v206, v206
    v_rcp_f32 v207, v207
    v_pk_mul_f32 v[192:193], v[192:193], v[200:201]
    v_pk_mul_f32 v[194:195], v[194:195], v[202:203]
    v_pk_mul_f32 v[196:197], v[196:197], v[204:205]
    v_pk_mul_f32 v[198:199], v[198:199], v[206:207]
    v_cvt_pk_bf16_f32 v216, v192, v193
    v_cvt_pk_bf16_f32 v217, v194, v195
    v_cvt_pk_bf16_f32 v220, v196, v197
    v_cvt_pk_bf16_f32 v221, v198, v199
    ds_write_b64 v225, v[216:217] offset:26624
    ds_write_b64 v225, v[220:221] offset:27648
    v_mov_b32 v4, 1
    ds_write_b32 v3, v4
    s_nop 0
    v_pk_fma_f32 v[192:193], v[128:129], v[120:121], v[156:157] op_sel:[0,1,0] op_sel_hi:[1,1,1] neg_lo:[0,1,0] neg_hi:[0,1,0]
    v_pk_fma_f32 v[194:195], v[130:131], v[120:121], v[158:159] op_sel:[0,1,0] op_sel_hi:[1,1,1] neg_lo:[0,1,0] neg_hi:[0,1,0]
    v_pk_fma_f32 v[196:197], v[132:133], v[120:121], v[160:161] op_sel:[0,1,0] op_sel_hi:[1,1,1] neg_lo:[0,1,0] neg_hi:[0,1,0]
    v_pk_fma_f32 v[198:199], v[134:135], v[120:121], v[162:163] op_sel:[0,1,0] op_sel_hi:[1,1,1] neg_lo:[0,1,0] neg_hi:[0,1,0]
    v_pk_fma_f32 v[192:193], v[8:9], v[120:121], v[192:193] op_sel_hi:[1,0,1]
    v_pk_fma_f32 v[194:195], v[10:11], v[120:121], v[194:195] op_sel_hi:[1,0,1]
    v_pk_fma_f32 v[196:197], v[24:25], v[120:121], v[196:197] op_sel_hi:[1,0,1]
    v_pk_fma_f32 v[198:199], v[26:27], v[120:121], v[198:199] op_sel_hi:[1,0,1]
    v_pk_mul_f32 v[200:201], v[192:193], v[192:193]
    v_pk_mul_f32 v[202:203], v[194:195], v[194:195]
    v_pk_mul_f32 v[204:205], v[196:197], v[196:197]
    v_pk_mul_f32 v[206:207], v[198:199], v[198:199]
    v_pk_fma_f32 v[200:201], v[200:201], v[184:185], v[184:185] op_sel:[0,1,0] op_sel_hi:[1,1,0]
    v_pk_fma_f32 v[202:203], v[202:203], v[184:185], v[184:185] op_sel:[0,1,0] op_sel_hi:[1,1,0]
    v_pk_fma_f32 v[204:205], v[204:205], v[184:185], v[184:185] op_sel:[0,1,0] op_sel_hi:[1,1,0]
    v_pk_fma_f32 v[206:207], v[206:207], v[184:185], v[184:185] op_sel:[0,1,0] op_sel_hi:[1,1,0]
    v_pk_mul_f32 v[200:201], v[200:201], v[192:193]
    v_pk_mul_f32 v[202:203], v[202:203], v[194:195]
    v_pk_mul_f32 v[204:205], v[204:205], v[196:197]
    v_pk_mul_f32 v[206:207], v[206:207], v[198:199]
    v_exp_f32 v200, v200
    v_exp_f32 v201, v201
    v_exp_f32 v202, v202
    v_exp_f32 v203, v203
    v_exp_f32 v204, v204
    v_exp_f32 v205, v205
    v_exp_f32 v206, v206
    v_exp_f32 v207, v207
    v_pk_add_f32 v[200:201], v[200:201], 1.0 op_sel_hi:[1,0]
    v_pk_add_f32 v[202:203], v[202:203], 1.0 op_sel_hi:[1,0]
    v_pk_add_f32 v[204:205], v[204:205], 1.0 op_sel_hi:[1,0]
    v_pk_add_f32 v[206:207], v[206:207], 1.0 op_sel_hi:[1,0]
    v_rcp_f32 v200, v200
    v_rcp_f32 v201, v201
    v_rcp_f32 v202, v202
    v_rcp_f32 v203, v203
    v_rcp_f32 v204, v204
    v_rcp_f32 v205, v205
    v_rcp_f32 v206, v206
    v_rcp_f32 v207, v207
    v_pk_mul_f32 v[192:193], v[192:193], v[200:201]
    v_pk_mul_f32 v[194:195], v[194:195], v[202:203]
    v_pk_mul_f32 v[196:197], v[196:197], v[204:205]
    v_pk_mul_f32 v[198:199], v[198:199], v[206:207]
    v_cvt_pk_bf16_f32 v208, v192, v193
    v_cvt_pk_bf16_f32 v209, v194, v195
    v_cvt_pk_bf16_f32 v210, v196, v197
    v_cvt_pk_bf16_f32 v211, v198, v199
    ds_write_b128 v224, v[208:211] offset:0
    v_pk_fma_f32 v[192:193], v[128:129], v[122:123], v[156:157] op_sel:[0,1,0] op_sel_hi:[1,1,1] neg_lo:[0,1,0] neg_hi:[0,1,0]
    v_pk_fma_f32 v[194:195], v[130:131], v[122:123], v[158:159] op_sel:[0,1,0] op_sel_hi:[1,1,1] neg_lo:[0,1,0] neg_hi:[0,1,0]
    v_pk_fma_f32 v[196:197], v[132:133], v[122:123], v[160:161] op_sel:[0,1,0] op_sel_hi:[1,1,1] neg_lo:[0,1,0] neg_hi:[0,1,0]
    v_pk_fma_f32 v[198:199], v[134:135], v[122:123], v[162:163] op_sel:[0,1,0] op_sel_hi:[1,1,1] neg_lo:[0,1,0] neg_hi:[0,1,0]
    v_pk_fma_f32 v[192:193], v[12:13], v[122:123], v[192:193] op_sel_hi:[1,0,1]
    v_pk_fma_f32 v[194:195], v[14:15], v[122:123], v[194:195] op_sel_hi:[1,0,1]
    v_pk_fma_f32 v[196:197], v[28:29], v[122:123], v[196:197] op_sel_hi:[1,0,1]
    v_pk_fma_f32 v[198:199], v[30:31], v[122:123], v[198:199] op_sel_hi:[1,0,1]
    v_pk_mul_f32 v[200:201], v[192:193], v[192:193]
    v_pk_mul_f32 v[202:203], v[194:195], v[194:195]
    v_pk_mul_f32 v[204:205], v[196:197], v[196:197]
    v_pk_mul_f32 v[206:207], v[198:199], v[198:199]
    v_pk_fma_f32 v[200:201], v[200:201], v[184:185], v[184:185] op_sel:[0,1,0] op_sel_hi:[1,1,0]
    v_pk_fma_f32 v[202:203], v[202:203], v[184:185], v[184:185] op_sel:[0,1,0] op_sel_hi:[1,1,0]
    v_pk_fma_f32 v[204:205], v[204:205], v[184:185], v[184:185] op_sel:[0,1,0] op_sel_hi:[1,1,0]
    v_pk_fma_f32 v[206:207], v[206:207], v[184:185], v[184:185] op_sel:[0,1,0] op_sel_hi:[1,1,0]
    v_pk_mul_f32 v[200:201], v[200:201], v[192:193]
    v_pk_mul_f32 v[202:203], v[202:203], v[194:195]
    v_pk_mul_f32 v[204:205], v[204:205], v[196:197]
    v_pk_mul_f32 v[206:207], v[206:207], v[198:199]
    v_exp_f32 v200, v200
    v_exp_f32 v201, v201
    v_exp_f32 v202, v202
    v_exp_f32 v203, v203
    v_exp_f32 v204, v204
    v_exp_f32 v205, v205
    v_exp_f32 v206, v206
    v_exp_f32 v207, v207
    v_pk_add_f32 v[200:201], v[200:201], 1.0 op_sel_hi:[1,0]
    v_pk_add_f32 v[202:203], v[202:203], 1.0 op_sel_hi:[1,0]
    v_pk_add_f32 v[204:205], v[204:205], 1.0 op_sel_hi:[1,0]
    v_pk_add_f32 v[206:207], v[206:207], 1.0 op_sel_hi:[1,0]
    v_rcp_f32 v200, v200
    v_rcp_f32 v201, v201
    v_rcp_f32 v202, v202
    v_rcp_f32 v203, v203
    v_rcp_f32 v204, v204
    v_rcp_f32 v205, v205
    v_rcp_f32 v206, v206
    v_rcp_f32 v207, v207
    v_pk_mul_f32 v[192:193], v[192:193], v[200:201]
    v_pk_mul_f32 v[194:195], v[194:195], v[202:203]
    v_pk_mul_f32 v[196:197], v[196:197], v[204:205]
    v_pk_mul_f32 v[198:199], v[198:199], v[206:207]
    v_cvt_pk_bf16_f32 v212, v192, v193
    v_cvt_pk_bf16_f32 v213, v194, v195
    v_cvt_pk_bf16_f32 v214, v196, v197
    v_cvt_pk_bf16_f32 v215, v198, v199
    ds_write_b128 v224, v[212:215] offset:1024
    v_mov_b32 v4, 3
    ds_write_b32 v3, v4
    s_nop 0
    v_pk_fma_f32 v[192:193], v[128:129], v[124:125], v[156:157] op_sel:[0,1,0] op_sel_hi:[1,1,1] neg_lo:[0,1,0] neg_hi:[0,1,0]
    v_pk_fma_f32 v[194:195], v[130:131], v[124:125], v[158:159] op_sel:[0,1,0] op_sel_hi:[1,1,1] neg_lo:[0,1,0] neg_hi:[0,1,0]
    v_pk_fma_f32 v[196:197], v[132:133], v[124:125], v[160:161] op_sel:[0,1,0] op_sel_hi:[1,1,1] neg_lo:[0,1,0] neg_hi:[0,1,0]
    v_pk_fma_f32 v[198:199], v[134:135], v[124:125], v[162:163] op_sel:[0,1,0] op_sel_hi:[1,1,1] neg_lo:[0,1,0] neg_hi:[0,1,0]
    v_pk_fma_f32 v[192:193], v[16:17], v[124:125], v[192:193] op_sel_hi:[1,0,1]
    v_pk_fma_f32 v[194:195], v[18:19], v[124:125], v[194:195] op_sel_hi:[1,0,1]
    v_pk_fma_f32 v[196:197], v[32:33], v[124:125], v[196:197] op_sel_hi:[1,0,1]
    v_pk_fma_f32 v[198:199], v[34:35], v[124:125], v[198:199] op_sel_hi:[1,0,1]
    v_pk_mul_f32 v[200:201], v[192:193], v[192:193]
    v_pk_mul_f32 v[202:203], v[194:195], v[194:195]
    v_pk_mul_f32 v[204:205], v[196:197], v[196:197]
    v_pk_mul_f32 v[206:207], v[198:199], v[198:199]
    v_pk_fma_f32 v[200:201], v[200:201], v[184:185], v[184:185] op_sel:[0,1,0] op_sel_hi:[1,1,0]
    v_pk_fma_f32 v[202:203], v[202:203], v[184:185], v[184:185] op_sel:[0,1,0] op_sel_hi:[1,1,0]
    v_pk_fma_f32 v[204:205], v[204:205], v[184:185], v[184:185] op_sel:[0,1,0] op_sel_hi:[1,1,0]
    v_pk_fma_f32 v[206:207], v[206:207], v[184:185], v[184:185] op_sel:[0,1,0] op_sel_hi:[1,1,0]
    v_pk_mul_f32 v[200:201], v[200:201], v[192:193]
    v_pk_mul_f32 v[202:203], v[202:203], v[194:195]
    v_pk_mul_f32 v[204:205], v[204:205], v[196:197]
    v_pk_mul_f32 v[206:207], v[206:207], v[198:199]
    v_exp_f32 v200, v200
    v_exp_f32 v201, v201
    v_exp_f32 v202, v202
    v_exp_f32 v203, v203
    v_exp_f32 v204, v204
    v_exp_f32 v205, v205
    v_exp_f32 v206, v206
    v_exp_f32 v207, v207
    v_pk_add_f32 v[200:201], v[200:201], 1.0 op_sel_hi:[1,0]
    v_pk_add_f32 v[202:203], v[202:203], 1.0 op_sel_hi:[1,0]
    v_pk_add_f32 v[204:205], v[204:205], 1.0 op_sel_hi:[1,0]
    v_pk_add_f32 v[206:207], v[206:207], 1.0 op_sel_hi:[1,0]
    v_rcp_f32 v200, v200
    v_rcp_f32 v201, v201
    v_rcp_f32 v202, v202
    v_rcp_f32 v203, v203
    v_rcp_f32 v204, v204
    v_rcp_f32 v205, v205
    v_rcp_f32 v206, v206
    v_rcp_f32 v207, v207
    v_pk_mul_f32 v[192:193], v[192:193], v[200:201]
    v_pk_mul_f32 v[194:195], v[194:195], v[202:203]
    v_pk_mul_f32 v[196:197], v[196:197], v[204:205]
    v_pk_mul_f32 v[198:199], v[198:199], v[206:207]
    v_cvt_pk_bf16_f32 v216, v192, v193
    v_cvt_pk_bf16_f32 v217, v194, v195
    v_cvt_pk_bf16_f32 v218, v196, v197
    v_cvt_pk_bf16_f32 v219, v198, v199
    ds_write_b128 v224, v[216:219] offset:2048
    v_pk_fma_f32 v[192:193], v[128:129], v[126:127], v[156:157] op_sel:[0,1,0] op_sel_hi:[1,1,1] neg_lo:[0,1,0] neg_hi:[0,1,0]
    v_pk_fma_f32 v[194:195], v[130:131], v[126:127], v[158:159] op_sel:[0,1,0] op_sel_hi:[1,1,1] neg_lo:[0,1,0] neg_hi:[0,1,0]
    v_pk_fma_f32 v[196:197], v[132:133], v[126:127], v[160:161] op_sel:[0,1,0] op_sel_hi:[1,1,1] neg_lo:[0,1,0] neg_hi:[0,1,0]
    v_pk_fma_f32 v[198:199], v[134:135], v[126:127], v[162:163] op_sel:[0,1,0] op_sel_hi:[1,1,1] neg_lo:[0,1,0] neg_hi:[0,1,0]
    v_pk_fma_f32 v[192:193], v[20:21], v[126:127], v[192:193] op_sel_hi:[1,0,1]
    v_pk_fma_f32 v[194:195], v[22:23], v[126:127], v[194:195] op_sel_hi:[1,0,1]
    v_pk_fma_f32 v[196:197], v[36:37], v[126:127], v[196:197] op_sel_hi:[1,0,1]
    v_pk_fma_f32 v[198:199], v[38:39], v[126:127], v[198:199] op_sel_hi:[1,0,1]
    v_pk_mul_f32 v[200:201], v[192:193], v[192:193]
    v_pk_mul_f32 v[202:203], v[194:195], v[194:195]
    v_pk_mul_f32 v[204:205], v[196:197], v[196:197]
    v_pk_mul_f32 v[206:207], v[198:199], v[198:199]
    v_pk_fma_f32 v[200:201], v[200:201], v[184:185], v[184:185] op_sel:[0,1,0] op_sel_hi:[1,1,0]
    v_pk_fma_f32 v[202:203], v[202:203], v[184:185], v[184:185] op_sel:[0,1,0] op_sel_hi:[1,1,0]
    v_pk_fma_f32 v[204:205], v[204:205], v[184:185], v[184:185] op_sel:[0,1,0] op_sel_hi:[1,1,0]
    v_pk_fma_f32 v[206:207], v[206:207], v[184:185], v[184:185] op_sel:[0,1,0] op_sel_hi:[1,1,0]
    v_pk_mul_f32 v[200:201], v[200:201], v[192:193]
    v_pk_mul_f32 v[202:203], v[202:203], v[194:195]
    v_pk_mul_f32 v[204:205], v[204:205], v[196:197]
    v_pk_mul_f32 v[206:207], v[206:207], v[198:199]
    v_exp_f32 v200, v200
    v_exp_f32 v201, v201
    v_exp_f32 v202, v202
    v_exp_f32 v203, v203
    v_exp_f32 v204, v204
    v_exp_f32 v205, v205
    v_exp_f32 v206, v206
    v_exp_f32 v207, v207
    v_pk_add_f32 v[200:201], v[200:201], 1.0 op_sel_hi:[1,0]
    v_pk_add_f32 v[202:203], v[202:203], 1.0 op_sel_hi:[1,0]
    v_pk_add_f32 v[204:205], v[204:205], 1.0 op_sel_hi:[1,0]
    v_pk_add_f32 v[206:207], v[206:207], 1.0 op_sel_hi:[1,0]
    v_rcp_f32 v200, v200
    v_rcp_f32 v201, v201
    v_rcp_f32 v202, v202
    v_rcp_f32 v203, v203
    v_rcp_f32 v204, v204
    v_rcp_f32 v205, v205
    v_rcp_f32 v206, v206
    v_rcp_f32 v207, v207
    v_pk_mul_f32 v[192:193], v[192:193], v[200:201]
    v_pk_mul_f32 v[194:195], v[194:195], v[202:203]
    v_pk_mul_f32 v[196:197], v[196:197], v[204:205]
    v_pk_mul_f32 v[198:199], v[198:199], v[206:207]
    v_cvt_pk_bf16_f32 v220, v192, v193
    v_cvt_pk_bf16_f32 v221, v194, v195
    v_cvt_pk_bf16_f32 v222, v196, v197
    v_cvt_pk_bf16_f32 v223, v198, v199
    ds_write_b128 v224, v[220:223] offset:3072
    v_mov_b32 v4, 5
    ds_write_b32 v3, v4
    s_nop 0
    v_pk_fma_f32 v[192:193], v[136:137], v[120:121], v[164:165] op_sel:[0,1,0] op_sel_hi:[1,1,1] neg_lo:[0,1,0] neg_hi:[0,1,0]
    v_pk_fma_f32 v[194:195], v[138:139], v[120:121], v[166:167] op_sel:[0,1,0] op_sel_hi:[1,1,1] neg_lo:[0,1,0] neg_hi:[0,1,0]
    v_pk_fma_f32 v[196:197], v[140:141], v[120:121], v[168:169] op_sel:[0,1,0] op_sel_hi:[1,1,1] neg_lo:[0,1,0] neg_hi:[0,1,0]
    v_pk_fma_f32 v[198:199], v[142:143], v[120:121], v[170:171] op_sel:[0,1,0] op_sel_hi:[1,1,1] neg_lo:[0,1,0] neg_hi:[0,1,0]
    v_pk_fma_f32 v[192:193], v[40:41], v[120:121], v[192:193] op_sel_hi:[1,0,1]
    v_pk_fma_f32 v[194:195], v[42:43], v[120:121], v[194:195] op_sel_hi:[1,0,1]
    v_pk_fma_f32 v[196:197], v[56:57], v[120:121], v[196:197] op_sel_hi:[1,0,1]
    v_pk_fma_f32 v[198:199], v[58:59], v[120:121], v[198:199] op_sel_hi:[1,0,1]
    v_pk_mul_f32 v[200:201], v[192:193], v[192:193]
    v_pk_mul_f32 v[202:203], v[194:195], v[194:195]
    v_pk_mul_f32 v[204:205], v[196:197], v[196:197]
    v_pk_mul_f32 v[206:207], v[198:199], v[198:199]
    v_pk_fma_f32 v[200:201], v[200:201], v[184:185], v[184:185] op_sel:[0,1,0] op_sel_hi:[1,1,0]
    v_pk_fma_f32 v[202:203], v[202:203], v[184:185], v[184:185] op_sel:[0,1,0] op_sel_hi:[1,1,0]
    v_pk_fma_f32 v[204:205], v[204:205], v[184:185], v[184:185] op_sel:[0,1,0] op_sel_hi:[1,1,0]
    v_pk_fma_f32 v[206:207], v[206:207], v[184:185], v[184:185] op_sel:[0,1,0] op_sel_hi:[1,1,0]
    v_pk_mul_f32 v[200:201], v[200:201], v[192:193]
    v_pk_mul_f32 v[202:203], v[202:203], v[194:195]
    v_pk_mul_f32 v[204:205], v[204:205], v[196:197]
    v_pk_mul_f32 v[206:207], v[206:207], v[198:199]
    v_exp_f32 v200, v200
    v_exp_f32 v201, v201
    v_exp_f32 v202, v202
    v_exp_f32 v203, v203
    v_exp_f32 v204, v204
    v_exp_f32 v205, v205
    v_exp_f32 v206, v206
    v_exp_f32 v207, v207
    v_pk_add_f32 v[200:201], v[200:201], 1.0 op_sel_hi:[1,0]
    v_pk_add_f32 v[202:203], v[202:203], 1.0 op_sel_hi:[1,0]
    v_pk_add_f32 v[204:205], v[204:205], 1.0 op_sel_hi:[1,0]
    v_pk_add_f32 v[206:207], v[206:207], 1.0 op_sel_hi:[1,0]
    v_rcp_f32 v200, v200
    v_rcp_f32 v201, v201
    v_rcp_f32 v202, v202
    v_rcp_f32 v203, v203
    v_rcp_f32 v204, v204
    v_rcp_f32 v205, v205
    v_rcp_f32 v206, v206
    v_rcp_f32 v207, v207
    v_pk_mul_f32 v[192:193], v[192:193], v[200:201]
    v_pk_mul_f32 v[194:195], v[194:195], v[202:203]
    v_pk_mul_f32 v[196:197], v[196:197], v[204:205]
    v_pk_mul_f32 v[198:199], v[198:199], v[206:207]
    v_cvt_pk_bf16_f32 v208, v192, v193
    v_cvt_pk_bf16_f32 v209, v194, v195
    v_cvt_pk_bf16_f32 v210, v196, v197
    v_cvt_pk_bf16_f32 v211, v198, v199
    ds_write_b128 v224, v[208:211] offset:8192
    v_pk_fma_f32 v[192:193], v[136:137], v[122:123], v[164:165] op_sel:[0,1,0] op_sel_hi:[1,1,1] neg_lo:[0,1,0] neg_hi:[0,1,0]
    v_pk_fma_f32 v[194:195], v[138:139], v[122:123], v[166:167] op_sel:[0,1,0] op_sel_hi:[1,1,1] neg_lo:[0,1,0] neg_hi:[0,1,0]
    v_pk_fma_f32 v[196:197], v[140:141], v[122:123], v[168:169] op_sel:[0,1,0] op_sel_hi:[1,1,1] neg_lo:[0,1,0] neg_hi:[0,1,0]
    v_pk_fma_f32 v[198:199], v[142:143], v[122:123], v[170:171] op_sel:[0,1,0] op_sel_hi:[1,1,1] neg_lo:[0,1,0] neg_hi:[0,1,0]
    v_pk_fma_f32 v[192:193], v[44:45], v[122:123], v[192:193] op_sel_hi:[1,0,1]
    v_pk_fma_f32 v[194:195], v[46:47], v[122:123], v[194:195] op_sel_hi:[1,0,1]
    v_pk_fma_f32 v[196:197], v[60:61], v[122:123], v[196:197] op_sel_hi:[1,0,1]
    v_pk_fma_f32 v[198:199], v[62:63], v[122:123], v[198:199] op_sel_hi:[1,0,1]
    v_pk_mul_f32 v[200:201], v[192:193], v[192:193]
    v_pk_mul_f32 v[202:203], v[194:195], v[194:195]
    v_pk_mul_f32 v[204:205], v[196:197], v[196:197]
    v_pk_mul_f32 v[206:207], v[198:199], v[198:199]
    v_pk_fma_f32 v[200:201], v[200:201], v[184:185], v[184:185] op_sel:[0,1,0] op_sel_hi:[1,1,0]
    v_pk_fma_f32 v[202:203], v[202:203], v[184:185], v[184:185] op_sel:[0,1,0] op_sel_hi:[1,1,0]
    v_pk_fma_f32 v[204:205], v[204:205], v[184:185], v[184:185] op_sel:[0,1,0] op_sel_hi:[1,1,0]
    v_pk_fma_f32 v[206:207], v[206:207], v[184:185], v[184:185] op_sel:[0,1,0] op_sel_hi:[1,1,0]
    v_pk_mul_f32 v[200:201], v[200:201], v[192:193]
    v_pk_mul_f32 v[202:203], v[202:203], v[194:195]
    v_pk_mul_f32 v[204:205], v[204:205], v[196:197]
    v_pk_mul_f32 v[206:207], v[206:207], v[198:199]
    v_exp_f32 v200, v200
    v_exp_f32 v201, v201
    v_exp_f32 v202, v202
    v_exp_f32 v203, v203
    v_exp_f32 v204, v204
    v_exp_f32 v205, v205
    v_exp_f32 v206, v206
    v_exp_f32 v207, v207
    v_pk_add_f32 v[200:201], v[200:201], 1.0 op_sel_hi:[1,0]
    v_pk_add_f32 v[202:203], v[202:203], 1.0 op_sel_hi:[1,0]
    v_pk_add_f32 v[204:205], v[204:205], 1.0 op_sel_hi:[1,0]
    v_pk_add_f32 v[206:207], v[206:207], 1.0 op_sel_hi:[1,0]
    v_rcp_f32 v200, v200
    v_rcp_f32 v201, v201
    v_rcp_f32 v202, v202
    v_rcp_f32 v203, v203
    v_rcp_f32 v204, v204
    v_rcp_f32 v205, v205
    v_rcp_f32 v206, v206
    v_rcp_f32 v207, v207
    v_pk_mul_f32 v[192:193], v[192:193], v[200:201]
    v_pk_mul_f32 v[194:195], v[194:195], v[202:203]
    v_pk_mul_f32 v[196:197], v[196:197], v[204:205]
    v_pk_mul_f32 v[198:199], v[198:199], v[206:207]
    v_cvt_pk_bf16_f32 v212, v192, v193
    v_cvt_pk_bf16_f32 v213, v194, v195
    v_cvt_pk_bf16_f32 v214, v196, v197
    v_cvt_pk_bf16_f32 v215, v198, v199
    ds_write_b128 v224, v[212:215] offset:9216
    v_mov_b32 v4, 7
    ds_write_b32 v3, v4
    s_nop 0
    v_pk_fma_f32 v[192:193], v[136:137], v[124:125], v[164:165] op_sel:[0,1,0] op_sel_hi:[1,1,1] neg_lo:[0,1,0] neg_hi:[0,1,0]
    v_pk_fma_f32 v[194:195], v[138:139], v[124:125], v[166:167] op_sel:[0,1,0] op_sel_hi:[1,1,1] neg_lo:[0,1,0] neg_hi:[0,1,0]
    v_pk_fma_f32 v[196:197], v[140:141], v[124:125], v[168:169] op_sel:[0,1,0] op_sel_hi:[1,1,1] neg_lo:[0,1,0] neg_hi:[0,1,0]
    v_pk_fma_f32 v[198:199], v[142:143], v[124:125], v[170:171] op_sel:[0,1,0] op_sel_hi:[1,1,1] neg_lo:[0,1,0] neg_hi:[0,1,0]
    v_pk_fma_f32 v[192:193], v[48:49], v[124:125], v[192:193] op_sel_hi:[1,0,1]
    v_pk_fma_f32 v[194:195], v[50:51], v[124:125], v[194:195] op_sel_hi:[1,0,1]
    v_pk_fma_f32 v[196:197], v[64:65], v[124:125], v[196:197] op_sel_hi:[1,0,1]
    v_pk_fma_f32 v[198:199], v[66:67], v[124:125], v[198:199] op_sel_hi:[1,0,1]
    v_pk_mul_f32 v[200:201], v[192:193], v[192:193]
    v_pk_mul_f32 v[202:203], v[194:195], v[194:195]
    v_pk_mul_f32 v[204:205], v[196:197], v[196:197]
    v_pk_mul_f32 v[206:207], v[198:199], v[198:199]
    v_pk_fma_f32 v[200:201], v[200:201], v[184:185], v[184:185] op_sel:[0,1,0] op_sel_hi:[1,1,0]
    v_pk_fma_f32 v[202:203], v[202:203], v[184:185], v[184:185] op_sel:[0,1,0] op_sel_hi:[1,1,0]
    v_pk_fma_f32 v[204:205], v[204:205], v[184:185], v[184:185] op_sel:[0,1,0] op_sel_hi:[1,1,0]
    v_pk_fma_f32 v[206:207], v[206:207], v[184:185], v[184:185] op_sel:[0,1,0] op_sel_hi:[1,1,0]
    v_pk_mul_f32 v[200:201], v[200:201], v[192:193]
    v_pk_mul_f32 v[202:203], v[202:203], v[194:195]
    v_pk_mul_f32 v[204:205], v[204:205], v[196:197]
    v_pk_mul_f32 v[206:207], v[206:207], v[198:199]
    v_exp_f32 v200, v200
    v_exp_f32 v201, v201
    v_exp_f32 v202, v202
    v_exp_f32 v203, v203
    v_exp_f32 v204, v204
    v_exp_f32 v205, v205
    v_exp_f32 v206, v206
    v_exp_f32 v207, v207
    v_pk_add_f32 v[200:201], v[200:201], 1.0 op_sel_hi:[1,0]
    v_pk_add_f32 v[202:203], v[202:203], 1.0 op_sel_hi:[1,0]
    v_pk_add_f32 v[204:205], v[204:205], 1.0 op_sel_hi:[1,0]
    v_pk_add_f32 v[206:207], v[206:207], 1.0 op_sel_hi:[1,0]
    v_rcp_f32 v200, v200
    v_rcp_f32 v201, v201
    v_rcp_f32 v202, v202
    v_rcp_f32 v203, v203
    v_rcp_f32 v204, v204
    v_rcp_f32 v205, v205
    v_rcp_f32 v206, v206
    v_rcp_f32 v207, v207
    v_pk_mul_f32 v[192:193], v[192:193], v[200:201]
    v_pk_mul_f32 v[194:195], v[194:195], v[202:203]
    v_pk_mul_f32 v[196:197], v[196:197], v[204:205]
    v_pk_mul_f32 v[198:199], v[198:199], v[206:207]
    v_cvt_pk_bf16_f32 v216, v192, v193
    v_cvt_pk_bf16_f32 v217, v194, v195
    v_cvt_pk_bf16_f32 v218, v196, v197
    v_cvt_pk_bf16_f32 v219, v198, v199
    ds_write_b128 v224, v[216:219] offset:10240
    v_pk_fma_f32 v[192:193], v[136:137], v[126:127], v[164:165] op_sel:[0,1,0] op_sel_hi:[1,1,1] neg_lo:[0,1,0] neg_hi:[0,1,0]
    v_pk_fma_f32 v[194:195], v[138:139], v[126:127], v[166:167] op_sel:[0,1,0] op_sel_hi:[1,1,1] neg_lo:[0,1,0] neg_hi:[0,1,0]
    v_pk_fma_f32 v[196:197], v[140:141], v[126:127], v[168:169] op_sel:[0,1,0] op_sel_hi:[1,1,1] neg_lo:[0,1,0] neg_hi:[0,1,0]
    v_pk_fma_f32 v[198:199], v[142:143], v[126:127], v[170:171] op_sel:[0,1,0] op_sel_hi:[1,1,1] neg_lo:[0,1,0] neg_hi:[0,1,0]
    v_pk_fma_f32 v[192:193], v[52:53], v[126:127], v[192:193] op_sel_hi:[1,0,1]
    v_pk_fma_f32 v[194:195], v[54:55], v[126:127], v[194:195] op_sel_hi:[1,0,1]
    v_pk_fma_f32 v[196:197], v[68:69], v[126:127], v[196:197] op_sel_hi:[1,0,1]
    v_pk_fma_f32 v[198:199], v[70:71], v[126:127], v[198:199] op_sel_hi:[1,0,1]
    v_pk_mul_f32 v[200:201], v[192:193], v[192:193]
    v_pk_mul_f32 v[202:203], v[194:195], v[194:195]
    v_pk_mul_f32 v[204:205], v[196:197], v[196:197]
    v_pk_mul_f32 v[206:207], v[198:199], v[198:199]
    v_pk_fma_f32 v[200:201], v[200:201], v[184:185], v[184:185] op_sel:[0,1,0] op_sel_hi:[1,1,0]
    v_pk_fma_f32 v[202:203], v[202:203], v[184:185], v[184:185] op_sel:[0,1,0] op_sel_hi:[1,1,0]
    v_pk_fma_f32 v[204:205], v[204:205], v[184:185], v[184:185] op_sel:[0,1,0] op_sel_hi:[1,1,0]
    v_pk_fma_f32 v[206:207], v[206:207], v[184:185], v[184:185] op_sel:[0,1,0] op_sel_hi:[1,1,0]
    v_pk_mul_f32 v[200:201], v[200:201], v[192:193]
    v_pk_mul_f32 v[202:203], v[202:203], v[194:195]
    v_pk_mul_f32 v[204:205], v[204:205], v[196:197]
    v_pk_mul_f32 v[206:207], v[206:207], v[198:199]
    v_exp_f32 v200, v200
    v_exp_f32 v201, v201
    v_exp_f32 v202, v202
    v_exp_f32 v203, v203
    v_exp_f32 v204, v204
    v_exp_f32 v205, v205
    v_exp_f32 v206, v206
    v_exp_f32 v207, v207
    v_pk_add_f32 v[200:201], v[200:201], 1.0 op_sel_hi:[1,0]
    v_pk_add_f32 v[202:203], v[202:203], 1.0 op_sel_hi:[1,0]
    v_pk_add_f32 v[204:205], v[204:205], 1.0 op_sel_hi:[1,0]
    v_pk_add_f32 v[206:207], v[206:207], 1.0 op_sel_hi:[1,0]
    v_rcp_f32 v200, v200
    v_rcp_f32 v201, v201
    v_rcp_f32 v202, v202
    v_rcp_f32 v203, v203
    v_rcp_f32 v204, v204
    v_rcp_f32 v205, v205
    v_rcp_f32 v206, v206
    v_rcp_f32 v207, v207
    v_pk_mul_f32 v[192:193], v[192:193], v[200:201]
    v_pk_mul_f32 v[194:195], v[194:195], v[202:203]
    v_pk_mul_f32 v[196:197], v[196:197], v[204:205]
    v_pk_mul_f32 v[198:199], v[198:199], v[206:207]
    v_cvt_pk_bf16_f32 v220, v192, v193
    v_cvt_pk_bf16_f32 v221, v194, v195
    v_cvt_pk_bf16_f32 v222, v196, v197
    v_cvt_pk_bf16_f32 v223, v198, v199
    ds_write_b128 v224, v[220:223] offset:11264
    v_mov_b32 v4, 9
    ds_write_b32 v3, v4
    s_nop 0
    v_pk_fma_f32 v[192:193], v[144:145], v[120:121], v[172:173] op_sel:[0,1,0] op_sel_hi:[1,1,1] neg_lo:[0,1,0] neg_hi:[0,1,0]
    v_pk_fma_f32 v[194:195], v[146:147], v[120:121], v[174:175] op_sel:[0,1,0] op_sel_hi:[1,1,1] neg_lo:[0,1,0] neg_hi:[0,1,0]
    v_pk_fma_f32 v[196:197], v[148:149], v[120:121], v[176:177] op_sel:[0,1,0] op_sel_hi:[1,1,1] neg_lo:[0,1,0] neg_hi:[0,1,0]
    v_pk_fma_f32 v[198:199], v[150:151], v[120:121], v[178:179] op_sel:[0,1,0] op_sel_hi:[1,1,1] neg_lo:[0,1,0] neg_hi:[0,1,0]
    v_pk_fma_f32 v[192:193], v[72:73], v[120:121], v[192:193] op_sel_hi:[1,0,1]
    v_pk_fma_f32 v[194:195], v[74:75], v[120:121], v[194:195] op_sel_hi:[1,0,1]
    v_pk_fma_f32 v[196:197], v[88:89], v[120:121], v[196:197] op_sel_hi:[1,0,1]
    v_pk_fma_f32 v[198:199], v[90:91], v[120:121], v[198:199] op_sel_hi:[1,0,1]
    v_pk_mul_f32 v[200:201], v[192:193], v[192:193]
    v_pk_mul_f32 v[202:203], v[194:195], v[194:195]
    v_pk_mul_f32 v[204:205], v[196:197], v[196:197]
    v_pk_mul_f32 v[206:207], v[198:199], v[198:199]
    v_pk_fma_f32 v[200:201], v[200:201], v[184:185], v[184:185] op_sel:[0,1,0] op_sel_hi:[1,1,0]
    v_pk_fma_f32 v[202:203], v[202:203], v[184:185], v[184:185] op_sel:[0,1,0] op_sel_hi:[1,1,0]
    v_pk_fma_f32 v[204:205], v[204:205], v[184:185], v[184:185] op_sel:[0,1,0] op_sel_hi:[1,1,0]
    v_pk_fma_f32 v[206:207], v[206:207], v[184:185], v[184:185] op_sel:[0,1,0] op_sel_hi:[1,1,0]
    v_pk_mul_f32 v[200:201], v[200:201], v[192:193]
    v_pk_mul_f32 v[202:203], v[202:203], v[194:195]
    v_pk_mul_f32 v[204:205], v[204:205], v[196:197]
    v_pk_mul_f32 v[206:207], v[206:207], v[198:199]
    v_exp_f32 v200, v200
    v_exp_f32 v201, v201
    v_exp_f32 v202, v202
    v_exp_f32 v203, v203
    v_exp_f32 v204, v204
    v_exp_f32 v205, v205
    v_exp_f32 v206, v206
    v_exp_f32 v207, v207
    v_pk_add_f32 v[200:201], v[200:201], 1.0 op_sel_hi:[1,0]
    v_pk_add_f32 v[202:203], v[202:203], 1.0 op_sel_hi:[1,0]
    v_pk_add_f32 v[204:205], v[204:205], 1.0 op_sel_hi:[1,0]
    v_pk_add_f32 v[206:207], v[206:207], 1.0 op_sel_hi:[1,0]
    v_rcp_f32 v200, v200
    v_rcp_f32 v201, v201
    v_rcp_f32 v202, v202
    v_rcp_f32 v203, v203
    v_rcp_f32 v204, v204
    v_rcp_f32 v205, v205
    v_rcp_f32 v206, v206
    v_rcp_f32 v207, v207
    v_pk_mul_f32 v[192:193], v[192:193], v[200:201]
    v_pk_mul_f32 v[194:195], v[194:195], v[202:203]
    v_pk_mul_f32 v[196:197], v[196:197], v[204:205]
    v_pk_mul_f32 v[198:199], v[198:199], v[206:207]
    v_cvt_pk_bf16_f32 v208, v192, v193
    v_cvt_pk_bf16_f32 v209, v194, v195
    v_cvt_pk_bf16_f32 v210, v196, v197
    v_cvt_pk_bf16_f32 v211, v198, v199
    ds_write_b128 v224, v[208:211] offset:16384
    v_mov_b32 v4, 10
    ds_write_b32 v3, v4
    s_nop 0
    v_pk_fma_f32 v[192:193], v[144:145], v[122:123], v[172:173] op_sel:[0,1,0] op_sel_hi:[1,1,1] neg_lo:[0,1,0] neg_hi:[0,1,0]
    v_pk_fma_f32 v[194:195], v[146:147], v[122:123], v[174:175] op_sel:[0,1,0] op_sel_hi:[1,1,1] neg_lo:[0,1,0] neg_hi:[0,1,0]
    v_pk_fma_f32 v[196:197], v[148:149], v[122:123], v[176:177] op_sel:[0,1,0] op_sel_hi:[1,1,1] neg_lo:[0,1,0] neg_hi:[0,1,0]
    v_pk_fma_f32 v[198:199], v[150:151], v[122:123], v[178:179] op_sel:[0,1,0] op_sel_hi:[1,1,1] neg_lo:[0,1,0] neg_hi:[0,1,0]
    v_pk_fma_f32 v[192:193], v[76:77], v[122:123], v[192:193] op_sel_hi:[1,0,1]
    v_pk_fma_f32 v[194:195], v[78:79], v[122:123], v[194:195] op_sel_hi:[1,0,1]
    v_pk_fma_f32 v[196:197], v[92:93], v[122:123], v[196:197] op_sel_hi:[1,0,1]
    v_pk_fma_f32 v[198:199], v[94:95], v[122:123], v[198:199] op_sel_hi:[1,0,1]
    v_pk_mul_f32 v[200:201], v[192:193], v[192:193]
    v_pk_mul_f32 v[202:203], v[194:195], v[194:195]
    v_pk_mul_f32 v[204:205], v[196:197], v[196:197]
    v_pk_mul_f32 v[206:207], v[198:199], v[198:199]
    v_pk_fma_f32 v[200:201], v[200:201], v[184:185], v[184:185] op_sel:[0,1,0] op_sel_hi:[1,1,0]
    v_pk_fma_f32 v[202:203], v[202:203], v[184:185], v[184:185] op_sel:[0,1,0] op_sel_hi:[1,1,0]
    v_pk_fma_f32 v[204:205], v[204:205], v[184:185], v[184:185] op_sel:[0,1,0] op_sel_hi:[1,1,0]
    v_pk_fma_f32 v[206:207], v[206:207], v[184:185], v[184:185] op_sel:[0,1,0] op_sel_hi:[1,1,0]
    v_pk_mul_f32 v[200:201], v[200:201], v[192:193]
    v_pk_mul_f32 v[202:203], v[202:203], v[194:195]
    v_pk_mul_f32 v[204:205], v[204:205], v[196:197]
    v_pk_mul_f32 v[206:207], v[206:207], v[198:199]
    v_exp_f32 v200, v200
    v_exp_f32 v201, v201
    v_exp_f32 v202, v202
    v_exp_f32 v203, v203
    v_exp_f32 v204, v204
    v_exp_f32 v205, v205
    v_exp_f32 v206, v206
    v_exp_f32 v207, v207
    v_pk_add_f32 v[200:201], v[200:201], 1.0 op_sel_hi:[1,0]
    v_pk_add_f32 v[202:203], v[202:203], 1.0 op_sel_hi:[1,0]
    v_pk_add_f32 v[204:205], v[204:205], 1.0 op_sel_hi:[1,0]
    v_pk_add_f32 v[206:207], v[206:207], 1.0 op_sel_hi:[1,0]
    v_rcp_f32 v200, v200
    v_rcp_f32 v201, v201
    v_rcp_f32 v202, v202
    v_rcp_f32 v203, v203
    v_rcp_f32 v204, v204
    v_rcp_f32 v205, v205
    v_rcp_f32 v206, v206
    v_rcp_f32 v207, v207
    v_pk_mul_f32 v[192:193], v[192:193], v[200:201]
    v_pk_mul_f32 v[194:195], v[194:195], v[202:203]
    v_pk_mul_f32 v[196:197], v[196:197], v[204:205]
    v_pk_mul_f32 v[198:199], v[198:199], v[206:207]
    v_cvt_pk_bf16_f32 v212, v192, v193
    v_cvt_pk_bf16_f32 v213, v194, v195
    v_cvt_pk_bf16_f32 v214, v196, v197
    v_cvt_pk_bf16_f32 v215, v198, v199
    ds_write_b128 v224, v[212:215] offset:17408
    v_mov_b32 v4, 11
    ds_write_b32 v3, v4
    s_nop 0
    v_pk_fma_f32 v[192:193], v[144:145], v[124:125], v[172:173] op_sel:[0,1,0] op_sel_hi:[1,1,1] neg_lo:[0,1,0] neg_hi:[0,1,0]
    v_pk_fma_f32 v[194:195], v[146:147], v[124:125], v[174:175] op_sel:[0,1,0] op_sel_hi:[1,1,1] neg_lo:[0,1,0] neg_hi:[0,1,0]
    v_pk_fma_f32 v[196:197], v[148:149], v[124:125], v[176:177] op_sel:[0,1,0] op_sel_hi:[1,1,1] neg_lo:[0,1,0] neg_hi:[0,1,0]
    v_pk_fma_f32 v[198:199], v[150:151], v[124:125], v[178:179] op_sel:[0,1,0] op_sel_hi:[1,1,1] neg_lo:[0,1,0] neg_hi:[0,1,0]
    v_pk_fma_f32 v[192:193], v[80:81], v[124:125], v[192:193] op_sel_hi:[1,0,1]
    v_pk_fma_f32 v[194:195], v[82:83], v[124:125], v[194:195] op_sel_hi:[1,0,1]
    v_pk_fma_f32 v[196:197], v[96:97], v[124:125], v[196:197] op_sel_hi:[1,0,1]
    v_pk_fma_f32 v[198:199], v[98:99], v[124:125], v[198:199] op_sel_hi:[1,0,1]
    v_pk_mul_f32 v[200:201], v[192:193], v[192:193]
    v_pk_mul_f32 v[202:203], v[194:195], v[194:195]
    v_pk_mul_f32 v[204:205], v[196:197], v[196:197]
    v_pk_mul_f32 v[206:207], v[198:199], v[198:199]
    v_pk_fma_f32 v[200:201], v[200:201], v[184:185], v[184:185] op_sel:[0,1,0] op_sel_hi:[1,1,0]
    v_pk_fma_f32 v[202:203], v[202:203], v[184:185], v[184:185] op_sel:[0,1,0] op_sel_hi:[1,1,0]
    v_pk_fma_f32 v[204:205], v[204:205], v[184:185], v[184:185] op_sel:[0,1,0] op_sel_hi:[1,1,0]
    v_pk_fma_f32 v[206:207], v[206:207], v[184:185], v[184:185] op_sel:[0,1,0] op_sel_hi:[1,1,0]
    v_pk_mul_f32 v[200:201], v[200:201], v[192:193]
    v_pk_mul_f32 v[202:203], v[202:203], v[194:195]
    v_pk_mul_f32 v[204:205], v[204:205], v[196:197]
    v_pk_mul_f32 v[206:207], v[206:207], v[198:199]
    v_exp_f32 v200, v200
    v_exp_f32 v201, v201
    v_exp_f32 v202, v202
    v_exp_f32 v203, v203
    v_exp_f32 v204, v204
    v_exp_f32 v205, v205
    v_exp_f32 v206, v206
    v_exp_f32 v207, v207
    v_pk_add_f32 v[200:201], v[200:201], 1.0 op_sel_hi:[1,0]
    v_pk_add_f32 v[202:203], v[202:203], 1.0 op_sel_hi:[1,0]
    v_pk_add_f32 v[204:205], v[204:205], 1.0 op_sel_hi:[1,0]
    v_pk_add_f32 v[206:207], v[206:207], 1.0 op_sel_hi:[1,0]
    v_rcp_f32 v200, v200
    v_rcp_f32 v201, v201
    v_rcp_f32 v202, v202
    v_rcp_f32 v203, v203
    v_rcp_f32 v204, v204
    v_rcp_f32 v205, v205
    v_rcp_f32 v206, v206
    v_rcp_f32 v207, v207
    v_pk_mul_f32 v[192:193], v[192:193], v[200:201]
    v_pk_mul_f32 v[194:195], v[194:195], v[202:203]
    v_pk_mul_f32 v[196:197], v[196:197], v[204:205]
    v_pk_mul_f32 v[198:199], v[198:199], v[206:207]
    v_cvt_pk_bf16_f32 v216, v192, v193
    v_cvt_pk_bf16_f32 v217, v194, v195
    v_cvt_pk_bf16_f32 v218, v196, v197
    v_cvt_pk_bf16_f32 v219, v198, v199
    ds_write_b128 v224, v[216:219] offset:18432
    v_mov_b32 v4, 12
    ds_write_b32 v3, v4
    s_nop 0
    v_pk_fma_f32 v[192:193], v[144:145], v[126:127], v[172:173] op_sel:[0,1,0] op_sel_hi:[1,1,1] neg_lo:[0,1,0] neg_hi:[0,1,0]
    v_pk_fma_f32 v[194:195], v[146:147], v[126:127], v[174:175] op_sel:[0,1,0] op_sel_hi:[1,1,1] neg_lo:[0,1,0] neg_hi:[0,1,0]
    v_pk_fma_f32 v[196:197], v[148:149], v[126:127], v[176:177] op_sel:[0,1,0] op_sel_hi:[1,1,1] neg_lo:[0,1,0] neg_hi:[0,1,0]
    v_pk_fma_f32 v[198:199], v[150:151], v[126:127], v[178:179] op_sel:[0,1,0] op_sel_hi:[1,1,1] neg_lo:[0,1,0] neg_hi:[0,1,0]
    v_pk_fma_f32 v[192:193], v[84:85], v[126:127], v[192:193] op_sel_hi:[1,0,1]
    v_pk_fma_f32 v[194:195], v[86:87], v[126:127], v[194:195] op_sel_hi:[1,0,1]
    v_pk_fma_f32 v[196:197], v[100:101], v[126:127], v[196:197] op_sel_hi:[1,0,1]
    v_pk_fma_f32 v[198:199], v[102:103], v[126:127], v[198:199] op_sel_hi:[1,0,1]
    v_pk_mul_f32 v[200:201], v[192:193], v[192:193]
    v_pk_mul_f32 v[202:203], v[194:195], v[194:195]
    v_pk_mul_f32 v[204:205], v[196:197], v[196:197]
    v_pk_mul_f32 v[206:207], v[198:199], v[198:199]
    v_pk_fma_f32 v[200:201], v[200:201], v[184:185], v[184:185] op_sel:[0,1,0] op_sel_hi:[1,1,0]
    v_pk_fma_f32 v[202:203], v[202:203], v[184:185], v[184:185] op_sel:[0,1,0] op_sel_hi:[1,1,0]
    v_pk_fma_f32 v[204:205], v[204:205], v[184:185], v[184:185] op_sel:[0,1,0] op_sel_hi:[1,1,0]
    v_pk_fma_f32 v[206:207], v[206:207], v[184:185], v[184:185] op_sel:[0,1,0] op_sel_hi:[1,1,0]
    v_pk_mul_f32 v[200:201], v[200:201], v[192:193]
    v_pk_mul_f32 v[202:203], v[202:203], v[194:195]
    v_pk_mul_f32 v[204:205], v[204:205], v[196:197]
    v_pk_mul_f32 v[206:207], v[206:207], v[198:199]
    v_exp_f32 v200, v200
    v_exp_f32 v201, v201
    v_exp_f32 v202, v202
    v_exp_f32 v203, v203
    v_exp_f32 v204, v204
    v_exp_f32 v205, v205
    v_exp_f32 v206, v206
    v_exp_f32 v207, v207
    v_pk_add_f32 v[200:201], v[200:201], 1.0 op_sel_hi:[1,0]
    v_pk_add_f32 v[202:203], v[202:203], 1.0 op_sel_hi:[1,0]
    v_pk_add_f32 v[204:205], v[204:205], 1.0 op_sel_hi:[1,0]
    v_pk_add_f32 v[206:207], v[206:207], 1.0 op_sel_hi:[1,0]
    v_rcp_f32 v200, v200
    v_rcp_f32 v201, v201
    v_rcp_f32 v202, v202
    v_rcp_f32 v203, v203
    v_rcp_f32 v204, v204
    v_rcp_f32 v205, v205
    v_rcp_f32 v206, v206
    v_rcp_f32 v207, v207
    v_pk_mul_f32 v[192:193], v[192:193], v[200:201]
    v_pk_mul_f32 v[194:195], v[194:195], v[202:203]
    v_pk_mul_f32 v[196:197], v[196:197], v[204:205]
    v_pk_mul_f32 v[198:199], v[198:199], v[206:207]
    v_cvt_pk_bf16_f32 v220, v192, v193
    v_cvt_pk_bf16_f32 v221, v194, v195
    v_cvt_pk_bf16_f32 v222, v196, v197
    v_cvt_pk_bf16_f32 v223, v198, v199
    ds_write_b128 v224, v[220:223] offset:19456
    v_mov_b32 v4, 13
    ds_write_b32 v3, v4
    s_lshr_b32 s53, s45, 3
    s_lshl_b32 s68, s66, 1
    s_add_u32 s68, s68, s53
    s_lshl_b32 s68, s68, 1
    s_lshl_b32 s56, s68, 10
    v_add_u32 v119, s56, v2
    v_xor_b32 v120, 0x800, v119
    v_add_u32 v121, 0x10000, v119
    v_add_u32 v122, 0x10000, v120
    s_lshl_b32 s53, s67, 2
    v_bfe_u32 v3, v1, 2, 3
    v_xor_b32 v3, s53, v3
    v_lshlrev_b32 v3, 5, v3
    v_and_b32 v4, 3, v1
    v_lshl_add_u32 v3, v4, 3, v3
    v_lshrrev_b32 v4, 2, v1
    v_mul_u32_u24 v4, 256, v4
    v_add_u32 v123, v3, v4
    v_xor_b32 v124, 32, v123
    v_xor_b32 v125, 64, v123
    v_xor_b32 v126, 96, v123
    v_add_u32 v127, 0x10000, v123
    v_add_u32 v128, 0x20000, v123
    v_add_u32 v129, 0x10000, v124
    v_add_u32 v130, 0x20000, v124
    v_add_u32 v131, 0x10000, v125
    v_add_u32 v132, 0x20000, v125
    v_add_u32 v133, 0x10000, v126
    v_add_u32 v134, 0x20000, v126
    s_and_b32 s69, s45, 7
    s_lshl_b32 s69, s69, 1
    s_add_u32 s69, s69, s67
    s_lshl_b32 s54, s44, 4
    s_add_u32 s54, s54, s69
    s_lshl_b32 s54, s54, 14
    s_add_u32 s54, s54, s56
    s_add_u32 s54, s54, 0xc00000
    s_add_u32 s55, s54, 8192
    s_lshl_b32 s69, s69, 7
    v_lshrrev_b32 v118, 4, v1
    v_lshlrev_b32 v118, 3, v118
    v_and_b32 v3, 7, v1
    v_lshlrev_b32 v3, 2, v3
    v_add_u32 v3, 162816, v3
    s_mov_b32 s61, 0
sequential_preLN__sliding_block__dense_activation_gelu__prompt_kernel_lw81:
    ds_read_b32 v4, v3
    s_waitcnt lgkmcnt(0)
    v_cmp_gt_u32 vcc, 13, v4
    s_cmp_eq_u64 vcc, 0
    s_cbranch_scc1 sequential_preLN__sliding_block__dense_activation_gelu__prompt_kernel_lwd82
    s_add_u32 s61, s61, 1
    s_cmp_lt_u32 s61, 262144
    s_cbranch_scc1 sequential_preLN__sliding_block__dense_activation_gelu__prompt_kernel_lw81
sequential_preLN__sliding_block__dense_activation_gelu__prompt_kernel_lwd82:
    ds_read_b128 v[136:139], v121 offset:0
    ds_read_b64_tr_b16 v[168:169], v123 offset:0
    ds_read_b64_tr_b16 v[170:171], v123 offset:4096
    ds_read_b128 v[140:143], v121 offset:1024
    ds_read_b128 v[144:147], v122 offset:0
    ds_read_b128 v[148:151], v122 offset:1024
    ds_read_b64_tr_b16 v[172:173], v124 offset:0
    ds_read_b64_tr_b16 v[174:175], v124 offset:4096
    ds_read_b64_tr_b16 v[176:177], v125 offset:0
    ds_read_b64_tr_b16 v[178:179], v125 offset:4096
    ds_read_b64_tr_b16 v[180:181], v126 offset:0
    ds_read_b64_tr_b16 v[182:183], v126 offset:4096
    s_waitcnt lgkmcnt(4)
    v_mfma_f32_16x16x32_bf16 v[8:11], v[168:171], v[136:139], 0
    ds_read_b128 v[152:155], v121 offset:8192
    v_mfma_f32_16x16x32_bf16 v[12:15], v[168:171], v[140:143], 0
    ds_read_b64_tr_b16 v[184:185], v123 offset:8192
    v_mfma_f32_16x16x32_bf16 v[16:19], v[168:171], v[144:147], 0
    ds_read_b64_tr_b16 v[186:187], v123 offset:12288
    v_mfma_f32_16x16x32_bf16 v[20:23], v[168:171], v[148:151], 0
    ds_read_b128 v[156:159], v121 offset:9216
    v_mfma_f32_16x16x32_bf16 v[36:39], v[172:175], v[148:151], 0
    ds_read_b128 v[160:163], v122 offset:8192
    v_mfma_f32_16x16x32_bf16 v[32:35], v[172:175], v[144:147], 0
    ds_read_b128 v[164:167], v122 offset:9216
    v_mfma_f32_16x16x32_bf16 v[28:31], v[172:175], v[140:143], 0
    ds_read_b64_tr_b16 v[188:189], v124 offset:8192
    v_mfma_f32_16x16x32_bf16 v[24:27], v[172:175], v[136:139], 0
    ds_read_b64_tr_b16 v[190:191], v124 offset:12288
    s_waitcnt lgkmcnt(8)
    v_mfma_f32_16x16x32_bf16 v[40:43], v[176:179], v[136:139], 0
    ds_read_b64_tr_b16 v[192:193], v125 offset:8192
    v_mfma_f32_16x16x32_bf16 v[44:47], v[176:179], v[140:143], 0
    ds_read_b64_tr_b16 v[194:195], v125 offset:12288
    v_mfma_f32_16x16x32_bf16 v[48:51], v[176:179], v[144:147], 0
    ds_read_b64_tr_b16 v[196:197], v126 offset:8192
    v_mfma_f32_16x16x32_bf16 v[52:55], v[176:179], v[148:151], 0
    ds_read_b64_tr_b16 v[198:199], v126 offset:12288
    v_mfma_f32_16x16x32_bf16 v[68:71], v[180:183], v[148:151], 0
    v_mfma_f32_16x16x32_bf16 v[64:67], v[180:183], v[144:147], 0
    v_mfma_f32_16x16x32_bf16 v[60:63], v[180:183], v[140:143], 0
    v_mfma_f32_16x16x32_bf16 v[56:59], v[180:183], v[136:139], 0
    s_waitcnt lgkmcnt(4)
    v_mfma_f32_16x16x32_bf16 v[8:11], v[184:187], v[152:155], v[8:11]
    ds_read_b128 v[136:139], v121 offset:16384
    v_mfma_f32_16x16x32_bf16 v[12:15], v[184:187], v[156:159], v[12:15]
    ds_read_b64_tr_b16 v[168:169], v123 offset:16384
    v_mfma_f32_16x16x32_bf16 v[16:19], v[184:187], v[160:163], v[16:19]
    ds_read_b64_tr_b16 v[170:171], v123 offset:20480
    v_mfma_f32_16x16x32_bf16 v[20:23], v[184:187], v[164:167], v[20:23]
    ds_read_b128 v[140:143], v121 offset:17408
    v_mfma_f32_16x16x32_bf16 v[36:39], v[188:191], v[164:167], v[36:39]
    ds_read_b128 v[144:147], v122 offset:16384
    v_mfma_f32_16x16x32_bf16 v[32:35], v[188:191], v[160:163], v[32:35]
    ds_read_b128 v[148:151], v122 offset:17408
    v_mfma_f32_16x16x32_bf16 v[28:31], v[188:191], v[156:159], v[28:31]
    ds_read_b64_tr_b16 v[172:173], v124 offset:16384
    v_mfma_f32_16x16x32_bf16 v[24:27], v[188:191], v[152:155], v[24:27]
    ds_read_b64_tr_b16 v[174:175], v124 offset:20480
    s_waitcnt lgkmcnt(8)
    v_mfma_f32_16x16x32_bf16 v[40:43], v[192:195], v[152:155], v[40:43]
    ds_read_b64_tr_b16 v[176:177], v125 offset:16384
    v_mfma_f32_16x16x32_bf16 v[44:47], v[192:195], v[156:159], v[44:47]
    ds_read_b64_tr_b16 v[178:179], v125 offset:20480
    v_mfma_f32_16x16x32_bf16 v[48:51], v[192:195], v[160:163], v[48:51]
    ds_read_b64_tr_b16 v[180:181], v126 offset:16384
    v_mfma_f32_16x16x32_bf16 v[52:55], v[192:195], v[164:167], v[52:55]
    ds_read_b64_tr_b16 v[182:183], v126 offset:20480
    v_mfma_f32_16x16x32_bf16 v[68:71], v[196:199], v[164:167], v[68:71]
    buffer_load_dwordx4 v[72:75], v2, s[24:27], s54 offen offset:0 sc1
    v_mfma_f32_16x16x32_bf16 v[64:67], v[196:199], v[160:163], v[64:67]
    buffer_load_dwordx4 v[76:79], v2, s[24:27], s54 offen offset:1024 sc1
    v_mfma_f32_16x16x32_bf16 v[60:63], v[196:199], v[156:159], v[60:63]
    buffer_load_dwordx4 v[80:83], v2, s[24:27], s55 offen offset:0 sc1
    v_mfma_f32_16x16x32_bf16 v[56:59], v[196:199], v[152:155], v[56:59]
    buffer_load_dwordx4 v[84:87], v2, s[24:27], s55 offen offset:1024 sc1
    s_waitcnt lgkmcnt(4)
    v_mfma_f32_16x16x32_bf16 v[8:11], v[168:171], v[136:139], v[8:11]
    ds_read_b128 v[152:155], v121 offset:24576
    v_mfma_f32_16x16x32_bf16 v[12:15], v[168:171], v[140:143], v[12:15]
    ds_read_b64_tr_b16 v[184:185], v123 offset:24576
    v_mfma_f32_16x16x32_bf16 v[16:19], v[168:171], v[144:147], v[16:19]
    ds_read_b64_tr_b16 v[186:187], v123 offset:28672
    v_mfma_f32_16x16x32_bf16 v[20:23], v[168:171], v[148:151], v[20:23]
    ds_read_b128 v[156:159], v121 offset:25600
    v_mfma_f32_16x16x32_bf16 v[36:39], v[172:175], v[148:151], v[36:39]
    ds_read_b128 v[160:163], v122 offset:24576
    v_mfma_f32_16x16x32_bf16 v[32:35], v[172:175], v[144:147], v[32:35]
    ds_read_b128 v[164:167], v122 offset:25600
    v_mfma_f32_16x16x32_bf16 v[28:31], v[172:175], v[140:143], v[28:31]
    ds_read_b64_tr_b16 v[188:189], v124 offset:24576
    v_mfma_f32_16x16x32_bf16 v[24:27], v[172:175], v[136:139], v[24:27]
    ds_read_b64_tr_b16 v[190:191], v124 offset:28672
    s_waitcnt lgkmcnt(8)
    v_mfma_f32_16x16x32_bf16 v[40:43], v[176:179], v[136:139], v[40:43]
    ds_read_b64_tr_b16 v[192:193], v125 offset:24576
    v_mfma_f32_16x16x32_bf16 v[44:47], v[176:179], v[140:143], v[44:47]
    ds_read_b64_tr_b16 v[194:195], v125 offset:28672
    v_mfma_f32_16x16x32_bf16 v[48:51], v[176:179], v[144:147], v[48:51]
    ds_read_b64_tr_b16 v[196:197], v126 offset:24576
    v_mfma_f32_16x16x32_bf16 v[52:55], v[176:179], v[148:151], v[52:55]
    ds_read_b64_tr_b16 v[198:199], v126 offset:28672
    v_mfma_f32_16x16x32_bf16 v[68:71], v[180:183], v[148:151], v[68:71]
    buffer_load_dwordx2 v[88:89], v118, s[40:43], s69 offen offset:0
    v_mfma_f32_16x16x32_bf16 v[64:67], v[180:183], v[144:147], v[64:67]
    buffer_load_dwordx2 v[90:91], v118, s[40:43], s69 offen offset:32
    v_mfma_f32_16x16x32_bf16 v[60:63], v[180:183], v[140:143], v[60:63]
    buffer_load_dwordx2 v[92:93], v118, s[40:43], s69 offen offset:64
    v_mfma_f32_16x16x32_bf16 v[56:59], v[180:183], v[136:139], v[56:59]
    buffer_load_dwordx2 v[94:95], v118, s[40:43], s69 offen offset:96
    s_waitcnt lgkmcnt(4)
    v_mfma_f32_16x16x32_bf16 v[8:11], v[184:187], v[152:155], v[8:11]
    ds_read_b128 v[136:139], v121 offset:32768
    v_mfma_f32_16x16x32_bf16 v[12:15], v[184:187], v[156:159], v[12:15]
    ds_read_b64_tr_b16 v[168:169], v123 offset:32768
    v_mfma_f32_16x16x32_bf16 v[16:19], v[184:187], v[160:163], v[16:19]
    ds_read_b64_tr_b16 v[170:171], v123 offset:36864
    v_mfma_f32_16x16x32_bf16 v[20:23], v[184:187], v[164:167], v[20:23]
    ds_read_b128 v[140:143], v121 offset:33792
    v_mfma_f32_16x16x32_bf16 v[36:39], v[188:191], v[164:167], v[36:39]
    ds_read_b128 v[144:147], v122 offset:32768
    v_mfma_f32_16x16x32_bf16 v[32:35], v[188:191], v[160:163], v[32:35]
    ds_read_b128 v[148:151], v122 offset:33792
    v_mfma_f32_16x16x32_bf16 v[28:31], v[188:191], v[156:159], v[28:31]
    ds_read_b64_tr_b16 v[172:173], v124 offset:32768
    v_mfma_f32_16x16x32_bf16 v[24:27], v[188:191], v[152:155], v[24:27]
    ds_read_b64_tr_b16 v[174:175], v124 offset:36864
    s_waitcnt lgkmcnt(8)
    v_mfma_f32_16x16x32_bf16 v[40:43], v[192:195], v[152:155], v[40:43]
    ds_read_b64_tr_b16 v[176:177], v125 offset:32768
    v_mfma_f32_16x16x32_bf16 v[44:47], v[192:195], v[156:159], v[44:47]
    ds_read_b64_tr_b16 v[178:179], v125 offset:36864
    v_mfma_f32_16x16x32_bf16 v[48:51], v[192:195], v[160:163], v[48:51]
    ds_read_b64_tr_b16 v[180:181], v126 offset:32768
    v_mfma_f32_16x16x32_bf16 v[52:55], v[192:195], v[164:167], v[52:55]
    ds_read_b64_tr_b16 v[182:183], v126 offset:36864
    v_mfma_f32_16x16x32_bf16 v[68:71], v[196:199], v[164:167], v[68:71]
    v_mfma_f32_16x16x32_bf16 v[64:67], v[196:199], v[160:163], v[64:67]
    v_mfma_f32_16x16x32_bf16 v[60:63], v[196:199], v[156:159], v[60:63]
    v_mfma_f32_16x16x32_bf16 v[56:59], v[196:199], v[152:155], v[56:59]
    s_waitcnt lgkmcnt(4)
    v_mfma_f32_16x16x32_bf16 v[8:11], v[168:171], v[136:139], v[8:11]
    ds_read_b128 v[152:155], v121 offset:40960
    v_mfma_f32_16x16x32_bf16 v[12:15], v[168:171], v[140:143], v[12:15]
    ds_read_b64_tr_b16 v[184:185], v123 offset:40960
    v_mfma_f32_16x16x32_bf16 v[16:19], v[168:171], v[144:147], v[16:19]
    ds_read_b64_tr_b16 v[186:187], v123 offset:45056
    v_mfma_f32_16x16x32_bf16 v[20:23], v[168:171], v[148:151], v[20:23]
    ds_read_b128 v[156:159], v121 offset:41984
    v_mfma_f32_16x16x32_bf16 v[36:39], v[172:175], v[148:151], v[36:39]
    ds_read_b128 v[160:163], v122 offset:40960
    v_mfma_f32_16x16x32_bf16 v[32:35], v[172:175], v[144:147], v[32:35]
    ds_read_b128 v[164:167], v122 offset:41984
    v_mfma_f32_16x16x32_bf16 v[28:31], v[172:175], v[140:143], v[28:31]
    ds_read_b64_tr_b16 v[188:189], v124 offset:40960
    v_mfma_f32_16x16x32_bf16 v[24:27], v[172:175], v[136:139], v[24:27]
    ds_read_b64_tr_b16 v[190:191], v124 offset:45056
    s_waitcnt lgkmcnt(8)
    v_mfma_f32_16x16x32_bf16 v[40:43], v[176:179], v[136:139], v[40:43]
    ds_read_b64_tr_b16 v[192:193], v125 offset:40960
    v_mfma_f32_16x16x32_bf16 v[44:47], v[176:179], v[140:143], v[44:47]
    ds_read_b64_tr_b16 v[194:195], v125 offset:45056
    v_mfma_f32_16x16x32_bf16 v[48:51], v[176:179], v[144:147], v[48:51]
    ds_read_b64_tr_b16 v[196:197], v126 offset:40960
    v_mfma_f32_16x16x32_bf16 v[52:55], v[176:179], v[148:151], v[52:55]
    ds_read_b64_tr_b16 v[198:199], v126 offset:45056
    v_mfma_f32_16x16x32_bf16 v[68:71], v[180:183], v[148:151], v[68:71]
    v_mfma_f32_16x16x32_bf16 v[64:67], v[180:183], v[144:147], v[64:67]
    v_mfma_f32_16x16x32_bf16 v[60:63], v[180:183], v[140:143], v[60:63]
    v_mfma_f32_16x16x32_bf16 v[56:59], v[180:183], v[136:139], v[56:59]
    s_waitcnt lgkmcnt(4)
    v_mfma_f32_16x16x32_bf16 v[8:11], v[184:187], v[152:155], v[8:11]
    ds_read_b128 v[136:139], v121 offset:49152
    v_mfma_f32_16x16x32_bf16 v[12:15], v[184:187], v[156:159], v[12:15]
    ds_read_b64_tr_b16 v[168:169], v123 offset:49152
    v_mfma_f32_16x16x32_bf16 v[16:19], v[184:187], v[160:163], v[16:19]
    ds_read_b64_tr_b16 v[170:171], v123 offset:53248
    v_mfma_f32_16x16x32_bf16 v[20:23], v[184:187], v[164:167], v[20:23]
    ds_read_b128 v[140:143], v121 offset:50176
    v_mfma_f32_16x16x32_bf16 v[36:39], v[188:191], v[164:167], v[36:39]
    ds_read_b128 v[144:147], v122 offset:49152
    v_mfma_f32_16x16x32_bf16 v[32:35], v[188:191], v[160:163], v[32:35]
    ds_read_b128 v[148:151], v122 offset:50176
    v_mfma_f32_16x16x32_bf16 v[28:31], v[188:191], v[156:159], v[28:31]
    ds_read_b64_tr_b16 v[172:173], v124 offset:49152
    v_mfma_f32_16x16x32_bf16 v[24:27], v[188:191], v[152:155], v[24:27]
    ds_read_b64_tr_b16 v[174:175], v124 offset:53248
    s_waitcnt lgkmcnt(8)
    v_mfma_f32_16x16x32_bf16 v[40:43], v[192:195], v[152:155], v[40:43]
    ds_read_b64_tr_b16 v[176:177], v125 offset:49152
    v_mfma_f32_16x16x32_bf16 v[44:47], v[192:195], v[156:159], v[44:47]
    ds_read_b64_tr_b16 v[178:179], v125 offset:53248
    v_mfma_f32_16x16x32_bf16 v[48:51], v[192:195], v[160:163], v[48:51]
    ds_read_b64_tr_b16 v[180:181], v126 offset:49152
    v_mfma_f32_16x16x32_bf16 v[52:55], v[192:195], v[164:167], v[52:55]
    ds_read_b64_tr_b16 v[182:183], v126 offset:53248
    v_mfma_f32_16x16x32_bf16 v[68:71], v[196:199], v[164:167], v[68:71]
    v_mfma_f32_16x16x32_bf16 v[64:67], v[196:199], v[160:163], v[64:67]
    v_mfma_f32_16x16x32_bf16 v[60:63], v[196:199], v[156:159], v[60:63]
    v_mfma_f32_16x16x32_bf16 v[56:59], v[196:199], v[152:155], v[56:59]
    s_waitcnt lgkmcnt(0)
    s_lshl_b32 s53, s47, 2
    s_add_u32 s53, s53, 162816
    v_mov_b32 v3, s53
    v_mov_b32 v4, 15
    ds_write_b32 v3, v4
    v_mfma_f32_16x16x32_bf16 v[8:11], v[168:171], v[136:139], v[8:11]
    v_mfma_f32_16x16x32_bf16 v[12:15], v[168:171], v[140:143], v[12:15]
    v_mfma_f32_16x16x32_bf16 v[16:19], v[168:171], v[144:147], v[16:19]
    v_mfma_f32_16x16x32_bf16 v[20:23], v[168:171], v[148:151], v[20:23]
    v_mfma_f32_16x16x32_bf16 v[36:39], v[172:175], v[148:151], v[36:39]
    v_mfma_f32_16x16x32_bf16 v[32:35], v[172:175], v[144:147], v[32:35]
    v_mfma_f32_16x16x32_bf16 v[28:31], v[172:175], v[140:143], v[28:31]
    v_mfma_f32_16x16x32_bf16 v[24:27], v[172:175], v[136:139], v[24:27]
    v_mfma_f32_16x16x32_bf16 v[40:43], v[176:179], v[136:139], v[40:43]
    v_mfma_f32_16x16x32_bf16 v[44:47], v[176:179], v[140:143], v[44:47]
    v_mfma_f32_16x16x32_bf16 v[48:51], v[176:179], v[144:147], v[48:51]
    v_mfma_f32_16x16x32_bf16 v[52:55], v[176:179], v[148:151], v[52:55]
    v_mfma_f32_16x16x32_bf16 v[68:71], v[180:183], v[148:151], v[68:71]
    v_mfma_f32_16x16x32_bf16 v[64:67], v[180:183], v[144:147], v[64:67]
    v_mfma_f32_16x16x32_bf16 v[60:63], v[180:183], v[140:143], v[60:63]
    v_mfma_f32_16x16x32_bf16 v[56:59], v[180:183], v[136:139], v[56:59]
    s_waitcnt vmcnt(0)
    v_and_b32 v3, 15, v1
    v_lshlrev_b32 v3, 11, v3
    v_bfe_u32 v4, v1, 4, 1
    v_lshl_add_u32 v3, v4, 5, v3
    v_lshrrev_b32 v4, 5, v1
    v_lshl_add_u32 v118, v4, 4, v3
    s_lshl_b32 s70, s44, 3
    s_add_u32 s70, s70, s68
    s_lshl_b32 s70, s70, 15
    s_add_u32 s70, s70, s69
    s_lshl_b32 s71, s49, 2
    s_add_u32 s71, s71, s47
    s_lshl_b32 s71, s71, 12
    s_add_u32 s71, s71, 0x2000000
    s_xor_b32 s72, s71, 0x20000
    s_xor_b32 s73, s49, 8
    s_lshl_b32 s73, s73, 2
    s_add_u32 s73, s73, s47
    s_lshl_b32 s73, s73, 7
    s_add_u32 s73, s73, 0x29a0000
    v_lshlrev_b32 v112, 16, v88
    v_and_b32 v113, 0xffff0000, v88
    v_lshlrev_b32 v114, 16, v89
    v_and_b32 v115, 0xffff0000, v89
    v_pk_add_f32 v[8:9], v[8:9], v[112:113]
    v_pk_add_f32 v[10:11], v[10:11], v[114:115]
    v_lshlrev_b32 v112, 16, v72
    v_and_b32 v113, 0xffff0000, v72
    v_lshlrev_b32 v114, 16, v73
    v_and_b32 v115, 0xffff0000, v73
    v_pk_add_f32 v[8:9], v[8:9], v[112:113]
    v_pk_add_f32 v[10:11], v[10:11], v[114:115]
    v_lshlrev_b32 v112, 16, v88
    v_and_b32 v113, 0xffff0000, v88
    v_lshlrev_b32 v114, 16, v89
    v_and_b32 v115, 0xffff0000, v89
    v_pk_add_f32 v[12:13], v[12:13], v[112:113]
    v_pk_add_f32 v[14:15], v[14:15], v[114:115]
    v_lshlrev_b32 v112, 16, v76
    v_and_b32 v113, 0xffff0000, v76
    v_lshlrev_b32 v114, 16, v77
    v_and_b32 v115, 0xffff0000, v77
    v_pk_add_f32 v[12:13], v[12:13], v[112:113]
    v_pk_add_f32 v[14:15], v[14:15], v[114:115]
    v_lshlrev_b32 v112, 16, v90
    v_and_b32 v113, 0xffff0000, v90
    v_lshlrev_b32 v114, 16, v91
    v_and_b32 v115, 0xffff0000, v91
    v_pk_add_f32 v[24:25], v[24:25], v[112:113]
    v_pk_add_f32 v[26:27], v[26:27], v[114:115]
    v_lshlrev_b32 v112, 16, v74
    v_and_b32 v113, 0xffff0000, v74
    v_lshlrev_b32 v114, 16, v75
    v_and_b32 v115, 0xffff0000, v75
    v_pk_add_f32 v[24:25], v[24:25], v[112:113]
    v_pk_add_f32 v[26:27], v[26:27], v[114:115]
    v_lshlrev_b32 v112, 16, v90
    v_and_b32 v113, 0xffff0000, v90
    v_lshlrev_b32 v114, 16, v91
    v_and_b32 v115, 0xffff0000, v91
    v_pk_add_f32 v[28:29], v[28:29], v[112:113]
    v_pk_add_f32 v[30:31], v[30:31], v[114:115]
    v_lshlrev_b32 v112, 16, v78
    v_and_b32 v113, 0xffff0000, v78
    v_lshlrev_b32 v114, 16, v79
    v_and_b32 v115, 0xffff0000, v79
    v_pk_add_f32 v[28:29], v[28:29], v[112:113]
    v_pk_add_f32 v[30:31], v[30:31], v[114:115]
    v_lshlrev_b32 v112, 16, v92
    v_and_b32 v113, 0xffff0000, v92
    v_lshlrev_b32 v114, 16, v93
    v_and_b32 v115, 0xffff0000, v93
    v_pk_add_f32 v[40:41], v[40:41], v[112:113]
    v_pk_add_f32 v[42:43], v[42:43], v[114:115]
    v_lshlrev_b32 v112, 16, v80
    v_and_b32 v113, 0xffff0000, v80
    v_lshlrev_b32 v114, 16, v81
    v_and_b32 v115, 0xffff0000, v81
    v_pk_add_f32 v[40:41], v[40:41], v[112:113]
    v_pk_add_f32 v[42:43], v[42:43], v[114:115]
    v_lshlrev_b32 v112, 16, v92
    v_and_b32 v113, 0xffff0000, v92
    v_lshlrev_b32 v114, 16, v93
    v_and_b32 v115, 0xffff0000, v93
    v_pk_add_f32 v[44:45], v[44:45], v[112:113]
    v_pk_add_f32 v[46:47], v[46:47], v[114:115]
    v_lshlrev_b32 v112, 16, v84
    v_and_b32 v113, 0xffff0000, v84
    v_lshlrev_b32 v114, 16, v85
    v_and_b32 v115, 0xffff0000, v85
    v_pk_add_f32 v[44:45], v[44:45], v[112:113]
    v_pk_add_f32 v[46:47], v[46:47], v[114:115]
    v_lshlrev_b32 v112, 16, v94
    v_and_b32 v113, 0xffff0000, v94
    v_lshlrev_b32 v114, 16, v95
    v_and_b32 v115, 0xffff0000, v95
    v_pk_add_f32 v[56:57], v[56:57], v[112:113]
    v_pk_add_f32 v[58:59], v[58:59], v[114:115]
    v_lshlrev_b32 v112, 16, v82
    v_and_b32 v113, 0xffff0000, v82
    v_lshlrev_b32 v114, 16, v83
    v_and_b32 v115, 0xffff0000, v83
    v_pk_add_f32 v[56:57], v[56:57], v[112:113]
    v_pk_add_f32 v[58:59], v[58:59], v[114:115]
    v_lshlrev_b32 v112, 16, v94
    v_and_b32 v113, 0xffff0000, v94
    v_lshlrev_b32 v114, 16, v95
    v_and_b32 v115, 0xffff0000, v95
    v_pk_add_f32 v[60:61], v[60:61], v[112:113]
    v_pk_add_f32 v[62:63], v[62:63], v[114:115]
    v_lshlrev_b32 v112, 16, v86
    v_and_b32 v113, 0xffff0000, v86
    v_lshlrev_b32 v114, 16, v87
    v_and_b32 v115, 0xffff0000, v87
    v_pk_add_f32 v[60:61], v[60:61], v[112:113]
    v_pk_add_f32 v[62:63], v[62:63], v[114:115]
    s_barrier
    s_barrier
    s_waitcnt lgkmcnt(0)
    ds_read_b128 v[152:155], v119 offset:0
    ds_read_b64_tr_b16 v[184:185], v127 offset:57344
    ds_read_b64_tr_b16 v[186:187], v127 offset:61440
    ds_read_b128 v[156:159], v119 offset:1024
    ds_read_b128 v[160:163], v120 offset:0
    ds_read_b128 v[164:167], v120 offset:1024
    ds_read_b64_tr_b16 v[188:189], v129 offset:57344
    ds_read_b64_tr_b16 v[190:191], v129 offset:61440
    ds_read_b64_tr_b16 v[192:193], v131 offset:57344
    ds_read_b64_tr_b16 v[194:195], v131 offset:61440
    ds_read_b64_tr_b16 v[196:197], v133 offset:57344
    ds_read_b64_tr_b16 v[198:199], v133 offset:61440
    s_waitcnt lgkmcnt(4)
    v_mfma_f32_16x16x32_bf16 v[8:11], v[184:187], v[152:155], v[8:11]
    ds_read_b128 v[136:139], v119 offset:8192
    v_mfma_f32_16x16x32_bf16 v[12:15], v[184:187], v[156:159], v[12:15]
    ds_read_b64_tr_b16 v[168:169], v128 offset:0
    v_mfma_f32_16x16x32_bf16 v[16:19], v[184:187], v[160:163], v[16:19]
    ds_read_b64_tr_b16 v[170:171], v128 offset:4096
    v_mfma_f32_16x16x32_bf16 v[20:23], v[184:187], v[164:167], v[20:23]
    ds_read_b128 v[140:143], v119 offset:9216
    v_mfma_f32_16x16x32_bf16 v[36:39], v[188:191], v[164:167], v[36:39]
    ds_read_b128 v[144:147], v120 offset:8192
    v_mfma_f32_16x16x32_bf16 v[32:35], v[188:191], v[160:163], v[32:35]
    ds_read_b128 v[148:151], v120 offset:9216
    v_mfma_f32_16x16x32_bf16 v[28:31], v[188:191], v[156:159], v[28:31]
    ds_read_b64_tr_b16 v[172:173], v130 offset:0
    v_mfma_f32_16x16x32_bf16 v[24:27], v[188:191], v[152:155], v[24:27]
    ds_read_b64_tr_b16 v[174:175], v130 offset:4096
    s_waitcnt lgkmcnt(8)
    v_mfma_f32_16x16x32_bf16 v[40:43], v[192:195], v[152:155], v[40:43]
    ds_read_b64_tr_b16 v[176:177], v132 offset:0
    v_mfma_f32_16x16x32_bf16 v[44:47], v[192:195], v[156:159], v[44:47]
    ds_read_b64_tr_b16 v[178:179], v132 offset:4096
    v_mfma_f32_16x16x32_bf16 v[48:51], v[192:195], v[160:163], v[48:51]
    ds_read_b64_tr_b16 v[180:181], v134 offset:0
    v_mfma_f32_16x16x32_bf16 v[52:55], v[192:195], v[164:167], v[52:55]
    ds_read_b64_tr_b16 v[182:183], v134 offset:4096
    v_mfma_f32_16x16x32_bf16 v[68:71], v[196:199], v[164:167], v[68:71]
    v_mfma_f32_16x16x32_bf16 v[64:67], v[196:199], v[160:163], v[64:67]
    v_mfma_f32_16x16x32_bf16 v[60:63], v[196:199], v[156:159], v[60:63]
    v_mfma_f32_16x16x32_bf16 v[56:59], v[196:199], v[152:155], v[56:59]
    s_waitcnt lgkmcnt(4)
    v_mfma_f32_16x16x32_bf16 v[8:11], v[168:171], v[136:139], v[8:11]
    v_mfma_f32_16x16x32_bf16 v[12:15], v[168:171], v[140:143], v[12:15]
    v_mfma_f32_16x16x32_bf16 v[16:19], v[168:171], v[144:147], v[16:19]
    v_mfma_f32_16x16x32_bf16 v[20:23], v[168:171], v[148:151], v[20:23]
    s_waitcnt lgkmcnt(0)
    s_barrier
    v_mfma_f32_16x16x32_bf16 v[36:39], v[172:175], v[148:151], v[36:39]
    ds_read_b128 v[152:155], v119 offset:16384
    v_mfma_f32_16x16x32_bf16 v[32:35], v[172:175], v[144:147], v[32:35]
    ds_read_b64_tr_b16 v[184:185], v128 offset:8192
    v_mfma_f32_16x16x32_bf16 v[28:31], v[172:175], v[140:143], v[28:31]
    ds_read_b64_tr_b16 v[186:187], v128 offset:12288
    v_mfma_f32_16x16x32_bf16 v[24:27], v[172:175], v[136:139], v[24:27]
    ds_read_b128 v[156:159], v119 offset:17408
    v_mfma_f32_16x16x32_bf16 v[40:43], v[176:179], v[136:139], v[40:43]
    ds_read_b128 v[160:163], v120 offset:16384
    v_mfma_f32_16x16x32_bf16 v[44:47], v[176:179], v[140:143], v[44:47]
    ds_read_b128 v[164:167], v120 offset:17408
    v_mfma_f32_16x16x32_bf16 v[48:51], v[176:179], v[144:147], v[48:51]
    ds_read_b64_tr_b16 v[188:189], v130 offset:8192
    v_mfma_f32_16x16x32_bf16 v[52:55], v[176:179], v[148:151], v[52:55]
    ds_read_b64_tr_b16 v[190:191], v130 offset:12288
    v_mfma_f32_16x16x32_bf16 v[68:71], v[180:183], v[148:151], v[68:71]
    ds_read_b64_tr_b16 v[192:193], v132 offset:8192
    v_mfma_f32_16x16x32_bf16 v[64:67], v[180:183], v[144:147], v[64:67]
    ds_read_b64_tr_b16 v[194:195], v132 offset:12288
    v_mfma_f32_16x16x32_bf16 v[60:63], v[180:183], v[140:143], v[60:63]
    ds_read_b64_tr_b16 v[196:197], v134 offset:8192
    v_mfma_f32_16x16x32_bf16 v[56:59], v[180:183], v[136:139], v[56:59]
    ds_read_b64_tr_b16 v[198:199], v134 offset:12288
    s_waitcnt lgkmcnt(4)
    v_mfma_f32_16x16x32_bf16 v[8:11], v[184:187], v[152:155], v[8:11]
    ds_read_b128 v[136:139], v119 offset:24576
    v_mfma_f32_16x16x32_bf16 v[12:15], v[184:187], v[156:159], v[12:15]
    ds_read_b64_tr_b16 v[168:169], v128 offset:16384
    v_mfma_f32_16x16x32_bf16 v[16:19], v[184:187], v[160:163], v[16:19]
    ds_read_b64_tr_b16 v[170:171], v128 offset:20480
    v_mfma_f32_16x16x32_bf16 v[20:23], v[184:187], v[164:167], v[20:23]
    ds_read_b128 v[140:143], v119 offset:25600
    v_mfma_f32_16x16x32_bf16 v[36:39], v[188:191], v[164:167], v[36:39]
    ds_read_b128 v[144:147], v120 offset:24576
    v_mfma_f32_16x16x32_bf16 v[32:35], v[188:191], v[160:163], v[32:35]
    ds_read_b128 v[148:151], v120 offset:25600
    v_mfma_f32_16x16x32_bf16 v[28:31], v[188:191], v[156:159], v[28:31]
    ds_read_b64_tr_b16 v[172:173], v130 offset:16384
    v_mfma_f32_16x16x32_bf16 v[24:27], v[188:191], v[152:155], v[24:27]
    ds_read_b64_tr_b16 v[174:175], v130 offset:20480
    s_waitcnt lgkmcnt(8)
    v_mfma_f32_16x16x32_bf16 v[40:43], v[192:195], v[152:155], v[40:43]
    ds_read_b64_tr_b16 v[176:177], v132 offset:16384
    v_mfma_f32_16x16x32_bf16 v[44:47], v[192:195], v[156:159], v[44:47]
    ds_read_b64_tr_b16 v[178:179], v132 offset:20480
    v_mfma_f32_16x16x32_bf16 v[48:51], v[192:195], v[160:163], v[48:51]
    ds_read_b64_tr_b16 v[180:181], v134 offset:16384
    v_mfma_f32_16x16x32_bf16 v[52:55], v[192:195], v[164:167], v[52:55]
    ds_read_b64_tr_b16 v[182:183], v134 offset:20480
    v_mfma_f32_16x16x32_bf16 v[68:71], v[196:199], v[164:167], v[68:71]
    v_mfma_f32_16x16x32_bf16 v[64:67], v[196:199], v[160:163], v[64:67]
    v_mfma_f32_16x16x32_bf16 v[60:63], v[196:199], v[156:159], v[60:63]
    v_mfma_f32_16x16x32_bf16 v[56:59], v[196:199], v[152:155], v[56:59]
    s_waitcnt lgkmcnt(4)
    v_mfma_f32_16x16x32_bf16 v[8:11], v[168:171], v[136:139], v[8:11]
    v_mfma_f32_16x16x32_bf16 v[12:15], v[168:171], v[140:143], v[12:15]
    v_mfma_f32_16x16x32_bf16 v[16:19], v[168:171], v[144:147], v[16:19]
    v_mfma_f32_16x16x32_bf16 v[20:23], v[168:171], v[148:151], v[20:23]
    s_waitcnt lgkmcnt(0)
    s_barrier
    v_mfma_f32_16x16x32_bf16 v[36:39], v[172:175], v[148:151], v[36:39]
    ds_read_b128 v[152:155], v119 offset:32768
    v_mfma_f32_16x16x32_bf16 v[32:35], v[172:175], v[144:147], v[32:35]
    ds_read_b64_tr_b16 v[184:185], v127 offset:16384
    v_mfma_f32_16x16x32_bf16 v[28:31], v[172:175], v[140:143], v[28:31]
    ds_read_b64_tr_b16 v[186:187], v127 offset:20480
    v_mfma_f32_16x16x32_bf16 v[24:27], v[172:175], v[136:139], v[24:27]
    ds_read_b128 v[156:159], v119 offset:33792
    v_mfma_f32_16x16x32_bf16 v[40:43], v[176:179], v[136:139], v[40:43]
    ds_read_b128 v[160:163], v120 offset:32768
    v_mfma_f32_16x16x32_bf16 v[44:47], v[176:179], v[140:143], v[44:47]
    ds_read_b128 v[164:167], v120 offset:33792
    v_mfma_f32_16x16x32_bf16 v[48:51], v[176:179], v[144:147], v[48:51]
    ds_read_b64_tr_b16 v[188:189], v129 offset:16384
    v_mfma_f32_16x16x32_bf16 v[52:55], v[176:179], v[148:151], v[52:55]
    ds_read_b64_tr_b16 v[190:191], v129 offset:20480
    v_mfma_f32_16x16x32_bf16 v[68:71], v[180:183], v[148:151], v[68:71]
    ds_read_b64_tr_b16 v[192:193], v131 offset:16384
    v_mfma_f32_16x16x32_bf16 v[64:67], v[180:183], v[144:147], v[64:67]
    ds_read_b64_tr_b16 v[194:195], v131 offset:20480
    v_mfma_f32_16x16x32_bf16 v[60:63], v[180:183], v[140:143], v[60:63]
    ds_read_b64_tr_b16 v[196:197], v133 offset:16384
    v_mfma_f32_16x16x32_bf16 v[56:59], v[180:183], v[136:139], v[56:59]
    ds_read_b64_tr_b16 v[198:199], v133 offset:20480
    s_waitcnt lgkmcnt(4)
    v_mfma_f32_16x16x32_bf16 v[8:11], v[184:187], v[152:155], v[8:11]
    ds_read_b128 v[136:139], v119 offset:40960
    v_mfma_f32_16x16x32_bf16 v[12:15], v[184:187], v[156:159], v[12:15]
    ds_read_b64_tr_b16 v[168:169], v127 offset:24576
    v_mfma_f32_16x16x32_bf16 v[16:19], v[184:187], v[160:163], v[16:19]
    ds_read_b64_tr_b16 v[170:171], v127 offset:28672
    v_mfma_f32_16x16x32_bf16 v[20:23], v[184:187], v[164:167], v[20:23]
    ds_read_b128 v[140:143], v119 offset:41984
    v_mfma_f32_16x16x32_bf16 v[36:39], v[188:191], v[164:167], v[36:39]
    ds_read_b128 v[144:147], v120 offset:40960
    v_mfma_f32_16x16x32_bf16 v[32:35], v[188:191], v[160:163], v[32:35]
    ds_read_b128 v[148:151], v120 offset:41984
    v_mfma_f32_16x16x32_bf16 v[28:31], v[188:191], v[156:159], v[28:31]
    ds_read_b64_tr_b16 v[172:173], v129 offset:24576
    v_mfma_f32_16x16x32_bf16 v[24:27], v[188:191], v[152:155], v[24:27]
    ds_read_b64_tr_b16 v[174:175], v129 offset:28672
    s_waitcnt lgkmcnt(8)
    v_mfma_f32_16x16x32_bf16 v[40:43], v[192:195], v[152:155], v[40:43]
    ds_read_b64_tr_b16 v[176:177], v131 offset:24576
    v_mfma_f32_16x16x32_bf16 v[44:47], v[192:195], v[156:159], v[44:47]
    ds_read_b64_tr_b16 v[178:179], v131 offset:28672
    v_mfma_f32_16x16x32_bf16 v[48:51], v[192:195], v[160:163], v[48:51]
    ds_read_b64_tr_b16 v[180:181], v133 offset:24576
    v_mfma_f32_16x16x32_bf16 v[52:55], v[192:195], v[164:167], v[52:55]
    ds_read_b64_tr_b16 v[182:183], v133 offset:28672
    v_mfma_f32_16x16x32_bf16 v[68:71], v[196:199], v[164:167], v[68:71]
    v_mfma_f32_16x16x32_bf16 v[64:67], v[196:199], v[160:163], v[64:67]
    v_mfma_f32_16x16x32_bf16 v[60:63], v[196:199], v[156:159], v[60:63]
    v_mfma_f32_16x16x32_bf16 v[56:59], v[196:199], v[152:155], v[56:59]
    s_waitcnt lgkmcnt(4)
    v_mfma_f32_16x16x32_bf16 v[8:11], v[168:171], v[136:139], v[8:11]
    v_mfma_f32_16x16x32_bf16 v[12:15], v[168:171], v[140:143], v[12:15]
    v_mfma_f32_16x16x32_bf16 v[16:19], v[168:171], v[144:147], v[16:19]
    v_mfma_f32_16x16x32_bf16 v[20:23], v[168:171], v[148:151], v[20:23]
    s_waitcnt lgkmcnt(0)
    s_barrier
    v_mfma_f32_16x16x32_bf16 v[36:39], v[172:175], v[148:151], v[36:39]
    ds_read_b128 v[152:155], v119 offset:49152
    v_mfma_f32_16x16x32_bf16 v[32:35], v[172:175], v[144:147], v[32:35]
    ds_read_b64_tr_b16 v[184:185], v127 offset:32768
    v_mfma_f32_16x16x32_bf16 v[28:31], v[172:175], v[140:143], v[28:31]
    ds_read_b64_tr_b16 v[186:187], v127 offset:36864
    v_mfma_f32_16x16x32_bf16 v[24:27], v[172:175], v[136:139], v[24:27]
    ds_read_b128 v[156:159], v119 offset:50176
    v_mfma_f32_16x16x32_bf16 v[40:43], v[176:179], v[136:139], v[40:43]
    ds_read_b128 v[160:163], v120 offset:49152
    v_mfma_f32_16x16x32_bf16 v[44:47], v[176:179], v[140:143], v[44:47]
    ds_read_b128 v[164:167], v120 offset:50176
    v_mfma_f32_16x16x32_bf16 v[48:51], v[176:179], v[144:147], v[48:51]
    ds_read_b64_tr_b16 v[188:189], v129 offset:32768
    v_mfma_f32_16x16x32_bf16 v[52:55], v[176:179], v[148:151], v[52:55]
    ds_read_b64_tr_b16 v[190:191], v129 offset:36864
    v_mfma_f32_16x16x32_bf16 v[68:71], v[180:183], v[148:151], v[68:71]
    ds_read_b64_tr_b16 v[192:193], v131 offset:32768
    v_mfma_f32_16x16x32_bf16 v[64:67], v[180:183], v[144:147], v[64:67]
    ds_read_b64_tr_b16 v[194:195], v131 offset:36864
    v_mfma_f32_16x16x32_bf16 v[60:63], v[180:183], v[140:143], v[60:63]
    ds_read_b64_tr_b16 v[196:197], v133 offset:32768
    v_mfma_f32_16x16x32_bf16 v[56:59], v[180:183], v[136:139], v[56:59]
    ds_read_b64_tr_b16 v[198:199], v133 offset:36864
    s_waitcnt lgkmcnt(4)
    v_mfma_f32_16x16x32_bf16 v[8:11], v[184:187], v[152:155], v[8:11]
    ds_read_b128 v[136:139], v119 offset:57344
    v_mfma_f32_16x16x32_bf16 v[12:15], v[184:187], v[156:159], v[12:15]
    ds_read_b64_tr_b16 v[168:169], v127 offset:40960
    v_mfma_f32_16x16x32_bf16 v[16:19], v[184:187], v[160:163], v[16:19]
    ds_read_b64_tr_b16 v[170:171], v127 offset:45056
    v_mfma_f32_16x16x32_bf16 v[20:23], v[184:187], v[164:167], v[20:23]
    ds_read_b128 v[140:143], v119 offset:58368
    v_mfma_f32_16x16x32_bf16 v[36:39], v[188:191], v[164:167], v[36:39]
    ds_read_b128 v[144:147], v120 offset:57344
    v_mfma_f32_16x16x32_bf16 v[32:35], v[188:191], v[160:163], v[32:35]
    ds_read_b128 v[148:151], v120 offset:58368
    v_mfma_f32_16x16x32_bf16 v[28:31], v[188:191], v[156:159], v[28:31]
    ds_read_b64_tr_b16 v[172:173], v129 offset:40960
    v_mfma_f32_16x16x32_bf16 v[24:27], v[188:191], v[152:155], v[24:27]
    ds_read_b64_tr_b16 v[174:175], v129 offset:45056
    s_waitcnt lgkmcnt(8)
    v_mfma_f32_16x16x32_bf16 v[40:43], v[192:195], v[152:155], v[40:43]
    ds_read_b64_tr_b16 v[176:177], v131 offset:40960
    v_mfma_f32_16x16x32_bf16 v[44:47], v[192:195], v[156:159], v[44:47]
    ds_read_b64_tr_b16 v[178:179], v131 offset:45056
    v_mfma_f32_16x16x32_bf16 v[48:51], v[192:195], v[160:163], v[48:51]
    ds_read_b64_tr_b16 v[180:181], v133 offset:40960
    v_mfma_f32_16x16x32_bf16 v[52:55], v[192:195], v[164:167], v[52:55]
    ds_read_b64_tr_b16 v[182:183], v133 offset:45056
    v_mfma_f32_16x16x32_bf16 v[68:71], v[196:199], v[164:167], v[68:71]
    v_mfma_f32_16x16x32_bf16 v[64:67], v[196:199], v[160:163], v[64:67]
    v_mfma_f32_16x16x32_bf16 v[60:63], v[196:199], v[156:159], v[60:63]
    v_mfma_f32_16x16x32_bf16 v[56:59], v[196:199], v[152:155], v[56:59]
    s_waitcnt lgkmcnt(4)
    v_mfma_f32_16x16x32_bf16 v[8:11], v[168:171], v[136:139], v[8:11]
    v_mfma_f32_16x16x32_bf16 v[12:15], v[168:171], v[140:143], v[12:15]
    v_mfma_f32_16x16x32_bf16 v[16:19], v[168:171], v[144:147], v[16:19]
    v_mfma_f32_16x16x32_bf16 v[20:23], v[168:171], v[148:151], v[20:23]
    s_waitcnt lgkmcnt(0)
    s_barrier
    v_mfma_f32_16x16x32_bf16 v[36:39], v[172:175], v[148:151], v[36:39]
    ds_read_b128 v[152:155], v121 offset:0
    v_mfma_f32_16x16x32_bf16 v[32:35], v[172:175], v[144:147], v[32:35]
    ds_read_b64_tr_b16 v[184:185], v127 offset:57344
    v_mfma_f32_16x16x32_bf16 v[28:31], v[172:175], v[140:143], v[28:31]
    ds_read_b64_tr_b16 v[186:187], v127 offset:61440
    v_mfma_f32_16x16x32_bf16 v[24:27], v[172:175], v[136:139], v[24:27]
    ds_read_b128 v[156:159], v121 offset:1024
    v_mfma_f32_16x16x32_bf16 v[40:43], v[176:179], v[136:139], v[40:43]
    ds_read_b128 v[160:163], v122 offset:0
    v_mfma_f32_16x16x32_bf16 v[44:47], v[176:179], v[140:143], v[44:47]
    ds_read_b128 v[164:167], v122 offset:1024
    v_mfma_f32_16x16x32_bf16 v[48:51], v[176:179], v[144:147], v[48:51]
    ds_read_b64_tr_b16 v[188:189], v129 offset:57344
    v_mfma_f32_16x16x32_bf16 v[52:55], v[176:179], v[148:151], v[52:55]
    ds_read_b64_tr_b16 v[190:191], v129 offset:61440
    v_mfma_f32_16x16x32_bf16 v[68:71], v[180:183], v[148:151], v[68:71]
    ds_read_b64_tr_b16 v[192:193], v131 offset:57344
    v_mfma_f32_16x16x32_bf16 v[64:67], v[180:183], v[144:147], v[64:67]
    ds_read_b64_tr_b16 v[194:195], v131 offset:61440
    v_mfma_f32_16x16x32_bf16 v[60:63], v[180:183], v[140:143], v[60:63]
    ds_read_b64_tr_b16 v[196:197], v133 offset:57344
    v_mfma_f32_16x16x32_bf16 v[56:59], v[180:183], v[136:139], v[56:59]
    ds_read_b64_tr_b16 v[198:199], v133 offset:61440
    s_waitcnt lgkmcnt(4)
    v_mfma_f32_16x16x32_bf16 v[8:11], v[184:187], v[152:155], v[8:11]
    ds_read_b128 v[136:139], v121 offset:8192
    v_mfma_f32_16x16x32_bf16 v[12:15], v[184:187], v[156:159], v[12:15]
    ds_read_b64_tr_b16 v[168:169], v128 offset:0
    v_mfma_f32_16x16x32_bf16 v[16:19], v[184:187], v[160:163], v[16:19]
    ds_read_b64_tr_b16 v[170:171], v128 offset:4096
    v_mfma_f32_16x16x32_bf16 v[20:23], v[184:187], v[164:167], v[20:23]
    ds_read_b128 v[140:143], v121 offset:9216
    v_mfma_f32_16x16x32_bf16 v[36:39], v[188:191], v[164:167], v[36:39]
    ds_read_b128 v[144:147], v122 offset:8192
    v_mfma_f32_16x16x32_bf16 v[32:35], v[188:191], v[160:163], v[32:35]
    ds_read_b128 v[148:151], v122 offset:9216
    v_mfma_f32_16x16x32_bf16 v[28:31], v[188:191], v[156:159], v[28:31]
    ds_read_b64_tr_b16 v[172:173], v130 offset:0
    v_mfma_f32_16x16x32_bf16 v[24:27], v[188:191], v[152:155], v[24:27]
    ds_read_b64_tr_b16 v[174:175], v130 offset:4096
    s_waitcnt lgkmcnt(8)
    v_mfma_f32_16x16x32_bf16 v[40:43], v[192:195], v[152:155], v[40:43]
    ds_read_b64_tr_b16 v[176:177], v132 offset:0
    v_mfma_f32_16x16x32_bf16 v[44:47], v[192:195], v[156:159], v[44:47]
    ds_read_b64_tr_b16 v[178:179], v132 offset:4096
    v_mfma_f32_16x16x32_bf16 v[48:51], v[192:195], v[160:163], v[48:51]
    ds_read_b64_tr_b16 v[180:181], v134 offset:0
    v_mfma_f32_16x16x32_bf16 v[52:55], v[192:195], v[164:167], v[52:55]
    ds_read_b64_tr_b16 v[182:183], v134 offset:4096
    v_mfma_f32_16x16x32_bf16 v[68:71], v[196:199], v[164:167], v[68:71]
    v_mfma_f32_16x16x32_bf16 v[64:67], v[196:199], v[160:163], v[64:67]
    v_mfma_f32_16x16x32_bf16 v[60:63], v[196:199], v[156:159], v[60:63]
    v_mfma_f32_16x16x32_bf16 v[56:59], v[196:199], v[152:155], v[56:59]
    s_waitcnt lgkmcnt(4)
    v_mfma_f32_16x16x32_bf16 v[8:11], v[168:171], v[136:139], v[8:11]
    v_mfma_f32_16x16x32_bf16 v[12:15], v[168:171], v[140:143], v[12:15]
    v_mfma_f32_16x16x32_bf16 v[16:19], v[168:171], v[144:147], v[16:19]
    v_mfma_f32_16x16x32_bf16 v[20:23], v[168:171], v[148:151], v[20:23]
    s_waitcnt lgkmcnt(0)
    s_barrier
    v_mfma_f32_16x16x32_bf16 v[36:39], v[172:175], v[148:151], v[36:39]
    ds_read_b128 v[152:155], v119 offset:0
    v_mfma_f32_16x16x32_bf16 v[32:35], v[172:175], v[144:147], v[32:35]
    ds_read_b64_tr_b16 v[184:185], v128 offset:8192
    v_mfma_f32_16x16x32_bf16 v[28:31], v[172:175], v[140:143], v[28:31]
    ds_read_b64_tr_b16 v[186:187], v128 offset:12288
    v_mfma_f32_16x16x32_bf16 v[24:27], v[172:175], v[136:139], v[24:27]
    ds_read_b128 v[156:159], v119 offset:1024
    v_mfma_f32_16x16x32_bf16 v[40:43], v[176:179], v[136:139], v[40:43]
    ds_read_b128 v[160:163], v120 offset:0
    v_mfma_f32_16x16x32_bf16 v[44:47], v[176:179], v[140:143], v[44:47]
    ds_read_b128 v[164:167], v120 offset:1024
    v_mfma_f32_16x16x32_bf16 v[48:51], v[176:179], v[144:147], v[48:51]
    ds_read_b64_tr_b16 v[188:189], v130 offset:8192
    v_mfma_f32_16x16x32_bf16 v[52:55], v[176:179], v[148:151], v[52:55]
    ds_read_b64_tr_b16 v[190:191], v130 offset:12288
    v_mfma_f32_16x16x32_bf16 v[68:71], v[180:183], v[148:151], v[68:71]
    ds_read_b64_tr_b16 v[192:193], v132 offset:8192
    v_mfma_f32_16x16x32_bf16 v[64:67], v[180:183], v[144:147], v[64:67]
    ds_read_b64_tr_b16 v[194:195], v132 offset:12288
    v_mfma_f32_16x16x32_bf16 v[60:63], v[180:183], v[140:143], v[60:63]
    ds_read_b64_tr_b16 v[196:197], v134 offset:8192
    v_mfma_f32_16x16x32_bf16 v[56:59], v[180:183], v[136:139], v[56:59]
    ds_read_b64_tr_b16 v[198:199], v134 offset:12288
    s_waitcnt lgkmcnt(4)
    v_mfma_f32_16x16x32_bf16 v[8:11], v[184:187], v[152:155], v[8:11]
    ds_read_b128 v[136:139], v119 offset:8192
    v_mfma_f32_16x16x32_bf16 v[12:15], v[184:187], v[156:159], v[12:15]
    ds_read_b64_tr_b16 v[168:169], v128 offset:16384
    v_mfma_f32_16x16x32_bf16 v[16:19], v[184:187], v[160:163], v[16:19]
    ds_read_b64_tr_b16 v[170:171], v128 offset:20480
    v_mfma_f32_16x16x32_bf16 v[20:23], v[184:187], v[164:167], v[20:23]
    ds_read_b128 v[140:143], v119 offset:9216
    v_mfma_f32_16x16x32_bf16 v[36:39], v[188:191], v[164:167], v[36:39]
    ds_read_b128 v[144:147], v120 offset:8192
    v_mfma_f32_16x16x32_bf16 v[32:35], v[188:191], v[160:163], v[32:35]
    ds_read_b128 v[148:151], v120 offset:9216
    v_mfma_f32_16x16x32_bf16 v[28:31], v[188:191], v[156:159], v[28:31]
    ds_read_b64_tr_b16 v[172:173], v130 offset:16384
    v_mfma_f32_16x16x32_bf16 v[24:27], v[188:191], v[152:155], v[24:27]
    ds_read_b64_tr_b16 v[174:175], v130 offset:20480
    s_waitcnt lgkmcnt(8)
    v_mfma_f32_16x16x32_bf16 v[40:43], v[192:195], v[152:155], v[40:43]
    ds_read_b64_tr_b16 v[176:177], v132 offset:16384
    v_mfma_f32_16x16x32_bf16 v[44:47], v[192:195], v[156:159], v[44:47]
    ds_read_b64_tr_b16 v[178:179], v132 offset:20480
    v_mfma_f32_16x16x32_bf16 v[48:51], v[192:195], v[160:163], v[48:51]
    ds_read_b64_tr_b16 v[180:181], v134 offset:16384
    v_mfma_f32_16x16x32_bf16 v[52:55], v[192:195], v[164:167], v[52:55]
    ds_read_b64_tr_b16 v[182:183], v134 offset:20480
    v_mfma_f32_16x16x32_bf16 v[68:71], v[196:199], v[164:167], v[68:71]
    v_mfma_f32_16x16x32_bf16 v[64:67], v[196:199], v[160:163], v[64:67]
    v_mfma_f32_16x16x32_bf16 v[60:63], v[196:199], v[156:159], v[60:63]
    v_mfma_f32_16x16x32_bf16 v[56:59], v[196:199], v[152:155], v[56:59]
    s_waitcnt lgkmcnt(4)
    v_mfma_f32_16x16x32_bf16 v[8:11], v[168:171], v[136:139], v[8:11]
    v_mfma_f32_16x16x32_bf16 v[12:15], v[168:171], v[140:143], v[12:15]
    v_mfma_f32_16x16x32_bf16 v[16:19], v[168:171], v[144:147], v[16:19]
    v_mfma_f32_16x16x32_bf16 v[20:23], v[168:171], v[148:151], v[20:23]
    s_waitcnt lgkmcnt(0)
    s_barrier
    v_mfma_f32_16x16x32_bf16 v[36:39], v[172:175], v[148:151], v[36:39]
    ds_read_b128 v[152:155], v119 offset:16384
    v_mfma_f32_16x16x32_bf16 v[32:35], v[172:175], v[144:147], v[32:35]
    ds_read_b64_tr_b16 v[184:185], v127 offset:16384
    v_mfma_f32_16x16x32_bf16 v[28:31], v[172:175], v[140:143], v[28:31]
    ds_read_b64_tr_b16 v[186:187], v127 offset:20480
    v_mfma_f32_16x16x32_bf16 v[24:27], v[172:175], v[136:139], v[24:27]
    ds_read_b128 v[156:159], v119 offset:17408
    v_mfma_f32_16x16x32_bf16 v[40:43], v[176:179], v[136:139], v[40:43]
    ds_read_b128 v[160:163], v120 offset:16384
    v_mfma_f32_16x16x32_bf16 v[44:47], v[176:179], v[140:143], v[44:47]
    ds_read_b128 v[164:167], v120 offset:17408
    v_mfma_f32_16x16x32_bf16 v[48:51], v[176:179], v[144:147], v[48:51]
    ds_read_b64_tr_b16 v[188:189], v129 offset:16384
    v_mfma_f32_16x16x32_bf16 v[52:55], v[176:179], v[148:151], v[52:55]
    ds_read_b64_tr_b16 v[190:191], v129 offset:20480
    v_mfma_f32_16x16x32_bf16 v[68:71], v[180:183], v[148:151], v[68:71]
    ds_read_b64_tr_b16 v[192:193], v131 offset:16384
    v_mfma_f32_16x16x32_bf16 v[64:67], v[180:183], v[144:147], v[64:67]
    ds_read_b64_tr_b16 v[194:195], v131 offset:20480
    v_mfma_f32_16x16x32_bf16 v[60:63], v[180:183], v[140:143], v[60:63]
    ds_read_b64_tr_b16 v[196:197], v133 offset:16384
    v_mfma_f32_16x16x32_bf16 v[56:59], v[180:183], v[136:139], v[56:59]
    ds_read_b64_tr_b16 v[198:199], v133 offset:20480
    s_waitcnt lgkmcnt(4)
    v_mfma_f32_16x16x32_bf16 v[8:11], v[184:187], v[152:155], v[8:11]
    ds_read_b128 v[136:139], v119 offset:24576
    v_mfma_f32_16x16x32_bf16 v[12:15], v[184:187], v[156:159], v[12:15]
    ds_read_b64_tr_b16 v[168:169], v127 offset:24576
    v_mfma_f32_16x16x32_bf16 v[16:19], v[184:187], v[160:163], v[16:19]
    ds_read_b64_tr_b16 v[170:171], v127 offset:28672
    v_mfma_f32_16x16x32_bf16 v[20:23], v[184:187], v[164:167], v[20:23]
    ds_read_b128 v[140:143], v119 offset:25600
    v_mfma_f32_16x16x32_bf16 v[36:39], v[188:191], v[164:167], v[36:39]
    ds_read_b128 v[144:147], v120 offset:24576
    v_mfma_f32_16x16x32_bf16 v[32:35], v[188:191], v[160:163], v[32:35]
    ds_read_b128 v[148:151], v120 offset:25600
    v_mfma_f32_16x16x32_bf16 v[28:31], v[188:191], v[156:159], v[28:31]
    ds_read_b64_tr_b16 v[172:173], v129 offset:24576
    v_mfma_f32_16x16x32_bf16 v[24:27], v[188:191], v[152:155], v[24:27]
    ds_read_b64_tr_b16 v[174:175], v129 offset:28672
    s_waitcnt lgkmcnt(8)
    v_mfma_f32_16x16x32_bf16 v[40:43], v[192:195], v[152:155], v[40:43]
    ds_read_b64_tr_b16 v[176:177], v131 offset:24576
    v_mfma_f32_16x16x32_bf16 v[44:47], v[192:195], v[156:159], v[44:47]
    ds_read_b64_tr_b16 v[178:179], v131 offset:28672
    v_mfma_f32_16x16x32_bf16 v[48:51], v[192:195], v[160:163], v[48:51]
    ds_read_b64_tr_b16 v[180:181], v133 offset:24576
    v_mfma_f32_16x16x32_bf16 v[52:55], v[192:195], v[164:167], v[52:55]
    ds_read_b64_tr_b16 v[182:183], v133 offset:28672
    v_mfma_f32_16x16x32_bf16 v[68:71], v[196:199], v[164:167], v[68:71]
    v_mfma_f32_16x16x32_bf16 v[64:67], v[196:199], v[160:163], v[64:67]
    v_mfma_f32_16x16x32_bf16 v[60:63], v[196:199], v[156:159], v[60:63]
    v_mfma_f32_16x16x32_bf16 v[56:59], v[196:199], v[152:155], v[56:59]
    s_waitcnt lgkmcnt(4)
    v_mfma_f32_16x16x32_bf16 v[8:11], v[168:171], v[136:139], v[8:11]
    v_mfma_f32_16x16x32_bf16 v[12:15], v[168:171], v[140:143], v[12:15]
    v_mfma_f32_16x16x32_bf16 v[16:19], v[168:171], v[144:147], v[16:19]
    v_mfma_f32_16x16x32_bf16 v[20:23], v[168:171], v[148:151], v[20:23]
    s_waitcnt lgkmcnt(0)
    s_barrier
    v_mfma_f32_16x16x32_bf16 v[36:39], v[172:175], v[148:151], v[36:39]
    ds_read_b128 v[152:155], v119 offset:32768
    v_mfma_f32_16x16x32_bf16 v[32:35], v[172:175], v[144:147], v[32:35]
    ds_read_b64_tr_b16 v[184:185], v127 offset:32768
    v_mfma_f32_16x16x32_bf16 v[28:31], v[172:175], v[140:143], v[28:31]
    ds_read_b64_tr_b16 v[186:187], v127 offset:36864
    v_mfma_f32_16x16x32_bf16 v[24:27], v[172:175], v[136:139], v[24:27]
    ds_read_b128 v[156:159], v119 offset:33792
    v_mfma_f32_16x16x32_bf16 v[40:43], v[176:179], v[136:139], v[40:43]
    ds_read_b128 v[160:163], v120 offset:32768
    v_mfma_f32_16x16x32_bf16 v[44:47], v[176:179], v[140:143], v[44:47]
    ds_read_b128 v[164:167], v120 offset:33792
    v_mfma_f32_16x16x32_bf16 v[48:51], v[176:179], v[144:147], v[48:51]
    ds_read_b64_tr_b16 v[188:189], v129 offset:32768
    v_mfma_f32_16x16x32_bf16 v[52:55], v[176:179], v[148:151], v[52:55]
    ds_read_b64_tr_b16 v[190:191], v129 offset:36864
    v_mfma_f32_16x16x32_bf16 v[68:71], v[180:183], v[148:151], v[68:71]
    ds_read_b64_tr_b16 v[192:193], v131 offset:32768
    v_mfma_f32_16x16x32_bf16 v[64:67], v[180:183], v[144:147], v[64:67]
    ds_read_b64_tr_b16 v[194:195], v131 offset:36864
    v_mfma_f32_16x16x32_bf16 v[60:63], v[180:183], v[140:143], v[60:63]
    ds_read_b64_tr_b16 v[196:197], v133 offset:32768
    v_mfma_f32_16x16x32_bf16 v[56:59], v[180:183], v[136:139], v[56:59]
    ds_read_b64_tr_b16 v[198:199], v133 offset:36864
    s_waitcnt lgkmcnt(4)
    v_mfma_f32_16x16x32_bf16 v[8:11], v[184:187], v[152:155], v[8:11]
    ds_read_b128 v[136:139], v119 offset:40960
    v_mfma_f32_16x16x32_bf16 v[12:15], v[184:187], v[156:159], v[12:15]
    ds_read_b64_tr_b16 v[168:169], v127 offset:40960
    v_mfma_f32_16x16x32_bf16 v[16:19], v[184:187], v[160:163], v[16:19]
    ds_read_b64_tr_b16 v[170:171], v127 offset:45056
    v_mfma_f32_16x16x32_bf16 v[20:23], v[184:187], v[164:167], v[20:23]
    ds_read_b128 v[140:143], v119 offset:41984
    v_mfma_f32_16x16x32_bf16 v[36:39], v[188:191], v[164:167], v[36:39]
    ds_read_b128 v[144:147], v120 offset:40960
    v_mfma_f32_16x16x32_bf16 v[32:35], v[188:191], v[160:163], v[32:35]
    ds_read_b128 v[148:151], v120 offset:41984
    v_mfma_f32_16x16x32_bf16 v[28:31], v[188:191], v[156:159], v[28:31]
    ds_read_b64_tr_b16 v[172:173], v129 offset:40960
    v_mfma_f32_16x16x32_bf16 v[24:27], v[188:191], v[152:155], v[24:27]
    ds_read_b64_tr_b16 v[174:175], v129 offset:45056
    s_waitcnt lgkmcnt(8)
    v_mfma_f32_16x16x32_bf16 v[40:43], v[192:195], v[152:155], v[40:43]
    ds_read_b64_tr_b16 v[176:177], v131 offset:40960
    v_mfma_f32_16x16x32_bf16 v[44:47], v[192:195], v[156:159], v[44:47]
    ds_read_b64_tr_b16 v[178:179], v131 offset:45056
    v_mfma_f32_16x16x32_bf16 v[48:51], v[192:195], v[160:163], v[48:51]
    ds_read_b64_tr_b16 v[180:181], v133 offset:40960
    v_mfma_f32_16x16x32_bf16 v[52:55], v[192:195], v[164:167], v[52:55]
    ds_read_b64_tr_b16 v[182:183], v133 offset:45056
    v_mfma_f32_16x16x32_bf16 v[68:71], v[196:199], v[164:167], v[68:71]
    v_mfma_f32_16x16x32_bf16 v[64:67], v[196:199], v[160:163], v[64:67]
    v_mfma_f32_16x16x32_bf16 v[60:63], v[196:199], v[156:159], v[60:63]
    v_mfma_f32_16x16x32_bf16 v[56:59], v[196:199], v[152:155], v[56:59]
    s_waitcnt lgkmcnt(4)
    v_mfma_f32_16x16x32_bf16 v[8:11], v[168:171], v[136:139], v[8:11]
    v_mfma_f32_16x16x32_bf16 v[12:15], v[168:171], v[140:143], v[12:15]
    v_mfma_f32_16x16x32_bf16 v[16:19], v[168:171], v[144:147], v[16:19]
    v_mfma_f32_16x16x32_bf16 v[20:23], v[168:171], v[148:151], v[20:23]
    s_waitcnt lgkmcnt(0)
    s_barrier
    v_mfma_f32_16x16x32_bf16 v[36:39], v[172:175], v[148:151], v[36:39]
    ds_read_b128 v[152:155], v119 offset:49152
    v_mfma_f32_16x16x32_bf16 v[32:35], v[172:175], v[144:147], v[32:35]
    ds_read_b64_tr_b16 v[184:185], v127 offset:57344
    v_mfma_f32_16x16x32_bf16 v[28:31], v[172:175], v[140:143], v[28:31]
    ds_read_b64_tr_b16 v[186:187], v127 offset:61440
    v_mfma_f32_16x16x32_bf16 v[24:27], v[172:175], v[136:139], v[24:27]
    ds_read_b128 v[156:159], v119 offset:50176
    v_mfma_f32_16x16x32_bf16 v[40:43], v[176:179], v[136:139], v[40:43]
    ds_read_b128 v[160:163], v120 offset:49152
    v_mfma_f32_16x16x32_bf16 v[44:47], v[176:179], v[140:143], v[44:47]
    ds_read_b128 v[164:167], v120 offset:50176
    v_mfma_f32_16x16x32_bf16 v[48:51], v[176:179], v[144:147], v[48:51]
    ds_read_b64_tr_b16 v[188:189], v129 offset:57344
    v_mfma_f32_16x16x32_bf16 v[52:55], v[176:179], v[148:151], v[52:55]
    ds_read_b64_tr_b16 v[190:191], v129 offset:61440
    v_mfma_f32_16x16x32_bf16 v[68:71], v[180:183], v[148:151], v[68:71]
    ds_read_b64_tr_b16 v[192:193], v131 offset:57344
    v_mfma_f32_16x16x32_bf16 v[64:67], v[180:183], v[144:147], v[64:67]
    ds_read_b64_tr_b16 v[194:195], v131 offset:61440
    v_mfma_f32_16x16x32_bf16 v[60:63], v[180:183], v[140:143], v[60:63]
    ds_read_b64_tr_b16 v[196:197], v133 offset:57344
    v_mfma_f32_16x16x32_bf16 v[56:59], v[180:183], v[136:139], v[56:59]
    ds_read_b64_tr_b16 v[198:199], v133 offset:61440
    s_waitcnt lgkmcnt(4)
    v_mfma_f32_16x16x32_bf16 v[8:11], v[184:187], v[152:155], v[8:11]
    ds_read_b128 v[136:139], v119 offset:57344
    v_mfma_f32_16x16x32_bf16 v[12:15], v[184:187], v[156:159], v[12:15]
    ds_read_b64_tr_b16 v[168:169], v128 offset:0
    v_mfma_f32_16x16x32_bf16 v[16:19], v[184:187], v[160:163], v[16:19]
    ds_read_b64_tr_b16 v[170:171], v128 offset:4096
    v_mfma_f32_16x16x32_bf16 v[20:23], v[184:187], v[164:167], v[20:23]
    ds_read_b128 v[140:143], v119 offset:58368
    v_mfma_f32_16x16x32_bf16 v[36:39], v[188:191], v[164:167], v[36:39]
    ds_read_b128 v[144:147], v120 offset:57344
    v_mfma_f32_16x16x32_bf16 v[32:35], v[188:191], v[160:163], v[32:35]
    ds_read_b128 v[148:151], v120 offset:58368
    v_mfma_f32_16x16x32_bf16 v[28:31], v[188:191], v[156:159], v[28:31]
    ds_read_b64_tr_b16 v[172:173], v130 offset:0
    v_mfma_f32_16x16x32_bf16 v[24:27], v[188:191], v[152:155], v[24:27]
    ds_read_b64_tr_b16 v[174:175], v130 offset:4096
    s_waitcnt lgkmcnt(8)
    v_mfma_f32_16x16x32_bf16 v[40:43], v[192:195], v[152:155], v[40:43]
    ds_read_b64_tr_b16 v[176:177], v132 offset:0
    v_mfma_f32_16x16x32_bf16 v[44:47], v[192:195], v[156:159], v[44:47]
    ds_read_b64_tr_b16 v[178:179], v132 offset:4096
    v_mfma_f32_16x16x32_bf16 v[48:51], v[192:195], v[160:163], v[48:51]
    ds_read_b64_tr_b16 v[180:181], v134 offset:0
    v_mfma_f32_16x16x32_bf16 v[52:55], v[192:195], v[164:167], v[52:55]
    ds_read_b64_tr_b16 v[182:183], v134 offset:4096
    v_mfma_f32_16x16x32_bf16 v[68:71], v[196:199], v[164:167], v[68:71]
    v_mfma_f32_16x16x32_bf16 v[64:67], v[196:199], v[160:163], v[64:67]
    v_mfma_f32_16x16x32_bf16 v[60:63], v[196:199], v[156:159], v[60:63]
    v_mfma_f32_16x16x32_bf16 v[56:59], v[196:199], v[152:155], v[56:59]
    s_waitcnt lgkmcnt(4)
    v_mfma_f32_16x16x32_bf16 v[8:11], v[168:171], v[136:139], v[8:11]
    v_mfma_f32_16x16x32_bf16 v[12:15], v[168:171], v[140:143], v[12:15]
    v_mfma_f32_16x16x32_bf16 v[16:19], v[168:171], v[144:147], v[16:19]
    v_mfma_f32_16x16x32_bf16 v[20:23], v[168:171], v[148:151], v[20:23]
    s_waitcnt lgkmcnt(0)
    s_barrier
    v_mfma_f32_16x16x32_bf16 v[36:39], v[172:175], v[148:151], v[36:39]
    ds_read_b128 v[152:155], v121 offset:0
    v_mfma_f32_16x16x32_bf16 v[32:35], v[172:175], v[144:147], v[32:35]
    ds_read_b64_tr_b16 v[184:185], v128 offset:8192
    v_mfma_f32_16x16x32_bf16 v[28:31], v[172:175], v[140:143], v[28:31]
    ds_read_b64_tr_b16 v[186:187], v128 offset:12288
    v_mfma_f32_16x16x32_bf16 v[24:27], v[172:175], v[136:139], v[24:27]
    ds_read_b128 v[156:159], v121 offset:1024
    v_mfma_f32_16x16x32_bf16 v[40:43], v[176:179], v[136:139], v[40:43]
    ds_read_b128 v[160:163], v122 offset:0
    v_mfma_f32_16x16x32_bf16 v[44:47], v[176:179], v[140:143], v[44:47]
    ds_read_b128 v[164:167], v122 offset:1024
    v_mfma_f32_16x16x32_bf16 v[48:51], v[176:179], v[144:147], v[48:51]
    ds_read_b64_tr_b16 v[188:189], v130 offset:8192
    v_mfma_f32_16x16x32_bf16 v[52:55], v[176:179], v[148:151], v[52:55]
    ds_read_b64_tr_b16 v[190:191], v130 offset:12288
    v_mfma_f32_16x16x32_bf16 v[68:71], v[180:183], v[148:151], v[68:71]
    ds_read_b64_tr_b16 v[192:193], v132 offset:8192
    v_mfma_f32_16x16x32_bf16 v[64:67], v[180:183], v[144:147], v[64:67]
    ds_read_b64_tr_b16 v[194:195], v132 offset:12288
    v_mfma_f32_16x16x32_bf16 v[60:63], v[180:183], v[140:143], v[60:63]
    ds_read_b64_tr_b16 v[196:197], v134 offset:8192
    v_mfma_f32_16x16x32_bf16 v[56:59], v[180:183], v[136:139], v[56:59]
    ds_read_b64_tr_b16 v[198:199], v134 offset:12288
    s_waitcnt lgkmcnt(4)
    v_mfma_f32_16x16x32_bf16 v[8:11], v[184:187], v[152:155], v[8:11]
    ds_read_b128 v[136:139], v121 offset:8192
    v_mfma_f32_16x16x32_bf16 v[12:15], v[184:187], v[156:159], v[12:15]
    ds_read_b64_tr_b16 v[168:169], v128 offset:16384
    v_mfma_f32_16x16x32_bf16 v[16:19], v[184:187], v[160:163], v[16:19]
    ds_read_b64_tr_b16 v[170:171], v128 offset:20480
    v_mfma_f32_16x16x32_bf16 v[20:23], v[184:187], v[164:167], v[20:23]
    ds_read_b128 v[140:143], v121 offset:9216
    v_mfma_f32_16x16x32_bf16 v[36:39], v[188:191], v[164:167], v[36:39]
    ds_read_b128 v[144:147], v122 offset:8192
    v_mfma_f32_16x16x32_bf16 v[32:35], v[188:191], v[160:163], v[32:35]
    ds_read_b128 v[148:151], v122 offset:9216
    v_mfma_f32_16x16x32_bf16 v[28:31], v[188:191], v[156:159], v[28:31]
    ds_read_b64_tr_b16 v[172:173], v130 offset:16384
    v_mfma_f32_16x16x32_bf16 v[24:27], v[188:191], v[152:155], v[24:27]
    ds_read_b64_tr_b16 v[174:175], v130 offset:20480
    s_waitcnt lgkmcnt(8)
    v_mfma_f32_16x16x32_bf16 v[40:43], v[192:195], v[152:155], v[40:43]
    ds_read_b64_tr_b16 v[176:177], v132 offset:16384
    v_mfma_f32_16x16x32_bf16 v[44:47], v[192:195], v[156:159], v[44:47]
    ds_read_b64_tr_b16 v[178:179], v132 offset:20480
    v_mfma_f32_16x16x32_bf16 v[48:51], v[192:195], v[160:163], v[48:51]
    ds_read_b64_tr_b16 v[180:181], v134 offset:16384
    v_mfma_f32_16x16x32_bf16 v[52:55], v[192:195], v[164:167], v[52:55]
    ds_read_b64_tr_b16 v[182:183], v134 offset:20480
    v_mfma_f32_16x16x32_bf16 v[68:71], v[196:199], v[164:167], v[68:71]
    v_mfma_f32_16x16x32_bf16 v[64:67], v[196:199], v[160:163], v[64:67]
    v_mfma_f32_16x16x32_bf16 v[60:63], v[196:199], v[156:159], v[60:63]
    v_mfma_f32_16x16x32_bf16 v[56:59], v[196:199], v[152:155], v[56:59]
    s_waitcnt lgkmcnt(4)
    v_mfma_f32_16x16x32_bf16 v[8:11], v[168:171], v[136:139], v[8:11]
    v_mfma_f32_16x16x32_bf16 v[12:15], v[168:171], v[140:143], v[12:15]
    v_mfma_f32_16x16x32_bf16 v[16:19], v[168:171], v[144:147], v[16:19]
    v_mfma_f32_16x16x32_bf16 v[20:23], v[168:171], v[148:151], v[20:23]
    s_waitcnt lgkmcnt(0)
    s_barrier
    v_mfma_f32_16x16x32_bf16 v[36:39], v[172:175], v[148:151], v[36:39]
    ds_read_b128 v[152:155], v119 offset:0
    v_mfma_f32_16x16x32_bf16 v[32:35], v[172:175], v[144:147], v[32:35]
    ds_read_b64_tr_b16 v[184:185], v127 offset:16384
    v_mfma_f32_16x16x32_bf16 v[28:31], v[172:175], v[140:143], v[28:31]
    ds_read_b64_tr_b16 v[186:187], v127 offset:20480
    v_mfma_f32_16x16x32_bf16 v[24:27], v[172:175], v[136:139], v[24:27]
    ds_read_b128 v[156:159], v119 offset:1024
    v_mfma_f32_16x16x32_bf16 v[40:43], v[176:179], v[136:139], v[40:43]
    ds_read_b128 v[160:163], v120 offset:0
    v_mfma_f32_16x16x32_bf16 v[44:47], v[176:179], v[140:143], v[44:47]
    ds_read_b128 v[164:167], v120 offset:1024
    v_mfma_f32_16x16x32_bf16 v[48:51], v[176:179], v[144:147], v[48:51]
    ds_read_b64_tr_b16 v[188:189], v129 offset:16384
    v_mfma_f32_16x16x32_bf16 v[52:55], v[176:179], v[148:151], v[52:55]
    ds_read_b64_tr_b16 v[190:191], v129 offset:20480
    v_mfma_f32_16x16x32_bf16 v[68:71], v[180:183], v[148:151], v[68:71]
    ds_read_b64_tr_b16 v[192:193], v131 offset:16384
    v_mfma_f32_16x16x32_bf16 v[64:67], v[180:183], v[144:147], v[64:67]
    ds_read_b64_tr_b16 v[194:195], v131 offset:20480
    v_mfma_f32_16x16x32_bf16 v[60:63], v[180:183], v[140:143], v[60:63]
    ds_read_b64_tr_b16 v[196:197], v133 offset:16384
    v_mfma_f32_16x16x32_bf16 v[56:59], v[180:183], v[136:139], v[56:59]
    ds_read_b64_tr_b16 v[198:199], v133 offset:20480
    s_waitcnt lgkmcnt(4)
    v_mfma_f32_16x16x32_bf16 v[8:11], v[184:187], v[152:155], v[8:11]
    ds_read_b128 v[136:139], v119 offset:8192
    v_mfma_f32_16x16x32_bf16 v[12:15], v[184:187], v[156:159], v[12:15]
    ds_read_b64_tr_b16 v[168:169], v127 offset:24576
    v_mfma_f32_16x16x32_bf16 v[16:19], v[184:187], v[160:163], v[16:19]
    ds_read_b64_tr_b16 v[170:171], v127 offset:28672
    v_mfma_f32_16x16x32_bf16 v[20:23], v[184:187], v[164:167], v[20:23]
    ds_read_b128 v[140:143], v119 offset:9216
    v_mfma_f32_16x16x32_bf16 v[36:39], v[188:191], v[164:167], v[36:39]
    ds_read_b128 v[144:147], v120 offset:8192
    v_mfma_f32_16x16x32_bf16 v[32:35], v[188:191], v[160:163], v[32:35]
    ds_read_b128 v[148:151], v120 offset:9216
    v_mfma_f32_16x16x32_bf16 v[28:31], v[188:191], v[156:159], v[28:31]
    ds_read_b64_tr_b16 v[172:173], v129 offset:24576
    v_mfma_f32_16x16x32_bf16 v[24:27], v[188:191], v[152:155], v[24:27]
    ds_read_b64_tr_b16 v[174:175], v129 offset:28672
    s_waitcnt lgkmcnt(8)
    v_mfma_f32_16x16x32_bf16 v[40:43], v[192:195], v[152:155], v[40:43]
    ds_read_b64_tr_b16 v[176:177], v131 offset:24576
    v_mfma_f32_16x16x32_bf16 v[44:47], v[192:195], v[156:159], v[44:47]
    ds_read_b64_tr_b16 v[178:179], v131 offset:28672
    v_mfma_f32_16x16x32_bf16 v[48:51], v[192:195], v[160:163], v[48:51]
    ds_read_b64_tr_b16 v[180:181], v133 offset:24576
    v_mfma_f32_16x16x32_bf16 v[52:55], v[192:195], v[164:167], v[52:55]
    ds_read_b64_tr_b16 v[182:183], v133 offset:28672
    v_mfma_f32_16x16x32_bf16 v[68:71], v[196:199], v[164:167], v[68:71]
    v_mfma_f32_16x16x32_bf16 v[64:67], v[196:199], v[160:163], v[64:67]
    v_mfma_f32_16x16x32_bf16 v[60:63], v[196:199], v[156:159], v[60:63]
    v_mfma_f32_16x16x32_bf16 v[56:59], v[196:199], v[152:155], v[56:59]
    s_waitcnt lgkmcnt(4)
    v_mfma_f32_16x16x32_bf16 v[8:11], v[168:171], v[136:139], v[8:11]
    v_mfma_f32_16x16x32_bf16 v[12:15], v[168:171], v[140:143], v[12:15]
    v_mfma_f32_16x16x32_bf16 v[16:19], v[168:171], v[144:147], v[16:19]
    v_mfma_f32_16x16x32_bf16 v[20:23], v[168:171], v[148:151], v[20:23]
    s_waitcnt lgkmcnt(0)
    s_barrier
    v_mfma_f32_16x16x32_bf16 v[36:39], v[172:175], v[148:151], v[36:39]
    ds_read_b128 v[152:155], v119 offset:16384
    v_mfma_f32_16x16x32_bf16 v[32:35], v[172:175], v[144:147], v[32:35]
    ds_read_b64_tr_b16 v[184:185], v127 offset:32768
    v_mfma_f32_16x16x32_bf16 v[28:31], v[172:175], v[140:143], v[28:31]
    ds_read_b64_tr_b16 v[186:187], v127 offset:36864
    v_mfma_f32_16x16x32_bf16 v[24:27], v[172:175], v[136:139], v[24:27]
    ds_read_b128 v[156:159], v119 offset:17408
    v_mfma_f32_16x16x32_bf16 v[40:43], v[176:179], v[136:139], v[40:43]
    ds_read_b128 v[160:163], v120 offset:16384
    v_mfma_f32_16x16x32_bf16 v[44:47], v[176:179], v[140:143], v[44:47]
    ds_read_b128 v[164:167], v120 offset:17408
    v_mfma_f32_16x16x32_bf16 v[48:51], v[176:179], v[144:147], v[48:51]
    ds_read_b64_tr_b16 v[188:189], v129 offset:32768
    v_mfma_f32_16x16x32_bf16 v[52:55], v[176:179], v[148:151], v[52:55]
    ds_read_b64_tr_b16 v[190:191], v129 offset:36864
    v_mfma_f32_16x16x32_bf16 v[68:71], v[180:183], v[148:151], v[68:71]
    ds_read_b64_tr_b16 v[192:193], v131 offset:32768
    v_mfma_f32_16x16x32_bf16 v[64:67], v[180:183], v[144:147], v[64:67]
    ds_read_b64_tr_b16 v[194:195], v131 offset:36864
    v_mfma_f32_16x16x32_bf16 v[60:63], v[180:183], v[140:143], v[60:63]
    ds_read_b64_tr_b16 v[196:197], v133 offset:32768
    v_mfma_f32_16x16x32_bf16 v[56:59], v[180:183], v[136:139], v[56:59]
    ds_read_b64_tr_b16 v[198:199], v133 offset:36864
    s_waitcnt lgkmcnt(4)
    v_mfma_f32_16x16x32_bf16 v[8:11], v[184:187], v[152:155], v[8:11]
    ds_read_b128 v[136:139], v119 offset:24576
    v_mfma_f32_16x16x32_bf16 v[12:15], v[184:187], v[156:159], v[12:15]
    ds_read_b64_tr_b16 v[168:169], v127 offset:40960
    v_mfma_f32_16x16x32_bf16 v[16:19], v[184:187], v[160:163], v[16:19]
    ds_read_b64_tr_b16 v[170:171], v127 offset:45056
    v_mfma_f32_16x16x32_bf16 v[20:23], v[184:187], v[164:167], v[20:23]
    ds_read_b128 v[140:143], v119 offset:25600
    v_mfma_f32_16x16x32_bf16 v[36:39], v[188:191], v[164:167], v[36:39]
    ds_read_b128 v[144:147], v120 offset:24576
    v_mfma_f32_16x16x32_bf16 v[32:35], v[188:191], v[160:163], v[32:35]
    ds_read_b128 v[148:151], v120 offset:25600
    v_mfma_f32_16x16x32_bf16 v[28:31], v[188:191], v[156:159], v[28:31]
    ds_read_b64_tr_b16 v[172:173], v129 offset:40960
    v_mfma_f32_16x16x32_bf16 v[24:27], v[188:191], v[152:155], v[24:27]
    ds_read_b64_tr_b16 v[174:175], v129 offset:45056
    s_waitcnt lgkmcnt(8)
    v_mfma_f32_16x16x32_bf16 v[40:43], v[192:195], v[152:155], v[40:43]
    ds_read_b64_tr_b16 v[176:177], v131 offset:40960
    v_mfma_f32_16x16x32_bf16 v[44:47], v[192:195], v[156:159], v[44:47]
    ds_read_b64_tr_b16 v[178:179], v131 offset:45056
    v_mfma_f32_16x16x32_bf16 v[48:51], v[192:195], v[160:163], v[48:51]
    ds_read_b64_tr_b16 v[180:181], v133 offset:40960
    v_mfma_f32_16x16x32_bf16 v[52:55], v[192:195], v[164:167], v[52:55]
    ds_read_b64_tr_b16 v[182:183], v133 offset:45056
    v_mfma_f32_16x16x32_bf16 v[68:71], v[196:199], v[164:167], v[68:71]
    v_mfma_f32_16x16x32_bf16 v[64:67], v[196:199], v[160:163], v[64:67]
    v_mfma_f32_16x16x32_bf16 v[60:63], v[196:199], v[156:159], v[60:63]
    v_mfma_f32_16x16x32_bf16 v[56:59], v[196:199], v[152:155], v[56:59]
    s_waitcnt lgkmcnt(4)
    v_mfma_f32_16x16x32_bf16 v[8:11], v[168:171], v[136:139], v[8:11]
    v_mfma_f32_16x16x32_bf16 v[12:15], v[168:171], v[140:143], v[12:15]
    v_mfma_f32_16x16x32_bf16 v[16:19], v[168:171], v[144:147], v[16:19]
    v_mfma_f32_16x16x32_bf16 v[20:23], v[168:171], v[148:151], v[20:23]
    s_waitcnt lgkmcnt(0)
    s_barrier
    v_mfma_f32_16x16x32_bf16 v[36:39], v[172:175], v[148:151], v[36:39]
    ds_read_b128 v[152:155], v119 offset:32768
    v_mfma_f32_16x16x32_bf16 v[32:35], v[172:175], v[144:147], v[32:35]
    ds_read_b64_tr_b16 v[184:185], v127 offset:57344
    v_mfma_f32_16x16x32_bf16 v[28:31], v[172:175], v[140:143], v[28:31]
    ds_read_b64_tr_b16 v[186:187], v127 offset:61440
    v_mfma_f32_16x16x32_bf16 v[24:27], v[172:175], v[136:139], v[24:27]
    ds_read_b128 v[156:159], v119 offset:33792
    v_mfma_f32_16x16x32_bf16 v[40:43], v[176:179], v[136:139], v[40:43]
    ds_read_b128 v[160:163], v120 offset:32768
    v_mfma_f32_16x16x32_bf16 v[44:47], v[176:179], v[140:143], v[44:47]
    ds_read_b128 v[164:167], v120 offset:33792
    v_mfma_f32_16x16x32_bf16 v[48:51], v[176:179], v[144:147], v[48:51]
    ds_read_b64_tr_b16 v[188:189], v129 offset:57344
    v_mfma_f32_16x16x32_bf16 v[52:55], v[176:179], v[148:151], v[52:55]
    ds_read_b64_tr_b16 v[190:191], v129 offset:61440
    v_mfma_f32_16x16x32_bf16 v[68:71], v[180:183], v[148:151], v[68:71]
    ds_read_b64_tr_b16 v[192:193], v131 offset:57344
    v_mfma_f32_16x16x32_bf16 v[64:67], v[180:183], v[144:147], v[64:67]
    ds_read_b64_tr_b16 v[194:195], v131 offset:61440
    v_mfma_f32_16x16x32_bf16 v[60:63], v[180:183], v[140:143], v[60:63]
    ds_read_b64_tr_b16 v[196:197], v133 offset:57344
    v_mfma_f32_16x16x32_bf16 v[56:59], v[180:183], v[136:139], v[56:59]
    ds_read_b64_tr_b16 v[198:199], v133 offset:61440
    s_waitcnt lgkmcnt(4)
    v_mfma_f32_16x16x32_bf16 v[8:11], v[184:187], v[152:155], v[8:11]
    ds_read_b128 v[136:139], v119 offset:40960
    v_mfma_f32_16x16x32_bf16 v[12:15], v[184:187], v[156:159], v[12:15]
    ds_read_b64_tr_b16 v[168:169], v128 offset:0
    v_mfma_f32_16x16x32_bf16 v[16:19], v[184:187], v[160:163], v[16:19]
    ds_read_b64_tr_b16 v[170:171], v128 offset:4096
    v_mfma_f32_16x16x32_bf16 v[20:23], v[184:187], v[164:167], v[20:23]
    ds_read_b128 v[140:143], v119 offset:41984
    v_mfma_f32_16x16x32_bf16 v[36:39], v[188:191], v[164:167], v[36:39]
    ds_read_b128 v[144:147], v120 offset:40960
    v_mfma_f32_16x16x32_bf16 v[32:35], v[188:191], v[160:163], v[32:35]
    ds_read_b128 v[148:151], v120 offset:41984
    v_mfma_f32_16x16x32_bf16 v[28:31], v[188:191], v[156:159], v[28:31]
    ds_read_b64_tr_b16 v[172:173], v130 offset:0
    v_mfma_f32_16x16x32_bf16 v[24:27], v[188:191], v[152:155], v[24:27]
    ds_read_b64_tr_b16 v[174:175], v130 offset:4096
    s_waitcnt lgkmcnt(8)
    v_mfma_f32_16x16x32_bf16 v[40:43], v[192:195], v[152:155], v[40:43]
    ds_read_b64_tr_b16 v[176:177], v132 offset:0
    v_mfma_f32_16x16x32_bf16 v[44:47], v[192:195], v[156:159], v[44:47]
    ds_read_b64_tr_b16 v[178:179], v132 offset:4096
    v_mfma_f32_16x16x32_bf16 v[48:51], v[192:195], v[160:163], v[48:51]
    ds_read_b64_tr_b16 v[180:181], v134 offset:0
    v_mfma_f32_16x16x32_bf16 v[52:55], v[192:195], v[164:167], v[52:55]
    ds_read_b64_tr_b16 v[182:183], v134 offset:4096
    v_mfma_f32_16x16x32_bf16 v[68:71], v[196:199], v[164:167], v[68:71]
    v_mfma_f32_16x16x32_bf16 v[64:67], v[196:199], v[160:163], v[64:67]
    v_mfma_f32_16x16x32_bf16 v[60:63], v[196:199], v[156:159], v[60:63]
    v_mfma_f32_16x16x32_bf16 v[56:59], v[196:199], v[152:155], v[56:59]
    s_waitcnt lgkmcnt(4)
    v_mfma_f32_16x16x32_bf16 v[8:11], v[168:171], v[136:139], v[8:11]
    v_mfma_f32_16x16x32_bf16 v[12:15], v[168:171], v[140:143], v[12:15]
    v_mfma_f32_16x16x32_bf16 v[16:19], v[168:171], v[144:147], v[16:19]
    v_mfma_f32_16x16x32_bf16 v[20:23], v[168:171], v[148:151], v[20:23]
    s_waitcnt lgkmcnt(0)
    s_barrier
    v_mfma_f32_16x16x32_bf16 v[36:39], v[172:175], v[148:151], v[36:39]
    ds_read_b128 v[152:155], v119 offset:49152
    v_mfma_f32_16x16x32_bf16 v[32:35], v[172:175], v[144:147], v[32:35]
    ds_read_b64_tr_b16 v[184:185], v128 offset:8192
    v_mfma_f32_16x16x32_bf16 v[28:31], v[172:175], v[140:143], v[28:31]
    ds_read_b64_tr_b16 v[186:187], v128 offset:12288
    v_mfma_f32_16x16x32_bf16 v[24:27], v[172:175], v[136:139], v[24:27]
    ds_read_b128 v[156:159], v119 offset:50176
    v_mfma_f32_16x16x32_bf16 v[40:43], v[176:179], v[136:139], v[40:43]
    ds_read_b128 v[160:163], v120 offset:49152
    v_mfma_f32_16x16x32_bf16 v[44:47], v[176:179], v[140:143], v[44:47]
    ds_read_b128 v[164:167], v120 offset:50176
    v_mfma_f32_16x16x32_bf16 v[48:51], v[176:179], v[144:147], v[48:51]
    ds_read_b64_tr_b16 v[188:189], v130 offset:8192
    v_mfma_f32_16x16x32_bf16 v[52:55], v[176:179], v[148:151], v[52:55]
    ds_read_b64_tr_b16 v[190:191], v130 offset:12288
    v_mfma_f32_16x16x32_bf16 v[68:71], v[180:183], v[148:151], v[68:71]
    ds_read_b64_tr_b16 v[192:193], v132 offset:8192
    v_mfma_f32_16x16x32_bf16 v[64:67], v[180:183], v[144:147], v[64:67]
    ds_read_b64_tr_b16 v[194:195], v132 offset:12288
    v_mfma_f32_16x16x32_bf16 v[60:63], v[180:183], v[140:143], v[60:63]
    ds_read_b64_tr_b16 v[196:197], v134 offset:8192
    v_mfma_f32_16x16x32_bf16 v[56:59], v[180:183], v[136:139], v[56:59]
    ds_read_b64_tr_b16 v[198:199], v134 offset:12288
    s_waitcnt lgkmcnt(4)
    v_mfma_f32_16x16x32_bf16 v[8:11], v[184:187], v[152:155], v[8:11]
    ds_read_b128 v[136:139], v119 offset:57344
    v_mfma_f32_16x16x32_bf16 v[12:15], v[184:187], v[156:159], v[12:15]
    ds_read_b64_tr_b16 v[168:169], v128 offset:16384
    v_mfma_f32_16x16x32_bf16 v[16:19], v[184:187], v[160:163], v[16:19]
    ds_read_b64_tr_b16 v[170:171], v128 offset:20480
    v_mfma_f32_16x16x32_bf16 v[20:23], v[184:187], v[164:167], v[20:23]
    ds_read_b128 v[140:143], v119 offset:58368
    v_mfma_f32_16x16x32_bf16 v[36:39], v[188:191], v[164:167], v[36:39]
    ds_read_b128 v[144:147], v120 offset:57344
    v_mfma_f32_16x16x32_bf16 v[32:35], v[188:191], v[160:163], v[32:35]
    ds_read_b128 v[148:151], v120 offset:58368
    v_mfma_f32_16x16x32_bf16 v[28:31], v[188:191], v[156:159], v[28:31]
    ds_read_b64_tr_b16 v[172:173], v130 offset:16384
    v_mfma_f32_16x16x32_bf16 v[24:27], v[188:191], v[152:155], v[24:27]
    ds_read_b64_tr_b16 v[174:175], v130 offset:20480
    s_waitcnt lgkmcnt(8)
    v_mfma_f32_16x16x32_bf16 v[40:43], v[192:195], v[152:155], v[40:43]
    ds_read_b64_tr_b16 v[176:177], v132 offset:16384
    v_mfma_f32_16x16x32_bf16 v[44:47], v[192:195], v[156:159], v[44:47]
    ds_read_b64_tr_b16 v[178:179], v132 offset:20480
    v_mfma_f32_16x16x32_bf16 v[48:51], v[192:195], v[160:163], v[48:51]
    ds_read_b64_tr_b16 v[180:181], v134 offset:16384
    v_mfma_f32_16x16x32_bf16 v[52:55], v[192:195], v[164:167], v[52:55]
    ds_read_b64_tr_b16 v[182:183], v134 offset:20480
    v_mfma_f32_16x16x32_bf16 v[68:71], v[196:199], v[164:167], v[68:71]
    v_mfma_f32_16x16x32_bf16 v[64:67], v[196:199], v[160:163], v[64:67]
    v_mfma_f32_16x16x32_bf16 v[60:63], v[196:199], v[156:159], v[60:63]
    v_mfma_f32_16x16x32_bf16 v[56:59], v[196:199], v[152:155], v[56:59]
    s_waitcnt lgkmcnt(4)
    v_mfma_f32_16x16x32_bf16 v[8:11], v[168:171], v[136:139], v[8:11]
    v_mfma_f32_16x16x32_bf16 v[12:15], v[168:171], v[140:143], v[12:15]
    v_mfma_f32_16x16x32_bf16 v[16:19], v[168:171], v[144:147], v[16:19]
    v_mfma_f32_16x16x32_bf16 v[20:23], v[168:171], v[148:151], v[20:23]
    s_waitcnt lgkmcnt(0)
    s_barrier
    v_mfma_f32_16x16x32_bf16 v[36:39], v[172:175], v[148:151], v[36:39]
    ds_read_b128 v[152:155], v121 offset:0
    v_mfma_f32_16x16x32_bf16 v[32:35], v[172:175], v[144:147], v[32:35]
    ds_read_b64_tr_b16 v[184:185], v127 offset:16384
    v_mfma_f32_16x16x32_bf16 v[28:31], v[172:175], v[140:143], v[28:31]
    ds_read_b64_tr_b16 v[186:187], v127 offset:20480
    v_mfma_f32_16x16x32_bf16 v[24:27], v[172:175], v[136:139], v[24:27]
    ds_read_b128 v[156:159], v121 offset:1024
    v_mfma_f32_16x16x32_bf16 v[40:43], v[176:179], v[136:139], v[40:43]
    ds_read_b128 v[160:163], v122 offset:0
    v_mfma_f32_16x16x32_bf16 v[44:47], v[176:179], v[140:143], v[44:47]
    ds_read_b128 v[164:167], v122 offset:1024
    v_mfma_f32_16x16x32_bf16 v[48:51], v[176:179], v[144:147], v[48:51]
    ds_read_b64_tr_b16 v[188:189], v129 offset:16384
    v_mfma_f32_16x16x32_bf16 v[52:55], v[176:179], v[148:151], v[52:55]
    ds_read_b64_tr_b16 v[190:191], v129 offset:20480
    v_mfma_f32_16x16x32_bf16 v[68:71], v[180:183], v[148:151], v[68:71]
    ds_read_b64_tr_b16 v[192:193], v131 offset:16384
    v_mfma_f32_16x16x32_bf16 v[64:67], v[180:183], v[144:147], v[64:67]
    ds_read_b64_tr_b16 v[194:195], v131 offset:20480
    v_mfma_f32_16x16x32_bf16 v[60:63], v[180:183], v[140:143], v[60:63]
    ds_read_b64_tr_b16 v[196:197], v133 offset:16384
    v_mfma_f32_16x16x32_bf16 v[56:59], v[180:183], v[136:139], v[56:59]
    ds_read_b64_tr_b16 v[198:199], v133 offset:20480
    s_waitcnt lgkmcnt(4)
    v_mfma_f32_16x16x32_bf16 v[8:11], v[184:187], v[152:155], v[8:11]
    ds_read_b128 v[136:139], v121 offset:8192
    v_mfma_f32_16x16x32_bf16 v[12:15], v[184:187], v[156:159], v[12:15]
    ds_read_b64_tr_b16 v[168:169], v127 offset:24576
    v_mfma_f32_16x16x32_bf16 v[16:19], v[184:187], v[160:163], v[16:19]
    ds_read_b64_tr_b16 v[170:171], v127 offset:28672
    v_mfma_f32_16x16x32_bf16 v[20:23], v[184:187], v[164:167], v[20:23]
    ds_read_b128 v[140:143], v121 offset:9216
    v_mfma_f32_16x16x32_bf16 v[36:39], v[188:191], v[164:167], v[36:39]
    ds_read_b128 v[144:147], v122 offset:8192
    v_mfma_f32_16x16x32_bf16 v[32:35], v[188:191], v[160:163], v[32:35]
    ds_read_b128 v[148:151], v122 offset:9216
    v_mfma_f32_16x16x32_bf16 v[28:31], v[188:191], v[156:159], v[28:31]
    ds_read_b64_tr_b16 v[172:173], v129 offset:24576
    v_mfma_f32_16x16x32_bf16 v[24:27], v[188:191], v[152:155], v[24:27]
    ds_read_b64_tr_b16 v[174:175], v129 offset:28672
    s_waitcnt lgkmcnt(8)
    v_mfma_f32_16x16x32_bf16 v[40:43], v[192:195], v[152:155], v[40:43]
    ds_read_b64_tr_b16 v[176:177], v131 offset:24576
    v_mfma_f32_16x16x32_bf16 v[44:47], v[192:195], v[156:159], v[44:47]
    ds_read_b64_tr_b16 v[178:179], v131 offset:28672
    v_mfma_f32_16x16x32_bf16 v[48:51], v[192:195], v[160:163], v[48:51]
    ds_read_b64_tr_b16 v[180:181], v133 offset:24576
    v_mfma_f32_16x16x32_bf16 v[52:55], v[192:195], v[164:167], v[52:55]
    ds_read_b64_tr_b16 v[182:183], v133 offset:28672
    v_mfma_f32_16x16x32_bf16 v[68:71], v[196:199], v[164:167], v[68:71]
    v_mfma_f32_16x16x32_bf16 v[64:67], v[196:199], v[160:163], v[64:67]
    v_mfma_f32_16x16x32_bf16 v[60:63], v[196:199], v[156:159], v[60:63]
    v_mfma_f32_16x16x32_bf16 v[56:59], v[196:199], v[152:155], v[56:59]
    s_waitcnt lgkmcnt(4)
    v_mfma_f32_16x16x32_bf16 v[8:11], v[168:171], v[136:139], v[8:11]
    v_mfma_f32_16x16x32_bf16 v[12:15], v[168:171], v[140:143], v[12:15]
    v_mfma_f32_16x16x32_bf16 v[16:19], v[168:171], v[144:147], v[16:19]
    v_mfma_f32_16x16x32_bf16 v[20:23], v[168:171], v[148:151], v[20:23]
    s_waitcnt lgkmcnt(0)
    s_barrier
    v_mfma_f32_16x16x32_bf16 v[36:39], v[172:175], v[148:151], v[36:39]
    ds_read_b128 v[152:155], v119 offset:0
    v_mfma_f32_16x16x32_bf16 v[32:35], v[172:175], v[144:147], v[32:35]
    ds_read_b64_tr_b16 v[184:185], v127 offset:32768
    v_mfma_f32_16x16x32_bf16 v[28:31], v[172:175], v[140:143], v[28:31]
    ds_read_b64_tr_b16 v[186:187], v127 offset:36864
    v_mfma_f32_16x16x32_bf16 v[24:27], v[172:175], v[136:139], v[24:27]
    ds_read_b128 v[156:159], v119 offset:1024
    v_mfma_f32_16x16x32_bf16 v[40:43], v[176:179], v[136:139], v[40:43]
    ds_read_b128 v[160:163], v120 offset:0
    v_mfma_f32_16x16x32_bf16 v[44:47], v[176:179], v[140:143], v[44:47]
    ds_read_b128 v[164:167], v120 offset:1024
    v_mfma_f32_16x16x32_bf16 v[48:51], v[176:179], v[144:147], v[48:51]
    ds_read_b64_tr_b16 v[188:189], v129 offset:32768
    v_mfma_f32_16x16x32_bf16 v[52:55], v[176:179], v[148:151], v[52:55]
    ds_read_b64_tr_b16 v[190:191], v129 offset:36864
    v_mfma_f32_16x16x32_bf16 v[68:71], v[180:183], v[148:151], v[68:71]
    ds_read_b64_tr_b16 v[192:193], v131 offset:32768
    v_mfma_f32_16x16x32_bf16 v[64:67], v[180:183], v[144:147], v[64:67]
    ds_read_b64_tr_b16 v[194:195], v131 offset:36864
    v_mfma_f32_16x16x32_bf16 v[60:63], v[180:183], v[140:143], v[60:63]
    ds_read_b64_tr_b16 v[196:197], v133 offset:32768
    v_mfma_f32_16x16x32_bf16 v[56:59], v[180:183], v[136:139], v[56:59]
    ds_read_b64_tr_b16 v[198:199], v133 offset:36864
    s_waitcnt lgkmcnt(4)
    v_mfma_f32_16x16x32_bf16 v[8:11], v[184:187], v[152:155], v[8:11]
    ds_read_b128 v[136:139], v119 offset:8192
    v_mfma_f32_16x16x32_bf16 v[12:15], v[184:187], v[156:159], v[12:15]
    ds_read_b64_tr_b16 v[168:169], v127 offset:40960
    v_mfma_f32_16x16x32_bf16 v[16:19], v[184:187], v[160:163], v[16:19]
    ds_read_b64_tr_b16 v[170:171], v127 offset:45056
    v_mfma_f32_16x16x32_bf16 v[20:23], v[184:187], v[164:167], v[20:23]
    ds_read_b128 v[140:143], v119 offset:9216
    v_mfma_f32_16x16x32_bf16 v[36:39], v[188:191], v[164:167], v[36:39]
    ds_read_b128 v[144:147], v120 offset:8192
    v_mfma_f32_16x16x32_bf16 v[32:35], v[188:191], v[160:163], v[32:35]
    ds_read_b128 v[148:151], v120 offset:9216
    v_mfma_f32_16x16x32_bf16 v[28:31], v[188:191], v[156:159], v[28:31]
    ds_read_b64_tr_b16 v[172:173], v129 offset:40960
    v_mfma_f32_16x16x32_bf16 v[24:27], v[188:191], v[152:155], v[24:27]
    ds_read_b64_tr_b16 v[174:175], v129 offset:45056
    s_waitcnt lgkmcnt(8)
    v_mfma_f32_16x16x32_bf16 v[40:43], v[192:195], v[152:155], v[40:43]
    ds_read_b64_tr_b16 v[176:177], v131 offset:40960
    v_mfma_f32_16x16x32_bf16 v[44:47], v[192:195], v[156:159], v[44:47]
    ds_read_b64_tr_b16 v[178:179], v131 offset:45056
    v_mfma_f32_16x16x32_bf16 v[48:51], v[192:195], v[160:163], v[48:51]
    ds_read_b64_tr_b16 v[180:181], v133 offset:40960
    v_mfma_f32_16x16x32_bf16 v[52:55], v[192:195], v[164:167], v[52:55]
    ds_read_b64_tr_b16 v[182:183], v133 offset:45056
    v_mfma_f32_16x16x32_bf16 v[68:71], v[196:199], v[164:167], v[68:71]
    v_mfma_f32_16x16x32_bf16 v[64:67], v[196:199], v[160:163], v[64:67]
    v_mfma_f32_16x16x32_bf16 v[60:63], v[196:199], v[156:159], v[60:63]
    v_mfma_f32_16x16x32_bf16 v[56:59], v[196:199], v[152:155], v[56:59]
    s_waitcnt lgkmcnt(4)
    v_mfma_f32_16x16x32_bf16 v[8:11], v[168:171], v[136:139], v[8:11]
    v_mfma_f32_16x16x32_bf16 v[12:15], v[168:171], v[140:143], v[12:15]
    v_mfma_f32_16x16x32_bf16 v[16:19], v[168:171], v[144:147], v[16:19]
    v_mfma_f32_16x16x32_bf16 v[20:23], v[168:171], v[148:151], v[20:23]
    s_waitcnt lgkmcnt(0)
    s_barrier
    v_mfma_f32_16x16x32_bf16 v[36:39], v[172:175], v[148:151], v[36:39]
    ds_read_b128 v[152:155], v119 offset:16384
    v_mfma_f32_16x16x32_bf16 v[32:35], v[172:175], v[144:147], v[32:35]
    ds_read_b64_tr_b16 v[184:185], v127 offset:57344
    v_mfma_f32_16x16x32_bf16 v[28:31], v[172:175], v[140:143], v[28:31]
    ds_read_b64_tr_b16 v[186:187], v127 offset:61440
    v_mfma_f32_16x16x32_bf16 v[24:27], v[172:175], v[136:139], v[24:27]
    ds_read_b128 v[156:159], v119 offset:17408
    v_mfma_f32_16x16x32_bf16 v[40:43], v[176:179], v[136:139], v[40:43]
    ds_read_b128 v[160:163], v120 offset:16384
    v_mfma_f32_16x16x32_bf16 v[44:47], v[176:179], v[140:143], v[44:47]
    ds_read_b128 v[164:167], v120 offset:17408
    v_mfma_f32_16x16x32_bf16 v[48:51], v[176:179], v[144:147], v[48:51]
    ds_read_b64_tr_b16 v[188:189], v129 offset:57344
    v_mfma_f32_16x16x32_bf16 v[52:55], v[176:179], v[148:151], v[52:55]
    ds_read_b64_tr_b16 v[190:191], v129 offset:61440
    v_mfma_f32_16x16x32_bf16 v[68:71], v[180:183], v[148:151], v[68:71]
    ds_read_b64_tr_b16 v[192:193], v131 offset:57344
    v_mfma_f32_16x16x32_bf16 v[64:67], v[180:183], v[144:147], v[64:67]
    ds_read_b64_tr_b16 v[194:195], v131 offset:61440
    v_mfma_f32_16x16x32_bf16 v[60:63], v[180:183], v[140:143], v[60:63]
    ds_read_b64_tr_b16 v[196:197], v133 offset:57344
    v_mfma_f32_16x16x32_bf16 v[56:59], v[180:183], v[136:139], v[56:59]
    ds_read_b64_tr_b16 v[198:199], v133 offset:61440
    s_waitcnt lgkmcnt(4)
    v_mfma_f32_16x16x32_bf16 v[8:11], v[184:187], v[152:155], v[8:11]
    ds_read_b128 v[136:139], v119 offset:24576
    v_mfma_f32_16x16x32_bf16 v[12:15], v[184:187], v[156:159], v[12:15]
    ds_read_b64_tr_b16 v[168:169], v128 offset:0
    v_mfma_f32_16x16x32_bf16 v[16:19], v[184:187], v[160:163], v[16:19]
    ds_read_b64_tr_b16 v[170:171], v128 offset:4096
    v_mfma_f32_16x16x32_bf16 v[20:23], v[184:187], v[164:167], v[20:23]
    ds_read_b128 v[140:143], v119 offset:25600
    v_mfma_f32_16x16x32_bf16 v[36:39], v[188:191], v[164:167], v[36:39]
    ds_read_b128 v[144:147], v120 offset:24576
    v_mfma_f32_16x16x32_bf16 v[32:35], v[188:191], v[160:163], v[32:35]
    ds_read_b128 v[148:151], v120 offset:25600
    v_mfma_f32_16x16x32_bf16 v[28:31], v[188:191], v[156:159], v[28:31]
    ds_read_b64_tr_b16 v[172:173], v130 offset:0
    v_mfma_f32_16x16x32_bf16 v[24:27], v[188:191], v[152:155], v[24:27]
    ds_read_b64_tr_b16 v[174:175], v130 offset:4096
    s_waitcnt lgkmcnt(8)
    v_mfma_f32_16x16x32_bf16 v[40:43], v[192:195], v[152:155], v[40:43]
    ds_read_b64_tr_b16 v[176:177], v132 offset:0
    v_mfma_f32_16x16x32_bf16 v[44:47], v[192:195], v[156:159], v[44:47]
    ds_read_b64_tr_b16 v[178:179], v132 offset:4096
    v_mfma_f32_16x16x32_bf16 v[48:51], v[192:195], v[160:163], v[48:51]
    ds_read_b64_tr_b16 v[180:181], v134 offset:0
    v_mfma_f32_16x16x32_bf16 v[52:55], v[192:195], v[164:167], v[52:55]
    ds_read_b64_tr_b16 v[182:183], v134 offset:4096
    v_mfma_f32_16x16x32_bf16 v[68:71], v[196:199], v[164:167], v[68:71]
    v_mfma_f32_16x16x32_bf16 v[64:67], v[196:199], v[160:163], v[64:67]
    v_mfma_f32_16x16x32_bf16 v[60:63], v[196:199], v[156:159], v[60:63]
    v_mfma_f32_16x16x32_bf16 v[56:59], v[196:199], v[152:155], v[56:59]
    s_waitcnt lgkmcnt(4)
    v_mfma_f32_16x16x32_bf16 v[8:11], v[168:171], v[136:139], v[8:11]
    v_mfma_f32_16x16x32_bf16 v[12:15], v[168:171], v[140:143], v[12:15]
    v_mfma_f32_16x16x32_bf16 v[16:19], v[168:171], v[144:147], v[16:19]
    v_mfma_f32_16x16x32_bf16 v[20:23], v[168:171], v[148:151], v[20:23]
    s_waitcnt lgkmcnt(0)
    s_barrier
    v_mfma_f32_16x16x32_bf16 v[36:39], v[172:175], v[148:151], v[36:39]
    ds_read_b128 v[152:155], v119 offset:32768
    v_mfma_f32_16x16x32_bf16 v[32:35], v[172:175], v[144:147], v[32:35]
    ds_read_b64_tr_b16 v[184:185], v128 offset:8192
    v_mfma_f32_16x16x32_bf16 v[28:31], v[172:175], v[140:143], v[28:31]
    ds_read_b64_tr_b16 v[186:187], v128 offset:12288
    v_mfma_f32_16x16x32_bf16 v[24:27], v[172:175], v[136:139], v[24:27]
    ds_read_b128 v[156:159], v119 offset:33792
    v_mfma_f32_16x16x32_bf16 v[40:43], v[176:179], v[136:139], v[40:43]
    ds_read_b128 v[160:163], v120 offset:32768
    v_mfma_f32_16x16x32_bf16 v[44:47], v[176:179], v[140:143], v[44:47]
    ds_read_b128 v[164:167], v120 offset:33792
    v_mfma_f32_16x16x32_bf16 v[48:51], v[176:179], v[144:147], v[48:51]
    ds_read_b64_tr_b16 v[188:189], v130 offset:8192
    v_mfma_f32_16x16x32_bf16 v[52:55], v[176:179], v[148:151], v[52:55]
    ds_read_b64_tr_b16 v[190:191], v130 offset:12288
    v_mfma_f32_16x16x32_bf16 v[68:71], v[180:183], v[148:151], v[68:71]
    ds_read_b64_tr_b16 v[192:193], v132 offset:8192
    v_mfma_f32_16x16x32_bf16 v[64:67], v[180:183], v[144:147], v[64:67]
    ds_read_b64_tr_b16 v[194:195], v132 offset:12288
    v_mfma_f32_16x16x32_bf16 v[60:63], v[180:183], v[140:143], v[60:63]
    ds_read_b64_tr_b16 v[196:197], v134 offset:8192
    v_mfma_f32_16x16x32_bf16 v[56:59], v[180:183], v[136:139], v[56:59]
    ds_read_b64_tr_b16 v[198:199], v134 offset:12288
    s_waitcnt lgkmcnt(4)
    v_mfma_f32_16x16x32_bf16 v[8:11], v[184:187], v[152:155], v[8:11]
    ds_read_b128 v[136:139], v119 offset:40960
    v_mfma_f32_16x16x32_bf16 v[12:15], v[184:187], v[156:159], v[12:15]
    ds_read_b64_tr_b16 v[168:169], v128 offset:16384
    v_mfma_f32_16x16x32_bf16 v[16:19], v[184:187], v[160:163], v[16:19]
    ds_read_b64_tr_b16 v[170:171], v128 offset:20480
    v_mfma_f32_16x16x32_bf16 v[20:23], v[184:187], v[164:167], v[20:23]
    ds_read_b128 v[140:143], v119 offset:41984
    v_mfma_f32_16x16x32_bf16 v[36:39], v[188:191], v[164:167], v[36:39]
    ds_read_b128 v[144:147], v120 offset:40960
    v_mfma_f32_16x16x32_bf16 v[32:35], v[188:191], v[160:163], v[32:35]
    ds_read_b128 v[148:151], v120 offset:41984
    v_mfma_f32_16x16x32_bf16 v[28:31], v[188:191], v[156:159], v[28:31]
    ds_read_b64_tr_b16 v[172:173], v130 offset:16384
    v_mfma_f32_16x16x32_bf16 v[24:27], v[188:191], v[152:155], v[24:27]
    ds_read_b64_tr_b16 v[174:175], v130 offset:20480
    s_waitcnt lgkmcnt(8)
    v_mfma_f32_16x16x32_bf16 v[40:43], v[192:195], v[152:155], v[40:43]
    ds_read_b64_tr_b16 v[176:177], v132 offset:16384
    v_mfma_f32_16x16x32_bf16 v[44:47], v[192:195], v[156:159], v[44:47]
    ds_read_b64_tr_b16 v[178:179], v132 offset:20480
    v_mfma_f32_16x16x32_bf16 v[48:51], v[192:195], v[160:163], v[48:51]
    ds_read_b64_tr_b16 v[180:181], v134 offset:16384
    v_mfma_f32_16x16x32_bf16 v[52:55], v[192:195], v[164:167], v[52:55]
    ds_read_b64_tr_b16 v[182:183], v134 offset:20480
    v_mfma_f32_16x16x32_bf16 v[68:71], v[196:199], v[164:167], v[68:71]
    v_mfma_f32_16x16x32_bf16 v[64:67], v[196:199], v[160:163], v[64:67]
    v_mfma_f32_16x16x32_bf16 v[60:63], v[196:199], v[156:159], v[60:63]
    v_mfma_f32_16x16x32_bf16 v[56:59], v[196:199], v[152:155], v[56:59]
    s_waitcnt lgkmcnt(4)
    v_mfma_f32_16x16x32_bf16 v[8:11], v[168:171], v[136:139], v[8:11]
    v_mfma_f32_16x16x32_bf16 v[12:15], v[168:171], v[140:143], v[12:15]
    v_mfma_f32_16x16x32_bf16 v[16:19], v[168:171], v[144:147], v[16:19]
    v_mfma_f32_16x16x32_bf16 v[20:23], v[168:171], v[148:151], v[20:23]
    s_waitcnt lgkmcnt(0)
    s_barrier
    v_mfma_f32_16x16x32_bf16 v[36:39], v[172:175], v[148:151], v[36:39]
    ds_read_b128 v[152:155], v119 offset:49152
    v_mfma_f32_16x16x32_bf16 v[32:35], v[172:175], v[144:147], v[32:35]
    ds_read_b64_tr_b16 v[184:185], v127 offset:16384
    v_mfma_f32_16x16x32_bf16 v[28:31], v[172:175], v[140:143], v[28:31]
    ds_read_b64_tr_b16 v[186:187], v127 offset:20480
    v_mfma_f32_16x16x32_bf16 v[24:27], v[172:175], v[136:139], v[24:27]
    ds_read_b128 v[156:159], v119 offset:50176
    v_mfma_f32_16x16x32_bf16 v[40:43], v[176:179], v[136:139], v[40:43]
    ds_read_b128 v[160:163], v120 offset:49152
    v_mfma_f32_16x16x32_bf16 v[44:47], v[176:179], v[140:143], v[44:47]
    ds_read_b128 v[164:167], v120 offset:50176
    v_mfma_f32_16x16x32_bf16 v[48:51], v[176:179], v[144:147], v[48:51]
    ds_read_b64_tr_b16 v[188:189], v129 offset:16384
    v_mfma_f32_16x16x32_bf16 v[52:55], v[176:179], v[148:151], v[52:55]
    ds_read_b64_tr_b16 v[190:191], v129 offset:20480
    v_mfma_f32_16x16x32_bf16 v[68:71], v[180:183], v[148:151], v[68:71]
    ds_read_b64_tr_b16 v[192:193], v131 offset:16384
    v_mfma_f32_16x16x32_bf16 v[64:67], v[180:183], v[144:147], v[64:67]
    ds_read_b64_tr_b16 v[194:195], v131 offset:20480
    v_mfma_f32_16x16x32_bf16 v[60:63], v[180:183], v[140:143], v[60:63]
    ds_read_b64_tr_b16 v[196:197], v133 offset:16384
    v_mfma_f32_16x16x32_bf16 v[56:59], v[180:183], v[136:139], v[56:59]
    ds_read_b64_tr_b16 v[198:199], v133 offset:20480
    s_waitcnt lgkmcnt(4)
    v_mfma_f32_16x16x32_bf16 v[8:11], v[184:187], v[152:155], v[8:11]
    ds_read_b128 v[136:139], v119 offset:57344
    v_mfma_f32_16x16x32_bf16 v[12:15], v[184:187], v[156:159], v[12:15]
    ds_read_b64_tr_b16 v[168:169], v127 offset:24576
    v_mfma_f32_16x16x32_bf16 v[16:19], v[184:187], v[160:163], v[16:19]
    ds_read_b64_tr_b16 v[170:171], v127 offset:28672
    v_mfma_f32_16x16x32_bf16 v[20:23], v[184:187], v[164:167], v[20:23]
    ds_read_b128 v[140:143], v119 offset:58368
    v_mfma_f32_16x16x32_bf16 v[36:39], v[188:191], v[164:167], v[36:39]
    ds_read_b128 v[144:147], v120 offset:57344
    v_mfma_f32_16x16x32_bf16 v[32:35], v[188:191], v[160:163], v[32:35]
    ds_read_b128 v[148:151], v120 offset:58368
    v_mfma_f32_16x16x32_bf16 v[28:31], v[188:191], v[156:159], v[28:31]
    ds_read_b64_tr_b16 v[172:173], v129 offset:24576
    v_mfma_f32_16x16x32_bf16 v[24:27], v[188:191], v[152:155], v[24:27]
    ds_read_b64_tr_b16 v[174:175], v129 offset:28672
    s_waitcnt lgkmcnt(8)
    v_mfma_f32_16x16x32_bf16 v[40:43], v[192:195], v[152:155], v[40:43]
    ds_read_b64_tr_b16 v[176:177], v131 offset:24576
    v_mfma_f32_16x16x32_bf16 v[44:47], v[192:195], v[156:159], v[44:47]
    ds_read_b64_tr_b16 v[178:179], v131 offset:28672
    v_mfma_f32_16x16x32_bf16 v[48:51], v[192:195], v[160:163], v[48:51]
    ds_read_b64_tr_b16 v[180:181], v133 offset:24576
    v_mfma_f32_16x16x32_bf16 v[52:55], v[192:195], v[164:167], v[52:55]
    ds_read_b64_tr_b16 v[182:183], v133 offset:28672
    v_mfma_f32_16x16x32_bf16 v[68:71], v[196:199], v[164:167], v[68:71]
    v_mfma_f32_16x16x32_bf16 v[64:67], v[196:199], v[160:163], v[64:67]
    v_mfma_f32_16x16x32_bf16 v[60:63], v[196:199], v[156:159], v[60:63]
    v_mfma_f32_16x16x32_bf16 v[56:59], v[196:199], v[152:155], v[56:59]
    s_waitcnt lgkmcnt(4)
    v_mfma_f32_16x16x32_bf16 v[8:11], v[168:171], v[136:139], v[8:11]
    v_mfma_f32_16x16x32_bf16 v[12:15], v[168:171], v[140:143], v[12:15]
    v_mfma_f32_16x16x32_bf16 v[16:19], v[168:171], v[144:147], v[16:19]
    v_mfma_f32_16x16x32_bf16 v[20:23], v[168:171], v[148:151], v[20:23]
    s_waitcnt lgkmcnt(0)
    s_barrier
    v_mfma_f32_16x16x32_bf16 v[36:39], v[172:175], v[148:151], v[36:39]
    ds_read_b128 v[152:155], v121 offset:0
    v_mfma_f32_16x16x32_bf16 v[32:35], v[172:175], v[144:147], v[32:35]
    ds_read_b64_tr_b16 v[184:185], v127 offset:32768
    v_mfma_f32_16x16x32_bf16 v[28:31], v[172:175], v[140:143], v[28:31]
    ds_read_b64_tr_b16 v[186:187], v127 offset:36864
    v_mfma_f32_16x16x32_bf16 v[24:27], v[172:175], v[136:139], v[24:27]
    ds_read_b128 v[156:159], v121 offset:1024
    v_mfma_f32_16x16x32_bf16 v[40:43], v[176:179], v[136:139], v[40:43]
    ds_read_b128 v[160:163], v122 offset:0
    v_mfma_f32_16x16x32_bf16 v[44:47], v[176:179], v[140:143], v[44:47]
    ds_read_b128 v[164:167], v122 offset:1024
    v_mfma_f32_16x16x32_bf16 v[48:51], v[176:179], v[144:147], v[48:51]
    ds_read_b64_tr_b16 v[188:189], v129 offset:32768
    v_mfma_f32_16x16x32_bf16 v[52:55], v[176:179], v[148:151], v[52:55]
    ds_read_b64_tr_b16 v[190:191], v129 offset:36864
    v_mfma_f32_16x16x32_bf16 v[68:71], v[180:183], v[148:151], v[68:71]
    ds_read_b64_tr_b16 v[192:193], v131 offset:32768
    v_mfma_f32_16x16x32_bf16 v[64:67], v[180:183], v[144:147], v[64:67]
    ds_read_b64_tr_b16 v[194:195], v131 offset:36864
    v_mfma_f32_16x16x32_bf16 v[60:63], v[180:183], v[140:143], v[60:63]
    ds_read_b64_tr_b16 v[196:197], v133 offset:32768
    v_mfma_f32_16x16x32_bf16 v[56:59], v[180:183], v[136:139], v[56:59]
    ds_read_b64_tr_b16 v[198:199], v133 offset:36864
    s_waitcnt lgkmcnt(4)
    v_mfma_f32_16x16x32_bf16 v[8:11], v[184:187], v[152:155], v[8:11]
    ds_read_b128 v[136:139], v121 offset:8192
    v_mfma_f32_16x16x32_bf16 v[12:15], v[184:187], v[156:159], v[12:15]
    ds_read_b64_tr_b16 v[168:169], v127 offset:40960
    v_mfma_f32_16x16x32_bf16 v[16:19], v[184:187], v[160:163], v[16:19]
    ds_read_b64_tr_b16 v[170:171], v127 offset:45056
    v_mfma_f32_16x16x32_bf16 v[20:23], v[184:187], v[164:167], v[20:23]
    ds_read_b128 v[140:143], v121 offset:9216
    v_mfma_f32_16x16x32_bf16 v[36:39], v[188:191], v[164:167], v[36:39]
    ds_read_b128 v[144:147], v122 offset:8192
    v_mfma_f32_16x16x32_bf16 v[32:35], v[188:191], v[160:163], v[32:35]
    ds_read_b128 v[148:151], v122 offset:9216
    v_mfma_f32_16x16x32_bf16 v[28:31], v[188:191], v[156:159], v[28:31]
    ds_read_b64_tr_b16 v[172:173], v129 offset:40960
    v_mfma_f32_16x16x32_bf16 v[24:27], v[188:191], v[152:155], v[24:27]
    ds_read_b64_tr_b16 v[174:175], v129 offset:45056
    s_waitcnt lgkmcnt(8)
    v_mfma_f32_16x16x32_bf16 v[40:43], v[192:195], v[152:155], v[40:43]
    ds_read_b64_tr_b16 v[176:177], v131 offset:40960
    v_mfma_f32_16x16x32_bf16 v[44:47], v[192:195], v[156:159], v[44:47]
    ds_read_b64_tr_b16 v[178:179], v131 offset:45056
    v_mfma_f32_16x16x32_bf16 v[48:51], v[192:195], v[160:163], v[48:51]
    ds_read_b64_tr_b16 v[180:181], v133 offset:40960
    v_mfma_f32_16x16x32_bf16 v[52:55], v[192:195], v[164:167], v[52:55]
    ds_read_b64_tr_b16 v[182:183], v133 offset:45056
    v_mfma_f32_16x16x32_bf16 v[68:71], v[196:199], v[164:167], v[68:71]
    v_mfma_f32_16x16x32_bf16 v[64:67], v[196:199], v[160:163], v[64:67]
    v_mfma_f32_16x16x32_bf16 v[60:63], v[196:199], v[156:159], v[60:63]
    v_mfma_f32_16x16x32_bf16 v[56:59], v[196:199], v[152:155], v[56:59]
    s_waitcnt lgkmcnt(4)
    v_mfma_f32_16x16x32_bf16 v[8:11], v[168:171], v[136:139], v[8:11]
    v_mfma_f32_16x16x32_bf16 v[12:15], v[168:171], v[140:143], v[12:15]
    v_mfma_f32_16x16x32_bf16 v[16:19], v[168:171], v[144:147], v[16:19]
    v_mfma_f32_16x16x32_bf16 v[20:23], v[168:171], v[148:151], v[20:23]
    s_waitcnt lgkmcnt(0)
    s_barrier
    v_mfma_f32_16x16x32_bf16 v[36:39], v[172:175], v[148:151], v[36:39]
    ds_read_b128 v[152:155], v119 offset:0
    v_mfma_f32_16x16x32_bf16 v[32:35], v[172:175], v[144:147], v[32:35]
    ds_read_b64_tr_b16 v[184:185], v127 offset:57344
    v_mfma_f32_16x16x32_bf16 v[28:31], v[172:175], v[140:143], v[28:31]
    ds_read_b64_tr_b16 v[186:187], v127 offset:61440
    v_mfma_f32_16x16x32_bf16 v[24:27], v[172:175], v[136:139], v[24:27]
    ds_read_b128 v[156:159], v119 offset:1024
    v_mfma_f32_16x16x32_bf16 v[40:43], v[176:179], v[136:139], v[40:43]
    ds_read_b128 v[160:163], v120 offset:0
    v_mfma_f32_16x16x32_bf16 v[44:47], v[176:179], v[140:143], v[44:47]
    ds_read_b128 v[164:167], v120 offset:1024
    v_mfma_f32_16x16x32_bf16 v[48:51], v[176:179], v[144:147], v[48:51]
    ds_read_b64_tr_b16 v[188:189], v129 offset:57344
    v_mfma_f32_16x16x32_bf16 v[52:55], v[176:179], v[148:151], v[52:55]
    ds_read_b64_tr_b16 v[190:191], v129 offset:61440
    v_mfma_f32_16x16x32_bf16 v[68:71], v[180:183], v[148:151], v[68:71]
    ds_read_b64_tr_b16 v[192:193], v131 offset:57344
    v_mfma_f32_16x16x32_bf16 v[64:67], v[180:183], v[144:147], v[64:67]
    ds_read_b64_tr_b16 v[194:195], v131 offset:61440
    v_mfma_f32_16x16x32_bf16 v[60:63], v[180:183], v[140:143], v[60:63]
    ds_read_b64_tr_b16 v[196:197], v133 offset:57344
    v_mfma_f32_16x16x32_bf16 v[56:59], v[180:183], v[136:139], v[56:59]
    ds_read_b64_tr_b16 v[198:199], v133 offset:61440
    s_waitcnt lgkmcnt(4)
    v_mfma_f32_16x16x32_bf16 v[8:11], v[184:187], v[152:155], v[8:11]
    ds_read_b128 v[136:139], v119 offset:8192
    v_mfma_f32_16x16x32_bf16 v[12:15], v[184:187], v[156:159], v[12:15]
    ds_read_b64_tr_b16 v[168:169], v128 offset:0
    v_mfma_f32_16x16x32_bf16 v[16:19], v[184:187], v[160:163], v[16:19]
    ds_read_b64_tr_b16 v[170:171], v128 offset:4096
    v_mfma_f32_16x16x32_bf16 v[20:23], v[184:187], v[164:167], v[20:23]
    ds_read_b128 v[140:143], v119 offset:9216
    v_mfma_f32_16x16x32_bf16 v[36:39], v[188:191], v[164:167], v[36:39]
    ds_read_b128 v[144:147], v120 offset:8192
    v_mfma_f32_16x16x32_bf16 v[32:35], v[188:191], v[160:163], v[32:35]
    ds_read_b128 v[148:151], v120 offset:9216
    v_mfma_f32_16x16x32_bf16 v[28:31], v[188:191], v[156:159], v[28:31]
    ds_read_b64_tr_b16 v[172:173], v130 offset:0
    v_mfma_f32_16x16x32_bf16 v[24:27], v[188:191], v[152:155], v[24:27]
    ds_read_b64_tr_b16 v[174:175], v130 offset:4096
    s_waitcnt lgkmcnt(8)
    v_mfma_f32_16x16x32_bf16 v[40:43], v[192:195], v[152:155], v[40:43]
    ds_read_b64_tr_b16 v[176:177], v132 offset:0
    v_mfma_f32_16x16x32_bf16 v[44:47], v[192:195], v[156:159], v[44:47]
    ds_read_b64_tr_b16 v[178:179], v132 offset:4096
    v_mfma_f32_16x16x32_bf16 v[48:51], v[192:195], v[160:163], v[48:51]
    ds_read_b64_tr_b16 v[180:181], v134 offset:0
    v_mfma_f32_16x16x32_bf16 v[52:55], v[192:195], v[164:167], v[52:55]
    ds_read_b64_tr_b16 v[182:183], v134 offset:4096
    v_mfma_f32_16x16x32_bf16 v[68:71], v[196:199], v[164:167], v[68:71]
    v_mfma_f32_16x16x32_bf16 v[64:67], v[196:199], v[160:163], v[64:67]
    v_mfma_f32_16x16x32_bf16 v[60:63], v[196:199], v[156:159], v[60:63]
    v_mfma_f32_16x16x32_bf16 v[56:59], v[196:199], v[152:155], v[56:59]
    s_waitcnt lgkmcnt(4)
    v_mfma_f32_16x16x32_bf16 v[8:11], v[168:171], v[136:139], v[8:11]
    v_mfma_f32_16x16x32_bf16 v[12:15], v[168:171], v[140:143], v[12:15]
    v_mfma_f32_16x16x32_bf16 v[16:19], v[168:171], v[144:147], v[16:19]
    v_mfma_f32_16x16x32_bf16 v[20:23], v[168:171], v[148:151], v[20:23]
    s_waitcnt lgkmcnt(0)
    s_barrier
    v_mfma_f32_16x16x32_bf16 v[36:39], v[172:175], v[148:151], v[36:39]
    ds_read_b128 v[152:155], v119 offset:16384
    v_mfma_f32_16x16x32_bf16 v[32:35], v[172:175], v[144:147], v[32:35]
    ds_read_b64_tr_b16 v[184:185], v128 offset:8192
    v_mfma_f32_16x16x32_bf16 v[28:31], v[172:175], v[140:143], v[28:31]
    ds_read_b64_tr_b16 v[186:187], v128 offset:12288
    v_mfma_f32_16x16x32_bf16 v[24:27], v[172:175], v[136:139], v[24:27]
    ds_read_b128 v[156:159], v119 offset:17408
    v_mfma_f32_16x16x32_bf16 v[40:43], v[176:179], v[136:139], v[40:43]
    ds_read_b64_tr_b16 v[188:189], v130 offset:8192
    v_mfma_f32_16x16x32_bf16 v[44:47], v[176:179], v[140:143], v[44:47]
    ds_read_b64_tr_b16 v[190:191], v130 offset:12288
    v_mfma_f32_16x16x32_bf16 v[48:51], v[176:179], v[144:147], v[48:51]
    ds_read_b64_tr_b16 v[192:193], v132 offset:8192
    v_mfma_f32_16x16x32_bf16 v[52:55], v[176:179], v[148:151], v[52:55]
    ds_read_b64_tr_b16 v[194:195], v132 offset:12288
    v_mfma_f32_16x16x32_bf16 v[68:71], v[180:183], v[148:151], v[68:71]
    ds_read_b64_tr_b16 v[196:197], v134 offset:8192
    v_mfma_f32_16x16x32_bf16 v[64:67], v[180:183], v[144:147], v[64:67]
    ds_read_b64_tr_b16 v[198:199], v134 offset:12288
    v_mfma_f32_16x16x32_bf16 v[60:63], v[180:183], v[140:143], v[60:63]
    v_mfma_f32_16x16x32_bf16 v[56:59], v[180:183], v[136:139], v[56:59]
    s_waitcnt lgkmcnt(4)
    v_mfma_f32_16x16x32_bf16 v[8:11], v[184:187], v[152:155], v[8:11]
    ds_read_b128 v[136:139], v119 offset:24576
    ds_read_b64_tr_b16 v[168:169], v128 offset:16384
    v_mfma_f32_16x16x32_bf16 v[12:15], v[184:187], v[156:159], v[12:15]
    ds_read_b64_tr_b16 v[170:171], v128 offset:20480
    ds_read_b128 v[140:143], v119 offset:25600
    v_mfma_f32_16x16x32_bf16 v[28:31], v[188:191], v[156:159], v[28:31]
    ds_read_b64_tr_b16 v[172:173], v130 offset:16384
    ds_read_b64_tr_b16 v[174:175], v130 offset:20480
    v_mfma_f32_16x16x32_bf16 v[24:27], v[188:191], v[152:155], v[24:27]
    ds_read_b64_tr_b16 v[176:177], v132 offset:16384
    ds_read_b64_tr_b16 v[178:179], v132 offset:20480
    s_waitcnt lgkmcnt(8)
    v_mfma_f32_16x16x32_bf16 v[40:43], v[192:195], v[152:155], v[40:43]
    ds_read_b64_tr_b16 v[180:181], v134 offset:16384
    ds_read_b64_tr_b16 v[182:183], v134 offset:20480
    v_mfma_f32_16x16x32_bf16 v[44:47], v[192:195], v[156:159], v[44:47]
    v_cvt_pk_bf16_f32 v96, v16, v17
    v_cvt_pk_bf16_f32 v97, v18, v19
    v_mfma_f32_16x16x32_bf16 v[60:63], v[196:199], v[156:159], v[60:63]
    v_cvt_pk_bf16_f32 v98, v32, v33
    v_cvt_pk_bf16_f32 v99, v34, v35
    v_mfma_f32_16x16x32_bf16 v[56:59], v[196:199], v[152:155], v[56:59]
    buffer_store_dwordx4 v[96:99], v2, s[24:27], s71 offen offset:0 sc1
    s_nop 0
    v_cvt_pk_bf16_f32 v100, v20, v21
    v_cvt_pk_bf16_f32 v101, v22, v23
    v_cvt_pk_bf16_f32 v102, v36, v37
    v_cvt_pk_bf16_f32 v103, v38, v39
    buffer_store_dwordx4 v[100:103], v2, s[24:27], s71 offen offset:1024 sc1
    s_waitcnt lgkmcnt(4)
    v_mfma_f32_16x16x32_bf16 v[8:11], v[168:171], v[136:139], v[8:11]
    v_mfma_f32_16x16x32_bf16 v[12:15], v[168:171], v[140:143], v[12:15]
    v_mfma_f32_16x16x32_bf16 v[28:31], v[172:175], v[140:143], v[28:31]
    v_mfma_f32_16x16x32_bf16 v[24:27], v[172:175], v[136:139], v[24:27]
    s_waitcnt lgkmcnt(0)
    s_barrier
    v_mfma_f32_16x16x32_bf16 v[40:43], v[176:179], v[136:139], v[40:43]
    ds_read_b128 v[152:155], v119 offset:32768
    ds_read_b64_tr_b16 v[184:185], v127 offset:16384
    ds_read_b64_tr_b16 v[186:187], v127 offset:20480
    v_mfma_f32_16x16x32_bf16 v[44:47], v[176:179], v[140:143], v[44:47]
    ds_read_b128 v[156:159], v119 offset:33792
    ds_read_b64_tr_b16 v[188:189], v129 offset:16384
    ds_read_b64_tr_b16 v[190:191], v129 offset:20480
    v_mfma_f32_16x16x32_bf16 v[60:63], v[180:183], v[140:143], v[60:63]
    ds_read_b64_tr_b16 v[192:193], v131 offset:16384
    ds_read_b64_tr_b16 v[194:195], v131 offset:20480
    ds_read_b64_tr_b16 v[196:197], v133 offset:16384
    v_mfma_f32_16x16x32_bf16 v[56:59], v[180:183], v[136:139], v[56:59]
    ds_read_b64_tr_b16 v[198:199], v133 offset:20480
    s_nop 0
    v_cvt_pk_bf16_f32 v104, v48, v49
    v_cvt_pk_bf16_f32 v105, v50, v51
    v_cvt_pk_bf16_f32 v106, v64, v65
    v_cvt_pk_bf16_f32 v107, v66, v67
    buffer_store_dwordx4 v[104:107], v2, s[24:27], s71 offen offset:2048 sc1
    v_cvt_pk_bf16_f32 v108, v52, v53
    v_cvt_pk_bf16_f32 v109, v54, v55
    v_cvt_pk_bf16_f32 v110, v68, v69
    v_cvt_pk_bf16_f32 v111, v70, v71
    buffer_store_dwordx4 v[108:111], v2, s[24:27], s71 offen offset:3072 sc1
    s_waitcnt lgkmcnt(4)
    v_mfma_f32_16x16x32_bf16 v[8:11], v[184:187], v[152:155], v[8:11]
    ds_read_b128 v[136:139], v119 offset:40960
    ds_read_b64_tr_b16 v[168:169], v127 offset:24576
    v_mfma_f32_16x16x32_bf16 v[12:15], v[184:187], v[156:159], v[12:15]
    ds_read_b64_tr_b16 v[170:171], v127 offset:28672
    ds_read_b128 v[140:143], v119 offset:41984
    v_mfma_f32_16x16x32_bf16 v[28:31], v[188:191], v[156:159], v[28:31]
    ds_read_b64_tr_b16 v[172:173], v129 offset:24576
    ds_read_b64_tr_b16 v[174:175], v129 offset:28672
    v_mfma_f32_16x16x32_bf16 v[24:27], v[188:191], v[152:155], v[24:27]
    ds_read_b64_tr_b16 v[176:177], v131 offset:24576
    ds_read_b64_tr_b16 v[178:179], v131 offset:28672
    s_waitcnt lgkmcnt(8)
    v_mfma_f32_16x16x32_bf16 v[40:43], v[192:195], v[152:155], v[40:43]
    ds_read_b64_tr_b16 v[180:181], v133 offset:24576
    ds_read_b64_tr_b16 v[182:183], v133 offset:28672
    v_mfma_f32_16x16x32_bf16 v[44:47], v[192:195], v[156:159], v[44:47]
    v_mfma_f32_16x16x32_bf16 v[60:63], v[196:199], v[156:159], v[60:63]
    v_mfma_f32_16x16x32_bf16 v[56:59], v[196:199], v[152:155], v[56:59]
    s_waitcnt lgkmcnt(4)
    v_mfma_f32_16x16x32_bf16 v[8:11], v[168:171], v[136:139], v[8:11]
    v_mfma_f32_16x16x32_bf16 v[12:15], v[168:171], v[140:143], v[12:15]
    v_mfma_f32_16x16x32_bf16 v[28:31], v[172:175], v[140:143], v[28:31]
    v_mfma_f32_16x16x32_bf16 v[24:27], v[172:175], v[136:139], v[24:27]
    s_waitcnt lgkmcnt(0)
    s_barrier
    v_mfma_f32_16x16x32_bf16 v[40:43], v[176:179], v[136:139], v[40:43]
    ds_read_b128 v[152:155], v119 offset:49152
    ds_read_b64_tr_b16 v[184:185], v127 offset:32768
    ds_read_b64_tr_b16 v[186:187], v127 offset:36864
    v_mfma_f32_16x16x32_bf16 v[44:47], v[176:179], v[140:143], v[44:47]
    ds_read_b128 v[156:159], v119 offset:50176
    ds_read_b64_tr_b16 v[188:189], v129 offset:32768
    ds_read_b64_tr_b16 v[190:191], v129 offset:36864
    v_mfma_f32_16x16x32_bf16 v[60:63], v[180:183], v[140:143], v[60:63]
    ds_read_b64_tr_b16 v[192:193], v131 offset:32768
    ds_read_b64_tr_b16 v[194:195], v131 offset:36864
    ds_read_b64_tr_b16 v[196:197], v133 offset:32768
    v_mfma_f32_16x16x32_bf16 v[56:59], v[180:183], v[136:139], v[56:59]
    ds_read_b64_tr_b16 v[198:199], v133 offset:36864
    s_waitcnt lgkmcnt(4)
    v_mfma_f32_16x16x32_bf16 v[8:11], v[184:187], v[152:155], v[8:11]
    ds_read_b128 v[136:139], v119 offset:57344
    ds_read_b64_tr_b16 v[168:169], v127 offset:40960
    v_mfma_f32_16x16x32_bf16 v[12:15], v[184:187], v[156:159], v[12:15]
    ds_read_b64_tr_b16 v[170:171], v127 offset:45056
    ds_read_b128 v[140:143], v119 offset:58368
    v_mfma_f32_16x16x32_bf16 v[28:31], v[188:191], v[156:159], v[28:31]
    ds_read_b64_tr_b16 v[172:173], v129 offset:40960
    ds_read_b64_tr_b16 v[174:175], v129 offset:45056
    v_mfma_f32_16x16x32_bf16 v[24:27], v[188:191], v[152:155], v[24:27]
    ds_read_b64_tr_b16 v[176:177], v131 offset:40960
    ds_read_b64_tr_b16 v[178:179], v131 offset:45056
    s_waitcnt lgkmcnt(8)
    v_mfma_f32_16x16x32_bf16 v[40:43], v[192:195], v[152:155], v[40:43]
    ds_read_b64_tr_b16 v[180:181], v133 offset:40960
    ds_read_b64_tr_b16 v[182:183], v133 offset:45056
    v_mfma_f32_16x16x32_bf16 v[44:47], v[192:195], v[156:159], v[44:47]
    v_mfma_f32_16x16x32_bf16 v[60:63], v[196:199], v[156:159], v[60:63]
    v_mfma_f32_16x16x32_bf16 v[56:59], v[196:199], v[152:155], v[56:59]
    s_waitcnt vmcnt(0)
    s_lshl_b32 s53, s49, 2
    s_add_u32 s53, s53, s47
    s_lshl_b32 s53, s53, 7
    s_add_u32 s53, s53, 0x29a0000
    v_mov_b32 v3, 0
    v_mov_b32 v4, s50
    s_mov_b64 exec, 1
    buffer_store_dword v4, v3, s[24:27], s53 offen sc1
    s_mov_b64 exec, -1
    s_waitcnt lgkmcnt(4)
    v_mfma_f32_16x16x32_bf16 v[8:11], v[168:171], v[136:139], v[8:11]
    v_mfma_f32_16x16x32_bf16 v[12:15], v[168:171], v[140:143], v[12:15]
    v_mfma_f32_16x16x32_bf16 v[28:31], v[172:175], v[140:143], v[28:31]
    v_mfma_f32_16x16x32_bf16 v[24:27], v[172:175], v[136:139], v[24:27]
    s_waitcnt lgkmcnt(0)
    s_barrier
    v_mfma_f32_16x16x32_bf16 v[40:43], v[176:179], v[136:139], v[40:43]
    ds_read_b128 v[152:155], v121 offset:0
    ds_read_b64_tr_b16 v[184:185], v127 offset:57344
    ds_read_b64_tr_b16 v[186:187], v127 offset:61440
    v_mfma_f32_16x16x32_bf16 v[44:47], v[176:179], v[140:143], v[44:47]
    ds_read_b128 v[156:159], v121 offset:1024
    ds_read_b64_tr_b16 v[188:189], v129 offset:57344
    ds_read_b64_tr_b16 v[190:191], v129 offset:61440
    v_mfma_f32_16x16x32_bf16 v[60:63], v[180:183], v[140:143], v[60:63]
    ds_read_b64_tr_b16 v[192:193], v131 offset:57344
    ds_read_b64_tr_b16 v[194:195], v131 offset:61440
    ds_read_b64_tr_b16 v[196:197], v133 offset:57344
    v_mfma_f32_16x16x32_bf16 v[56:59], v[180:183], v[136:139], v[56:59]
    ds_read_b64_tr_b16 v[198:199], v133 offset:61440
    s_waitcnt lgkmcnt(4)
    v_mfma_f32_16x16x32_bf16 v[8:11], v[184:187], v[152:155], v[8:11]
    ds_read_b128 v[136:139], v121 offset:8192
    ds_read_b64_tr_b16 v[168:169], v128 offset:0
    v_mfma_f32_16x16x32_bf16 v[12:15], v[184:187], v[156:159], v[12:15]
    ds_read_b64_tr_b16 v[170:171], v128 offset:4096
    ds_read_b128 v[140:143], v121 offset:9216
    v_mfma_f32_16x16x32_bf16 v[28:31], v[188:191], v[156:159], v[28:31]
    ds_read_b64_tr_b16 v[172:173], v130 offset:0
    ds_read_b64_tr_b16 v[174:175], v130 offset:4096
    v_mfma_f32_16x16x32_bf16 v[24:27], v[188:191], v[152:155], v[24:27]
    ds_read_b64_tr_b16 v[176:177], v132 offset:0
    ds_read_b64_tr_b16 v[178:179], v132 offset:4096
    s_waitcnt lgkmcnt(8)
    v_mfma_f32_16x16x32_bf16 v[40:43], v[192:195], v[152:155], v[40:43]
    ds_read_b64_tr_b16 v[180:181], v134 offset:0
    ds_read_b64_tr_b16 v[182:183], v134 offset:4096
    v_mfma_f32_16x16x32_bf16 v[44:47], v[192:195], v[156:159], v[44:47]
    v_mfma_f32_16x16x32_bf16 v[60:63], v[196:199], v[156:159], v[60:63]
    v_mfma_f32_16x16x32_bf16 v[56:59], v[196:199], v[152:155], v[56:59]
    s_waitcnt lgkmcnt(4)
    v_mfma_f32_16x16x32_bf16 v[8:11], v[168:171], v[136:139], v[8:11]
    v_mfma_f32_16x16x32_bf16 v[12:15], v[168:171], v[140:143], v[12:15]
    v_mfma_f32_16x16x32_bf16 v[28:31], v[172:175], v[140:143], v[28:31]
    v_mfma_f32_16x16x32_bf16 v[24:27], v[172:175], v[136:139], v[24:27]
    s_waitcnt lgkmcnt(0)
    s_barrier
    v_mfma_f32_16x16x32_bf16 v[40:43], v[176:179], v[136:139], v[40:43]
    ds_read_b128 v[152:155], v119 offset:0
    ds_read_b64_tr_b16 v[184:185], v128 offset:8192
    ds_read_b64_tr_b16 v[186:187], v128 offset:12288
    v_mfma_f32_16x16x32_bf16 v[44:47], v[176:179], v[140:143], v[44:47]
    ds_read_b128 v[156:159], v119 offset:1024
    ds_read_b64_tr_b16 v[188:189], v130 offset:8192
    ds_read_b64_tr_b16 v[190:191], v130 offset:12288
    v_mfma_f32_16x16x32_bf16 v[60:63], v[180:183], v[140:143], v[60:63]
    ds_read_b64_tr_b16 v[192:193], v132 offset:8192
    ds_read_b64_tr_b16 v[194:195], v132 offset:12288
    ds_read_b64_tr_b16 v[196:197], v134 offset:8192
    v_mfma_f32_16x16x32_bf16 v[56:59], v[180:183], v[136:139], v[56:59]
    ds_read_b64_tr_b16 v[198:199], v134 offset:12288
    s_waitcnt lgkmcnt(4)
    v_mfma_f32_16x16x32_bf16 v[8:11], v[184:187], v[152:155], v[8:11]
    ds_read_b128 v[136:139], v119 offset:8192
    ds_read_b64_tr_b16 v[168:169], v128 offset:16384
    v_mfma_f32_16x16x32_bf16 v[12:15], v[184:187], v[156:159], v[12:15]
    ds_read_b64_tr_b16 v[170:171], v128 offset:20480
    ds_read_b128 v[140:143], v119 offset:9216
    v_mfma_f32_16x16x32_bf16 v[28:31], v[188:191], v[156:159], v[28:31]
    ds_read_b64_tr_b16 v[172:173], v130 offset:16384
    ds_read_b64_tr_b16 v[174:175], v130 offset:20480
    v_mfma_f32_16x16x32_bf16 v[24:27], v[188:191], v[152:155], v[24:27]
    ds_read_b64_tr_b16 v[176:177], v132 offset:16384
    ds_read_b64_tr_b16 v[178:179], v132 offset:20480
    s_waitcnt lgkmcnt(8)
    v_mfma_f32_16x16x32_bf16 v[40:43], v[192:195], v[152:155], v[40:43]
    ds_read_b64_tr_b16 v[180:181], v134 offset:16384
    ds_read_b64_tr_b16 v[182:183], v134 offset:20480
    v_mfma_f32_16x16x32_bf16 v[44:47], v[192:195], v[156:159], v[44:47]
    v_mfma_f32_16x16x32_bf16 v[60:63], v[196:199], v[156:159], v[60:63]
    v_mfma_f32_16x16x32_bf16 v[56:59], v[196:199], v[152:155], v[56:59]
    s_waitcnt lgkmcnt(4)
    v_mfma_f32_16x16x32_bf16 v[8:11], v[168:171], v[136:139], v[8:11]
    v_mfma_f32_16x16x32_bf16 v[12:15], v[168:171], v[140:143], v[12:15]
    v_mfma_f32_16x16x32_bf16 v[28:31], v[172:175], v[140:143], v[28:31]
    v_mfma_f32_16x16x32_bf16 v[24:27], v[172:175], v[136:139], v[24:27]
    s_waitcnt lgkmcnt(0)
    s_barrier
    v_mfma_f32_16x16x32_bf16 v[40:43], v[176:179], v[136:139], v[40:43]
    ds_read_b128 v[152:155], v119 offset:16384
    ds_read_b64_tr_b16 v[184:185], v127 offset:16384
    ds_read_b64_tr_b16 v[186:187], v127 offset:20480
    v_mfma_f32_16x16x32_bf16 v[44:47], v[176:179], v[140:143], v[44:47]
    ds_read_b128 v[156:159], v119 offset:17408
    ds_read_b64_tr_b16 v[188:189], v129 offset:16384
    ds_read_b64_tr_b16 v[190:191], v129 offset:20480
    v_mfma_f32_16x16x32_bf16 v[60:63], v[180:183], v[140:143], v[60:63]
    ds_read_b64_tr_b16 v[192:193], v131 offset:16384
    ds_read_b64_tr_b16 v[194:195], v131 offset:20480
    ds_read_b64_tr_b16 v[196:197], v133 offset:16384
    v_mfma_f32_16x16x32_bf16 v[56:59], v[180:183], v[136:139], v[56:59]
    ds_read_b64_tr_b16 v[198:199], v133 offset:20480
    s_waitcnt lgkmcnt(4)
    v_mfma_f32_16x16x32_bf16 v[8:11], v[184:187], v[152:155], v[8:11]
    ds_read_b128 v[136:139], v119 offset:24576
    ds_read_b64_tr_b16 v[168:169], v127 offset:24576
    v_mfma_f32_16x16x32_bf16 v[12:15], v[184:187], v[156:159], v[12:15]
    ds_read_b64_tr_b16 v[170:171], v127 offset:28672
    ds_read_b128 v[140:143], v119 offset:25600
    v_mfma_f32_16x16x32_bf16 v[28:31], v[188:191], v[156:159], v[28:31]
    ds_read_b64_tr_b16 v[172:173], v129 offset:24576
    ds_read_b64_tr_b16 v[174:175], v129 offset:28672
    v_mfma_f32_16x16x32_bf16 v[24:27], v[188:191], v[152:155], v[24:27]
    ds_read_b64_tr_b16 v[176:177], v131 offset:24576
    ds_read_b64_tr_b16 v[178:179], v131 offset:28672
    s_waitcnt lgkmcnt(8)
    v_mfma_f32_16x16x32_bf16 v[40:43], v[192:195], v[152:155], v[40:43]
    ds_read_b64_tr_b16 v[180:181], v133 offset:24576
    ds_read_b64_tr_b16 v[182:183], v133 offset:28672
    v_mfma_f32_16x16x32_bf16 v[44:47], v[192:195], v[156:159], v[44:47]
    buffer_load_dword v116, v3, s[24:27], s73 offen sc1
    v_mfma_f32_16x16x32_bf16 v[60:63], v[196:199], v[156:159], v[60:63]
    v_mfma_f32_16x16x32_bf16 v[56:59], v[196:199], v[152:155], v[56:59]
    s_waitcnt lgkmcnt(4)
    v_mfma_f32_16x16x32_bf16 v[8:11], v[168:171], v[136:139], v[8:11]
    v_mfma_f32_16x16x32_bf16 v[12:15], v[168:171], v[140:143], v[12:15]
    v_mfma_f32_16x16x32_bf16 v[28:31], v[172:175], v[140:143], v[28:31]
    v_mfma_f32_16x16x32_bf16 v[24:27], v[172:175], v[136:139], v[24:27]
    s_waitcnt lgkmcnt(0)
    s_barrier
    v_mfma_f32_16x16x32_bf16 v[40:43], v[176:179], v[136:139], v[40:43]
    ds_read_b128 v[152:155], v119 offset:32768
    ds_read_b64_tr_b16 v[184:185], v127 offset:32768
    ds_read_b64_tr_b16 v[186:187], v127 offset:36864
    v_mfma_f32_16x16x32_bf16 v[44:47], v[176:179], v[140:143], v[44:47]
    ds_read_b128 v[156:159], v119 offset:33792
    ds_read_b64_tr_b16 v[188:189], v129 offset:32768
    ds_read_b64_tr_b16 v[190:191], v129 offset:36864
    v_mfma_f32_16x16x32_bf16 v[60:63], v[180:183], v[140:143], v[60:63]
    ds_read_b64_tr_b16 v[192:193], v131 offset:32768
    ds_read_b64_tr_b16 v[194:195], v131 offset:36864
    ds_read_b64_tr_b16 v[196:197], v133 offset:32768
    v_mfma_f32_16x16x32_bf16 v[56:59], v[180:183], v[136:139], v[56:59]
    ds_read_b64_tr_b16 v[198:199], v133 offset:36864
    s_waitcnt vmcnt(0)
    v_cmp_ne_u32 vcc, s50, v116
    s_cmp_eq_u64 vcc, 0
    s_cbranch_scc1 sequential_preLN__sliding_block__dense_activation_gelu__prompt_kernel_xok83
    s_mov_b32 s61, 0
sequential_preLN__sliding_block__dense_activation_gelu__prompt_kernel_poll84:
    buffer_load_dword v116, v3, s[24:27], s73 offen sc1
    s_waitcnt vmcnt(0)
    v_cmp_ne_u32 vcc, s50, v116
    s_cmp_eq_u64 vcc, 0
    s_cbranch_scc1 sequential_preLN__sliding_block__dense_activation_gelu__prompt_kernel_pdone85
    s_add_u32 s61, s61, 1
    s_cmp_lt_u32 s61, 32768
    s_cbranch_scc1 sequential_preLN__sliding_block__dense_activation_gelu__prompt_kernel_poll84
sequential_preLN__sliding_block__dense_activation_gelu__prompt_kernel_pdone85:
sequential_preLN__sliding_block__dense_activation_gelu__prompt_kernel_xok83:
    buffer_load_dwordx4 v[72:75], v2, s[24:27], s72 offen offset:0 sc1
    buffer_load_dwordx4 v[76:79], v2, s[24:27], s72 offen offset:1024 sc1
    buffer_load_dwordx4 v[80:83], v2, s[24:27], s72 offen offset:2048 sc1
    buffer_load_dwordx4 v[84:87], v2, s[24:27], s72 offen offset:3072 sc1
    s_waitcnt lgkmcnt(4)
    v_mfma_f32_16x16x32_bf16 v[8:11], v[184:187], v[152:155], v[8:11]
    ds_read_b128 v[136:139], v119 offset:40960
    ds_read_b64_tr_b16 v[168:169], v127 offset:40960
    v_mfma_f32_16x16x32_bf16 v[12:15], v[184:187], v[156:159], v[12:15]
    ds_read_b64_tr_b16 v[170:171], v127 offset:45056
    ds_read_b128 v[140:143], v119 offset:41984
    v_mfma_f32_16x16x32_bf16 v[28:31], v[188:191], v[156:159], v[28:31]
    ds_read_b64_tr_b16 v[172:173], v129 offset:40960
    ds_read_b64_tr_b16 v[174:175], v129 offset:45056
    v_mfma_f32_16x16x32_bf16 v[24:27], v[188:191], v[152:155], v[24:27]
    ds_read_b64_tr_b16 v[176:177], v131 offset:40960
    ds_read_b64_tr_b16 v[178:179], v131 offset:45056
    s_waitcnt lgkmcnt(8)
    v_mfma_f32_16x16x32_bf16 v[40:43], v[192:195], v[152:155], v[40:43]
    ds_read_b64_tr_b16 v[180:181], v133 offset:40960
    ds_read_b64_tr_b16 v[182:183], v133 offset:45056
    v_mfma_f32_16x16x32_bf16 v[44:47], v[192:195], v[156:159], v[44:47]
    v_mfma_f32_16x16x32_bf16 v[60:63], v[196:199], v[156:159], v[60:63]
    v_mfma_f32_16x16x32_bf16 v[56:59], v[196:199], v[152:155], v[56:59]
    s_waitcnt lgkmcnt(4)
    v_mfma_f32_16x16x32_bf16 v[8:11], v[168:171], v[136:139], v[8:11]
    v_mfma_f32_16x16x32_bf16 v[12:15], v[168:171], v[140:143], v[12:15]
    v_mfma_f32_16x16x32_bf16 v[28:31], v[172:175], v[140:143], v[28:31]
    v_mfma_f32_16x16x32_bf16 v[24:27], v[172:175], v[136:139], v[24:27]
    s_waitcnt lgkmcnt(0)
    s_barrier
    v_mfma_f32_16x16x32_bf16 v[40:43], v[176:179], v[136:139], v[40:43]
    v_mfma_f32_16x16x32_bf16 v[44:47], v[176:179], v[140:143], v[44:47]
    v_mfma_f32_16x16x32_bf16 v[60:63], v[180:183], v[140:143], v[60:63]
    v_mfma_f32_16x16x32_bf16 v[56:59], v[180:183], v[136:139], v[56:59]
    s_add_u32 s53, s70, 0x8000
    s_nop 3
    s_waitcnt vmcnt(3)
    v_lshlrev_b32 v112, 16, v72
    v_and_b32 v113, 0xffff0000, v72
    v_lshlrev_b32 v114, 16, v73
    v_and_b32 v115, 0xffff0000, v73
    s_nop 0
    v_pk_add_f32 v[8:9], v[8:9], v[112:113]
    v_pk_add_f32 v[10:11], v[10:11], v[114:115]
    v_cvt_pk_bf16_f32 v96, v8, v9
    v_cvt_pk_bf16_f32 v97, v10, v11
    v_lshlrev_b32 v112, 16, v74
    v_and_b32 v113, 0xffff0000, v74
    v_lshlrev_b32 v114, 16, v75
    v_and_b32 v115, 0xffff0000, v75
    v_pk_add_f32 v[24:25], v[24:25], v[112:113]
    v_pk_add_f32 v[26:27], v[26:27], v[114:115]
    v_cvt_pk_bf16_f32 v98, v24, v25
    v_cvt_pk_bf16_f32 v99, v26, v27
    s_nop 1
    v_permlane16_swap_b32 v96, v98
    v_permlane16_swap_b32 v97, v99
    buffer_store_dwordx4 v[96:99], v118, s[28:31], s70 offen offset:0
    s_waitcnt vmcnt(3)
    v_lshlrev_b32 v112, 16, v76
    v_and_b32 v113, 0xffff0000, v76
    v_lshlrev_b32 v114, 16, v77
    v_and_b32 v115, 0xffff0000, v77
    v_pk_add_f32 v[12:13], v[12:13], v[112:113]
    v_pk_add_f32 v[14:15], v[14:15], v[114:115]
    v_cvt_pk_bf16_f32 v100, v12, v13
    v_cvt_pk_bf16_f32 v101, v14, v15
    v_lshlrev_b32 v112, 16, v78
    v_and_b32 v113, 0xffff0000, v78
    v_lshlrev_b32 v114, 16, v79
    v_and_b32 v115, 0xffff0000, v79
    v_pk_add_f32 v[28:29], v[28:29], v[112:113]
    v_pk_add_f32 v[30:31], v[30:31], v[114:115]
    v_cvt_pk_bf16_f32 v102, v28, v29
    v_cvt_pk_bf16_f32 v103, v30, v31
    s_nop 1
    v_permlane16_swap_b32 v100, v102
    v_permlane16_swap_b32 v101, v103
    buffer_store_dwordx4 v[100:103], v118, s[28:31], s53 offen offset:0
    s_waitcnt vmcnt(3)
    v_lshlrev_b32 v112, 16, v80
    v_and_b32 v113, 0xffff0000, v80
    v_lshlrev_b32 v114, 16, v81
    v_and_b32 v115, 0xffff0000, v81
    v_pk_add_f32 v[40:41], v[40:41], v[112:113]
    v_pk_add_f32 v[42:43], v[42:43], v[114:115]
    v_cvt_pk_bf16_f32 v104, v40, v41
    v_cvt_pk_bf16_f32 v105, v42, v43
    v_lshlrev_b32 v112, 16, v82
    v_and_b32 v113, 0xffff0000, v82
    v_lshlrev_b32 v114, 16, v83
    v_and_b32 v115, 0xffff0000, v83
    v_pk_add_f32 v[56:57], v[56:57], v[112:113]
    v_pk_add_f32 v[58:59], v[58:59], v[114:115]
    v_cvt_pk_bf16_f32 v106, v56, v57
    v_cvt_pk_bf16_f32 v107, v58, v59
    s_nop 1
    v_permlane16_swap_b32 v104, v106
    v_permlane16_swap_b32 v105, v107
    buffer_store_dwordx4 v[104:107], v118, s[28:31], s70 offen offset:64
    s_waitcnt vmcnt(3)
    v_lshlrev_b32 v112, 16, v84
    v_and_b32 v113, 0xffff0000, v84
    v_lshlrev_b32 v114, 16, v85
    v_and_b32 v115, 0xffff0000, v85
    v_pk_add_f32 v[44:45], v[44:45], v[112:113]
    v_pk_add_f32 v[46:47], v[46:47], v[114:115]
    v_cvt_pk_bf16_f32 v108, v44, v45
    v_cvt_pk_bf16_f32 v109, v46, v47
    v_lshlrev_b32 v112, 16, v86
    v_and_b32 v113, 0xffff0000, v86
    v_lshlrev_b32 v114, 16, v87
    v_and_b32 v115, 0xffff0000, v87
    v_pk_add_f32 v[60:61], v[60:61], v[112:113]
    v_pk_add_f32 v[62:63], v[62:63], v[114:115]
    v_cvt_pk_bf16_f32 v110, v60, v61
    v_cvt_pk_bf16_f32 v111, v62, v63
    s_nop 1
    v_permlane16_swap_b32 v108, v110
    v_permlane16_swap_b32 v109, v111
    buffer_store_dwordx4 v[108:111], v118, s[28:31], s53 offen offset:64
    s_endpgm
sequential_preLN__sliding_block__dense_activation_gelu__prompt_kernel_exit1:
    s_endpgm
sequential_preLN__sliding_block__dense_activation_gelu__prompt_kernel_end:
.section .rodata,"a"
.p2align 6
.amdhsa_kernel sequential_preLN__sliding_block__dense_activation_gelu__prompt_kernel
  .amdhsa_next_free_vgpr 256
  .amdhsa_next_free_sgpr 95
  .amdhsa_accum_offset 252
  .amdhsa_group_segment_fixed_size 0
  .amdhsa_kernarg_size 88
  .amdhsa_user_sgpr_count 2
  .amdhsa_user_sgpr_kernarg_segment_ptr 1
  .amdhsa_system_sgpr_workgroup_id_x 1
  .amdhsa_float_denorm_mode_32 3
.end_amdhsa_kernel
```
